```python
import torch

def _softmax(x, axis=-1):
    return torch.softmax(x, dim=axis)
def _gelu(x):
    return torch.nn.functional.gelu(x, approximate="tanh")
def _silu(x):
    return torch.nn.functional.silu(x)
def _sigmoid(x):
    return torch.sigmoid(x)
def _layernorm(x, axis=-1, eps=1e-5):
    m = x.mean(dim=axis, keepdim=True)
    v = x.var(dim=axis, keepdim=True, unbiased=False)
    return (x - m) / torch.sqrt(v + eps)
def _scatter_add(tgt, idx, src, axis=0):
    return tgt.clone().index_add_(axis, idx, src)
def _segment_sum(src, seg, n):
    out = torch.zeros((n,) + src.shape[1:], dtype=src.dtype)
    return out.index_add_(0, seg, src)
def _pad(x, pw):
    flat = tuple(v for pair in reversed(pw) for v in pair)
    return torch.nn.functional.pad(x, flat)

kernel_name = 'recurrent_scan__linear_kernel_hedgehog__dense_activation_squared_relu__prompt'

def setup_inputs():

    _w = (lambda a: (lambda t: t.to(torch.bfloat16) if t.is_floating_point() else t)(torch.as_tensor(a)))
    def _A_setup():
        B, S, D, H = 1, 2048, 1024, 32
        Dh = D // H
        return {
            "x": _w((lambda *s: torch.randn(*s, dtype=torch.bfloat16) * 0.05)(B, S, D)),
            "wqkv": _w((lambda *s: torch.randn(*s, dtype=torch.bfloat16) * 0.2)(D, 3 * D)),
            "w_phi": _w((lambda *s: torch.randn(*s, dtype=torch.bfloat16) * 0.2)(H, Dh, Dh) * (Dh ** -0.5)),
            "wo": _w((lambda *s: torch.randn(*s, dtype=torch.bfloat16) * 0.05)(D, D)),
        }
    _A_in = _A_setup()

    def _B_setup():
        B, S, D, F = 1, 2048, 1024, 3584
        return {
            "x": _w((lambda *s: torch.randn(*s, dtype=torch.bfloat16) * 0.05)(B, S, D)),
            "w1": _w((lambda *s: torch.randn(*s, dtype=torch.bfloat16) * 0.05)(D, F)),
            "b1": _w((lambda *s: torch.randn(*s, dtype=torch.bfloat16) * 0.4)(F)),
            "w2": _w((lambda *s: torch.randn(*s, dtype=torch.bfloat16) * 0.05)(F, D)),
            "b2": _w((lambda *s: torch.randn(*s, dtype=torch.bfloat16) * 3.2)(D)),
        }
    _B_in = _B_setup()

    return {
        "A_x": _A_in["x"],
        "A_wqkv": _A_in["wqkv"],
        "A_w_phi": _A_in["w_phi"],
        "A_wo": _A_in["wo"],
        "B_x": _B_in["x"],
        "B_w1": _B_in["w1"],
        "B_b1": _B_in["b1"],
        "B_w2": _B_in["w2"],
        "B_b2": _B_in["b2"],
    }

def reference(A_x, A_wqkv, A_w_phi, A_wo, B_x, B_w1, B_b1, B_w2, B_b2):
    def _A_ref(x, wqkv, w_phi, wo):
        B, S, D = x.shape
        H = 32; Dh = D // H
        qkv = (lambda x, *d: x.permute(*d))((x @ wqkv).reshape(B, S, 3, H, Dh), 2, 0, 3, 1, 4)
        q, k, v = qkv[0], qkv[1], qkv[2]
        pq = torch.einsum("bhsd,hdf->bhsf", q, w_phi)
        pk = torch.einsum("bhsd,hdf->bhsf", k, w_phi)
        phi_q = torch.concatenate([_softmax(pq, axis=-1), _softmax(-pq, axis=-1)], axis=-1)
        phi_k = torch.concatenate([_softmax(pk, axis=-1), _softmax(-pk, axis=-1)], axis=-1)
        kv = torch.einsum("bhsf,bhsd->bhfd", phi_k, v)
        z  = torch.einsum("bhsf->bhf", phi_k)
        num = torch.einsum("bhqf,bhfd->bhqd", phi_q, kv)
        den = torch.einsum("bhqf,bhf->bhq", phi_q, z)[..., None] + 1e-6
        o = num / den
        return (lambda x, *d: x.permute(*d))(o, 0, 2, 1, 3).reshape(B, S, D) @ wo

    def _B_ref(x, w1, b1, w2, b2):
        h = torch.einsum("bsd,df->bsf", x, w1) + b1
        zero = torch.zeros_like(h)
        r = torch.where(h > zero, h, zero)
        h = r * r
        out = torch.einsum("bsf,fd->bsd", h, w2) + b2
        return out

    x = A_x
    xn = _layernorm(x, axis=-1)
    s = _A_ref(xn, A_wqkv, A_w_phi, A_wo)
    g = _silu(_B_ref(xn, B_w1, B_b1, B_w2, B_b2))
    return x + s * g
```

```asm
; @launch grid=(256,1,1) block=(256,1,1) lds=163840
.amdgcn_target "amdgcn-amd-amdhsa--gfx950"
.text
.globl recurrent_scan__linear_kernel_hedgehog__dense_activation_squared_relu__prompt_kernel
.p2align 8
.type recurrent_scan__linear_kernel_hedgehog__dense_activation_squared_relu__prompt_kernel,@function
recurrent_scan__linear_kernel_hedgehog__dense_activation_squared_relu__prompt_kernel:
s_cmp_ge_u32 s2, 256
s_cbranch_scc1 L_end
s_load_dwordx16 s[64:79], s[0:1], 0
s_load_dwordx8 s[80:87], s[0:1], 64
s_getpc_b64 s[62:63]
v_lshlrev_b32 v2, 7, v0
global_load_dword v39, v2, s[62:63]
v_and_b32 v1, 63, v0
v_lshrrev_b32 v2, 6, v0
s_nop 0
v_readfirstlane_b32 s28, v2
s_and_b32 s38, s2, 7
s_lshr_b32 s39, s2, 3
s_and_b32 s54, s38, 1
s_lshr_b32 s50, s38, 1
s_and_b32 s51, s39, 3
s_lshr_b32 s7, s39, 2
s_lshl_b32 s4, s54, 2
s_add_u32 s4, s4, s51
s_lshl_b32 s5, s50, 3
s_add_u32 s5, s5, s7
s_lshl_b32 s6, s50, 2
s_add_u32 s6, s6, s51
s_and_b32 s48, s5, 1
s_mov_b32 s100, s54
s_lshr_b32 s38, s2, 3
s_lshl_b32 s38, s38, 1
s_lshr_b32 s39, s28, 1
s_add_u32 s38, s38, s39
s_lshl_b32 s59, s100, 9
s_add_u32 s38, s38, s59
s_and_b32 s39, s28, 1
s_lshr_b32 s51, s5, 3
v_min_u32 v2, 11, v1
v_mul_u32_u24 v3, 43, v2
v_lshrrev_b32 v3, 8, v3
v_mul_u32_u24 v4, 6, v3
v_sub_u32 v2, v2, v4
s_mul_i32 s49, s39, 6
v_add_u32 v2, s49, v2
v_lshrrev_b32 v4, 2, v2
v_and_b32 v2, 3, v2
v_lshlrev_b32 v2, 7, v2
v_lshl_add_u32 v2, v4, 11, v2
v_mul_u32_u24 v3, 393216, v3
v_add_u32 v2, v2, v3
s_mul_i32 s49, s38, 6144
s_lshl_b32 s50, s51, 9
s_add_u32 s49, s49, s50
v_add_u32 v50, s49, v2
v_min_u32 v2, 13, v1
v_mul_u32_u24 v3, 37, v2
v_lshrrev_b32 v3, 8, v3
v_mul_u32_u24 v4, 7, v3
v_sub_u32 v2, v2, v4
s_mul_i32 s49, s39, 7
v_add_u32 v2, s49, v2
v_lshlrev_b32 v2, 7, v2
v_mul_u32_u24 v3, 458752, v3
v_add_u32 v2, v2, v3
s_mul_i32 s49, s38, 7168
s_mul_i32 s50, s51, 1792
s_add_u32 s49, s49, s50
v_add_u32 v51, s49, v2
s_lshl_b32 s38, s4, 3
s_add_u32 s38, s38, s7
s_lshl_b32 s38, s38, 2
s_add_u32 s38, s38, s28
s_lshl_b32 s38, s38, 14
s_lshl_b32 s39, s100, 10
s_add_u32 s38, s38, s39
v_and_b32 v2, 7, v1
v_lshlrev_b32 v2, 11, v2
v_lshrrev_b32 v3, 3, v1
v_min_u32 v3, 1, v3
v_lshl_add_u32 v2, v3, 7, v2
v_add_u32 v52, s38, v2
s_waitcnt lgkmcnt(0)
s_mov_b32 s8, s66
s_mov_b32 s9, s67
s_mov_b32 s10, 6291456
s_mov_b32 s11, 0x20000
s_mov_b32 s20, s74
s_mov_b32 s21, s75
s_mov_b32 s22, 7340032
s_mov_b32 s23, 0x20000
s_mov_b32 s40, s64
s_mov_b32 s41, s65
s_mov_b32 s42, 4194304
s_mov_b32 s43, 0x20000
buffer_load_dword v39, v50, s[8:11], 0 offen
buffer_load_dword v39, v51, s[20:23], 0 offen
buffer_load_dword v39, v52, s[40:43], 0 offen
v_lshrrev_b32 v2, 5, v1
v_lshlrev_b32 v2, 1, v2
v_and_b32 v4, 3, v1
v_xor_b32 v2, v4, v2
v_lshlrev_b32 v2, 4, v2
v_lshrrev_b32 v3, 2, v1
v_mul_u32_u24 v3, 6144, v3
v_add_u32 v15, v2, v3
s_lshl_b32 s38, s5, 6
s_mul_i32 s39, s28, 98304
s_add_u32 s38, s38, s39
v_add_u32 v15, s38, v15
v_add_u32 v28, 1024, v15
v_add_u32 v29, 2048, v15
s_mul_i32 s29, s100, 3145728
s_mul_i32 s30, s100, 3670016
s_mul_i32 s32, s28, 3072
s_lshl_b32 s33, s28, 12
s_add_u32 s33, s33, 36864
s_mul_i32 s50, s5, 224
s_mul_i32 s39, s28, 114688
s_add_u32 s50, s50, s39
v_lshrrev_b32 v2, 4, v1
v_and_b32 v3, 15, v1
v_add_u32 v4, 0, v2
v_lshlrev_b32 v4, 1, v4
v_xor_b32 v4, v3, v4
v_min_u32 v4, 13, v4
v_lshlrev_b32 v4, 4, v4
v_add_u32 v5, 0, v2
v_mul_u32_u24 v5, 7168, v5
v_add_u32 v16, v4, v5
v_add_u32 v16, s50, v16
v_add_u32 v4, 0, v2
v_lshlrev_b32 v4, 1, v4
v_xor_b32 v4, v3, v4
v_min_u32 v4, 13, v4
v_lshlrev_b32 v4, 4, v4
v_add_u32 v5, 4, v2
v_mul_u32_u24 v5, 7168, v5
v_add_u32 v17, v4, v5
s_sub_u32 s50, s50, 1024
v_add_u32 v17, s50, v17
v_add_u32 v4, 4, v2
v_lshlrev_b32 v4, 1, v4
v_xor_b32 v4, v3, v4
v_min_u32 v4, 13, v4
v_lshlrev_b32 v4, 4, v4
v_add_u32 v5, 8, v2
v_mul_u32_u24 v5, 7168, v5
v_add_u32 v18, v4, v5
s_sub_u32 s50, s50, 1024
v_add_u32 v18, s50, v18
v_add_u32 v4, 4, v2
v_lshlrev_b32 v4, 1, v4
v_xor_b32 v4, v3, v4
v_min_u32 v4, 13, v4
v_lshlrev_b32 v4, 4, v4
v_add_u32 v5, 12, v2
v_mul_u32_u24 v5, 7168, v5
v_add_u32 v19, v4, v5
s_sub_u32 s50, s50, 1024
v_add_u32 v19, s50, v19
s_lshl_b32 s38, s4, 2
s_add_u32 s38, s38, s28
s_lshl_b32 s38, s38, 17
v_lshrrev_b32 v2, 4, v1
v_and_b32 v3, 7, v1
v_xor_b32 v3, v2, v3
v_lshrrev_b32 v2, 3, v1
v_lshlrev_b32 v2, 11, v2
v_add_u32 v2, s38, v2
v_xor_b32 v4, 4, v3
v_lshl_add_u32 v3, v3, 4, v2
v_lshl_add_u32 v4, v4, 4, v2
v_mov_b32 v20, v3
v_add_u32 v21, 15360, v4
v_add_u32 v22, 30720, v3
v_add_u32 v23, 46080, v4
s_lshl_b32 s31, s100, 10
s_add_u32 s34, s31, 65536
s_lshl_b32 s35, s28, 13
s_add_u32 s35, s35, 98304
s_mov_b32 s24, s86
s_mov_b32 s25, s87
s_mov_b32 s26, 268435456
s_mov_b32 s27, 0x20000
v_lshrrev_b32 v2, 4, v1
v_bfe_u32 v3, v1, 2, 2
v_and_b32 v4, 3, v1
v_and_b32 v5, 1, v2
v_lshl_add_u32 v6, v5, 3, v3
v_lshlrev_b32 v6, 6, v6
v_lshl_add_u32 v6, v5, 5, v6
v_lshl_add_u32 v6, v4, 3, v6
v_lshrrev_b32 v7, 1, v2
v_mul_u32_u24 v7, 3072, v7
v_add_u32 v6, v7, v6
v_xor_b32 v7, 32, v6
v_lshl_add_u32 v14, v5, 2, v3
v_lshlrev_b32 v14, 5, v14
v_lshl_add_u32 v5, v2, 3, v3
v_lshl_add_u32 v14, v5, 8, v14
v_lshl_add_u32 v14, v4, 3, v14
v_add_u32 v14, 36864, v14
s_and_b32 s89, s4, 3
s_lshl_b32 s89, s89, 2
s_add_u32 s89, s89, s28
s_min_u32 s89, s89, 12
s_sub_u32 s38, s89, 6
s_add_u32 s39, s38, s48
s_lshl_b32 s39, s39, 5
s_cmp_eq_u32 s48, 0
s_cselect_b32 s49, 192, 0
s_cmp_eq_u32 s89, 12
s_cselect_b32 s39, s49, s39
s_and_b32 s39, s39, 0xff
v_xor_b32 v26, s39, v14
s_and_b32 s38, s89, 1
s_lshl_b32 s38, s38, 5
v_xor_b32 v27, s38, v6
s_lshr_b32 s38, s89, 1
s_lshl_b32 s38, s38, 10
v_add_u32 v27, s38, v27
s_cmp_lt_u32 s89, 6
s_cselect_b32 s49, 1, 0
s_cselect_b64 vcc, -1, 0
s_mul_i32 s72, s49, -4096
s_add_u32 s72, s72, 16384
s_mul_i32 s38, s49, -768
s_add_u32 s38, s38, 1024
s_mul_i32 s39, s49, -2048
s_add_u32 s39, s39, 8192
s_mul_i32 s73, s72, -2
v_cndmask_b32 v24, v26, v27, vcc
v_add_u32 v25, s38, v24
v_add_u32 v26, s39, v24
v_add_u32 v27, s39, v25
v_mov_b32 v5, 0x3f803f80
v_accvgpr_write_b32 a128, v5
v_accvgpr_write_b32 a129, v5
v_accvgpr_write_b32 a130, v5
v_accvgpr_write_b32 a131, v5
s_lshl_b32 s38, s48, 5
v_xor_b32 v8, s38, v14
s_add_u32 s38, s38, 32
v_xor_b32 v9, s38, v14
s_add_u32 s38, s38, 32
v_xor_b32 v10, s38, v14
s_add_u32 s38, s38, 32
v_xor_b32 v11, s38, v14
s_add_u32 s38, s38, 32
v_xor_b32 v12, s38, v14
s_add_u32 s38, s38, 32
v_xor_b32 v13, s38, v14
s_add_u32 s38, s38, 32
s_cmp_eq_u32 s48, 0
s_cselect_b32 s38, 192, 0
v_xor_b32 v14, s38, v14
v_and_b32 v3, 15, v1
v_lshrrev_b32 v4, 1, v3
v_xor_b32 v4, v2, v4
v_lshlrev_b32 v4, 4, v4
v_lshl_add_u32 v4, v3, 7, v4
v_add_u32 v36, s35, v4
v_xor_b32 v37, 64, v36
s_mul_i32 s56, s100, -6291456
s_add_u32 s56, s56, 393216
s_mul_i32 s57, s100, -7340032
s_add_u32 s57, s57, 458752
s_mul_i32 s88, s100, -2048
s_add_u32 s88, s88, 128
s_lshr_b32 s38, s2, 3
s_lshl_b32 s38, s38, 1
s_lshr_b32 s39, s28, 1
s_add_u32 s38, s38, s39
s_and_b32 s39, s28, 1
s_lshr_b32 s51, s5, 3
v_min_u32 v2, 5, v1
s_mul_i32 s49, s39, 6
v_add_u32 v2, s49, v2
v_lshrrev_b32 v3, 2, v2
v_and_b32 v2, 3, v2
v_lshlrev_b32 v2, 7, v2
v_lshl_add_u32 v2, v3, 11, v2
s_mul_i32 s49, s38, 6144
s_lshl_b32 s50, s51, 9
s_add_u32 s49, s49, s50
v_add_u32 v43, s49, v2
v_min_u32 v2, 6, v1
s_mul_i32 s49, s39, 7
v_add_u32 v2, s49, v2
v_lshlrev_b32 v2, 7, v2
s_mul_i32 s49, s38, 7168
s_mul_i32 s50, s51, 1792
s_add_u32 s49, s49, s50
v_add_u32 v44, s49, v2
s_mul_i32 s36, s100, 3145728
s_add_u32 s36, s36, 786432
s_mul_i32 s37, s100, 3670016
s_add_u32 s37, s37, 917504
s_mul_i32 s38, s2, 28672
s_add_u32 s92, s78, s38
s_addc_u32 s93, s79, 0
s_sub_u32 s94, 7340032, s38
s_mov_b32 s95, 0x20000
s_lshl_b32 s38, s2, 13
s_add_u32 s96, s70, s38
s_addc_u32 s97, s71, 0
s_sub_u32 s98, 2097152, s38
s_mov_b32 s99, 0x20000
v_min_u32 v38, 18, v1
v_lshlrev_b32 v38, 7, v38
v_min_u32 v40, 5, v1
v_lshlrev_b32 v40, 7, v40
s_mul_i32 s61, s28, 7168
s_lshl_b32 s101, s28, 11
s_add_u32 m0, s32, 0
s_nop 0
buffer_load_dwordx4 v15, s[8:11], s29 offen offset:0 lds
buffer_load_dwordx4 v28, s[8:11], s29 offen offset:1024 lds
buffer_load_dwordx4 v29, s[8:11], s29 offen offset:2048 lds
s_add_u32 s29, s29, 393216
s_add_u32 m0, s33, 0
s_nop 0
buffer_load_dwordx4 v16, s[20:23], s30 offen offset:0 lds
buffer_load_dwordx4 v17, s[20:23], s30 offen offset:1024 lds
buffer_load_dwordx4 v18, s[20:23], s30 offen offset:2048 lds
buffer_load_dwordx4 v19, s[20:23], s30 offen offset:3072 lds
s_add_u32 s30, s30, 458752
s_add_u32 m0, s35, 0
s_nop 0
buffer_load_dwordx4 v20, s[40:43], s31 offen offset:0 lds
buffer_load_dwordx4 v21, s[40:43], s31 offen offset:1024 lds
buffer_load_dwordx4 v22, s[40:43], s31 offen offset:2048 lds
buffer_load_dwordx4 v23, s[40:43], s31 offen offset:3072 lds
s_add_u32 m0, s35, 4096
s_nop 0
buffer_load_dwordx4 v20, s[40:43], s34 offen offset:0 lds
buffer_load_dwordx4 v21, s[40:43], s34 offen offset:1024 lds
buffer_load_dwordx4 v22, s[40:43], s34 offen offset:2048 lds
buffer_load_dwordx4 v23, s[40:43], s34 offen offset:3072 lds
s_add_u32 s31, s31, 128
s_add_u32 s34, s31, 65536
s_or_b32 s38, s2, s28
s_cmp_lg_u32 s38, 0
s_cbranch_scc1 L_clr_1
v_mov_b32 v100, 0
v_mov_b32 v101, 0
v_mov_b32 v102, 0
v_mov_b32 v103, 0
v_lshlrev_b32 v47, 4, v1
s_mov_b32 s38, 39845888
buffer_store_dwordx4 v[100:103], v47, s[24:27], s38 offen offset:0 sc1
buffer_store_dwordx4 v[100:103], v47, s[24:27], s38 offen offset:1024 sc1
buffer_store_dwordx4 v[100:103], v47, s[24:27], s38 offen offset:2048 sc1
buffer_store_dwordx4 v[100:103], v47, s[24:27], s38 offen offset:3072 sc1
s_add_u32 s38, s38, 4096
buffer_store_dwordx4 v[100:103], v47, s[24:27], s38 offen offset:0 sc1
buffer_store_dwordx4 v[100:103], v47, s[24:27], s38 offen offset:1024 sc1
buffer_store_dwordx4 v[100:103], v47, s[24:27], s38 offen offset:2048 sc1
buffer_store_dwordx4 v[100:103], v47, s[24:27], s38 offen offset:3072 sc1
s_add_u32 s38, s38, 4096
buffer_store_dwordx4 v[100:103], v47, s[24:27], s38 offen offset:0 sc1
buffer_store_dwordx4 v[100:103], v47, s[24:27], s38 offen offset:1024 sc1
buffer_store_dwordx4 v[100:103], v47, s[24:27], s38 offen offset:2048 sc1
buffer_store_dwordx4 v[100:103], v47, s[24:27], s38 offen offset:3072 sc1
s_add_u32 s38, s38, 4096
buffer_store_dwordx4 v[100:103], v47, s[24:27], s38 offen offset:0 sc1
buffer_store_dwordx4 v[100:103], v47, s[24:27], s38 offen offset:1024 sc1
buffer_store_dwordx4 v[100:103], v47, s[24:27], s38 offen offset:2048 sc1
buffer_store_dwordx4 v[100:103], v47, s[24:27], s38 offen offset:3072 sc1
s_add_u32 s38, s38, 4096
L_clr_1:
s_add_u32 m0, s32, 12288
s_nop 0
buffer_load_dwordx4 v15, s[8:11], s29 offen offset:0 lds
buffer_load_dwordx4 v28, s[8:11], s29 offen offset:1024 lds
buffer_load_dwordx4 v29, s[8:11], s29 offen offset:2048 lds
s_add_u32 s29, s29, 393216
s_add_u32 m0, s33, 16384
v_lshlrev_b32 v42, 4, v1
buffer_load_dwordx4 v16, s[20:23], s30 offen offset:0 lds
buffer_load_dwordx4 v17, s[20:23], s30 offen offset:1024 lds
buffer_load_dwordx4 v18, s[20:23], s30 offen offset:2048 lds
buffer_load_dwordx4 v19, s[20:23], s30 offen offset:3072 lds
s_add_u32 s30, s30, 458752
s_add_u32 m0, s35, 32768
s_lshl_b32 s55, s2, 14
buffer_load_dwordx4 v20, s[40:43], s31 offen offset:0 lds
buffer_load_dwordx4 v21, s[40:43], s31 offen offset:1024 lds
buffer_load_dwordx4 v22, s[40:43], s31 offen offset:2048 lds
buffer_load_dwordx4 v23, s[40:43], s31 offen offset:3072 lds
s_add_u32 m0, s35, 36864
s_nop 0
buffer_load_dwordx4 v20, s[40:43], s34 offen offset:0 lds
s_lshl_b32 s38, s28, 12
buffer_load_dwordx4 v21, s[40:43], s34 offen offset:1024 lds
buffer_load_dwordx4 v22, s[40:43], s34 offen offset:2048 lds
buffer_load_dwordx4 v23, s[40:43], s34 offen offset:3072 lds
s_add_u32 s31, s31, 128
s_add_u32 s34, s31, 65536
s_add_u32 s55, s55, s38
buffer_load_dword v39, v43, s[8:11], s36 offen
buffer_load_dword v39, v44, s[20:23], s37 offen
s_add_u32 s36, s36, 393216
s_add_u32 s37, s37, 458752
buffer_load_dword v39, v43, s[8:11], s36 offen
buffer_load_dword v39, v44, s[20:23], s37 offen
s_add_u32 s36, s36, 393216
s_add_u32 s37, s37, 458752
s_getpc_b64 s[62:63]
L_pc:
s_lshr_b32 s38, s2, 3
s_lshl_b32 s38, s38, 2
s_add_u32 s38, s38, s28
s_lshl_b32 s38, s38, 3
v_lshrrev_b32 v4, 3, v1
v_add_u32 v4, s38, v4
v_lshlrev_b32 v4, 7, v4
v_min_u32 v5, L_end-L_pc, v4
global_load_dword v39, v5, s[62:63]
s_waitcnt vmcnt(20)
s_barrier
ds_read_b128 a[52:55], v36 offset:0
ds_read_b128 a[56:59], v36 offset:2048
ds_read_b128 a[60:63], v36 offset:4096
ds_read_b128 a[64:67], v36 offset:6144
ds_read_b64_tr_b16 a[0:1], v6 offset:0
ds_read_b64_tr_b16 a[2:3], v6 offset:256
ds_read_b64_tr_b16 a[4:5], v7 offset:0
ds_read_b64_tr_b16 a[6:7], v7 offset:256
ds_read_b64_tr_b16 a[8:9], v6 offset:1024
ds_read_b64_tr_b16 a[10:11], v6 offset:1280
ds_read_b64_tr_b16 a[12:13], v7 offset:1024
ds_read_b64_tr_b16 a[14:15], v7 offset:1280
ds_read_b128 a[68:71], v37 offset:0
ds_read_b128 a[72:75], v37 offset:2048
s_waitcnt lgkmcnt(6)
v_mfma_f32_16x16x32_bf16 v[48:51], a[0:3], a[52:55], 0
ds_read_b64_tr_b16 a[16:17], v6 offset:2048
ds_read_b64_tr_b16 a[18:19], v6 offset:2304
v_mfma_f32_16x16x32_bf16 v[52:55], a[0:3], a[56:59], 0
ds_read_b128 a[76:79], v37 offset:4096
s_add_u32 m0, s32, 24576
v_mfma_f32_16x16x32_bf16 v[56:59], a[0:3], a[60:63], 0
buffer_load_dwordx4 v15, s[8:11], s29 offen offset:0 lds
v_mfma_f32_16x16x32_bf16 v[60:63], a[0:3], a[64:67], 0
v_mfma_f32_16x16x32_bf16 v[64:67], a[4:7], a[52:55], 0
ds_read_b64_tr_b16 a[20:21], v7 offset:2048
ds_read_b64_tr_b16 a[22:23], v7 offset:2304
v_mfma_f32_16x16x32_bf16 v[68:71], a[4:7], a[56:59], 0
ds_read_b128 a[80:83], v37 offset:6144
v_mfma_f32_16x16x32_bf16 v[72:75], a[4:7], a[60:63], 0
buffer_load_dwordx4 v28, s[8:11], s29 offen offset:1024 lds
v_mfma_f32_16x16x32_bf16 v[76:79], a[4:7], a[64:67], 0
s_waitcnt lgkmcnt(8)
v_mfma_f32_16x16x32_bf16 v[80:83], a[8:11], a[52:55], 0
ds_read_b64_tr_b16 a[24:25], v8 offset:0
ds_read_b64_tr_b16 a[26:27], v8 offset:1024
v_mfma_f32_16x16x32_bf16 v[84:87], a[8:11], a[56:59], 0
v_mfma_f32_16x16x32_bf16 v[88:91], a[8:11], a[60:63], 0
buffer_load_dwordx4 v29, s[8:11], s29 offen offset:2048 lds
v_mfma_f32_16x16x32_bf16 v[92:95], a[8:11], a[64:67], 0
s_add_u32 s29, s29, 393216
v_mfma_f32_16x16x32_bf16 v[96:99], a[12:15], a[52:55], 0
ds_read_b64_tr_b16 a[28:29], v9 offset:0
ds_read_b64_tr_b16 a[30:31], v9 offset:1024
v_mfma_f32_16x16x32_bf16 v[100:103], a[12:15], a[56:59], 0
s_add_u32 m0, s33, 32768
v_mfma_f32_16x16x32_bf16 v[104:107], a[12:15], a[60:63], 0
buffer_load_dwordx4 v16, s[20:23], s30 offen offset:0 lds
v_mfma_f32_16x16x32_bf16 v[108:111], a[12:15], a[64:67], 0
s_waitcnt lgkmcnt(5)
v_mfma_f32_16x16x32_bf16 v[112:115], a[16:19], a[52:55], 0
ds_read_b64_tr_b16 a[32:33], v10 offset:0
ds_read_b64_tr_b16 a[34:35], v10 offset:1024
v_mfma_f32_16x16x32_bf16 v[116:119], a[16:19], a[56:59], 0
v_mfma_f32_16x16x32_bf16 v[120:123], a[16:19], a[60:63], 0
buffer_load_dwordx4 v17, s[20:23], s30 offen offset:1024 lds
v_mfma_f32_16x16x32_bf16 v[124:127], a[16:19], a[64:67], 0
v_mfma_f32_16x16x32_bf16 v[128:131], a[20:23], a[52:55], 0
ds_read_b64_tr_b16 a[36:37], v11 offset:0
ds_read_b64_tr_b16 a[38:39], v11 offset:1024
v_mfma_f32_16x16x32_bf16 v[132:135], a[20:23], a[56:59], 0
v_mfma_f32_16x16x32_bf16 v[136:139], a[20:23], a[60:63], 0
buffer_load_dwordx4 v18, s[20:23], s30 offen offset:2048 lds
v_mfma_f32_16x16x32_bf16 v[140:143], a[20:23], a[64:67], 0
s_waitcnt lgkmcnt(4)
v_mfma_f32_16x16x32_bf16 v[144:147], a[24:27], a[52:55], 0
ds_read_b64_tr_b16 a[40:41], v12 offset:0
ds_read_b64_tr_b16 a[42:43], v12 offset:1024
v_mfma_f32_16x16x32_bf16 v[148:151], a[24:27], a[56:59], 0
v_mfma_f32_16x16x32_bf16 v[152:155], a[24:27], a[60:63], 0
buffer_load_dwordx4 v19, s[20:23], s30 offen offset:3072 lds
v_mfma_f32_16x16x32_bf16 v[156:159], a[24:27], a[64:67], 0
s_add_u32 s30, s30, 458752
v_mfma_f32_16x16x32_bf16 v[160:163], a[28:31], a[52:55], 0
ds_read_b64_tr_b16 a[44:45], v13 offset:0
ds_read_b64_tr_b16 a[46:47], v13 offset:1024
v_mfma_f32_16x16x32_bf16 v[164:167], a[28:31], a[56:59], 0
s_add_u32 m0, s35, 0
v_mfma_f32_16x16x32_bf16 v[168:171], a[28:31], a[60:63], 0
buffer_load_dwordx4 v20, s[40:43], s31 offen offset:0 lds
v_mfma_f32_16x16x32_bf16 v[172:175], a[28:31], a[64:67], 0
s_waitcnt lgkmcnt(4)
v_mfma_f32_16x16x32_bf16 v[176:179], a[32:35], a[52:55], 0
ds_read_b64_tr_b16 a[48:49], v14 offset:0
ds_read_b64_tr_b16 a[50:51], v14 offset:1024
v_mfma_f32_16x16x32_bf16 v[180:183], a[32:35], a[56:59], 0
v_mfma_f32_16x16x32_bf16 v[184:187], a[32:35], a[60:63], 0
buffer_load_dwordx4 v21, s[40:43], s31 offen offset:1024 lds
v_mfma_f32_16x16x32_bf16 v[188:191], a[32:35], a[64:67], 0
ds_read_b64_tr_b16 a[120:121], v24
ds_read_b64_tr_b16 a[122:123], v25
v_mfma_f32_16x16x32_bf16 v[192:195], a[36:39], a[52:55], 0
ds_read_b64_tr_b16 a[0:1], v6 offset:6144
ds_read_b64_tr_b16 a[2:3], v6 offset:6400
v_mfma_f32_16x16x32_bf16 v[196:199], a[36:39], a[56:59], 0
v_mfma_f32_16x16x32_bf16 v[200:203], a[36:39], a[60:63], 0
buffer_load_dwordx4 v22, s[40:43], s31 offen offset:2048 lds
v_mfma_f32_16x16x32_bf16 v[204:207], a[36:39], a[64:67], 0
ds_read_b64_tr_b16 a[124:125], v26
ds_read_b64_tr_b16 a[126:127], v27
s_waitcnt lgkmcnt(8)
v_mfma_f32_16x16x32_bf16 v[208:211], a[40:43], a[52:55], 0
ds_read_b64_tr_b16 a[4:5], v7 offset:6144
ds_read_b64_tr_b16 a[6:7], v7 offset:6400
v_mfma_f32_16x16x32_bf16 v[212:215], a[40:43], a[56:59], 0
v_mfma_f32_16x16x32_bf16 v[216:219], a[40:43], a[60:63], 0
buffer_load_dwordx4 v23, s[40:43], s31 offen offset:3072 lds
v_mfma_f32_16x16x32_bf16 v[220:223], a[40:43], a[64:67], 0
v_add_u32 v24, s72, v24
v_add_u32 v25, s72, v25
v_mfma_f32_16x16x32_bf16 v[224:227], a[44:47], a[52:55], 0
ds_read_b64_tr_b16 a[8:9], v6 offset:7168
ds_read_b64_tr_b16 a[10:11], v6 offset:7424
v_mfma_f32_16x16x32_bf16 v[228:231], a[44:47], a[56:59], 0
s_add_u32 m0, s35, 4096
v_add_u32 v26, s72, v26
v_mfma_f32_16x16x32_bf16 v[232:235], a[44:47], a[60:63], 0
buffer_load_dwordx4 v20, s[40:43], s34 offen offset:0 lds
v_mfma_f32_16x16x32_bf16 v[236:239], a[44:47], a[64:67], 0
v_add_u32 v27, s72, v27
s_waitcnt lgkmcnt(6)
v_mfma_f32_16x16x32_bf16 v[240:243], a[48:51], a[52:55], 0
ds_read_b64_tr_b16 a[12:13], v7 offset:7168
ds_read_b64_tr_b16 a[14:15], v7 offset:7424
v_mfma_f32_16x16x32_bf16 v[244:247], a[48:51], a[56:59], 0
v_mfma_f32_16x16x32_bf16 v[248:251], a[48:51], a[60:63], 0
buffer_load_dwordx4 v21, s[40:43], s34 offen offset:1024 lds
v_mfma_f32_16x16x32_bf16 v[252:255], a[48:51], a[64:67], 0
v_mfma_f32_16x16x32_bf16 v[48:51], a[0:3], a[68:71], v[48:51]
ds_read_b64_tr_b16 a[16:17], v6 offset:8192
ds_read_b64_tr_b16 a[18:19], v6 offset:8448
v_mfma_f32_16x16x32_bf16 v[52:55], a[0:3], a[72:75], v[52:55]
v_mfma_f32_16x16x32_bf16 v[56:59], a[0:3], a[76:79], v[56:59]
buffer_load_dwordx4 v22, s[40:43], s34 offen offset:2048 lds
v_mfma_f32_16x16x32_bf16 v[60:63], a[0:3], a[80:83], v[60:63]
s_waitcnt lgkmcnt(4)
v_mfma_f32_16x16x32_bf16 v[64:67], a[4:7], a[68:71], v[64:67]
ds_read_b64_tr_b16 a[20:21], v7 offset:8192
ds_read_b64_tr_b16 a[22:23], v7 offset:8448
v_mfma_f32_16x16x32_bf16 v[68:71], a[4:7], a[72:75], v[68:71]
v_mfma_f32_16x16x32_bf16 v[72:75], a[4:7], a[76:79], v[72:75]
buffer_load_dwordx4 v23, s[40:43], s34 offen offset:3072 lds
v_mfma_f32_16x16x32_bf16 v[76:79], a[4:7], a[80:83], v[76:79]
s_add_u32 s31, s31, 128
s_add_u32 s34, s31, 65536
v_mfma_f32_16x16x32_bf16 a[116:119], a[120:123], a[128:131], 0
v_mfma_f32_16x16x32_bf16 v[80:83], a[8:11], a[68:71], v[80:83]
ds_read_b64_tr_b16 a[24:25], v8 offset:8192
ds_read_b64_tr_b16 a[26:27], v8 offset:9216
v_mfma_f32_16x16x32_bf16 v[84:87], a[8:11], a[72:75], v[84:87]
v_mfma_f32_16x16x32_bf16 v[88:91], a[8:11], a[76:79], v[88:91]
buffer_load_dword v39, v43, s[8:11], s36 offen
v_mfma_f32_16x16x32_bf16 v[92:95], a[8:11], a[80:83], v[92:95]
v_mfma_f32_16x16x32_bf16 a[116:119], a[124:127], a[128:131], a[116:119]
s_waitcnt lgkmcnt(4)
v_mfma_f32_16x16x32_bf16 v[96:99], a[12:15], a[68:71], v[96:99]
ds_read_b64_tr_b16 a[28:29], v9 offset:8192
ds_read_b64_tr_b16 a[30:31], v9 offset:9216
v_mfma_f32_16x16x32_bf16 v[100:103], a[12:15], a[72:75], v[100:103]
v_mfma_f32_16x16x32_bf16 v[104:107], a[12:15], a[76:79], v[104:107]
buffer_load_dword v39, v44, s[20:23], s37 offen
v_mfma_f32_16x16x32_bf16 v[108:111], a[12:15], a[80:83], v[108:111]
s_add_u32 s36, s36, 393216
s_add_u32 s37, s37, 458752
v_mfma_f32_16x16x32_bf16 v[112:115], a[16:19], a[68:71], v[112:115]
ds_read_b64_tr_b16 a[32:33], v10 offset:8192
ds_read_b64_tr_b16 a[34:35], v10 offset:9216
v_mfma_f32_16x16x32_bf16 v[116:119], a[16:19], a[72:75], v[116:119]
v_mfma_f32_16x16x32_bf16 v[120:123], a[16:19], a[76:79], v[120:123]
v_mfma_f32_16x16x32_bf16 v[124:127], a[16:19], a[80:83], v[124:127]
s_waitcnt lgkmcnt(4)
v_mfma_f32_16x16x32_bf16 v[128:131], a[20:23], a[68:71], v[128:131]
ds_read_b64_tr_b16 a[36:37], v11 offset:8192
ds_read_b64_tr_b16 a[38:39], v11 offset:9216
v_mfma_f32_16x16x32_bf16 v[132:135], a[20:23], a[72:75], v[132:135]
v_mfma_f32_16x16x32_bf16 v[136:139], a[20:23], a[76:79], v[136:139]
v_mfma_f32_16x16x32_bf16 v[140:143], a[20:23], a[80:83], v[140:143]
v_mfma_f32_16x16x32_bf16 v[144:147], a[24:27], a[68:71], v[144:147]
ds_read_b64_tr_b16 a[40:41], v12 offset:8192
ds_read_b64_tr_b16 a[42:43], v12 offset:9216
v_mfma_f32_16x16x32_bf16 v[148:151], a[24:27], a[72:75], v[148:151]
v_mfma_f32_16x16x32_bf16 v[152:155], a[24:27], a[76:79], v[152:155]
v_mfma_f32_16x16x32_bf16 v[156:159], a[24:27], a[80:83], v[156:159]
s_waitcnt lgkmcnt(4)
v_mfma_f32_16x16x32_bf16 v[160:163], a[28:31], a[68:71], v[160:163]
ds_read_b64_tr_b16 a[44:45], v13 offset:8192
ds_read_b64_tr_b16 a[46:47], v13 offset:9216
v_mfma_f32_16x16x32_bf16 v[164:167], a[28:31], a[72:75], v[164:167]
v_mfma_f32_16x16x32_bf16 v[168:171], a[28:31], a[76:79], v[168:171]
v_mfma_f32_16x16x32_bf16 v[172:175], a[28:31], a[80:83], v[172:175]
v_mfma_f32_16x16x32_bf16 v[176:179], a[32:35], a[68:71], v[176:179]
ds_read_b64_tr_b16 a[48:49], v14 offset:8192
ds_read_b64_tr_b16 a[50:51], v14 offset:9216
v_mfma_f32_16x16x32_bf16 v[180:183], a[32:35], a[72:75], v[180:183]
v_mfma_f32_16x16x32_bf16 v[184:187], a[32:35], a[76:79], v[184:187]
v_mfma_f32_16x16x32_bf16 v[188:191], a[32:35], a[80:83], v[188:191]
s_waitcnt vmcnt(22)
s_barrier
s_or_b32 s38, s2, s28
s_cmp_lg_u32 s38, 0
s_cbranch_scc1 L_flg_2
v_mov_b32 v2, 0
v_mov_b32 v3, 1
s_mov_b64 exec, 1
global_store_dword v2, v3, s[84:85] sc1
s_mov_b64 exec, -1
L_flg_2:
s_waitcnt lgkmcnt(4)
v_mfma_f32_16x16x32_bf16 v[192:195], a[36:39], a[68:71], v[192:195]
ds_read_b64_tr_b16 a[0:1], v6 offset:12288
ds_read_b64_tr_b16 a[2:3], v6 offset:12544
v_mfma_f32_16x16x32_bf16 v[196:199], a[36:39], a[72:75], v[196:199]
ds_read_b128 a[84:87], v36 offset:32768
v_mfma_f32_16x16x32_bf16 v[200:203], a[36:39], a[76:79], v[200:203]
v_mfma_f32_16x16x32_bf16 v[204:207], a[36:39], a[80:83], v[204:207]
ds_read_b128 a[88:91], v36 offset:34816
v_mfma_f32_16x16x32_bf16 v[208:211], a[40:43], a[68:71], v[208:211]
ds_read_b64_tr_b16 a[4:5], v7 offset:12288
ds_read_b64_tr_b16 a[6:7], v7 offset:12544
v_mfma_f32_16x16x32_bf16 v[212:215], a[40:43], a[72:75], v[212:215]
ds_read_b128 a[92:95], v36 offset:36864
v_mfma_f32_16x16x32_bf16 v[216:219], a[40:43], a[76:79], v[216:219]
v_mfma_f32_16x16x32_bf16 v[220:223], a[40:43], a[80:83], v[220:223]
ds_read_b128 a[96:99], v36 offset:38912
s_waitcnt lgkmcnt(8)
v_mfma_f32_16x16x32_bf16 v[224:227], a[44:47], a[68:71], v[224:227]
ds_read_b64_tr_b16 a[8:9], v6 offset:13312
ds_read_b64_tr_b16 a[10:11], v6 offset:13568
v_mfma_f32_16x16x32_bf16 v[228:231], a[44:47], a[72:75], v[228:231]
ds_read_b128 a[100:103], v37 offset:32768
v_mfma_f32_16x16x32_bf16 v[232:235], a[44:47], a[76:79], v[232:235]
v_mfma_f32_16x16x32_bf16 v[236:239], a[44:47], a[80:83], v[236:239]
v_mfma_f32_16x16x32_bf16 v[240:243], a[48:51], a[68:71], v[240:243]
ds_read_b64_tr_b16 a[12:13], v7 offset:13312
ds_read_b64_tr_b16 a[14:15], v7 offset:13568
v_mfma_f32_16x16x32_bf16 v[244:247], a[48:51], a[72:75], v[244:247]
ds_read_b128 a[104:107], v37 offset:34816
v_mfma_f32_16x16x32_bf16 v[248:251], a[48:51], a[76:79], v[248:251]
v_mfma_f32_16x16x32_bf16 v[252:255], a[48:51], a[80:83], v[252:255]
s_waitcnt lgkmcnt(6)
v_mfma_f32_16x16x32_bf16 v[48:51], a[0:3], a[84:87], v[48:51]
ds_read_b64_tr_b16 a[16:17], v6 offset:14336
ds_read_b64_tr_b16 a[18:19], v6 offset:14592
v_mfma_f32_16x16x32_bf16 v[52:55], a[0:3], a[88:91], v[52:55]
ds_read_b128 a[108:111], v37 offset:36864
s_add_u32 m0, s32, 0
v_mfma_f32_16x16x32_bf16 v[56:59], a[0:3], a[92:95], v[56:59]
buffer_load_dwordx4 v15, s[8:11], s29 offen offset:0 lds
v_mfma_f32_16x16x32_bf16 v[60:63], a[0:3], a[96:99], v[60:63]
v_mfma_f32_16x16x32_bf16 v[64:67], a[4:7], a[84:87], v[64:67]
ds_read_b64_tr_b16 a[20:21], v7 offset:14336
ds_read_b64_tr_b16 a[22:23], v7 offset:14592
v_mfma_f32_16x16x32_bf16 v[68:71], a[4:7], a[88:91], v[68:71]
ds_read_b128 a[112:115], v37 offset:38912
v_mfma_f32_16x16x32_bf16 v[72:75], a[4:7], a[92:95], v[72:75]
buffer_load_dwordx4 v28, s[8:11], s29 offen offset:1024 lds
v_mfma_f32_16x16x32_bf16 v[76:79], a[4:7], a[96:99], v[76:79]
s_waitcnt lgkmcnt(7)
v_mfma_f32_16x16x32_bf16 v[80:83], a[8:11], a[84:87], v[80:83]
ds_read_b64_tr_b16 a[24:25], v8 offset:16384
ds_read_b64_tr_b16 a[26:27], v8 offset:17408
v_mfma_f32_16x16x32_bf16 v[84:87], a[8:11], a[88:91], v[84:87]
s_mul_i32 s38, s5, 224
s_add_u32 s44, s76, s38
s_addc_u32 s45, s77, 0
v_mfma_f32_16x16x32_bf16 v[88:91], a[8:11], a[92:95], v[88:91]
buffer_load_dwordx4 v29, s[8:11], s29 offen offset:2048 lds
v_mfma_f32_16x16x32_bf16 v[92:95], a[8:11], a[96:99], v[92:95]
s_add_u32 s29, s29, 393216
s_sub_u32 s46, 7168, s38
v_mfma_f32_16x16x32_bf16 v[96:99], a[12:15], a[84:87], v[96:99]
ds_read_b64_tr_b16 a[28:29], v9 offset:16384
ds_read_b64_tr_b16 a[30:31], v9 offset:17408
v_mfma_f32_16x16x32_bf16 v[100:103], a[12:15], a[88:91], v[100:103]
s_add_u32 m0, s33, 0
s_mov_b32 s47, 0x20000
v_mfma_f32_16x16x32_bf16 v[104:107], a[12:15], a[92:95], v[104:107]
buffer_load_dwordx4 v16, s[20:23], s30 offen offset:0 lds
v_mfma_f32_16x16x32_bf16 v[108:111], a[12:15], a[96:99], v[108:111]
s_lshl_b32 s38, s48, 5
v_lshlrev_b32 v2, 3, v1
s_waitcnt lgkmcnt(5)
v_mfma_f32_16x16x32_bf16 v[112:115], a[16:19], a[84:87], v[112:115]
ds_read_b64_tr_b16 a[32:33], v10 offset:16384
ds_read_b64_tr_b16 a[34:35], v10 offset:17408
v_mfma_f32_16x16x32_bf16 v[116:119], a[16:19], a[88:91], v[116:119]
v_add_u32 v2, s38, v2
v_subrev_u32 v3, 224, v2
v_mfma_f32_16x16x32_bf16 v[120:123], a[16:19], a[92:95], v[120:123]
buffer_load_dwordx4 v17, s[20:23], s30 offen offset:1024 lds
v_mfma_f32_16x16x32_bf16 v[124:127], a[16:19], a[96:99], v[124:127]
v_min_u32 v2, v2, v3
v_mfma_f32_16x16x32_bf16 v[128:131], a[20:23], a[84:87], v[128:131]
ds_read_b64_tr_b16 a[36:37], v11 offset:16384
ds_read_b64_tr_b16 a[38:39], v11 offset:17408
v_mfma_f32_16x16x32_bf16 v[132:135], a[20:23], a[88:91], v[132:135]
v_mfma_f32_16x16x32_bf16 v[136:139], a[20:23], a[92:95], v[136:139]
buffer_load_dwordx4 v18, s[20:23], s30 offen offset:2048 lds
v_mfma_f32_16x16x32_bf16 v[140:143], a[20:23], a[96:99], v[140:143]
s_waitcnt lgkmcnt(4)
v_mfma_f32_16x16x32_bf16 v[144:147], a[24:27], a[84:87], v[144:147]
ds_read_b64_tr_b16 a[40:41], v12 offset:16384
ds_read_b64_tr_b16 a[42:43], v12 offset:17408
v_mfma_f32_16x16x32_bf16 v[148:151], a[24:27], a[88:91], v[148:151]
v_mfma_f32_16x16x32_bf16 v[152:155], a[24:27], a[92:95], v[152:155]
buffer_load_dwordx4 v19, s[20:23], s30 offen offset:3072 lds
v_mfma_f32_16x16x32_bf16 v[156:159], a[24:27], a[96:99], v[156:159]
s_add_u32 s30, s30, 458752
v_mfma_f32_16x16x32_bf16 v[160:163], a[28:31], a[84:87], v[160:163]
ds_read_b64_tr_b16 a[44:45], v13 offset:16384
ds_read_b64_tr_b16 a[46:47], v13 offset:17408
v_mfma_f32_16x16x32_bf16 v[164:167], a[28:31], a[88:91], v[164:167]
s_add_u32 m0, s35, 32768
v_mfma_f32_16x16x32_bf16 v[168:171], a[28:31], a[92:95], v[168:171]
buffer_load_dwordx4 v20, s[40:43], s31 offen offset:0 lds
v_mfma_f32_16x16x32_bf16 v[172:175], a[28:31], a[96:99], v[172:175]
s_waitcnt lgkmcnt(4)
v_mfma_f32_16x16x32_bf16 v[176:179], a[32:35], a[84:87], v[176:179]
ds_read_b64_tr_b16 a[48:49], v14 offset:16384
ds_read_b64_tr_b16 a[50:51], v14 offset:17408
v_mfma_f32_16x16x32_bf16 v[180:183], a[32:35], a[88:91], v[180:183]
v_mfma_f32_16x16x32_bf16 v[184:187], a[32:35], a[92:95], v[184:187]
buffer_load_dwordx4 v21, s[40:43], s31 offen offset:1024 lds
v_mfma_f32_16x16x32_bf16 v[188:191], a[32:35], a[96:99], v[188:191]
ds_read_b64_tr_b16 a[120:121], v24
ds_read_b64_tr_b16 a[122:123], v25
v_mfma_f32_16x16x32_bf16 v[192:195], a[36:39], a[84:87], v[192:195]
ds_read_b64_tr_b16 a[0:1], v6 offset:18432
ds_read_b64_tr_b16 a[2:3], v6 offset:18688
v_mfma_f32_16x16x32_bf16 v[196:199], a[36:39], a[88:91], v[196:199]
v_mfma_f32_16x16x32_bf16 v[200:203], a[36:39], a[92:95], v[200:203]
buffer_load_dwordx4 v22, s[40:43], s31 offen offset:2048 lds
v_mfma_f32_16x16x32_bf16 v[204:207], a[36:39], a[96:99], v[204:207]
ds_read_b64_tr_b16 a[124:125], v26
ds_read_b64_tr_b16 a[126:127], v27
s_waitcnt lgkmcnt(8)
v_mfma_f32_16x16x32_bf16 v[208:211], a[40:43], a[84:87], v[208:211]
ds_read_b64_tr_b16 a[4:5], v7 offset:18432
ds_read_b64_tr_b16 a[6:7], v7 offset:18688
v_mfma_f32_16x16x32_bf16 v[212:215], a[40:43], a[88:91], v[212:215]
v_mfma_f32_16x16x32_bf16 v[216:219], a[40:43], a[92:95], v[216:219]
buffer_load_dwordx4 v23, s[40:43], s31 offen offset:3072 lds
v_mfma_f32_16x16x32_bf16 v[220:223], a[40:43], a[96:99], v[220:223]
v_add_u32 v24, s72, v24
v_add_u32 v25, s72, v25
v_mfma_f32_16x16x32_bf16 v[224:227], a[44:47], a[84:87], v[224:227]
ds_read_b64_tr_b16 a[8:9], v6 offset:19456
ds_read_b64_tr_b16 a[10:11], v6 offset:19712
v_mfma_f32_16x16x32_bf16 v[228:231], a[44:47], a[88:91], v[228:231]
s_add_u32 m0, s35, 36864
v_add_u32 v26, s72, v26
v_mfma_f32_16x16x32_bf16 v[232:235], a[44:47], a[92:95], v[232:235]
buffer_load_dwordx4 v20, s[40:43], s34 offen offset:0 lds
v_mfma_f32_16x16x32_bf16 v[236:239], a[44:47], a[96:99], v[236:239]
v_add_u32 v27, s72, v27
s_waitcnt lgkmcnt(6)
v_mfma_f32_16x16x32_bf16 v[240:243], a[48:51], a[84:87], v[240:243]
ds_read_b64_tr_b16 a[12:13], v7 offset:19456
ds_read_b64_tr_b16 a[14:15], v7 offset:19712
v_mfma_f32_16x16x32_bf16 v[244:247], a[48:51], a[88:91], v[244:247]
v_mfma_f32_16x16x32_bf16 v[248:251], a[48:51], a[92:95], v[248:251]
buffer_load_dwordx4 v21, s[40:43], s34 offen offset:1024 lds
v_mfma_f32_16x16x32_bf16 v[252:255], a[48:51], a[96:99], v[252:255]
v_mfma_f32_16x16x32_bf16 v[48:51], a[0:3], a[100:103], v[48:51]
ds_read_b64_tr_b16 a[16:17], v6 offset:20480
ds_read_b64_tr_b16 a[18:19], v6 offset:20736
v_mfma_f32_16x16x32_bf16 v[52:55], a[0:3], a[104:107], v[52:55]
v_mfma_f32_16x16x32_bf16 v[56:59], a[0:3], a[108:111], v[56:59]
buffer_load_dwordx4 v22, s[40:43], s34 offen offset:2048 lds
v_mfma_f32_16x16x32_bf16 v[60:63], a[0:3], a[112:115], v[60:63]
s_waitcnt lgkmcnt(4)
v_mfma_f32_16x16x32_bf16 v[64:67], a[4:7], a[100:103], v[64:67]
ds_read_b64_tr_b16 a[20:21], v7 offset:20480
ds_read_b64_tr_b16 a[22:23], v7 offset:20736
v_mfma_f32_16x16x32_bf16 v[68:71], a[4:7], a[104:107], v[68:71]
v_mfma_f32_16x16x32_bf16 v[72:75], a[4:7], a[108:111], v[72:75]
buffer_load_dwordx4 v23, s[40:43], s34 offen offset:3072 lds
v_mfma_f32_16x16x32_bf16 v[76:79], a[4:7], a[112:115], v[76:79]
s_add_u32 s31, s31, 128
s_add_u32 s34, s31, 65536
v_mfma_f32_16x16x32_bf16 a[116:119], a[120:123], a[128:131], a[116:119]
v_mfma_f32_16x16x32_bf16 v[80:83], a[8:11], a[100:103], v[80:83]
ds_read_b64_tr_b16 a[24:25], v8 offset:24576
ds_read_b64_tr_b16 a[26:27], v8 offset:25600
v_mfma_f32_16x16x32_bf16 v[84:87], a[8:11], a[104:107], v[84:87]
v_mfma_f32_16x16x32_bf16 v[88:91], a[8:11], a[108:111], v[88:91]
buffer_load_dword v39, v43, s[8:11], s36 offen
v_mfma_f32_16x16x32_bf16 v[92:95], a[8:11], a[112:115], v[92:95]
v_mfma_f32_16x16x32_bf16 a[116:119], a[124:127], a[128:131], a[116:119]
s_waitcnt lgkmcnt(4)
v_mfma_f32_16x16x32_bf16 v[96:99], a[12:15], a[100:103], v[96:99]
ds_read_b64_tr_b16 a[28:29], v9 offset:24576
ds_read_b64_tr_b16 a[30:31], v9 offset:25600
v_mfma_f32_16x16x32_bf16 v[100:103], a[12:15], a[104:107], v[100:103]
v_mfma_f32_16x16x32_bf16 v[104:107], a[12:15], a[108:111], v[104:107]
buffer_load_dword v39, v44, s[20:23], s37 offen
v_mfma_f32_16x16x32_bf16 v[108:111], a[12:15], a[112:115], v[108:111]
s_add_u32 s36, s36, 393216
s_add_u32 s37, s37, 458752
v_mfma_f32_16x16x32_bf16 v[112:115], a[16:19], a[100:103], v[112:115]
ds_read_b64_tr_b16 a[32:33], v10 offset:24576
ds_read_b64_tr_b16 a[34:35], v10 offset:25600
v_mfma_f32_16x16x32_bf16 v[116:119], a[16:19], a[104:107], v[116:119]
v_mfma_f32_16x16x32_bf16 v[120:123], a[16:19], a[108:111], v[120:123]
buffer_load_dwordx4 a[132:135], v42, s[40:43], s55 offen offset:0
v_mfma_f32_16x16x32_bf16 v[124:127], a[16:19], a[112:115], v[124:127]
s_waitcnt lgkmcnt(4)
v_mfma_f32_16x16x32_bf16 v[128:131], a[20:23], a[100:103], v[128:131]
ds_read_b64_tr_b16 a[36:37], v11 offset:24576
ds_read_b64_tr_b16 a[38:39], v11 offset:25600
v_mfma_f32_16x16x32_bf16 v[132:135], a[20:23], a[104:107], v[132:135]
v_mfma_f32_16x16x32_bf16 v[136:139], a[20:23], a[108:111], v[136:139]
buffer_load_dwordx4 a[136:139], v42, s[40:43], s55 offen offset:1024
v_mfma_f32_16x16x32_bf16 v[140:143], a[20:23], a[112:115], v[140:143]
v_mfma_f32_16x16x32_bf16 v[144:147], a[24:27], a[100:103], v[144:147]
ds_read_b64_tr_b16 a[40:41], v12 offset:24576
ds_read_b64_tr_b16 a[42:43], v12 offset:25600
v_mfma_f32_16x16x32_bf16 v[148:151], a[24:27], a[104:107], v[148:151]
v_mfma_f32_16x16x32_bf16 v[152:155], a[24:27], a[108:111], v[152:155]
buffer_load_dwordx4 a[140:143], v42, s[40:43], s55 offen offset:2048
v_mfma_f32_16x16x32_bf16 v[156:159], a[24:27], a[112:115], v[156:159]
s_waitcnt lgkmcnt(4)
v_mfma_f32_16x16x32_bf16 v[160:163], a[28:31], a[100:103], v[160:163]
ds_read_b64_tr_b16 a[44:45], v13 offset:24576
ds_read_b64_tr_b16 a[46:47], v13 offset:25600
v_mfma_f32_16x16x32_bf16 v[164:167], a[28:31], a[104:107], v[164:167]
v_mfma_f32_16x16x32_bf16 v[168:171], a[28:31], a[108:111], v[168:171]
buffer_load_dwordx4 a[144:147], v42, s[40:43], s55 offen offset:3072
v_mfma_f32_16x16x32_bf16 v[172:175], a[28:31], a[112:115], v[172:175]
v_mfma_f32_16x16x32_bf16 v[176:179], a[32:35], a[100:103], v[176:179]
ds_read_b64_tr_b16 a[48:49], v14 offset:24576
ds_read_b64_tr_b16 a[50:51], v14 offset:25600
v_mfma_f32_16x16x32_bf16 v[180:183], a[32:35], a[104:107], v[180:183]
v_mfma_f32_16x16x32_bf16 v[184:187], a[32:35], a[108:111], v[184:187]
buffer_load_dwordx2 v[46:47], v2, s[44:47], 0 offen
v_mfma_f32_16x16x32_bf16 v[188:191], a[32:35], a[112:115], v[188:191]
s_waitcnt vmcnt(24)
s_barrier
s_waitcnt lgkmcnt(4)
v_mfma_f32_16x16x32_bf16 v[192:195], a[36:39], a[100:103], v[192:195]
ds_read_b64_tr_b16 a[0:1], v6 offset:24576
ds_read_b64_tr_b16 a[2:3], v6 offset:24832
v_mfma_f32_16x16x32_bf16 v[196:199], a[36:39], a[104:107], v[196:199]
ds_read_b128 a[52:55], v36 offset:0
v_mfma_f32_16x16x32_bf16 v[200:203], a[36:39], a[108:111], v[200:203]
v_mfma_f32_16x16x32_bf16 v[204:207], a[36:39], a[112:115], v[204:207]
ds_read_b128 a[56:59], v36 offset:2048
v_mfma_f32_16x16x32_bf16 v[208:211], a[40:43], a[100:103], v[208:211]
ds_read_b64_tr_b16 a[4:5], v7 offset:24576
ds_read_b64_tr_b16 a[6:7], v7 offset:24832
v_mfma_f32_16x16x32_bf16 v[212:215], a[40:43], a[104:107], v[212:215]
ds_read_b128 a[60:63], v36 offset:4096
v_mfma_f32_16x16x32_bf16 v[216:219], a[40:43], a[108:111], v[216:219]
v_mfma_f32_16x16x32_bf16 v[220:223], a[40:43], a[112:115], v[220:223]
ds_read_b128 a[64:67], v36 offset:6144
s_waitcnt lgkmcnt(8)
v_mfma_f32_16x16x32_bf16 v[224:227], a[44:47], a[100:103], v[224:227]
ds_read_b64_tr_b16 a[8:9], v6 offset:25600
ds_read_b64_tr_b16 a[10:11], v6 offset:25856
v_mfma_f32_16x16x32_bf16 v[228:231], a[44:47], a[104:107], v[228:231]
ds_read_b128 a[68:71], v37 offset:0
v_mfma_f32_16x16x32_bf16 v[232:235], a[44:47], a[108:111], v[232:235]
v_mfma_f32_16x16x32_bf16 v[236:239], a[44:47], a[112:115], v[236:239]
v_mfma_f32_16x16x32_bf16 v[240:243], a[48:51], a[100:103], v[240:243]
ds_read_b64_tr_b16 a[12:13], v7 offset:25600
ds_read_b64_tr_b16 a[14:15], v7 offset:25856
v_mfma_f32_16x16x32_bf16 v[244:247], a[48:51], a[104:107], v[244:247]
ds_read_b128 a[72:75], v37 offset:2048
v_mfma_f32_16x16x32_bf16 v[248:251], a[48:51], a[108:111], v[248:251]
v_mfma_f32_16x16x32_bf16 v[252:255], a[48:51], a[112:115], v[252:255]
s_waitcnt lgkmcnt(6)
v_mfma_f32_16x16x32_bf16 v[48:51], a[0:3], a[52:55], v[48:51]
ds_read_b64_tr_b16 a[16:17], v6 offset:26624
ds_read_b64_tr_b16 a[18:19], v6 offset:26880
v_mfma_f32_16x16x32_bf16 v[52:55], a[0:3], a[56:59], v[52:55]
ds_read_b128 a[76:79], v37 offset:4096
s_add_u32 m0, s32, 12288
v_mfma_f32_16x16x32_bf16 v[56:59], a[0:3], a[60:63], v[56:59]
buffer_load_dwordx4 v15, s[8:11], s29 offen offset:0 lds
v_mfma_f32_16x16x32_bf16 v[60:63], a[0:3], a[64:67], v[60:63]
v_mfma_f32_16x16x32_bf16 v[64:67], a[4:7], a[52:55], v[64:67]
ds_read_b64_tr_b16 a[20:21], v7 offset:26624
ds_read_b64_tr_b16 a[22:23], v7 offset:26880
v_mfma_f32_16x16x32_bf16 v[68:71], a[4:7], a[56:59], v[68:71]
ds_read_b128 a[80:83], v37 offset:6144
v_mfma_f32_16x16x32_bf16 v[72:75], a[4:7], a[60:63], v[72:75]
buffer_load_dwordx4 v28, s[8:11], s29 offen offset:1024 lds
v_mfma_f32_16x16x32_bf16 v[76:79], a[4:7], a[64:67], v[76:79]
s_waitcnt lgkmcnt(7)
v_mfma_f32_16x16x32_bf16 v[80:83], a[8:11], a[52:55], v[80:83]
ds_read_b64_tr_b16 a[24:25], v8 offset:32768
ds_read_b64_tr_b16 a[26:27], v8 offset:33792
v_mfma_f32_16x16x32_bf16 v[84:87], a[8:11], a[56:59], v[84:87]
s_lshl_b32 s38, s5, 11
s_add_u32 s44, s68, s38
s_addc_u32 s45, s69, 0
v_mfma_f32_16x16x32_bf16 v[88:91], a[8:11], a[60:63], v[88:91]
buffer_load_dwordx4 v29, s[8:11], s29 offen offset:2048 lds
v_mfma_f32_16x16x32_bf16 v[92:95], a[8:11], a[64:67], v[92:95]
s_add_u32 s29, s29, 393216
s_sub_u32 s46, 65536, s38
v_mfma_f32_16x16x32_bf16 v[96:99], a[12:15], a[52:55], v[96:99]
ds_read_b64_tr_b16 a[28:29], v9 offset:32768
ds_read_b64_tr_b16 a[30:31], v9 offset:33792
v_mfma_f32_16x16x32_bf16 v[100:103], a[12:15], a[56:59], v[100:103]
s_add_u32 m0, s33, 16384
s_mov_b32 s47, 0x20000
v_mfma_f32_16x16x32_bf16 v[104:107], a[12:15], a[60:63], v[104:107]
buffer_load_dwordx4 v16, s[20:23], s30 offen offset:0 lds
v_mfma_f32_16x16x32_bf16 v[108:111], a[12:15], a[64:67], v[108:111]
s_and_b32 s59, s28, 1
s_lshl_b32 s59, s59, 10
s_waitcnt lgkmcnt(5)
v_mfma_f32_16x16x32_bf16 v[112:115], a[16:19], a[52:55], v[112:115]
ds_read_b64_tr_b16 a[32:33], v10 offset:32768
ds_read_b64_tr_b16 a[34:35], v10 offset:33792
v_mfma_f32_16x16x32_bf16 v[116:119], a[16:19], a[56:59], v[116:119]
v_lshlrev_b32 v45, 4, v1
v_mfma_f32_16x16x32_bf16 v[120:123], a[16:19], a[60:63], v[120:123]
buffer_load_dwordx4 v17, s[20:23], s30 offen offset:1024 lds
v_mfma_f32_16x16x32_bf16 v[124:127], a[16:19], a[64:67], v[124:127]
v_mfma_f32_16x16x32_bf16 v[128:131], a[20:23], a[52:55], v[128:131]
ds_read_b64_tr_b16 a[36:37], v11 offset:32768
ds_read_b64_tr_b16 a[38:39], v11 offset:33792
v_mfma_f32_16x16x32_bf16 v[132:135], a[20:23], a[56:59], v[132:135]
v_mfma_f32_16x16x32_bf16 v[136:139], a[20:23], a[60:63], v[136:139]
buffer_load_dwordx4 v18, s[20:23], s30 offen offset:2048 lds
v_mfma_f32_16x16x32_bf16 v[140:143], a[20:23], a[64:67], v[140:143]
s_waitcnt lgkmcnt(4)
v_mfma_f32_16x16x32_bf16 v[144:147], a[24:27], a[52:55], v[144:147]
ds_read_b64_tr_b16 a[40:41], v12 offset:32768
ds_read_b64_tr_b16 a[42:43], v12 offset:33792
v_mfma_f32_16x16x32_bf16 v[148:151], a[24:27], a[56:59], v[148:151]
v_mfma_f32_16x16x32_bf16 v[152:155], a[24:27], a[60:63], v[152:155]
buffer_load_dwordx4 v19, s[20:23], s30 offen offset:3072 lds
v_mfma_f32_16x16x32_bf16 v[156:159], a[24:27], a[64:67], v[156:159]
s_add_u32 s30, s30, 458752
v_mfma_f32_16x16x32_bf16 v[160:163], a[28:31], a[52:55], v[160:163]
ds_read_b64_tr_b16 a[44:45], v13 offset:32768
ds_read_b64_tr_b16 a[46:47], v13 offset:33792
v_mfma_f32_16x16x32_bf16 v[164:167], a[28:31], a[56:59], v[164:167]
s_add_u32 m0, s35, 0
v_mfma_f32_16x16x32_bf16 v[168:171], a[28:31], a[60:63], v[168:171]
buffer_load_dwordx4 v20, s[40:43], s31 offen offset:0 lds
v_mfma_f32_16x16x32_bf16 v[172:175], a[28:31], a[64:67], v[172:175]
s_waitcnt lgkmcnt(4)
v_mfma_f32_16x16x32_bf16 v[176:179], a[32:35], a[52:55], v[176:179]
ds_read_b64_tr_b16 a[48:49], v14 offset:32768
ds_read_b64_tr_b16 a[50:51], v14 offset:33792
v_mfma_f32_16x16x32_bf16 v[180:183], a[32:35], a[56:59], v[180:183]
v_mfma_f32_16x16x32_bf16 v[184:187], a[32:35], a[60:63], v[184:187]
buffer_load_dwordx4 v21, s[40:43], s31 offen offset:1024 lds
v_mfma_f32_16x16x32_bf16 v[188:191], a[32:35], a[64:67], v[188:191]
ds_read_b64_tr_b16 a[120:121], v24
ds_read_b64_tr_b16 a[122:123], v25
v_mfma_f32_16x16x32_bf16 v[192:195], a[36:39], a[52:55], v[192:195]
ds_read_b64_tr_b16 a[0:1], v6 offset:30720
ds_read_b64_tr_b16 a[2:3], v6 offset:30976
v_mfma_f32_16x16x32_bf16 v[196:199], a[36:39], a[56:59], v[196:199]
v_mfma_f32_16x16x32_bf16 v[200:203], a[36:39], a[60:63], v[200:203]
buffer_load_dwordx4 v22, s[40:43], s31 offen offset:2048 lds
v_mfma_f32_16x16x32_bf16 v[204:207], a[36:39], a[64:67], v[204:207]
ds_read_b64_tr_b16 a[124:125], v26
ds_read_b64_tr_b16 a[126:127], v27
s_waitcnt lgkmcnt(8)
v_mfma_f32_16x16x32_bf16 v[208:211], a[40:43], a[52:55], v[208:211]
ds_read_b64_tr_b16 a[4:5], v7 offset:30720
ds_read_b64_tr_b16 a[6:7], v7 offset:30976
v_mfma_f32_16x16x32_bf16 v[212:215], a[40:43], a[56:59], v[212:215]
v_mfma_f32_16x16x32_bf16 v[216:219], a[40:43], a[60:63], v[216:219]
buffer_load_dwordx4 v23, s[40:43], s31 offen offset:3072 lds
v_mfma_f32_16x16x32_bf16 v[220:223], a[40:43], a[64:67], v[220:223]
v_add_u32 v24, s73, v24
v_add_u32 v25, s73, v25
v_mfma_f32_16x16x32_bf16 v[224:227], a[44:47], a[52:55], v[224:227]
ds_read_b64_tr_b16 a[8:9], v6 offset:31744
ds_read_b64_tr_b16 a[10:11], v6 offset:32000
v_mfma_f32_16x16x32_bf16 v[228:231], a[44:47], a[56:59], v[228:231]
s_add_u32 m0, s35, 4096
v_add_u32 v26, s73, v26
v_mfma_f32_16x16x32_bf16 v[232:235], a[44:47], a[60:63], v[232:235]
buffer_load_dwordx4 v20, s[40:43], s34 offen offset:0 lds
v_mfma_f32_16x16x32_bf16 v[236:239], a[44:47], a[64:67], v[236:239]
v_add_u32 v27, s73, v27
s_waitcnt lgkmcnt(6)
v_mfma_f32_16x16x32_bf16 v[240:243], a[48:51], a[52:55], v[240:243]
ds_read_b64_tr_b16 a[12:13], v7 offset:31744
ds_read_b64_tr_b16 a[14:15], v7 offset:32000
v_mfma_f32_16x16x32_bf16 v[244:247], a[48:51], a[56:59], v[244:247]
v_mfma_f32_16x16x32_bf16 v[248:251], a[48:51], a[60:63], v[248:251]
buffer_load_dwordx4 v21, s[40:43], s34 offen offset:1024 lds
v_mfma_f32_16x16x32_bf16 v[252:255], a[48:51], a[64:67], v[252:255]
v_mfma_f32_16x16x32_bf16 v[48:51], a[0:3], a[68:71], v[48:51]
ds_read_b64_tr_b16 a[16:17], v6 offset:32768
ds_read_b64_tr_b16 a[18:19], v6 offset:33024
v_mfma_f32_16x16x32_bf16 v[52:55], a[0:3], a[72:75], v[52:55]
v_mfma_f32_16x16x32_bf16 v[56:59], a[0:3], a[76:79], v[56:59]
buffer_load_dwordx4 v22, s[40:43], s34 offen offset:2048 lds
v_mfma_f32_16x16x32_bf16 v[60:63], a[0:3], a[80:83], v[60:63]
s_waitcnt lgkmcnt(4)
v_mfma_f32_16x16x32_bf16 v[64:67], a[4:7], a[68:71], v[64:67]
ds_read_b64_tr_b16 a[20:21], v7 offset:32768
ds_read_b64_tr_b16 a[22:23], v7 offset:33024
v_mfma_f32_16x16x32_bf16 v[68:71], a[4:7], a[72:75], v[68:71]
v_mfma_f32_16x16x32_bf16 v[72:75], a[4:7], a[76:79], v[72:75]
buffer_load_dwordx4 v23, s[40:43], s34 offen offset:3072 lds
v_mfma_f32_16x16x32_bf16 v[76:79], a[4:7], a[80:83], v[76:79]
s_add_u32 s31, s31, 128
s_add_u32 s34, s31, 65536
v_mfma_f32_16x16x32_bf16 a[116:119], a[120:123], a[128:131], a[116:119]
v_mfma_f32_16x16x32_bf16 v[80:83], a[8:11], a[68:71], v[80:83]
ds_read_b64_tr_b16 a[24:25], v8 offset:40960
ds_read_b64_tr_b16 a[26:27], v8 offset:41984
v_mfma_f32_16x16x32_bf16 v[84:87], a[8:11], a[72:75], v[84:87]
s_add_u32 m0, s59, 86016
v_mfma_f32_16x16x32_bf16 v[88:91], a[8:11], a[76:79], v[88:91]
buffer_load_dword v39, v43, s[8:11], s36 offen
v_mfma_f32_16x16x32_bf16 v[92:95], a[8:11], a[80:83], v[92:95]
v_mfma_f32_16x16x32_bf16 a[116:119], a[124:127], a[128:131], a[116:119]
s_waitcnt lgkmcnt(4)
v_mfma_f32_16x16x32_bf16 v[96:99], a[12:15], a[68:71], v[96:99]
ds_read_b64_tr_b16 a[28:29], v9 offset:40960
ds_read_b64_tr_b16 a[30:31], v9 offset:41984
v_mfma_f32_16x16x32_bf16 v[100:103], a[12:15], a[72:75], v[100:103]
v_mfma_f32_16x16x32_bf16 v[104:107], a[12:15], a[76:79], v[104:107]
buffer_load_dword v39, v44, s[20:23], s37 offen
v_mfma_f32_16x16x32_bf16 v[108:111], a[12:15], a[80:83], v[108:111]
s_add_u32 s36, s36, 393216
s_add_u32 s37, s37, 458752
v_mfma_f32_16x16x32_bf16 v[112:115], a[16:19], a[68:71], v[112:115]
ds_read_b64_tr_b16 a[32:33], v10 offset:40960
ds_read_b64_tr_b16 a[34:35], v10 offset:41984
v_mfma_f32_16x16x32_bf16 v[116:119], a[16:19], a[72:75], v[116:119]
v_mfma_f32_16x16x32_bf16 v[120:123], a[16:19], a[76:79], v[120:123]
buffer_load_dwordx4 v45, s[44:47], s59 offen lds
v_mfma_f32_16x16x32_bf16 v[124:127], a[16:19], a[80:83], v[124:127]
s_waitcnt lgkmcnt(4)
v_mfma_f32_16x16x32_bf16 v[128:131], a[20:23], a[68:71], v[128:131]
ds_read_b64_tr_b16 a[36:37], v11 offset:40960
ds_read_b64_tr_b16 a[38:39], v11 offset:41984
v_mfma_f32_16x16x32_bf16 v[132:135], a[20:23], a[72:75], v[132:135]
v_mfma_f32_16x16x32_bf16 v[136:139], a[20:23], a[76:79], v[136:139]
v_mfma_f32_16x16x32_bf16 v[140:143], a[20:23], a[80:83], v[140:143]
v_mfma_f32_16x16x32_bf16 v[144:147], a[24:27], a[68:71], v[144:147]
ds_read_b64_tr_b16 a[40:41], v12 offset:40960
ds_read_b64_tr_b16 a[42:43], v12 offset:41984
v_mfma_f32_16x16x32_bf16 v[148:151], a[24:27], a[72:75], v[148:151]
v_mfma_f32_16x16x32_bf16 v[152:155], a[24:27], a[76:79], v[152:155]
v_mfma_f32_16x16x32_bf16 v[156:159], a[24:27], a[80:83], v[156:159]
s_waitcnt lgkmcnt(4)
v_mfma_f32_16x16x32_bf16 v[160:163], a[28:31], a[68:71], v[160:163]
ds_read_b64_tr_b16 a[44:45], v13 offset:40960
ds_read_b64_tr_b16 a[46:47], v13 offset:41984
v_mfma_f32_16x16x32_bf16 v[164:167], a[28:31], a[72:75], v[164:167]
v_mfma_f32_16x16x32_bf16 v[168:171], a[28:31], a[76:79], v[168:171]
v_mfma_f32_16x16x32_bf16 v[172:175], a[28:31], a[80:83], v[172:175]
v_mfma_f32_16x16x32_bf16 v[176:179], a[32:35], a[68:71], v[176:179]
ds_read_b64_tr_b16 a[48:49], v14 offset:40960
ds_read_b64_tr_b16 a[50:51], v14 offset:41984
v_mfma_f32_16x16x32_bf16 v[180:183], a[32:35], a[72:75], v[180:183]
v_mfma_f32_16x16x32_bf16 v[184:187], a[32:35], a[76:79], v[184:187]
v_mfma_f32_16x16x32_bf16 v[188:191], a[32:35], a[80:83], v[188:191]
s_waitcnt vmcnt(18)
s_barrier
s_waitcnt lgkmcnt(4)
v_mfma_f32_16x16x32_bf16 v[192:195], a[36:39], a[68:71], v[192:195]
ds_read_b64_tr_b16 a[0:1], v6 offset:0
ds_read_b64_tr_b16 a[2:3], v6 offset:256
v_mfma_f32_16x16x32_bf16 v[196:199], a[36:39], a[72:75], v[196:199]
ds_read_b128 a[84:87], v36 offset:32768
v_mfma_f32_16x16x32_bf16 v[200:203], a[36:39], a[76:79], v[200:203]
v_mfma_f32_16x16x32_bf16 v[204:207], a[36:39], a[80:83], v[204:207]
ds_read_b128 a[88:91], v36 offset:34816
v_mfma_f32_16x16x32_bf16 v[208:211], a[40:43], a[68:71], v[208:211]
ds_read_b64_tr_b16 a[4:5], v7 offset:0
ds_read_b64_tr_b16 a[6:7], v7 offset:256
v_mfma_f32_16x16x32_bf16 v[212:215], a[40:43], a[72:75], v[212:215]
ds_read_b128 a[92:95], v36 offset:36864
v_mfma_f32_16x16x32_bf16 v[216:219], a[40:43], a[76:79], v[216:219]
v_mfma_f32_16x16x32_bf16 v[220:223], a[40:43], a[80:83], v[220:223]
ds_read_b128 a[96:99], v36 offset:38912
s_waitcnt lgkmcnt(8)
v_mfma_f32_16x16x32_bf16 v[224:227], a[44:47], a[68:71], v[224:227]
ds_read_b64_tr_b16 a[8:9], v6 offset:1024
ds_read_b64_tr_b16 a[10:11], v6 offset:1280
v_mfma_f32_16x16x32_bf16 v[228:231], a[44:47], a[72:75], v[228:231]
ds_read_b128 a[100:103], v37 offset:32768
v_mfma_f32_16x16x32_bf16 v[232:235], a[44:47], a[76:79], v[232:235]
v_mfma_f32_16x16x32_bf16 v[236:239], a[44:47], a[80:83], v[236:239]
v_mfma_f32_16x16x32_bf16 v[240:243], a[48:51], a[68:71], v[240:243]
ds_read_b64_tr_b16 a[12:13], v7 offset:1024
ds_read_b64_tr_b16 a[14:15], v7 offset:1280
v_mfma_f32_16x16x32_bf16 v[244:247], a[48:51], a[72:75], v[244:247]
ds_read_b128 a[104:107], v37 offset:34816
v_mfma_f32_16x16x32_bf16 v[248:251], a[48:51], a[76:79], v[248:251]
v_mfma_f32_16x16x32_bf16 v[252:255], a[48:51], a[80:83], v[252:255]
s_waitcnt lgkmcnt(6)
v_mfma_f32_16x16x32_bf16 v[48:51], a[0:3], a[84:87], v[48:51]
ds_read_b64_tr_b16 a[16:17], v6 offset:2048
ds_read_b64_tr_b16 a[18:19], v6 offset:2304
v_mfma_f32_16x16x32_bf16 v[52:55], a[0:3], a[88:91], v[52:55]
ds_read_b128 a[108:111], v37 offset:36864
s_add_u32 m0, s32, 24576
v_mfma_f32_16x16x32_bf16 v[56:59], a[0:3], a[92:95], v[56:59]
buffer_load_dwordx4 v15, s[8:11], s29 offen offset:0 lds
v_mfma_f32_16x16x32_bf16 v[60:63], a[0:3], a[96:99], v[60:63]
v_mfma_f32_16x16x32_bf16 v[64:67], a[4:7], a[84:87], v[64:67]
ds_read_b64_tr_b16 a[20:21], v7 offset:2048
ds_read_b64_tr_b16 a[22:23], v7 offset:2304
v_mfma_f32_16x16x32_bf16 v[68:71], a[4:7], a[88:91], v[68:71]
ds_read_b128 a[112:115], v37 offset:38912
v_mfma_f32_16x16x32_bf16 v[72:75], a[4:7], a[92:95], v[72:75]
buffer_load_dwordx4 v28, s[8:11], s29 offen offset:1024 lds
v_mfma_f32_16x16x32_bf16 v[76:79], a[4:7], a[96:99], v[76:79]
s_waitcnt lgkmcnt(7)
v_mfma_f32_16x16x32_bf16 v[80:83], a[8:11], a[84:87], v[80:83]
ds_read_b64_tr_b16 a[24:25], v8 offset:0
ds_read_b64_tr_b16 a[26:27], v8 offset:1024
v_mfma_f32_16x16x32_bf16 v[84:87], a[8:11], a[88:91], v[84:87]
v_lshlrev_b32 v2, 16, v46
v_and_b32 v3, 0xffff0000, v46
v_mfma_f32_16x16x32_bf16 v[88:91], a[8:11], a[92:95], v[88:91]
buffer_load_dwordx4 v29, s[8:11], s29 offen offset:2048 lds
v_mfma_f32_16x16x32_bf16 v[92:95], a[8:11], a[96:99], v[92:95]
s_add_u32 s29, s29, 393216
v_lshlrev_b32 v4, 16, v47
v_mfma_f32_16x16x32_bf16 v[96:99], a[12:15], a[84:87], v[96:99]
ds_read_b64_tr_b16 a[28:29], v9 offset:0
ds_read_b64_tr_b16 a[30:31], v9 offset:1024
v_mfma_f32_16x16x32_bf16 v[100:103], a[12:15], a[88:91], v[100:103]
s_add_u32 m0, s33, 32768
v_and_b32 v5, 0xffff0000, v47
v_mfma_f32_16x16x32_bf16 v[104:107], a[12:15], a[92:95], v[104:107]
buffer_load_dwordx4 v16, s[20:23], s30 offen offset:0 lds
v_mfma_f32_16x16x32_bf16 v[108:111], a[12:15], a[96:99], v[108:111]
v_lshlrev_b32 v45, 4, v1
v_add_u32 v45, 88064, v45
s_waitcnt lgkmcnt(5)
v_mfma_f32_16x16x32_bf16 v[112:115], a[16:19], a[84:87], v[112:115]
ds_read_b64_tr_b16 a[32:33], v10 offset:0
ds_read_b64_tr_b16 a[34:35], v10 offset:1024
v_mfma_f32_16x16x32_bf16 v[116:119], a[16:19], a[88:91], v[116:119]
ds_write_b128 v45, v[2:5]
v_mfma_f32_16x16x32_bf16 v[120:123], a[16:19], a[92:95], v[120:123]
buffer_load_dwordx4 v17, s[20:23], s30 offen offset:1024 lds
v_mfma_f32_16x16x32_bf16 v[124:127], a[16:19], a[96:99], v[124:127]
v_mfma_f32_16x16x32_bf16 v[128:131], a[20:23], a[84:87], v[128:131]
ds_read_b64_tr_b16 a[36:37], v11 offset:0
ds_read_b64_tr_b16 a[38:39], v11 offset:1024
v_mfma_f32_16x16x32_bf16 v[132:135], a[20:23], a[88:91], v[132:135]
v_mfma_f32_16x16x32_bf16 v[136:139], a[20:23], a[92:95], v[136:139]
buffer_load_dwordx4 v18, s[20:23], s30 offen offset:2048 lds
v_mfma_f32_16x16x32_bf16 v[140:143], a[20:23], a[96:99], v[140:143]
s_waitcnt lgkmcnt(5)
v_mfma_f32_16x16x32_bf16 v[144:147], a[24:27], a[84:87], v[144:147]
ds_read_b64_tr_b16 a[40:41], v12 offset:0
ds_read_b64_tr_b16 a[42:43], v12 offset:1024
v_mfma_f32_16x16x32_bf16 v[148:151], a[24:27], a[88:91], v[148:151]
v_mfma_f32_16x16x32_bf16 v[152:155], a[24:27], a[92:95], v[152:155]
buffer_load_dwordx4 v19, s[20:23], s30 offen offset:3072 lds
v_mfma_f32_16x16x32_bf16 v[156:159], a[24:27], a[96:99], v[156:159]
s_add_u32 s30, s30, 458752
v_mfma_f32_16x16x32_bf16 v[160:163], a[28:31], a[84:87], v[160:163]
ds_read_b64_tr_b16 a[44:45], v13 offset:0
ds_read_b64_tr_b16 a[46:47], v13 offset:1024
v_mfma_f32_16x16x32_bf16 v[164:167], a[28:31], a[88:91], v[164:167]
s_add_u32 m0, s35, 32768
v_mfma_f32_16x16x32_bf16 v[168:171], a[28:31], a[92:95], v[168:171]
buffer_load_dwordx4 v20, s[40:43], s31 offen offset:0 lds
v_mfma_f32_16x16x32_bf16 v[172:175], a[28:31], a[96:99], v[172:175]
s_waitcnt lgkmcnt(4)
v_mfma_f32_16x16x32_bf16 v[176:179], a[32:35], a[84:87], v[176:179]
ds_read_b64_tr_b16 a[48:49], v14 offset:0
ds_read_b64_tr_b16 a[50:51], v14 offset:1024
v_mfma_f32_16x16x32_bf16 v[180:183], a[32:35], a[88:91], v[180:183]
v_mfma_f32_16x16x32_bf16 v[184:187], a[32:35], a[92:95], v[184:187]
buffer_load_dwordx4 v21, s[40:43], s31 offen offset:1024 lds
v_mfma_f32_16x16x32_bf16 v[188:191], a[32:35], a[96:99], v[188:191]
ds_read_b64_tr_b16 a[120:121], v24
ds_read_b64_tr_b16 a[122:123], v25
v_mfma_f32_16x16x32_bf16 v[192:195], a[36:39], a[84:87], v[192:195]
ds_read_b64_tr_b16 a[0:1], v6 offset:6144
ds_read_b64_tr_b16 a[2:3], v6 offset:6400
v_mfma_f32_16x16x32_bf16 v[196:199], a[36:39], a[88:91], v[196:199]
v_mfma_f32_16x16x32_bf16 v[200:203], a[36:39], a[92:95], v[200:203]
buffer_load_dwordx4 v22, s[40:43], s31 offen offset:2048 lds
v_mfma_f32_16x16x32_bf16 v[204:207], a[36:39], a[96:99], v[204:207]
ds_read_b64_tr_b16 a[124:125], v26
ds_read_b64_tr_b16 a[126:127], v27
s_waitcnt lgkmcnt(8)
v_mfma_f32_16x16x32_bf16 v[208:211], a[40:43], a[84:87], v[208:211]
ds_read_b64_tr_b16 a[4:5], v7 offset:6144
ds_read_b64_tr_b16 a[6:7], v7 offset:6400
v_mfma_f32_16x16x32_bf16 v[212:215], a[40:43], a[88:91], v[212:215]
v_mfma_f32_16x16x32_bf16 v[216:219], a[40:43], a[92:95], v[216:219]
buffer_load_dwordx4 v23, s[40:43], s31 offen offset:3072 lds
v_mfma_f32_16x16x32_bf16 v[220:223], a[40:43], a[96:99], v[220:223]
v_add_u32 v24, s72, v24
v_add_u32 v25, s72, v25
v_mfma_f32_16x16x32_bf16 v[224:227], a[44:47], a[84:87], v[224:227]
ds_read_b64_tr_b16 a[8:9], v6 offset:7168
ds_read_b64_tr_b16 a[10:11], v6 offset:7424
v_mfma_f32_16x16x32_bf16 v[228:231], a[44:47], a[88:91], v[228:231]
s_add_u32 m0, s35, 36864
v_add_u32 v26, s72, v26
v_mfma_f32_16x16x32_bf16 v[232:235], a[44:47], a[92:95], v[232:235]
buffer_load_dwordx4 v20, s[40:43], s34 offen offset:0 lds
v_mfma_f32_16x16x32_bf16 v[236:239], a[44:47], a[96:99], v[236:239]
v_add_u32 v27, s72, v27
s_waitcnt lgkmcnt(6)
v_mfma_f32_16x16x32_bf16 v[240:243], a[48:51], a[84:87], v[240:243]
ds_read_b64_tr_b16 a[12:13], v7 offset:7168
ds_read_b64_tr_b16 a[14:15], v7 offset:7424
v_mfma_f32_16x16x32_bf16 v[244:247], a[48:51], a[88:91], v[244:247]
v_mfma_f32_16x16x32_bf16 v[248:251], a[48:51], a[92:95], v[248:251]
buffer_load_dwordx4 v21, s[40:43], s34 offen offset:1024 lds
v_mfma_f32_16x16x32_bf16 v[252:255], a[48:51], a[96:99], v[252:255]
v_mfma_f32_16x16x32_bf16 v[48:51], a[0:3], a[100:103], v[48:51]
ds_read_b64_tr_b16 a[16:17], v6 offset:8192
ds_read_b64_tr_b16 a[18:19], v6 offset:8448
v_mfma_f32_16x16x32_bf16 v[52:55], a[0:3], a[104:107], v[52:55]
v_mfma_f32_16x16x32_bf16 v[56:59], a[0:3], a[108:111], v[56:59]
buffer_load_dwordx4 v22, s[40:43], s34 offen offset:2048 lds
v_mfma_f32_16x16x32_bf16 v[60:63], a[0:3], a[112:115], v[60:63]
s_waitcnt lgkmcnt(4)
v_mfma_f32_16x16x32_bf16 v[64:67], a[4:7], a[100:103], v[64:67]
ds_read_b64_tr_b16 a[20:21], v7 offset:8192
ds_read_b64_tr_b16 a[22:23], v7 offset:8448
v_mfma_f32_16x16x32_bf16 v[68:71], a[4:7], a[104:107], v[68:71]
v_mfma_f32_16x16x32_bf16 v[72:75], a[4:7], a[108:111], v[72:75]
buffer_load_dwordx4 v23, s[40:43], s34 offen offset:3072 lds
v_mfma_f32_16x16x32_bf16 v[76:79], a[4:7], a[112:115], v[76:79]
s_add_u32 s31, s31, 128
s_add_u32 s34, s31, 65536
v_mfma_f32_16x16x32_bf16 a[116:119], a[120:123], a[128:131], a[116:119]
v_mfma_f32_16x16x32_bf16 v[80:83], a[8:11], a[100:103], v[80:83]
ds_read_b64_tr_b16 a[24:25], v8 offset:8192
ds_read_b64_tr_b16 a[26:27], v8 offset:9216
v_mfma_f32_16x16x32_bf16 v[84:87], a[8:11], a[104:107], v[84:87]
v_mfma_f32_16x16x32_bf16 v[88:91], a[8:11], a[108:111], v[88:91]
buffer_load_dword v39, v43, s[8:11], s36 offen
v_mfma_f32_16x16x32_bf16 v[92:95], a[8:11], a[112:115], v[92:95]
v_mfma_f32_16x16x32_bf16 a[116:119], a[124:127], a[128:131], a[116:119]
s_waitcnt lgkmcnt(4)
v_mfma_f32_16x16x32_bf16 v[96:99], a[12:15], a[100:103], v[96:99]
ds_read_b64_tr_b16 a[28:29], v9 offset:8192
ds_read_b64_tr_b16 a[30:31], v9 offset:9216
v_mfma_f32_16x16x32_bf16 v[100:103], a[12:15], a[104:107], v[100:103]
v_mfma_f32_16x16x32_bf16 v[104:107], a[12:15], a[108:111], v[104:107]
buffer_load_dword v39, v44, s[20:23], s37 offen
v_mfma_f32_16x16x32_bf16 v[108:111], a[12:15], a[112:115], v[108:111]
s_add_u32 s36, s36, s56
s_add_u32 s37, s37, s57
v_mfma_f32_16x16x32_bf16 v[112:115], a[16:19], a[100:103], v[112:115]
ds_read_b64_tr_b16 a[32:33], v10 offset:8192
ds_read_b64_tr_b16 a[34:35], v10 offset:9216
v_mfma_f32_16x16x32_bf16 v[116:119], a[16:19], a[104:107], v[116:119]
v_mfma_f32_16x16x32_bf16 v[120:123], a[16:19], a[108:111], v[120:123]
v_mfma_f32_16x16x32_bf16 v[124:127], a[16:19], a[112:115], v[124:127]
s_waitcnt lgkmcnt(4)
v_mfma_f32_16x16x32_bf16 v[128:131], a[20:23], a[100:103], v[128:131]
ds_read_b64_tr_b16 a[36:37], v11 offset:8192
ds_read_b64_tr_b16 a[38:39], v11 offset:9216
v_mfma_f32_16x16x32_bf16 v[132:135], a[20:23], a[104:107], v[132:135]
v_mfma_f32_16x16x32_bf16 v[136:139], a[20:23], a[108:111], v[136:139]
v_mfma_f32_16x16x32_bf16 v[140:143], a[20:23], a[112:115], v[140:143]
v_mfma_f32_16x16x32_bf16 v[144:147], a[24:27], a[100:103], v[144:147]
ds_read_b64_tr_b16 a[40:41], v12 offset:8192
ds_read_b64_tr_b16 a[42:43], v12 offset:9216
v_mfma_f32_16x16x32_bf16 v[148:151], a[24:27], a[104:107], v[148:151]
v_mfma_f32_16x16x32_bf16 v[152:155], a[24:27], a[108:111], v[152:155]
v_mfma_f32_16x16x32_bf16 v[156:159], a[24:27], a[112:115], v[156:159]
s_waitcnt lgkmcnt(4)
v_mfma_f32_16x16x32_bf16 v[160:163], a[28:31], a[100:103], v[160:163]
ds_read_b64_tr_b16 a[44:45], v13 offset:8192
ds_read_b64_tr_b16 a[46:47], v13 offset:9216
v_mfma_f32_16x16x32_bf16 v[164:167], a[28:31], a[104:107], v[164:167]
v_mfma_f32_16x16x32_bf16 v[168:171], a[28:31], a[108:111], v[168:171]
v_mfma_f32_16x16x32_bf16 v[172:175], a[28:31], a[112:115], v[172:175]
v_mfma_f32_16x16x32_bf16 v[176:179], a[32:35], a[100:103], v[176:179]
ds_read_b64_tr_b16 a[48:49], v14 offset:8192
ds_read_b64_tr_b16 a[50:51], v14 offset:9216
v_mfma_f32_16x16x32_bf16 v[180:183], a[32:35], a[104:107], v[180:183]
v_mfma_f32_16x16x32_bf16 v[184:187], a[32:35], a[108:111], v[184:187]
v_mfma_f32_16x16x32_bf16 v[188:191], a[32:35], a[112:115], v[188:191]
s_waitcnt vmcnt(17)
s_barrier
s_waitcnt lgkmcnt(4)
v_mfma_f32_16x16x32_bf16 v[192:195], a[36:39], a[100:103], v[192:195]
ds_read_b64_tr_b16 a[0:1], v6 offset:12288
ds_read_b64_tr_b16 a[2:3], v6 offset:12544
v_mfma_f32_16x16x32_bf16 v[196:199], a[36:39], a[104:107], v[196:199]
ds_read_b128 a[52:55], v36 offset:0
v_mfma_f32_16x16x32_bf16 v[200:203], a[36:39], a[108:111], v[200:203]
v_mfma_f32_16x16x32_bf16 v[204:207], a[36:39], a[112:115], v[204:207]
ds_read_b128 a[56:59], v36 offset:2048
v_mfma_f32_16x16x32_bf16 v[208:211], a[40:43], a[100:103], v[208:211]
ds_read_b64_tr_b16 a[4:5], v7 offset:12288
ds_read_b64_tr_b16 a[6:7], v7 offset:12544
v_mfma_f32_16x16x32_bf16 v[212:215], a[40:43], a[104:107], v[212:215]
ds_read_b128 a[60:63], v36 offset:4096
v_mfma_f32_16x16x32_bf16 v[216:219], a[40:43], a[108:111], v[216:219]
v_mfma_f32_16x16x32_bf16 v[220:223], a[40:43], a[112:115], v[220:223]
ds_read_b128 a[64:67], v36 offset:6144
s_waitcnt lgkmcnt(8)
v_mfma_f32_16x16x32_bf16 v[224:227], a[44:47], a[100:103], v[224:227]
ds_read_b64_tr_b16 a[8:9], v6 offset:13312
ds_read_b64_tr_b16 a[10:11], v6 offset:13568
v_mfma_f32_16x16x32_bf16 v[228:231], a[44:47], a[104:107], v[228:231]
ds_read_b128 a[68:71], v37 offset:0
v_mfma_f32_16x16x32_bf16 v[232:235], a[44:47], a[108:111], v[232:235]
v_mfma_f32_16x16x32_bf16 v[236:239], a[44:47], a[112:115], v[236:239]
v_mfma_f32_16x16x32_bf16 v[240:243], a[48:51], a[100:103], v[240:243]
ds_read_b64_tr_b16 a[12:13], v7 offset:13312
ds_read_b64_tr_b16 a[14:15], v7 offset:13568
v_mfma_f32_16x16x32_bf16 v[244:247], a[48:51], a[104:107], v[244:247]
ds_read_b128 a[72:75], v37 offset:2048
v_mfma_f32_16x16x32_bf16 v[248:251], a[48:51], a[108:111], v[248:251]
v_mfma_f32_16x16x32_bf16 v[252:255], a[48:51], a[112:115], v[252:255]
s_waitcnt lgkmcnt(6)
v_mfma_f32_16x16x32_bf16 v[48:51], a[0:3], a[52:55], v[48:51]
ds_read_b64_tr_b16 a[16:17], v6 offset:14336
ds_read_b64_tr_b16 a[18:19], v6 offset:14592
v_mfma_f32_16x16x32_bf16 v[52:55], a[0:3], a[56:59], v[52:55]
ds_read_b128 a[76:79], v37 offset:4096
s_add_u32 m0, s32, 0
v_mfma_f32_16x16x32_bf16 v[56:59], a[0:3], a[60:63], v[56:59]
buffer_load_dwordx4 v15, s[8:11], s29 offen offset:0 lds
v_mfma_f32_16x16x32_bf16 v[60:63], a[0:3], a[64:67], v[60:63]
v_mfma_f32_16x16x32_bf16 v[64:67], a[4:7], a[52:55], v[64:67]
ds_read_b64_tr_b16 a[20:21], v7 offset:14336
ds_read_b64_tr_b16 a[22:23], v7 offset:14592
v_mfma_f32_16x16x32_bf16 v[68:71], a[4:7], a[56:59], v[68:71]
ds_read_b128 a[80:83], v37 offset:6144
v_mfma_f32_16x16x32_bf16 v[72:75], a[4:7], a[60:63], v[72:75]
buffer_load_dwordx4 v28, s[8:11], s29 offen offset:1024 lds
v_mfma_f32_16x16x32_bf16 v[76:79], a[4:7], a[64:67], v[76:79]
s_waitcnt lgkmcnt(7)
v_mfma_f32_16x16x32_bf16 v[80:83], a[8:11], a[52:55], v[80:83]
ds_read_b64_tr_b16 a[24:25], v8 offset:16384
ds_read_b64_tr_b16 a[26:27], v8 offset:17408
v_mfma_f32_16x16x32_bf16 v[84:87], a[8:11], a[56:59], v[84:87]
v_lshrrev_b32 v2, 4, v1
v_bfe_u32 v3, v1, 2, 2
v_mfma_f32_16x16x32_bf16 v[88:91], a[8:11], a[60:63], v[88:91]
buffer_load_dwordx4 v29, s[8:11], s29 offen offset:2048 lds
v_mfma_f32_16x16x32_bf16 v[92:95], a[8:11], a[64:67], v[92:95]
s_add_u32 s29, s29, 393216
v_and_b32 v4, 3, v1
v_mfma_f32_16x16x32_bf16 v[96:99], a[12:15], a[52:55], v[96:99]
ds_read_b64_tr_b16 a[28:29], v9 offset:16384
ds_read_b64_tr_b16 a[30:31], v9 offset:17408
v_mfma_f32_16x16x32_bf16 v[100:103], a[12:15], a[56:59], v[100:103]
s_add_u32 m0, s33, 0
v_lshl_add_u32 v5, v2, 2, v3
v_mfma_f32_16x16x32_bf16 v[104:107], a[12:15], a[60:63], v[104:107]
buffer_load_dwordx4 v16, s[20:23], s30 offen offset:0 lds
v_mfma_f32_16x16x32_bf16 v[108:111], a[12:15], a[64:67], v[108:111]
v_lshlrev_b32 v45, 6, v5
v_lshl_add_u32 v45, v4, 3, v45
s_waitcnt lgkmcnt(5)
v_mfma_f32_16x16x32_bf16 v[112:115], a[16:19], a[52:55], v[112:115]
ds_read_b64_tr_b16 a[32:33], v10 offset:16384
ds_read_b64_tr_b16 a[34:35], v10 offset:17408
v_mfma_f32_16x16x32_bf16 v[116:119], a[16:19], a[56:59], v[116:119]
v_add_u32 v45, 86016, v45
ds_read_b64_tr_b16 a[184:185], v45 offset:0
v_mfma_f32_16x16x32_bf16 v[120:123], a[16:19], a[60:63], v[120:123]
buffer_load_dwordx4 v17, s[20:23], s30 offen offset:1024 lds
v_mfma_f32_16x16x32_bf16 v[124:127], a[16:19], a[64:67], v[124:127]
ds_read_b64_tr_b16 a[186:187], v45 offset:1024
ds_read_b64_tr_b16 a[188:189], v45 offset:32
v_mfma_f32_16x16x32_bf16 v[128:131], a[20:23], a[52:55], v[128:131]
ds_read_b64_tr_b16 a[36:37], v11 offset:16384
ds_read_b64_tr_b16 a[38:39], v11 offset:17408
v_mfma_f32_16x16x32_bf16 v[132:135], a[20:23], a[56:59], v[132:135]
ds_read_b64_tr_b16 a[190:191], v45 offset:1056
v_mfma_f32_16x16x32_bf16 v[136:139], a[20:23], a[60:63], v[136:139]
buffer_load_dwordx4 v18, s[20:23], s30 offen offset:2048 lds
v_mfma_f32_16x16x32_bf16 v[140:143], a[20:23], a[64:67], v[140:143]
s_waitcnt lgkmcnt(8)
v_mfma_f32_16x16x32_bf16 v[144:147], a[24:27], a[52:55], v[144:147]
ds_read_b64_tr_b16 a[40:41], v12 offset:16384
ds_read_b64_tr_b16 a[42:43], v12 offset:17408
v_mfma_f32_16x16x32_bf16 v[148:151], a[24:27], a[56:59], v[148:151]
v_mfma_f32_16x16x32_bf16 v[152:155], a[24:27], a[60:63], v[152:155]
buffer_load_dwordx4 v19, s[20:23], s30 offen offset:3072 lds
v_mfma_f32_16x16x32_bf16 v[156:159], a[24:27], a[64:67], v[156:159]
s_add_u32 s30, s30, 458752
v_mfma_f32_16x16x32_bf16 v[160:163], a[28:31], a[52:55], v[160:163]
ds_read_b64_tr_b16 a[44:45], v13 offset:16384
ds_read_b64_tr_b16 a[46:47], v13 offset:17408
v_mfma_f32_16x16x32_bf16 v[164:167], a[28:31], a[56:59], v[164:167]
s_add_u32 m0, s35, 0
v_mfma_f32_16x16x32_bf16 v[168:171], a[28:31], a[60:63], v[168:171]
buffer_load_dwordx4 v20, s[40:43], s31 offen offset:0 lds
v_mfma_f32_16x16x32_bf16 v[172:175], a[28:31], a[64:67], v[172:175]
s_waitcnt lgkmcnt(5)
v_mfma_f32_16x16x32_bf16 v[176:179], a[32:35], a[52:55], v[176:179]
ds_read_b64_tr_b16 a[48:49], v14 offset:16384
ds_read_b64_tr_b16 a[50:51], v14 offset:17408
v_mfma_f32_16x16x32_bf16 v[180:183], a[32:35], a[56:59], v[180:183]
v_mfma_f32_16x16x32_bf16 v[184:187], a[32:35], a[60:63], v[184:187]
buffer_load_dwordx4 v21, s[40:43], s31 offen offset:1024 lds
v_mfma_f32_16x16x32_bf16 v[188:191], a[32:35], a[64:67], v[188:191]
ds_read_b64_tr_b16 a[120:121], v24
ds_read_b64_tr_b16 a[122:123], v25
v_mfma_f32_16x16x32_bf16 v[192:195], a[36:39], a[52:55], v[192:195]
ds_read_b64_tr_b16 a[0:1], v6 offset:18432
ds_read_b64_tr_b16 a[2:3], v6 offset:18688
v_mfma_f32_16x16x32_bf16 v[196:199], a[36:39], a[56:59], v[196:199]
v_mfma_f32_16x16x32_bf16 v[200:203], a[36:39], a[60:63], v[200:203]
buffer_load_dwordx4 v22, s[40:43], s31 offen offset:2048 lds
v_mfma_f32_16x16x32_bf16 v[204:207], a[36:39], a[64:67], v[204:207]
ds_read_b64_tr_b16 a[124:125], v26
ds_read_b64_tr_b16 a[126:127], v27
s_waitcnt lgkmcnt(8)
v_mfma_f32_16x16x32_bf16 v[208:211], a[40:43], a[52:55], v[208:211]
ds_read_b64_tr_b16 a[4:5], v7 offset:18432
ds_read_b64_tr_b16 a[6:7], v7 offset:18688
v_mfma_f32_16x16x32_bf16 v[212:215], a[40:43], a[56:59], v[212:215]
v_mfma_f32_16x16x32_bf16 v[216:219], a[40:43], a[60:63], v[216:219]
buffer_load_dwordx4 v23, s[40:43], s31 offen offset:3072 lds
v_mfma_f32_16x16x32_bf16 v[220:223], a[40:43], a[64:67], v[220:223]
v_add_u32 v24, s72, v24
v_add_u32 v25, s72, v25
v_mfma_f32_16x16x32_bf16 v[224:227], a[44:47], a[52:55], v[224:227]
ds_read_b64_tr_b16 a[8:9], v6 offset:19456
ds_read_b64_tr_b16 a[10:11], v6 offset:19712
v_mfma_f32_16x16x32_bf16 v[228:231], a[44:47], a[56:59], v[228:231]
s_add_u32 m0, s35, 4096
v_add_u32 v26, s72, v26
v_mfma_f32_16x16x32_bf16 v[232:235], a[44:47], a[60:63], v[232:235]
buffer_load_dwordx4 v20, s[40:43], s34 offen offset:0 lds
v_mfma_f32_16x16x32_bf16 v[236:239], a[44:47], a[64:67], v[236:239]
v_add_u32 v27, s72, v27
s_waitcnt lgkmcnt(6)
v_mfma_f32_16x16x32_bf16 v[240:243], a[48:51], a[52:55], v[240:243]
ds_read_b64_tr_b16 a[12:13], v7 offset:19456
ds_read_b64_tr_b16 a[14:15], v7 offset:19712
v_mfma_f32_16x16x32_bf16 v[244:247], a[48:51], a[56:59], v[244:247]
v_mfma_f32_16x16x32_bf16 v[248:251], a[48:51], a[60:63], v[248:251]
buffer_load_dwordx4 v21, s[40:43], s34 offen offset:1024 lds
v_mfma_f32_16x16x32_bf16 v[252:255], a[48:51], a[64:67], v[252:255]
v_mfma_f32_16x16x32_bf16 v[48:51], a[0:3], a[68:71], v[48:51]
ds_read_b64_tr_b16 a[16:17], v6 offset:20480
ds_read_b64_tr_b16 a[18:19], v6 offset:20736
v_mfma_f32_16x16x32_bf16 v[52:55], a[0:3], a[72:75], v[52:55]
v_mfma_f32_16x16x32_bf16 v[56:59], a[0:3], a[76:79], v[56:59]
buffer_load_dwordx4 v22, s[40:43], s34 offen offset:2048 lds
v_mfma_f32_16x16x32_bf16 v[60:63], a[0:3], a[80:83], v[60:63]
s_waitcnt lgkmcnt(4)
v_mfma_f32_16x16x32_bf16 v[64:67], a[4:7], a[68:71], v[64:67]
ds_read_b64_tr_b16 a[20:21], v7 offset:20480
ds_read_b64_tr_b16 a[22:23], v7 offset:20736
v_mfma_f32_16x16x32_bf16 v[68:71], a[4:7], a[72:75], v[68:71]
v_mfma_f32_16x16x32_bf16 v[72:75], a[4:7], a[76:79], v[72:75]
buffer_load_dwordx4 v23, s[40:43], s34 offen offset:3072 lds
v_mfma_f32_16x16x32_bf16 v[76:79], a[4:7], a[80:83], v[76:79]
s_add_u32 s31, s31, 128
s_add_u32 s34, s31, 65536
v_mfma_f32_16x16x32_bf16 a[116:119], a[120:123], a[128:131], a[116:119]
v_mfma_f32_16x16x32_bf16 v[80:83], a[8:11], a[68:71], v[80:83]
ds_read_b64_tr_b16 a[24:25], v8 offset:24576
ds_read_b64_tr_b16 a[26:27], v8 offset:25600
v_mfma_f32_16x16x32_bf16 v[84:87], a[8:11], a[72:75], v[84:87]
v_mfma_f32_16x16x32_bf16 v[88:91], a[8:11], a[76:79], v[88:91]
buffer_load_dword v39, v43, s[8:11], s36 offen
v_mfma_f32_16x16x32_bf16 v[92:95], a[8:11], a[80:83], v[92:95]
v_mfma_f32_16x16x32_bf16 a[116:119], a[124:127], a[128:131], a[116:119]
s_waitcnt lgkmcnt(4)
v_mfma_f32_16x16x32_bf16 v[96:99], a[12:15], a[68:71], v[96:99]
ds_read_b64_tr_b16 a[28:29], v9 offset:24576
ds_read_b64_tr_b16 a[30:31], v9 offset:25600
v_mfma_f32_16x16x32_bf16 v[100:103], a[12:15], a[72:75], v[100:103]
v_mfma_f32_16x16x32_bf16 v[104:107], a[12:15], a[76:79], v[104:107]
buffer_load_dword v39, v44, s[20:23], s37 offen
v_mfma_f32_16x16x32_bf16 v[108:111], a[12:15], a[80:83], v[108:111]
s_add_u32 s36, s36, 393216
s_add_u32 s37, s37, 458752
v_mfma_f32_16x16x32_bf16 v[112:115], a[16:19], a[68:71], v[112:115]
ds_read_b64_tr_b16 a[32:33], v10 offset:24576
ds_read_b64_tr_b16 a[34:35], v10 offset:25600
v_mfma_f32_16x16x32_bf16 v[116:119], a[16:19], a[72:75], v[116:119]
v_mfma_f32_16x16x32_bf16 v[120:123], a[16:19], a[76:79], v[120:123]
v_mfma_f32_16x16x32_bf16 v[124:127], a[16:19], a[80:83], v[124:127]
s_waitcnt lgkmcnt(4)
v_mfma_f32_16x16x32_bf16 v[128:131], a[20:23], a[68:71], v[128:131]
ds_read_b64_tr_b16 a[36:37], v11 offset:24576
ds_read_b64_tr_b16 a[38:39], v11 offset:25600
v_mfma_f32_16x16x32_bf16 v[132:135], a[20:23], a[72:75], v[132:135]
v_mfma_f32_16x16x32_bf16 v[136:139], a[20:23], a[76:79], v[136:139]
v_mfma_f32_16x16x32_bf16 v[140:143], a[20:23], a[80:83], v[140:143]
v_mfma_f32_16x16x32_bf16 v[144:147], a[24:27], a[68:71], v[144:147]
ds_read_b64_tr_b16 a[40:41], v12 offset:24576
ds_read_b64_tr_b16 a[42:43], v12 offset:25600
v_mfma_f32_16x16x32_bf16 v[148:151], a[24:27], a[72:75], v[148:151]
v_mfma_f32_16x16x32_bf16 v[152:155], a[24:27], a[76:79], v[152:155]
v_mfma_f32_16x16x32_bf16 v[156:159], a[24:27], a[80:83], v[156:159]
s_waitcnt lgkmcnt(4)
v_mfma_f32_16x16x32_bf16 v[160:163], a[28:31], a[68:71], v[160:163]
ds_read_b64_tr_b16 a[44:45], v13 offset:24576
ds_read_b64_tr_b16 a[46:47], v13 offset:25600
v_mfma_f32_16x16x32_bf16 v[164:167], a[28:31], a[72:75], v[164:167]
v_mfma_f32_16x16x32_bf16 v[168:171], a[28:31], a[76:79], v[168:171]
v_mfma_f32_16x16x32_bf16 v[172:175], a[28:31], a[80:83], v[172:175]
v_mfma_f32_16x16x32_bf16 v[176:179], a[32:35], a[68:71], v[176:179]
ds_read_b64_tr_b16 a[48:49], v14 offset:24576
ds_read_b64_tr_b16 a[50:51], v14 offset:25600
v_mfma_f32_16x16x32_bf16 v[180:183], a[32:35], a[72:75], v[180:183]
v_mfma_f32_16x16x32_bf16 v[184:187], a[32:35], a[76:79], v[184:187]
v_mfma_f32_16x16x32_bf16 v[188:191], a[32:35], a[80:83], v[188:191]
s_waitcnt vmcnt(19)
s_barrier
s_waitcnt lgkmcnt(4)
v_mfma_f32_16x16x32_bf16 v[192:195], a[36:39], a[68:71], v[192:195]
ds_read_b64_tr_b16 a[0:1], v6 offset:24576
ds_read_b64_tr_b16 a[2:3], v6 offset:24832
v_mfma_f32_16x16x32_bf16 v[196:199], a[36:39], a[72:75], v[196:199]
ds_read_b128 a[84:87], v36 offset:32768
v_mfma_f32_16x16x32_bf16 v[200:203], a[36:39], a[76:79], v[200:203]
v_mfma_f32_16x16x32_bf16 v[204:207], a[36:39], a[80:83], v[204:207]
ds_read_b128 a[88:91], v36 offset:34816
v_mfma_f32_16x16x32_bf16 v[208:211], a[40:43], a[68:71], v[208:211]
ds_read_b64_tr_b16 a[4:5], v7 offset:24576
ds_read_b64_tr_b16 a[6:7], v7 offset:24832
v_mfma_f32_16x16x32_bf16 v[212:215], a[40:43], a[72:75], v[212:215]
ds_read_b128 a[92:95], v36 offset:36864
v_mfma_f32_16x16x32_bf16 v[216:219], a[40:43], a[76:79], v[216:219]
v_mfma_f32_16x16x32_bf16 v[220:223], a[40:43], a[80:83], v[220:223]
ds_read_b128 a[96:99], v36 offset:38912
s_waitcnt lgkmcnt(8)
v_mfma_f32_16x16x32_bf16 v[224:227], a[44:47], a[68:71], v[224:227]
ds_read_b64_tr_b16 a[8:9], v6 offset:25600
ds_read_b64_tr_b16 a[10:11], v6 offset:25856
v_mfma_f32_16x16x32_bf16 v[228:231], a[44:47], a[72:75], v[228:231]
ds_read_b128 a[100:103], v37 offset:32768
v_mfma_f32_16x16x32_bf16 v[232:235], a[44:47], a[76:79], v[232:235]
v_mfma_f32_16x16x32_bf16 v[236:239], a[44:47], a[80:83], v[236:239]
v_mfma_f32_16x16x32_bf16 v[240:243], a[48:51], a[68:71], v[240:243]
ds_read_b64_tr_b16 a[12:13], v7 offset:25600
ds_read_b64_tr_b16 a[14:15], v7 offset:25856
v_mfma_f32_16x16x32_bf16 v[244:247], a[48:51], a[72:75], v[244:247]
ds_read_b128 a[104:107], v37 offset:34816
v_mfma_f32_16x16x32_bf16 v[248:251], a[48:51], a[76:79], v[248:251]
v_mfma_f32_16x16x32_bf16 v[252:255], a[48:51], a[80:83], v[252:255]
s_waitcnt lgkmcnt(6)
v_mfma_f32_16x16x32_bf16 v[48:51], a[0:3], a[84:87], v[48:51]
ds_read_b64_tr_b16 a[16:17], v6 offset:26624
ds_read_b64_tr_b16 a[18:19], v6 offset:26880
v_mfma_f32_16x16x32_bf16 v[52:55], a[0:3], a[88:91], v[52:55]
ds_read_b128 a[108:111], v37 offset:36864
s_add_u32 m0, s32, 12288
v_mfma_f32_16x16x32_bf16 v[56:59], a[0:3], a[92:95], v[56:59]
buffer_load_dwordx4 v15, s[8:11], s29 offen offset:0 lds
v_mfma_f32_16x16x32_bf16 v[60:63], a[0:3], a[96:99], v[60:63]
v_mfma_f32_16x16x32_bf16 v[64:67], a[4:7], a[84:87], v[64:67]
ds_read_b64_tr_b16 a[20:21], v7 offset:26624
ds_read_b64_tr_b16 a[22:23], v7 offset:26880
v_mfma_f32_16x16x32_bf16 v[68:71], a[4:7], a[88:91], v[68:71]
ds_read_b128 a[112:115], v37 offset:38912
v_mfma_f32_16x16x32_bf16 v[72:75], a[4:7], a[92:95], v[72:75]
buffer_load_dwordx4 v28, s[8:11], s29 offen offset:1024 lds
v_mfma_f32_16x16x32_bf16 v[76:79], a[4:7], a[96:99], v[76:79]
v_mfma_f32_16x16x32_bf16 a[148:151], a[128:131], a[132:135], 0
v_mfma_f32_16x16x32_bf16 a[156:159], a[132:135], a[132:135], 0
s_waitcnt lgkmcnt(7)
v_mfma_f32_16x16x32_bf16 v[80:83], a[8:11], a[84:87], v[80:83]
ds_read_b64_tr_b16 a[24:25], v8 offset:32768
ds_read_b64_tr_b16 a[26:27], v8 offset:33792
v_mfma_f32_16x16x32_bf16 v[84:87], a[8:11], a[88:91], v[84:87]
v_mfma_f32_16x16x32_bf16 v[88:91], a[8:11], a[92:95], v[88:91]
buffer_load_dwordx4 v29, s[8:11], s29 offen offset:2048 lds
v_mfma_f32_16x16x32_bf16 v[92:95], a[8:11], a[96:99], v[92:95]
s_add_u32 s29, s29, s56
v_mfma_f32_16x16x32_bf16 a[152:155], a[128:131], a[140:143], 0
v_mfma_f32_16x16x32_bf16 a[160:163], a[140:143], a[140:143], 0
v_mfma_f32_16x16x32_bf16 v[96:99], a[12:15], a[84:87], v[96:99]
ds_read_b64_tr_b16 a[28:29], v9 offset:32768
ds_read_b64_tr_b16 a[30:31], v9 offset:33792
v_mfma_f32_16x16x32_bf16 v[100:103], a[12:15], a[88:91], v[100:103]
s_add_u32 m0, s33, 16384
v_mfma_f32_16x16x32_bf16 v[104:107], a[12:15], a[92:95], v[104:107]
buffer_load_dwordx4 v16, s[20:23], s30 offen offset:0 lds
v_mfma_f32_16x16x32_bf16 v[108:111], a[12:15], a[96:99], v[108:111]
v_mfma_f32_16x16x32_bf16 a[148:151], a[128:131], a[136:139], a[148:151]
v_mfma_f32_16x16x32_bf16 a[156:159], a[136:139], a[136:139], a[156:159]
s_waitcnt lgkmcnt(5)
v_mfma_f32_16x16x32_bf16 v[112:115], a[16:19], a[84:87], v[112:115]
ds_read_b64_tr_b16 a[32:33], v10 offset:32768
ds_read_b64_tr_b16 a[34:35], v10 offset:33792
v_mfma_f32_16x16x32_bf16 v[116:119], a[16:19], a[88:91], v[116:119]
v_mfma_f32_16x16x32_bf16 v[120:123], a[16:19], a[92:95], v[120:123]
buffer_load_dwordx4 v17, s[20:23], s30 offen offset:1024 lds
v_mfma_f32_16x16x32_bf16 v[124:127], a[16:19], a[96:99], v[124:127]
v_mfma_f32_16x16x32_bf16 a[152:155], a[128:131], a[144:147], a[152:155]
v_mfma_f32_16x16x32_bf16 a[160:163], a[144:147], a[144:147], a[160:163]
v_mfma_f32_16x16x32_bf16 v[128:131], a[20:23], a[84:87], v[128:131]
ds_read_b64_tr_b16 a[36:37], v11 offset:32768
ds_read_b64_tr_b16 a[38:39], v11 offset:33792
v_mfma_f32_16x16x32_bf16 v[132:135], a[20:23], a[88:91], v[132:135]
v_mfma_f32_16x16x32_bf16 v[136:139], a[20:23], a[92:95], v[136:139]
buffer_load_dwordx4 v18, s[20:23], s30 offen offset:2048 lds
v_mfma_f32_16x16x32_bf16 v[140:143], a[20:23], a[96:99], v[140:143]
s_waitcnt lgkmcnt(4)
v_mfma_f32_16x16x32_bf16 v[144:147], a[24:27], a[84:87], v[144:147]
ds_read_b64_tr_b16 a[40:41], v12 offset:32768
ds_read_b64_tr_b16 a[42:43], v12 offset:33792
v_mfma_f32_16x16x32_bf16 v[148:151], a[24:27], a[88:91], v[148:151]
v_mfma_f32_16x16x32_bf16 v[152:155], a[24:27], a[92:95], v[152:155]
buffer_load_dwordx4 v19, s[20:23], s30 offen offset:3072 lds
v_mfma_f32_16x16x32_bf16 v[156:159], a[24:27], a[96:99], v[156:159]
s_add_u32 s30, s30, s57
v_mfma_f32_16x16x32_bf16 v[160:163], a[28:31], a[84:87], v[160:163]
ds_read_b64_tr_b16 a[44:45], v13 offset:32768
ds_read_b64_tr_b16 a[46:47], v13 offset:33792
v_mfma_f32_16x16x32_bf16 v[164:167], a[28:31], a[88:91], v[164:167]
s_add_u32 m0, s35, 32768
v_lshrrev_b32 v45, 4, v1
v_mfma_f32_16x16x32_bf16 v[168:171], a[28:31], a[92:95], v[168:171]
buffer_load_dwordx4 v20, s[40:43], s31 offen offset:0 lds
v_mfma_f32_16x16x32_bf16 v[172:175], a[28:31], a[96:99], v[172:175]
v_lshlrev_b32 v45, 2, v45
v_and_b32 v46, 15, v1
s_waitcnt lgkmcnt(4)
v_mfma_f32_16x16x32_bf16 v[176:179], a[32:35], a[84:87], v[176:179]
ds_read_b64_tr_b16 a[48:49], v14 offset:32768
ds_read_b64_tr_b16 a[50:51], v14 offset:33792
v_mfma_f32_16x16x32_bf16 v[180:183], a[32:35], a[88:91], v[180:183]
v_sub_u32 v45, v46, v45
v_accvgpr_read_b32 v2, a156
v_mfma_f32_16x16x32_bf16 v[184:187], a[32:35], a[92:95], v[184:187]
buffer_load_dwordx4 v21, s[40:43], s31 offen offset:1024 lds
v_mfma_f32_16x16x32_bf16 v[188:191], a[32:35], a[96:99], v[188:191]
ds_read_b64_tr_b16 a[120:121], v24
ds_read_b64_tr_b16 a[122:123], v25
v_mfma_f32_16x16x32_bf16 v[192:195], a[36:39], a[84:87], v[192:195]
ds_read_b64_tr_b16 a[0:1], v6 offset:30720
ds_read_b64_tr_b16 a[2:3], v6 offset:30976
v_mfma_f32_16x16x32_bf16 v[196:199], a[36:39], a[88:91], v[196:199]
v_accvgpr_read_b32 v3, a157
v_accvgpr_read_b32 v4, a158
v_mfma_f32_16x16x32_bf16 v[200:203], a[36:39], a[92:95], v[200:203]
buffer_load_dwordx4 v22, s[40:43], s31 offen offset:2048 lds
v_mfma_f32_16x16x32_bf16 v[204:207], a[36:39], a[96:99], v[204:207]
ds_read_b64_tr_b16 a[124:125], v26
ds_read_b64_tr_b16 a[126:127], v27
s_waitcnt lgkmcnt(8)
v_mfma_f32_16x16x32_bf16 v[208:211], a[40:43], a[84:87], v[208:211]
ds_read_b64_tr_b16 a[4:5], v7 offset:30720
ds_read_b64_tr_b16 a[6:7], v7 offset:30976
v_mfma_f32_16x16x32_bf16 v[212:215], a[40:43], a[88:91], v[212:215]
v_accvgpr_read_b32 v5, a159
v_accvgpr_read_b32 v32, a160
v_mfma_f32_16x16x32_bf16 v[216:219], a[40:43], a[92:95], v[216:219]
buffer_load_dwordx4 v23, s[40:43], s31 offen offset:3072 lds
v_mfma_f32_16x16x32_bf16 v[220:223], a[40:43], a[96:99], v[220:223]
v_add_u32 v24, s73, v24
v_add_u32 v25, s73, v25
v_mfma_f32_16x16x32_bf16 v[224:227], a[44:47], a[84:87], v[224:227]
ds_read_b64_tr_b16 a[8:9], v6 offset:31744
ds_read_b64_tr_b16 a[10:11], v6 offset:32000
v_mfma_f32_16x16x32_bf16 v[228:231], a[44:47], a[88:91], v[228:231]
s_add_u32 m0, s35, 36864
v_add_u32 v26, s73, v26
v_mfma_f32_16x16x32_bf16 v[232:235], a[44:47], a[92:95], v[232:235]
buffer_load_dwordx4 v20, s[40:43], s34 offen offset:0 lds
v_mfma_f32_16x16x32_bf16 v[236:239], a[44:47], a[96:99], v[236:239]
v_add_u32 v27, s73, v27
v_accvgpr_read_b32 v33, a161
s_waitcnt lgkmcnt(6)
v_mfma_f32_16x16x32_bf16 v[240:243], a[48:51], a[84:87], v[240:243]
ds_read_b64_tr_b16 a[12:13], v7 offset:31744
ds_read_b64_tr_b16 a[14:15], v7 offset:32000
v_mfma_f32_16x16x32_bf16 v[244:247], a[48:51], a[88:91], v[244:247]
v_accvgpr_read_b32 v34, a162
v_accvgpr_read_b32 v35, a163
v_mfma_f32_16x16x32_bf16 v[248:251], a[48:51], a[92:95], v[248:251]
buffer_load_dwordx4 v21, s[40:43], s34 offen offset:1024 lds
v_mfma_f32_16x16x32_bf16 v[252:255], a[48:51], a[96:99], v[252:255]
v_mov_b32 v46, 0
v_mov_b32 v47, 0
v_mfma_f32_16x16x32_bf16 v[48:51], a[0:3], a[100:103], v[48:51]
ds_read_b64_tr_b16 a[16:17], v6 offset:32768
ds_read_b64_tr_b16 a[18:19], v6 offset:33024
v_mfma_f32_16x16x32_bf16 v[52:55], a[0:3], a[104:107], v[52:55]
v_cmp_eq_u32 vcc, 0, v45
s_nop 1
v_cndmask_b32 v46, v46, v2, vcc
v_cndmask_b32 v47, v47, v32, vcc
v_mfma_f32_16x16x32_bf16 v[56:59], a[0:3], a[108:111], v[56:59]
buffer_load_dwordx4 v22, s[40:43], s34 offen offset:2048 lds
v_mfma_f32_16x16x32_bf16 v[60:63], a[0:3], a[112:115], v[60:63]
v_cmp_eq_u32 vcc, 1, v45
s_nop 1
v_cndmask_b32 v46, v46, v3, vcc
v_cndmask_b32 v47, v47, v33, vcc
s_waitcnt lgkmcnt(4)
v_mfma_f32_16x16x32_bf16 v[64:67], a[4:7], a[100:103], v[64:67]
ds_read_b64_tr_b16 a[20:21], v7 offset:32768
ds_read_b64_tr_b16 a[22:23], v7 offset:33024
v_mfma_f32_16x16x32_bf16 v[68:71], a[4:7], a[104:107], v[68:71]
v_cmp_eq_u32 vcc, 2, v45
s_nop 1
v_cndmask_b32 v46, v46, v4, vcc
v_cndmask_b32 v47, v47, v34, vcc
v_mfma_f32_16x16x32_bf16 v[72:75], a[4:7], a[108:111], v[72:75]
buffer_load_dwordx4 v23, s[40:43], s34 offen offset:3072 lds
v_mfma_f32_16x16x32_bf16 v[76:79], a[4:7], a[112:115], v[76:79]
s_add_u32 s31, s31, s88
s_add_u32 s34, s31, 65536
v_mfma_f32_16x16x32_bf16 a[116:119], a[120:123], a[128:131], a[116:119]
v_mfma_f32_16x16x32_bf16 v[80:83], a[8:11], a[100:103], v[80:83]
ds_read_b64_tr_b16 a[24:25], v8 offset:40960
ds_read_b64_tr_b16 a[26:27], v8 offset:41984
v_mfma_f32_16x16x32_bf16 v[84:87], a[8:11], a[104:107], v[84:87]
v_cmp_eq_u32 vcc, 3, v45
s_nop 1
v_cndmask_b32 v46, v46, v5, vcc
v_cndmask_b32 v47, v47, v35, vcc
v_mfma_f32_16x16x32_bf16 v[88:91], a[8:11], a[108:111], v[88:91]
buffer_load_dword v39, v43, s[8:11], s36 offen
v_mfma_f32_16x16x32_bf16 v[92:95], a[8:11], a[112:115], v[92:95]
v_permlane32_swap_b32 v46, v47
v_add_f32 v46, v46, v47
v_mfma_f32_16x16x32_bf16 a[116:119], a[124:127], a[128:131], a[116:119]
s_waitcnt lgkmcnt(4)
v_mfma_f32_16x16x32_bf16 v[96:99], a[12:15], a[100:103], v[96:99]
ds_read_b64_tr_b16 a[28:29], v9 offset:40960
ds_read_b64_tr_b16 a[30:31], v9 offset:41984
v_mfma_f32_16x16x32_bf16 v[100:103], a[12:15], a[104:107], v[100:103]
v_mov_b32 v47, v46
s_nop 1
v_permlane16_swap_b32 v46, v47
v_mfma_f32_16x16x32_bf16 v[104:107], a[12:15], a[108:111], v[104:107]
buffer_load_dword v39, v44, s[20:23], s37 offen
v_mfma_f32_16x16x32_bf16 v[108:111], a[12:15], a[112:115], v[108:111]
s_add_u32 s36, s36, 393216
s_add_u32 s37, s37, 458752
v_mfma_f32_16x16x32_bf16 v[112:115], a[16:19], a[100:103], v[112:115]
ds_read_b64_tr_b16 a[32:33], v10 offset:40960
ds_read_b64_tr_b16 a[34:35], v10 offset:41984
v_mfma_f32_16x16x32_bf16 v[116:119], a[16:19], a[104:107], v[116:119]
v_add_f32 v46, v46, v47
s_nop 1
v_add_f32_dpp v46, v46, v46 row_ror:8 row_mask:0xf bank_mask:0xf
v_mfma_f32_16x16x32_bf16 v[120:123], a[16:19], a[108:111], v[120:123]
v_mfma_f32_16x16x32_bf16 v[124:127], a[16:19], a[112:115], v[124:127]
v_add_f32_dpp v46, v46, v46 row_ror:4 row_mask:0xf bank_mask:0xf
s_nop 1
v_add_f32_dpp v46, v46, v46 row_ror:2 row_mask:0xf bank_mask:0xf
s_waitcnt lgkmcnt(4)
v_mfma_f32_16x16x32_bf16 v[128:131], a[20:23], a[100:103], v[128:131]
ds_read_b64_tr_b16 a[36:37], v11 offset:40960
ds_read_b64_tr_b16 a[38:39], v11 offset:41984
v_mfma_f32_16x16x32_bf16 v[132:135], a[20:23], a[104:107], v[132:135]
v_add_f32_dpp v46, v46, v46 row_ror:1 row_mask:0xf bank_mask:0xf
v_mfma_f32_16x16x32_bf16 v[136:139], a[20:23], a[108:111], v[136:139]
v_mfma_f32_16x16x32_bf16 v[140:143], a[20:23], a[112:115], v[140:143]
v_mfma_f32_16x16x32_bf16 v[144:147], a[24:27], a[100:103], v[144:147]
ds_read_b64_tr_b16 a[40:41], v12 offset:40960
ds_read_b64_tr_b16 a[42:43], v12 offset:41984
v_mfma_f32_16x16x32_bf16 v[148:151], a[24:27], a[104:107], v[148:151]
v_mfma_f32_16x16x32_bf16 v[152:155], a[24:27], a[108:111], v[152:155]
v_mfma_f32_16x16x32_bf16 v[156:159], a[24:27], a[112:115], v[156:159]
s_waitcnt lgkmcnt(4)
v_mfma_f32_16x16x32_bf16 v[160:163], a[28:31], a[100:103], v[160:163]
ds_read_b64_tr_b16 a[44:45], v13 offset:40960
ds_read_b64_tr_b16 a[46:47], v13 offset:41984
v_mfma_f32_16x16x32_bf16 v[164:167], a[28:31], a[104:107], v[164:167]
v_mfma_f32_16x16x32_bf16 v[168:171], a[28:31], a[108:111], v[168:171]
v_mfma_f32_16x16x32_bf16 v[172:175], a[28:31], a[112:115], v[172:175]
v_mfma_f32_16x16x32_bf16 v[176:179], a[32:35], a[100:103], v[176:179]
ds_read_b64_tr_b16 a[48:49], v14 offset:40960
ds_read_b64_tr_b16 a[50:51], v14 offset:41984
v_mfma_f32_16x16x32_bf16 v[180:183], a[32:35], a[104:107], v[180:183]
v_mfma_f32_16x16x32_bf16 v[184:187], a[32:35], a[108:111], v[184:187]
v_mfma_f32_16x16x32_bf16 v[188:191], a[32:35], a[112:115], v[188:191]
s_waitcnt vmcnt(19)
s_barrier
s_waitcnt lgkmcnt(4)
v_mfma_f32_16x16x32_bf16 v[192:195], a[36:39], a[100:103], v[192:195]
ds_read_b64_tr_b16 a[0:1], v6 offset:0
ds_read_b64_tr_b16 a[2:3], v6 offset:256
v_mfma_f32_16x16x32_bf16 v[196:199], a[36:39], a[104:107], v[196:199]
ds_read_b128 a[52:55], v36 offset:0
v_mfma_f32_16x16x32_bf16 v[200:203], a[36:39], a[108:111], v[200:203]
v_mfma_f32_16x16x32_bf16 v[204:207], a[36:39], a[112:115], v[204:207]
ds_read_b128 a[56:59], v36 offset:2048
v_mfma_f32_16x16x32_bf16 v[208:211], a[40:43], a[100:103], v[208:211]
ds_read_b64_tr_b16 a[4:5], v7 offset:0
ds_read_b64_tr_b16 a[6:7], v7 offset:256
v_mfma_f32_16x16x32_bf16 v[212:215], a[40:43], a[104:107], v[212:215]
ds_read_b128 a[60:63], v36 offset:4096
v_mfma_f32_16x16x32_bf16 v[216:219], a[40:43], a[108:111], v[216:219]
v_mfma_f32_16x16x32_bf16 v[220:223], a[40:43], a[112:115], v[220:223]
ds_read_b128 a[64:67], v36 offset:6144
s_waitcnt lgkmcnt(8)
v_mfma_f32_16x16x32_bf16 v[224:227], a[44:47], a[100:103], v[224:227]
ds_read_b64_tr_b16 a[8:9], v6 offset:1024
ds_read_b64_tr_b16 a[10:11], v6 offset:1280
v_mfma_f32_16x16x32_bf16 v[228:231], a[44:47], a[104:107], v[228:231]
ds_read_b128 a[68:71], v37 offset:0
v_mfma_f32_16x16x32_bf16 v[232:235], a[44:47], a[108:111], v[232:235]
v_mfma_f32_16x16x32_bf16 v[236:239], a[44:47], a[112:115], v[236:239]
v_mfma_f32_16x16x32_bf16 v[240:243], a[48:51], a[100:103], v[240:243]
ds_read_b64_tr_b16 a[12:13], v7 offset:1024
ds_read_b64_tr_b16 a[14:15], v7 offset:1280
v_mfma_f32_16x16x32_bf16 v[244:247], a[48:51], a[104:107], v[244:247]
ds_read_b128 a[72:75], v37 offset:2048
v_mfma_f32_16x16x32_bf16 v[248:251], a[48:51], a[108:111], v[248:251]
v_mfma_f32_16x16x32_bf16 v[252:255], a[48:51], a[112:115], v[252:255]
s_waitcnt lgkmcnt(6)
v_mfma_f32_16x16x32_bf16 v[48:51], a[0:3], a[52:55], v[48:51]
ds_read_b64_tr_b16 a[16:17], v6 offset:2048
ds_read_b64_tr_b16 a[18:19], v6 offset:2304
v_mfma_f32_16x16x32_bf16 v[52:55], a[0:3], a[56:59], v[52:55]
ds_read_b128 a[76:79], v37 offset:4096
s_add_u32 m0, s32, 24576
v_mfma_f32_16x16x32_bf16 v[56:59], a[0:3], a[60:63], v[56:59]
buffer_load_dwordx4 v15, s[8:11], s29 offen offset:0 lds
v_mfma_f32_16x16x32_bf16 v[60:63], a[0:3], a[64:67], v[60:63]
v_accvgpr_read_b32 v2, a148
v_accvgpr_read_b32 v3, a152
v_mfma_f32_16x16x32_bf16 v[64:67], a[4:7], a[52:55], v[64:67]
ds_read_b64_tr_b16 a[20:21], v7 offset:2048
ds_read_b64_tr_b16 a[22:23], v7 offset:2304
v_mfma_f32_16x16x32_bf16 v[68:71], a[4:7], a[56:59], v[68:71]
ds_read_b128 a[80:83], v37 offset:6144
v_mul_f32 v47, 0.0009765625, v46
v_mfma_f32_16x16x32_bf16 v[72:75], a[4:7], a[60:63], v[72:75]
buffer_load_dwordx4 v28, s[8:11], s29 offen offset:1024 lds
v_mfma_f32_16x16x32_bf16 v[76:79], a[4:7], a[64:67], v[76:79]
v_permlane32_swap_b32 v2, v3
s_nop 1
v_add_f32_dpp v2, v2, v2 row_ror:8 row_mask:0xf bank_mask:0xf
s_waitcnt lgkmcnt(7)
v_mfma_f32_16x16x32_bf16 v[80:83], a[8:11], a[52:55], v[80:83]
ds_read_b64_tr_b16 a[24:25], v8 offset:0
ds_read_b64_tr_b16 a[26:27], v8 offset:1024
v_mfma_f32_16x16x32_bf16 v[84:87], a[8:11], a[56:59], v[84:87]
v_add_f32_dpp v2, v2, v2 row_ror:4 row_mask:0xf bank_mask:0xf
s_nop 1
v_add_f32_dpp v2, v2, v2 row_ror:2 row_mask:0xf bank_mask:0xf
v_mfma_f32_16x16x32_bf16 v[88:91], a[8:11], a[60:63], v[88:91]
buffer_load_dwordx4 v29, s[8:11], s29 offen offset:2048 lds
v_mfma_f32_16x16x32_bf16 v[92:95], a[8:11], a[64:67], v[92:95]
s_add_u32 s29, s29, 393216
v_add_f32_dpp v2, v2, v2 row_ror:1 row_mask:0xf bank_mask:0xf
v_mfma_f32_16x16x32_bf16 v[96:99], a[12:15], a[52:55], v[96:99]
ds_read_b64_tr_b16 a[28:29], v9 offset:0
ds_read_b64_tr_b16 a[30:31], v9 offset:1024
v_mfma_f32_16x16x32_bf16 v[100:103], a[12:15], a[56:59], v[100:103]
s_add_u32 m0, s33, 32768
v_mul_f32 v2, 0.0009765625, v2
v_mfma_f32_16x16x32_bf16 v[104:107], a[12:15], a[60:63], v[104:107]
buffer_load_dwordx4 v16, s[20:23], s30 offen offset:0 lds
v_mfma_f32_16x16x32_bf16 v[108:111], a[12:15], a[64:67], v[108:111]
v_fma_f32 v47, -v2, v2, v47
v_max_f32 v47, 0, v47
s_waitcnt lgkmcnt(5)
v_mfma_f32_16x16x32_bf16 v[112:115], a[16:19], a[52:55], v[112:115]
ds_read_b64_tr_b16 a[32:33], v10 offset:0
ds_read_b64_tr_b16 a[34:35], v10 offset:1024
v_mfma_f32_16x16x32_bf16 v[116:119], a[16:19], a[56:59], v[116:119]
v_cvt_pk_bf16_f32 v46, v2, v2
v_lshlrev_b32 v46, 16, v46
v_mfma_f32_16x16x32_bf16 v[120:123], a[16:19], a[60:63], v[120:123]
buffer_load_dwordx4 v17, s[20:23], s30 offen offset:1024 lds
v_mfma_f32_16x16x32_bf16 v[124:127], a[16:19], a[64:67], v[124:127]
v_cvt_pk_bf16_f32 v47, v47, v47
v_lshlrev_b32 v47, 16, v47
v_mfma_f32_16x16x32_bf16 v[128:131], a[20:23], a[52:55], v[128:131]
ds_read_b64_tr_b16 a[36:37], v11 offset:0
ds_read_b64_tr_b16 a[38:39], v11 offset:1024
v_mfma_f32_16x16x32_bf16 v[132:135], a[20:23], a[56:59], v[132:135]
v_add_f32 v47, 0x3727c5ac, v47
v_cvt_pk_bf16_f32 v47, v47, v47
v_mfma_f32_16x16x32_bf16 v[136:139], a[20:23], a[60:63], v[136:139]
buffer_load_dwordx4 v18, s[20:23], s30 offen offset:2048 lds
v_mfma_f32_16x16x32_bf16 v[140:143], a[20:23], a[64:67], v[140:143]
v_lshlrev_b32 v47, 16, v47
v_sqrt_f32 v47, v47
s_waitcnt lgkmcnt(4)
v_mfma_f32_16x16x32_bf16 v[144:147], a[24:27], a[52:55], v[144:147]
ds_read_b64_tr_b16 a[40:41], v12 offset:0
ds_read_b64_tr_b16 a[42:43], v12 offset:1024
v_mfma_f32_16x16x32_bf16 v[148:151], a[24:27], a[56:59], v[148:151]
v_xor_b32 v46, 0x80000000, v46
v_cvt_pk_bf16_f32 v47, v47, v47
v_mfma_f32_16x16x32_bf16 v[152:155], a[24:27], a[60:63], v[152:155]
buffer_load_dwordx4 v19, s[20:23], s30 offen offset:3072 lds
v_mfma_f32_16x16x32_bf16 v[156:159], a[24:27], a[64:67], v[156:159]
s_add_u32 s30, s30, 458752
v_lshlrev_b32 v47, 16, v47
v_mfma_f32_16x16x32_bf16 v[160:163], a[28:31], a[52:55], v[160:163]
ds_read_b64_tr_b16 a[44:45], v13 offset:0
ds_read_b64_tr_b16 a[46:47], v13 offset:1024
v_mfma_f32_16x16x32_bf16 v[164:167], a[28:31], a[56:59], v[164:167]
s_add_u32 m0, s35, 0
v_rcp_f32 v47, v47
v_mfma_f32_16x16x32_bf16 v[168:171], a[28:31], a[60:63], v[168:171]
buffer_load_dwordx4 v20, s[40:43], s31 offen offset:0 lds
v_mfma_f32_16x16x32_bf16 v[172:175], a[28:31], a[64:67], v[172:175]
s_lshl_b32 s60, s2, 7
s_lshl_b32 s38, s28, 4
s_waitcnt lgkmcnt(4)
v_mfma_f32_16x16x32_bf16 v[176:179], a[32:35], a[52:55], v[176:179]
ds_read_b64_tr_b16 a[48:49], v14 offset:0
ds_read_b64_tr_b16 a[50:51], v14 offset:1024
v_mfma_f32_16x16x32_bf16 v[180:183], a[32:35], a[56:59], v[180:183]
s_add_u32 s60, s60, s38
s_add_u32 s60, s60, 37748736
v_mfma_f32_16x16x32_bf16 v[184:187], a[32:35], a[60:63], v[184:187]
buffer_load_dwordx4 v21, s[40:43], s31 offen offset:1024 lds
v_mfma_f32_16x16x32_bf16 v[188:191], a[32:35], a[64:67], v[188:191]
ds_read_b64_tr_b16 a[120:121], v24
ds_read_b64_tr_b16 a[122:123], v25
v_mfma_f32_16x16x32_bf16 v[192:195], a[36:39], a[52:55], v[192:195]
ds_read_b64_tr_b16 a[0:1], v6 offset:6144
ds_read_b64_tr_b16 a[2:3], v6 offset:6400
v_mfma_f32_16x16x32_bf16 v[196:199], a[36:39], a[56:59], v[196:199]
v_lshrrev_b32 v45, 5, v1
v_lshlrev_b32 v45, 3, v45
v_mfma_f32_16x16x32_bf16 v[200:203], a[36:39], a[60:63], v[200:203]
buffer_load_dwordx4 v22, s[40:43], s31 offen offset:2048 lds
v_mfma_f32_16x16x32_bf16 v[204:207], a[36:39], a[64:67], v[204:207]
ds_read_b64_tr_b16 a[124:125], v26
ds_read_b64_tr_b16 a[126:127], v27
s_waitcnt lgkmcnt(8)
v_mfma_f32_16x16x32_bf16 v[208:211], a[40:43], a[52:55], v[208:211]
ds_read_b64_tr_b16 a[4:5], v7 offset:6144
ds_read_b64_tr_b16 a[6:7], v7 offset:6400
v_mfma_f32_16x16x32_bf16 v[212:215], a[40:43], a[56:59], v[212:215]
v_mfma_f32_16x16x32_bf16 v[216:219], a[40:43], a[60:63], v[216:219]
buffer_load_dwordx4 v23, s[40:43], s31 offen offset:3072 lds
v_mfma_f32_16x16x32_bf16 v[220:223], a[40:43], a[64:67], v[220:223]
v_add_u32 v24, s72, v24
v_add_u32 v25, s72, v25
v_mfma_f32_16x16x32_bf16 v[224:227], a[44:47], a[52:55], v[224:227]
ds_read_b64_tr_b16 a[8:9], v6 offset:7168
ds_read_b64_tr_b16 a[10:11], v6 offset:7424
v_mfma_f32_16x16x32_bf16 v[228:231], a[44:47], a[56:59], v[228:231]
s_add_u32 m0, s35, 4096
v_add_u32 v26, s72, v26
v_mfma_f32_16x16x32_bf16 v[232:235], a[44:47], a[60:63], v[232:235]
buffer_load_dwordx4 v20, s[40:43], s34 offen offset:0 lds
v_mfma_f32_16x16x32_bf16 v[236:239], a[44:47], a[64:67], v[236:239]
v_add_u32 v27, s72, v27
s_waitcnt lgkmcnt(6)
v_mfma_f32_16x16x32_bf16 v[240:243], a[48:51], a[52:55], v[240:243]
ds_read_b64_tr_b16 a[12:13], v7 offset:7168
ds_read_b64_tr_b16 a[14:15], v7 offset:7424
v_mfma_f32_16x16x32_bf16 v[244:247], a[48:51], a[56:59], v[244:247]
v_mfma_f32_16x16x32_bf16 v[248:251], a[48:51], a[60:63], v[248:251]
buffer_load_dwordx4 v21, s[40:43], s34 offen offset:1024 lds
v_mfma_f32_16x16x32_bf16 v[252:255], a[48:51], a[64:67], v[252:255]
v_mfma_f32_16x16x32_bf16 v[48:51], a[0:3], a[68:71], v[48:51]
ds_read_b64_tr_b16 a[16:17], v6 offset:8192
ds_read_b64_tr_b16 a[18:19], v6 offset:8448
v_mfma_f32_16x16x32_bf16 v[52:55], a[0:3], a[72:75], v[52:55]
v_mfma_f32_16x16x32_bf16 v[56:59], a[0:3], a[76:79], v[56:59]
buffer_load_dwordx4 v22, s[40:43], s34 offen offset:2048 lds
v_mfma_f32_16x16x32_bf16 v[60:63], a[0:3], a[80:83], v[60:63]
s_waitcnt lgkmcnt(4)
v_mfma_f32_16x16x32_bf16 v[64:67], a[4:7], a[68:71], v[64:67]
ds_read_b64_tr_b16 a[20:21], v7 offset:8192
ds_read_b64_tr_b16 a[22:23], v7 offset:8448
v_mfma_f32_16x16x32_bf16 v[68:71], a[4:7], a[72:75], v[68:71]
v_mfma_f32_16x16x32_bf16 v[72:75], a[4:7], a[76:79], v[72:75]
buffer_load_dwordx4 v23, s[40:43], s34 offen offset:3072 lds
v_mfma_f32_16x16x32_bf16 v[76:79], a[4:7], a[80:83], v[76:79]
s_add_u32 s31, s31, 128
s_add_u32 s34, s31, 65536
v_mfma_f32_16x16x32_bf16 a[116:119], a[120:123], a[128:131], a[116:119]
v_mfma_f32_16x16x32_bf16 v[80:83], a[8:11], a[68:71], v[80:83]
ds_read_b64_tr_b16 a[24:25], v8 offset:8192
ds_read_b64_tr_b16 a[26:27], v8 offset:9216
v_mfma_f32_16x16x32_bf16 v[84:87], a[8:11], a[72:75], v[84:87]
v_mfma_f32_16x16x32_bf16 v[88:91], a[8:11], a[76:79], v[88:91]
buffer_load_dword v39, v43, s[8:11], s36 offen
v_mfma_f32_16x16x32_bf16 v[92:95], a[8:11], a[80:83], v[92:95]
v_mfma_f32_16x16x32_bf16 a[116:119], a[124:127], a[128:131], a[116:119]
s_waitcnt lgkmcnt(4)
v_mfma_f32_16x16x32_bf16 v[96:99], a[12:15], a[68:71], v[96:99]
ds_read_b64_tr_b16 a[28:29], v9 offset:8192
ds_read_b64_tr_b16 a[30:31], v9 offset:9216
v_mfma_f32_16x16x32_bf16 v[100:103], a[12:15], a[72:75], v[100:103]
v_mfma_f32_16x16x32_bf16 v[104:107], a[12:15], a[76:79], v[104:107]
buffer_load_dword v39, v44, s[20:23], s37 offen
v_mfma_f32_16x16x32_bf16 v[108:111], a[12:15], a[80:83], v[108:111]
s_add_u32 s36, s36, 393216
s_add_u32 s37, s37, 458752
v_mfma_f32_16x16x32_bf16 v[112:115], a[16:19], a[68:71], v[112:115]
ds_read_b64_tr_b16 a[32:33], v10 offset:8192
ds_read_b64_tr_b16 a[34:35], v10 offset:9216
v_mfma_f32_16x16x32_bf16 v[116:119], a[16:19], a[72:75], v[116:119]
v_mfma_f32_16x16x32_bf16 v[120:123], a[16:19], a[76:79], v[120:123]
buffer_load_dword v39, v38, s[92:95], s61 offen
v_mfma_f32_16x16x32_bf16 v[124:127], a[16:19], a[80:83], v[124:127]
s_waitcnt lgkmcnt(4)
v_mfma_f32_16x16x32_bf16 v[128:131], a[20:23], a[68:71], v[128:131]
ds_read_b64_tr_b16 a[36:37], v11 offset:8192
ds_read_b64_tr_b16 a[38:39], v11 offset:9216
v_mfma_f32_16x16x32_bf16 v[132:135], a[20:23], a[72:75], v[132:135]
v_mfma_f32_16x16x32_bf16 v[136:139], a[20:23], a[76:79], v[136:139]
buffer_load_dword v39, v40, s[96:99], s101 offen
v_mfma_f32_16x16x32_bf16 v[140:143], a[20:23], a[80:83], v[140:143]
s_add_u32 s61, s61, 2432
s_add_u32 s101, s101, 768
v_mfma_f32_16x16x32_bf16 v[144:147], a[24:27], a[68:71], v[144:147]
ds_read_b64_tr_b16 a[40:41], v12 offset:8192
ds_read_b64_tr_b16 a[42:43], v12 offset:9216
v_mfma_f32_16x16x32_bf16 v[148:151], a[24:27], a[72:75], v[148:151]
v_mfma_f32_16x16x32_bf16 v[152:155], a[24:27], a[76:79], v[152:155]
v_mfma_f32_16x16x32_bf16 v[156:159], a[24:27], a[80:83], v[156:159]
s_waitcnt lgkmcnt(4)
v_mfma_f32_16x16x32_bf16 v[160:163], a[28:31], a[68:71], v[160:163]
ds_read_b64_tr_b16 a[44:45], v13 offset:8192
ds_read_b64_tr_b16 a[46:47], v13 offset:9216
v_mfma_f32_16x16x32_bf16 v[164:167], a[28:31], a[72:75], v[164:167]
v_mfma_f32_16x16x32_bf16 v[168:171], a[28:31], a[76:79], v[168:171]
v_mfma_f32_16x16x32_bf16 v[172:175], a[28:31], a[80:83], v[172:175]
s_mov_b32 exec_lo, 1
s_mov_b32 exec_hi, 1
buffer_store_dwordx2 v[46:47], v45, s[24:27], s60 offen sc1
s_mov_b64 exec, -1
v_mfma_f32_16x16x32_bf16 v[176:179], a[32:35], a[68:71], v[176:179]
ds_read_b64_tr_b16 a[48:49], v14 offset:8192
ds_read_b64_tr_b16 a[50:51], v14 offset:9216
v_mfma_f32_16x16x32_bf16 v[180:183], a[32:35], a[72:75], v[180:183]
v_mfma_f32_16x16x32_bf16 v[184:187], a[32:35], a[76:79], v[184:187]
v_mfma_f32_16x16x32_bf16 v[188:191], a[32:35], a[80:83], v[188:191]
s_waitcnt vmcnt(22)
s_barrier
s_waitcnt lgkmcnt(4)
v_mfma_f32_16x16x32_bf16 v[192:195], a[36:39], a[68:71], v[192:195]
ds_read_b64_tr_b16 a[0:1], v6 offset:12288
ds_read_b64_tr_b16 a[2:3], v6 offset:12544
v_mfma_f32_16x16x32_bf16 v[196:199], a[36:39], a[72:75], v[196:199]
ds_read_b128 a[84:87], v36 offset:32768
v_mfma_f32_16x16x32_bf16 v[200:203], a[36:39], a[76:79], v[200:203]
v_mfma_f32_16x16x32_bf16 v[204:207], a[36:39], a[80:83], v[204:207]
ds_read_b128 a[88:91], v36 offset:34816
v_mfma_f32_16x16x32_bf16 v[208:211], a[40:43], a[68:71], v[208:211]
ds_read_b64_tr_b16 a[4:5], v7 offset:12288
ds_read_b64_tr_b16 a[6:7], v7 offset:12544
v_mfma_f32_16x16x32_bf16 v[212:215], a[40:43], a[72:75], v[212:215]
ds_read_b128 a[92:95], v36 offset:36864
v_mfma_f32_16x16x32_bf16 v[216:219], a[40:43], a[76:79], v[216:219]
v_mfma_f32_16x16x32_bf16 v[220:223], a[40:43], a[80:83], v[220:223]
ds_read_b128 a[96:99], v36 offset:38912
s_waitcnt lgkmcnt(8)
v_mfma_f32_16x16x32_bf16 v[224:227], a[44:47], a[68:71], v[224:227]
ds_read_b64_tr_b16 a[8:9], v6 offset:13312
ds_read_b64_tr_b16 a[10:11], v6 offset:13568
v_mfma_f32_16x16x32_bf16 v[228:231], a[44:47], a[72:75], v[228:231]
ds_read_b128 a[100:103], v37 offset:32768
v_mfma_f32_16x16x32_bf16 v[232:235], a[44:47], a[76:79], v[232:235]
v_mfma_f32_16x16x32_bf16 v[236:239], a[44:47], a[80:83], v[236:239]
v_mfma_f32_16x16x32_bf16 v[240:243], a[48:51], a[68:71], v[240:243]
ds_read_b64_tr_b16 a[12:13], v7 offset:13312
ds_read_b64_tr_b16 a[14:15], v7 offset:13568
v_mfma_f32_16x16x32_bf16 v[244:247], a[48:51], a[72:75], v[244:247]
ds_read_b128 a[104:107], v37 offset:34816
v_mfma_f32_16x16x32_bf16 v[248:251], a[48:51], a[76:79], v[248:251]
v_mfma_f32_16x16x32_bf16 v[252:255], a[48:51], a[80:83], v[252:255]
s_waitcnt lgkmcnt(6)
v_mfma_f32_16x16x32_bf16 v[48:51], a[0:3], a[84:87], v[48:51]
ds_read_b64_tr_b16 a[16:17], v6 offset:14336
ds_read_b64_tr_b16 a[18:19], v6 offset:14592
v_mfma_f32_16x16x32_bf16 v[52:55], a[0:3], a[88:91], v[52:55]
ds_read_b128 a[108:111], v37 offset:36864
s_add_u32 m0, s32, 0
v_mfma_f32_16x16x32_bf16 v[56:59], a[0:3], a[92:95], v[56:59]
buffer_load_dwordx4 v15, s[8:11], s29 offen offset:0 lds
v_mfma_f32_16x16x32_bf16 v[60:63], a[0:3], a[96:99], v[60:63]
v_mfma_f32_16x16x32_bf16 v[64:67], a[4:7], a[84:87], v[64:67]
ds_read_b64_tr_b16 a[20:21], v7 offset:14336
ds_read_b64_tr_b16 a[22:23], v7 offset:14592
v_mfma_f32_16x16x32_bf16 v[68:71], a[4:7], a[88:91], v[68:71]
ds_read_b128 a[112:115], v37 offset:38912
v_mfma_f32_16x16x32_bf16 v[72:75], a[4:7], a[92:95], v[72:75]
buffer_load_dwordx4 v28, s[8:11], s29 offen offset:1024 lds
v_mfma_f32_16x16x32_bf16 v[76:79], a[4:7], a[96:99], v[76:79]
s_waitcnt lgkmcnt(7)
v_mfma_f32_16x16x32_bf16 v[80:83], a[8:11], a[84:87], v[80:83]
ds_read_b64_tr_b16 a[24:25], v8 offset:16384
ds_read_b64_tr_b16 a[26:27], v8 offset:17408
v_mfma_f32_16x16x32_bf16 v[84:87], a[8:11], a[88:91], v[84:87]
s_lshl_b32 s59, s5, 11
s_lshl_b32 s38, s54, 10
v_mfma_f32_16x16x32_bf16 v[88:91], a[8:11], a[92:95], v[88:91]
buffer_load_dwordx4 v29, s[8:11], s29 offen offset:2048 lds
v_mfma_f32_16x16x32_bf16 v[92:95], a[8:11], a[96:99], v[92:95]
s_add_u32 s29, s29, 393216
s_add_u32 s59, s59, s38
v_mfma_f32_16x16x32_bf16 v[96:99], a[12:15], a[84:87], v[96:99]
ds_read_b64_tr_b16 a[28:29], v9 offset:16384
ds_read_b64_tr_b16 a[30:31], v9 offset:17408
v_mfma_f32_16x16x32_bf16 v[100:103], a[12:15], a[88:91], v[100:103]
s_add_u32 m0, s33, 0
s_lshl_b32 s38, s89, 6
v_mfma_f32_16x16x32_bf16 v[104:107], a[12:15], a[92:95], v[104:107]
buffer_load_dwordx4 v16, s[20:23], s30 offen offset:0 lds
v_mfma_f32_16x16x32_bf16 v[108:111], a[12:15], a[96:99], v[108:111]
s_add_u32 s59, s59, s38
s_add_u32 s59, s59, 38797312
s_waitcnt lgkmcnt(5)
v_mfma_f32_16x16x32_bf16 v[112:115], a[16:19], a[84:87], v[112:115]
ds_read_b64_tr_b16 a[32:33], v10 offset:16384
ds_read_b64_tr_b16 a[34:35], v10 offset:17408
v_mfma_f32_16x16x32_bf16 v[116:119], a[16:19], a[88:91], v[116:119]
v_lshrrev_b32 v45, 4, v1
v_lshlrev_b32 v45, 4, v45
v_mfma_f32_16x16x32_bf16 v[120:123], a[16:19], a[92:95], v[120:123]
buffer_load_dwordx4 v17, s[20:23], s30 offen offset:1024 lds
v_mfma_f32_16x16x32_bf16 v[124:127], a[16:19], a[96:99], v[124:127]
v_mfma_f32_16x16x32_bf16 v[128:131], a[20:23], a[84:87], v[128:131]
ds_read_b64_tr_b16 a[36:37], v11 offset:16384
ds_read_b64_tr_b16 a[38:39], v11 offset:17408
v_mfma_f32_16x16x32_bf16 v[132:135], a[20:23], a[88:91], v[132:135]
v_mfma_f32_16x16x32_bf16 v[136:139], a[20:23], a[92:95], v[136:139]
buffer_load_dwordx4 v18, s[20:23], s30 offen offset:2048 lds
v_mfma_f32_16x16x32_bf16 v[140:143], a[20:23], a[96:99], v[140:143]
s_waitcnt lgkmcnt(4)
v_mfma_f32_16x16x32_bf16 v[144:147], a[24:27], a[84:87], v[144:147]
ds_read_b64_tr_b16 a[40:41], v12 offset:16384
ds_read_b64_tr_b16 a[42:43], v12 offset:17408
v_mfma_f32_16x16x32_bf16 v[148:151], a[24:27], a[88:91], v[148:151]
v_mfma_f32_16x16x32_bf16 v[152:155], a[24:27], a[92:95], v[152:155]
buffer_load_dwordx4 v19, s[20:23], s30 offen offset:3072 lds
v_mfma_f32_16x16x32_bf16 v[156:159], a[24:27], a[96:99], v[156:159]
s_add_u32 s30, s30, 458752
v_mfma_f32_16x16x32_bf16 v[160:163], a[28:31], a[84:87], v[160:163]
ds_read_b64_tr_b16 a[44:45], v13 offset:16384
ds_read_b64_tr_b16 a[46:47], v13 offset:17408
v_mfma_f32_16x16x32_bf16 v[164:167], a[28:31], a[88:91], v[164:167]
s_add_u32 m0, s35, 32768
v_mfma_f32_16x16x32_bf16 v[168:171], a[28:31], a[92:95], v[168:171]
buffer_load_dwordx4 v20, s[40:43], s31 offen offset:0 lds
v_mfma_f32_16x16x32_bf16 v[172:175], a[28:31], a[96:99], v[172:175]
s_waitcnt lgkmcnt(4)
v_mfma_f32_16x16x32_bf16 v[176:179], a[32:35], a[84:87], v[176:179]
ds_read_b64_tr_b16 a[48:49], v14 offset:16384
ds_read_b64_tr_b16 a[50:51], v14 offset:17408
v_mfma_f32_16x16x32_bf16 v[180:183], a[32:35], a[88:91], v[180:183]
v_mfma_f32_16x16x32_bf16 v[184:187], a[32:35], a[92:95], v[184:187]
buffer_load_dwordx4 v21, s[40:43], s31 offen offset:1024 lds
v_mfma_f32_16x16x32_bf16 v[188:191], a[32:35], a[96:99], v[188:191]
ds_read_b64_tr_b16 a[120:121], v24
ds_read_b64_tr_b16 a[122:123], v25
v_mfma_f32_16x16x32_bf16 v[192:195], a[36:39], a[84:87], v[192:195]
ds_read_b64_tr_b16 a[0:1], v6 offset:18432
ds_read_b64_tr_b16 a[2:3], v6 offset:18688
v_mfma_f32_16x16x32_bf16 v[196:199], a[36:39], a[88:91], v[196:199]
v_mfma_f32_16x16x32_bf16 v[200:203], a[36:39], a[92:95], v[200:203]
buffer_load_dwordx4 v22, s[40:43], s31 offen offset:2048 lds
v_mfma_f32_16x16x32_bf16 v[204:207], a[36:39], a[96:99], v[204:207]
ds_read_b64_tr_b16 a[124:125], v26
ds_read_b64_tr_b16 a[126:127], v27
s_waitcnt lgkmcnt(8)
v_mfma_f32_16x16x32_bf16 v[208:211], a[40:43], a[84:87], v[208:211]
ds_read_b64_tr_b16 a[4:5], v7 offset:18432
ds_read_b64_tr_b16 a[6:7], v7 offset:18688
v_mfma_f32_16x16x32_bf16 v[212:215], a[40:43], a[88:91], v[212:215]
v_mfma_f32_16x16x32_bf16 v[216:219], a[40:43], a[92:95], v[216:219]
buffer_load_dwordx4 v23, s[40:43], s31 offen offset:3072 lds
v_mfma_f32_16x16x32_bf16 v[220:223], a[40:43], a[96:99], v[220:223]
v_mfma_f32_16x16x32_bf16 v[224:227], a[44:47], a[84:87], v[224:227]
ds_read_b64_tr_b16 a[8:9], v6 offset:19456
ds_read_b64_tr_b16 a[10:11], v6 offset:19712
v_mfma_f32_16x16x32_bf16 v[228:231], a[44:47], a[88:91], v[228:231]
s_add_u32 m0, s35, 36864
v_mfma_f32_16x16x32_bf16 v[232:235], a[44:47], a[92:95], v[232:235]
buffer_load_dwordx4 v20, s[40:43], s34 offen offset:0 lds
v_mfma_f32_16x16x32_bf16 v[236:239], a[44:47], a[96:99], v[236:239]
s_waitcnt lgkmcnt(6)
v_mfma_f32_16x16x32_bf16 v[240:243], a[48:51], a[84:87], v[240:243]
ds_read_b64_tr_b16 a[12:13], v7 offset:19456
ds_read_b64_tr_b16 a[14:15], v7 offset:19712
v_mfma_f32_16x16x32_bf16 v[244:247], a[48:51], a[88:91], v[244:247]
v_mfma_f32_16x16x32_bf16 v[248:251], a[48:51], a[92:95], v[248:251]
buffer_load_dwordx4 v21, s[40:43], s34 offen offset:1024 lds
v_mfma_f32_16x16x32_bf16 v[252:255], a[48:51], a[96:99], v[252:255]
v_mfma_f32_16x16x32_bf16 v[48:51], a[0:3], a[100:103], v[48:51]
ds_read_b64_tr_b16 a[16:17], v6 offset:20480
ds_read_b64_tr_b16 a[18:19], v6 offset:20736
v_mfma_f32_16x16x32_bf16 v[52:55], a[0:3], a[104:107], v[52:55]
v_mfma_f32_16x16x32_bf16 v[56:59], a[0:3], a[108:111], v[56:59]
buffer_load_dwordx4 v22, s[40:43], s34 offen offset:2048 lds
v_mfma_f32_16x16x32_bf16 v[60:63], a[0:3], a[112:115], v[60:63]
s_waitcnt lgkmcnt(4)
v_mfma_f32_16x16x32_bf16 v[64:67], a[4:7], a[100:103], v[64:67]
ds_read_b64_tr_b16 a[20:21], v7 offset:20480
ds_read_b64_tr_b16 a[22:23], v7 offset:20736
v_mfma_f32_16x16x32_bf16 v[68:71], a[4:7], a[104:107], v[68:71]
v_mfma_f32_16x16x32_bf16 v[72:75], a[4:7], a[108:111], v[72:75]
buffer_load_dwordx4 v23, s[40:43], s34 offen offset:3072 lds
v_mfma_f32_16x16x32_bf16 v[76:79], a[4:7], a[112:115], v[76:79]
s_add_u32 s31, s31, 128
s_add_u32 s34, s31, 65536
v_mfma_f32_16x16x32_bf16 a[116:119], a[120:123], a[128:131], a[116:119]
v_mfma_f32_16x16x32_bf16 v[80:83], a[8:11], a[100:103], v[80:83]
ds_read_b64_tr_b16 a[24:25], v8 offset:24576
ds_read_b64_tr_b16 a[26:27], v8 offset:25600
v_mfma_f32_16x16x32_bf16 v[84:87], a[8:11], a[104:107], v[84:87]
v_mov_b32 v30, 0
v_mfma_f32_16x16x32_bf16 v[88:91], a[8:11], a[108:111], v[88:91]
buffer_load_dword v39, v43, s[8:11], s36 offen
v_mfma_f32_16x16x32_bf16 v[92:95], a[8:11], a[112:115], v[92:95]
v_mfma_f32_16x16x32_bf16 a[116:119], a[124:127], a[128:131], a[116:119]
s_waitcnt lgkmcnt(4)
v_mfma_f32_16x16x32_bf16 v[96:99], a[12:15], a[100:103], v[96:99]
ds_read_b64_tr_b16 a[28:29], v9 offset:24576
ds_read_b64_tr_b16 a[30:31], v9 offset:25600
v_mfma_f32_16x16x32_bf16 v[100:103], a[12:15], a[104:107], v[100:103]
v_mfma_f32_16x16x32_bf16 v[104:107], a[12:15], a[108:111], v[104:107]
buffer_load_dword v39, v44, s[20:23], s37 offen
v_mfma_f32_16x16x32_bf16 v[108:111], a[12:15], a[112:115], v[108:111]
s_add_u32 s36, s36, 393216
s_add_u32 s37, s37, 458752
v_mfma_f32_16x16x32_bf16 v[112:115], a[16:19], a[100:103], v[112:115]
ds_read_b64_tr_b16 a[32:33], v10 offset:24576
ds_read_b64_tr_b16 a[34:35], v10 offset:25600
v_mfma_f32_16x16x32_bf16 v[116:119], a[16:19], a[104:107], v[116:119]
v_mfma_f32_16x16x32_bf16 v[120:123], a[16:19], a[108:111], v[120:123]
global_load_dword v31, v30, s[84:85] sc1
v_mfma_f32_16x16x32_bf16 v[124:127], a[16:19], a[112:115], v[124:127]
s_waitcnt lgkmcnt(4)
v_mfma_f32_16x16x32_bf16 v[128:131], a[20:23], a[100:103], v[128:131]
ds_read_b64_tr_b16 a[36:37], v11 offset:24576
ds_read_b64_tr_b16 a[38:39], v11 offset:25600
v_mfma_f32_16x16x32_bf16 v[132:135], a[20:23], a[104:107], v[132:135]
v_mfma_f32_16x16x32_bf16 v[136:139], a[20:23], a[108:111], v[136:139]
v_mfma_f32_16x16x32_bf16 v[140:143], a[20:23], a[112:115], v[140:143]
s_mov_b32 exec_lo, 0x00010001
s_mov_b32 exec_hi, 0x00010001
buffer_store_dwordx4 a[116:119], v45, s[24:27], s59 offen sc1
s_mov_b64 exec, -1
v_mfma_f32_16x16x32_bf16 v[144:147], a[24:27], a[100:103], v[144:147]
ds_read_b64_tr_b16 a[40:41], v12 offset:24576
ds_read_b64_tr_b16 a[42:43], v12 offset:25600
v_mfma_f32_16x16x32_bf16 v[148:151], a[24:27], a[104:107], v[148:151]
v_mfma_f32_16x16x32_bf16 v[152:155], a[24:27], a[108:111], v[152:155]
v_mfma_f32_16x16x32_bf16 v[156:159], a[24:27], a[112:115], v[156:159]
s_waitcnt lgkmcnt(4)
v_mfma_f32_16x16x32_bf16 v[160:163], a[28:31], a[100:103], v[160:163]
ds_read_b64_tr_b16 a[44:45], v13 offset:24576
ds_read_b64_tr_b16 a[46:47], v13 offset:25600
v_mfma_f32_16x16x32_bf16 v[164:167], a[28:31], a[104:107], v[164:167]
v_mfma_f32_16x16x32_bf16 v[168:171], a[28:31], a[108:111], v[168:171]
v_mfma_f32_16x16x32_bf16 v[172:175], a[28:31], a[112:115], v[172:175]
v_mfma_f32_16x16x32_bf16 v[176:179], a[32:35], a[100:103], v[176:179]
ds_read_b64_tr_b16 a[48:49], v14 offset:24576
ds_read_b64_tr_b16 a[50:51], v14 offset:25600
v_mfma_f32_16x16x32_bf16 v[180:183], a[32:35], a[104:107], v[180:183]
v_mfma_f32_16x16x32_bf16 v[184:187], a[32:35], a[108:111], v[184:187]
v_mfma_f32_16x16x32_bf16 v[188:191], a[32:35], a[112:115], v[188:191]
s_waitcnt vmcnt(24)
s_barrier
s_waitcnt lgkmcnt(4)
v_mfma_f32_16x16x32_bf16 v[192:195], a[36:39], a[100:103], v[192:195]
ds_read_b64_tr_b16 a[0:1], v6 offset:24576
ds_read_b64_tr_b16 a[2:3], v6 offset:24832
v_mfma_f32_16x16x32_bf16 v[196:199], a[36:39], a[104:107], v[196:199]
ds_read_b128 a[52:55], v36 offset:0
v_mfma_f32_16x16x32_bf16 v[200:203], a[36:39], a[108:111], v[200:203]
v_mfma_f32_16x16x32_bf16 v[204:207], a[36:39], a[112:115], v[204:207]
ds_read_b128 a[56:59], v36 offset:2048
v_mfma_f32_16x16x32_bf16 v[208:211], a[40:43], a[100:103], v[208:211]
ds_read_b64_tr_b16 a[4:5], v7 offset:24576
ds_read_b64_tr_b16 a[6:7], v7 offset:24832
v_mfma_f32_16x16x32_bf16 v[212:215], a[40:43], a[104:107], v[212:215]
ds_read_b128 a[60:63], v36 offset:4096
v_mfma_f32_16x16x32_bf16 v[216:219], a[40:43], a[108:111], v[216:219]
v_mfma_f32_16x16x32_bf16 v[220:223], a[40:43], a[112:115], v[220:223]
ds_read_b128 a[64:67], v36 offset:6144
s_waitcnt lgkmcnt(8)
v_mfma_f32_16x16x32_bf16 v[224:227], a[44:47], a[100:103], v[224:227]
ds_read_b64_tr_b16 a[8:9], v6 offset:25600
ds_read_b64_tr_b16 a[10:11], v6 offset:25856
v_mfma_f32_16x16x32_bf16 v[228:231], a[44:47], a[104:107], v[228:231]
ds_read_b128 a[68:71], v37 offset:0
v_mfma_f32_16x16x32_bf16 v[232:235], a[44:47], a[108:111], v[232:235]
v_mfma_f32_16x16x32_bf16 v[236:239], a[44:47], a[112:115], v[236:239]
v_mfma_f32_16x16x32_bf16 v[240:243], a[48:51], a[100:103], v[240:243]
ds_read_b64_tr_b16 a[12:13], v7 offset:25600
ds_read_b64_tr_b16 a[14:15], v7 offset:25856
v_mfma_f32_16x16x32_bf16 v[244:247], a[48:51], a[104:107], v[244:247]
ds_read_b128 a[72:75], v37 offset:2048
v_mfma_f32_16x16x32_bf16 v[248:251], a[48:51], a[108:111], v[248:251]
v_mfma_f32_16x16x32_bf16 v[252:255], a[48:51], a[112:115], v[252:255]
s_waitcnt lgkmcnt(6)
v_mfma_f32_16x16x32_bf16 v[48:51], a[0:3], a[52:55], v[48:51]
ds_read_b64_tr_b16 a[16:17], v6 offset:26624
ds_read_b64_tr_b16 a[18:19], v6 offset:26880
v_mfma_f32_16x16x32_bf16 v[52:55], a[0:3], a[56:59], v[52:55]
ds_read_b128 a[76:79], v37 offset:4096
s_add_u32 m0, s32, 12288
v_mfma_f32_16x16x32_bf16 v[56:59], a[0:3], a[60:63], v[56:59]
buffer_load_dwordx4 v15, s[8:11], s29 offen offset:0 lds
v_mfma_f32_16x16x32_bf16 v[60:63], a[0:3], a[64:67], v[60:63]
v_mfma_f32_16x16x32_bf16 v[64:67], a[4:7], a[52:55], v[64:67]
ds_read_b64_tr_b16 a[20:21], v7 offset:26624
ds_read_b64_tr_b16 a[22:23], v7 offset:26880
v_mfma_f32_16x16x32_bf16 v[68:71], a[4:7], a[56:59], v[68:71]
ds_read_b128 a[80:83], v37 offset:6144
v_mfma_f32_16x16x32_bf16 v[72:75], a[4:7], a[60:63], v[72:75]
buffer_load_dwordx4 v28, s[8:11], s29 offen offset:1024 lds
v_mfma_f32_16x16x32_bf16 v[76:79], a[4:7], a[64:67], v[76:79]
s_waitcnt lgkmcnt(7)
v_mfma_f32_16x16x32_bf16 v[80:83], a[8:11], a[52:55], v[80:83]
ds_read_b64_tr_b16 a[24:25], v8 offset:32768
ds_read_b64_tr_b16 a[26:27], v8 offset:33792
v_mfma_f32_16x16x32_bf16 v[84:87], a[8:11], a[56:59], v[84:87]
v_mfma_f32_16x16x32_bf16 v[88:91], a[8:11], a[60:63], v[88:91]
buffer_load_dwordx4 v29, s[8:11], s29 offen offset:2048 lds
v_mfma_f32_16x16x32_bf16 v[92:95], a[8:11], a[64:67], v[92:95]
s_add_u32 s29, s29, 393216
v_mfma_f32_16x16x32_bf16 v[96:99], a[12:15], a[52:55], v[96:99]
ds_read_b64_tr_b16 a[28:29], v9 offset:32768
ds_read_b64_tr_b16 a[30:31], v9 offset:33792
v_mfma_f32_16x16x32_bf16 v[100:103], a[12:15], a[56:59], v[100:103]
s_add_u32 m0, s33, 16384
v_mfma_f32_16x16x32_bf16 v[104:107], a[12:15], a[60:63], v[104:107]
buffer_load_dwordx4 v16, s[20:23], s30 offen offset:0 lds
v_mfma_f32_16x16x32_bf16 v[108:111], a[12:15], a[64:67], v[108:111]
s_waitcnt lgkmcnt(5)
v_mfma_f32_16x16x32_bf16 v[112:115], a[16:19], a[52:55], v[112:115]
ds_read_b64_tr_b16 a[32:33], v10 offset:32768
ds_read_b64_tr_b16 a[34:35], v10 offset:33792
v_mfma_f32_16x16x32_bf16 v[116:119], a[16:19], a[56:59], v[116:119]
v_mfma_f32_16x16x32_bf16 v[120:123], a[16:19], a[60:63], v[120:123]
buffer_load_dwordx4 v17, s[20:23], s30 offen offset:1024 lds
v_mfma_f32_16x16x32_bf16 v[124:127], a[16:19], a[64:67], v[124:127]
v_mfma_f32_16x16x32_bf16 v[128:131], a[20:23], a[52:55], v[128:131]
ds_read_b64_tr_b16 a[36:37], v11 offset:32768
ds_read_b64_tr_b16 a[38:39], v11 offset:33792
v_mfma_f32_16x16x32_bf16 v[132:135], a[20:23], a[56:59], v[132:135]
v_mfma_f32_16x16x32_bf16 v[136:139], a[20:23], a[60:63], v[136:139]
buffer_load_dwordx4 v18, s[20:23], s30 offen offset:2048 lds
v_mfma_f32_16x16x32_bf16 v[140:143], a[20:23], a[64:67], v[140:143]
s_waitcnt lgkmcnt(4)
v_mfma_f32_16x16x32_bf16 v[144:147], a[24:27], a[52:55], v[144:147]
ds_read_b64_tr_b16 a[40:41], v12 offset:32768
ds_read_b64_tr_b16 a[42:43], v12 offset:33792
v_mfma_f32_16x16x32_bf16 v[148:151], a[24:27], a[56:59], v[148:151]
v_mfma_f32_16x16x32_bf16 v[152:155], a[24:27], a[60:63], v[152:155]
buffer_load_dwordx4 v19, s[20:23], s30 offen offset:3072 lds
v_mfma_f32_16x16x32_bf16 v[156:159], a[24:27], a[64:67], v[156:159]
s_add_u32 s30, s30, 458752
v_mfma_f32_16x16x32_bf16 v[160:163], a[28:31], a[52:55], v[160:163]
ds_read_b64_tr_b16 a[44:45], v13 offset:32768
ds_read_b64_tr_b16 a[46:47], v13 offset:33792
v_mfma_f32_16x16x32_bf16 v[164:167], a[28:31], a[56:59], v[164:167]
s_add_u32 m0, s35, 0
v_mfma_f32_16x16x32_bf16 v[168:171], a[28:31], a[60:63], v[168:171]
buffer_load_dwordx4 v20, s[40:43], s31 offen offset:0 lds
v_mfma_f32_16x16x32_bf16 v[172:175], a[28:31], a[64:67], v[172:175]
s_waitcnt lgkmcnt(4)
v_mfma_f32_16x16x32_bf16 v[176:179], a[32:35], a[52:55], v[176:179]
ds_read_b64_tr_b16 a[48:49], v14 offset:32768
ds_read_b64_tr_b16 a[50:51], v14 offset:33792
v_mfma_f32_16x16x32_bf16 v[180:183], a[32:35], a[56:59], v[180:183]
v_mfma_f32_16x16x32_bf16 v[184:187], a[32:35], a[60:63], v[184:187]
buffer_load_dwordx4 v21, s[40:43], s31 offen offset:1024 lds
v_mfma_f32_16x16x32_bf16 v[188:191], a[32:35], a[64:67], v[188:191]
v_mfma_f32_16x16x32_bf16 v[192:195], a[36:39], a[52:55], v[192:195]
ds_read_b64_tr_b16 a[0:1], v6 offset:30720
ds_read_b64_tr_b16 a[2:3], v6 offset:30976
v_mfma_f32_16x16x32_bf16 v[196:199], a[36:39], a[56:59], v[196:199]
v_mfma_f32_16x16x32_bf16 v[200:203], a[36:39], a[60:63], v[200:203]
buffer_load_dwordx4 v22, s[40:43], s31 offen offset:2048 lds
v_mfma_f32_16x16x32_bf16 v[204:207], a[36:39], a[64:67], v[204:207]
s_waitcnt lgkmcnt(4)
v_mfma_f32_16x16x32_bf16 v[208:211], a[40:43], a[52:55], v[208:211]
ds_read_b64_tr_b16 a[4:5], v7 offset:30720
ds_read_b64_tr_b16 a[6:7], v7 offset:30976
v_mfma_f32_16x16x32_bf16 v[212:215], a[40:43], a[56:59], v[212:215]
v_mfma_f32_16x16x32_bf16 v[216:219], a[40:43], a[60:63], v[216:219]
buffer_load_dwordx4 v23, s[40:43], s31 offen offset:3072 lds
v_mfma_f32_16x16x32_bf16 v[220:223], a[40:43], a[64:67], v[220:223]
v_mfma_f32_16x16x32_bf16 v[224:227], a[44:47], a[52:55], v[224:227]
ds_read_b64_tr_b16 a[8:9], v6 offset:31744
ds_read_b64_tr_b16 a[10:11], v6 offset:32000
v_mfma_f32_16x16x32_bf16 v[228:231], a[44:47], a[56:59], v[228:231]
s_add_u32 m0, s35, 4096
v_mfma_f32_16x16x32_bf16 v[232:235], a[44:47], a[60:63], v[232:235]
buffer_load_dwordx4 v20, s[40:43], s34 offen offset:0 lds
v_mfma_f32_16x16x32_bf16 v[236:239], a[44:47], a[64:67], v[236:239]
s_waitcnt lgkmcnt(4)
v_mfma_f32_16x16x32_bf16 v[240:243], a[48:51], a[52:55], v[240:243]
ds_read_b64_tr_b16 a[12:13], v7 offset:31744
ds_read_b64_tr_b16 a[14:15], v7 offset:32000
v_mfma_f32_16x16x32_bf16 v[244:247], a[48:51], a[56:59], v[244:247]
v_mfma_f32_16x16x32_bf16 v[248:251], a[48:51], a[60:63], v[248:251]
buffer_load_dwordx4 v21, s[40:43], s34 offen offset:1024 lds
v_mfma_f32_16x16x32_bf16 v[252:255], a[48:51], a[64:67], v[252:255]
v_mfma_f32_16x16x32_bf16 v[48:51], a[0:3], a[68:71], v[48:51]
ds_read_b64_tr_b16 a[16:17], v6 offset:32768
ds_read_b64_tr_b16 a[18:19], v6 offset:33024
v_mfma_f32_16x16x32_bf16 v[52:55], a[0:3], a[72:75], v[52:55]
v_mfma_f32_16x16x32_bf16 v[56:59], a[0:3], a[76:79], v[56:59]
buffer_load_dwordx4 v22, s[40:43], s34 offen offset:2048 lds
v_mfma_f32_16x16x32_bf16 v[60:63], a[0:3], a[80:83], v[60:63]
s_waitcnt lgkmcnt(4)
v_mfma_f32_16x16x32_bf16 v[64:67], a[4:7], a[68:71], v[64:67]
ds_read_b64_tr_b16 a[20:21], v7 offset:32768
ds_read_b64_tr_b16 a[22:23], v7 offset:33024
v_mfma_f32_16x16x32_bf16 v[68:71], a[4:7], a[72:75], v[68:71]
v_mfma_f32_16x16x32_bf16 v[72:75], a[4:7], a[76:79], v[72:75]
buffer_load_dwordx4 v23, s[40:43], s34 offen offset:3072 lds
v_mfma_f32_16x16x32_bf16 v[76:79], a[4:7], a[80:83], v[76:79]
s_add_u32 s31, s31, 128
s_add_u32 s34, s31, 65536
v_mfma_f32_16x16x32_bf16 v[80:83], a[8:11], a[68:71], v[80:83]
ds_read_b64_tr_b16 a[24:25], v8 offset:40960
ds_read_b64_tr_b16 a[26:27], v8 offset:41984
v_mfma_f32_16x16x32_bf16 v[84:87], a[8:11], a[72:75], v[84:87]
v_mfma_f32_16x16x32_bf16 v[88:91], a[8:11], a[76:79], v[88:91]
buffer_load_dword v39, v43, s[8:11], s36 offen
v_mfma_f32_16x16x32_bf16 v[92:95], a[8:11], a[80:83], v[92:95]
s_waitcnt lgkmcnt(4)
v_mfma_f32_16x16x32_bf16 v[96:99], a[12:15], a[68:71], v[96:99]
ds_read_b64_tr_b16 a[28:29], v9 offset:40960
ds_read_b64_tr_b16 a[30:31], v9 offset:41984
v_mfma_f32_16x16x32_bf16 v[100:103], a[12:15], a[72:75], v[100:103]
v_mfma_f32_16x16x32_bf16 v[104:107], a[12:15], a[76:79], v[104:107]
buffer_load_dword v39, v44, s[20:23], s37 offen
v_mfma_f32_16x16x32_bf16 v[108:111], a[12:15], a[80:83], v[108:111]
s_add_u32 s36, s36, 393216
s_add_u32 s37, s37, 458752
v_mfma_f32_16x16x32_bf16 v[112:115], a[16:19], a[68:71], v[112:115]
ds_read_b64_tr_b16 a[32:33], v10 offset:40960
ds_read_b64_tr_b16 a[34:35], v10 offset:41984
v_mfma_f32_16x16x32_bf16 v[116:119], a[16:19], a[72:75], v[116:119]
v_mfma_f32_16x16x32_bf16 v[120:123], a[16:19], a[76:79], v[120:123]
buffer_load_dword v39, v38, s[92:95], s61 offen
v_mfma_f32_16x16x32_bf16 v[124:127], a[16:19], a[80:83], v[124:127]
s_waitcnt lgkmcnt(4)
v_mfma_f32_16x16x32_bf16 v[128:131], a[20:23], a[68:71], v[128:131]
ds_read_b64_tr_b16 a[36:37], v11 offset:40960
ds_read_b64_tr_b16 a[38:39], v11 offset:41984
v_mfma_f32_16x16x32_bf16 v[132:135], a[20:23], a[72:75], v[132:135]
v_mfma_f32_16x16x32_bf16 v[136:139], a[20:23], a[76:79], v[136:139]
buffer_load_dword v39, v40, s[96:99], s101 offen
v_mfma_f32_16x16x32_bf16 v[140:143], a[20:23], a[80:83], v[140:143]
s_add_u32 s61, s61, 2432
s_add_u32 s101, s101, 768
v_mfma_f32_16x16x32_bf16 v[144:147], a[24:27], a[68:71], v[144:147]
ds_read_b64_tr_b16 a[40:41], v12 offset:40960
ds_read_b64_tr_b16 a[42:43], v12 offset:41984
v_mfma_f32_16x16x32_bf16 v[148:151], a[24:27], a[72:75], v[148:151]
v_mfma_f32_16x16x32_bf16 v[152:155], a[24:27], a[76:79], v[152:155]
v_mfma_f32_16x16x32_bf16 v[156:159], a[24:27], a[80:83], v[156:159]
s_waitcnt lgkmcnt(4)
v_mfma_f32_16x16x32_bf16 v[160:163], a[28:31], a[68:71], v[160:163]
ds_read_b64_tr_b16 a[44:45], v13 offset:40960
ds_read_b64_tr_b16 a[46:47], v13 offset:41984
v_mfma_f32_16x16x32_bf16 v[164:167], a[28:31], a[72:75], v[164:167]
v_mfma_f32_16x16x32_bf16 v[168:171], a[28:31], a[76:79], v[168:171]
v_mfma_f32_16x16x32_bf16 v[172:175], a[28:31], a[80:83], v[172:175]
v_mfma_f32_16x16x32_bf16 v[176:179], a[32:35], a[68:71], v[176:179]
ds_read_b64_tr_b16 a[48:49], v14 offset:40960
ds_read_b64_tr_b16 a[50:51], v14 offset:41984
v_mfma_f32_16x16x32_bf16 v[180:183], a[32:35], a[72:75], v[180:183]
v_mfma_f32_16x16x32_bf16 v[184:187], a[32:35], a[76:79], v[184:187]
v_mfma_f32_16x16x32_bf16 v[188:191], a[32:35], a[80:83], v[188:191]
s_waitcnt vmcnt(20)
s_cmp_lg_u32 s28, 0
s_cbranch_scc1 L_adone_3
v_readfirstlane_b32 s53, v31
s_nop 3
s_cmp_ge_u32 s53, 1
s_cbranch_scc1 L_adone_3
s_mov_b32 s52, 0
L_poll_4:
global_load_dword v31, v30, s[84:85] sc1
s_waitcnt vmcnt(0)
v_readfirstlane_b32 s53, v31
s_add_u32 s52, s52, 1
s_nop 2
s_cmp_ge_u32 s53, 1
s_cbranch_scc1 L_adone_3
s_cmp_lt_u32 s52, 20000
s_cbranch_scc1 L_poll_4
L_adone_3:
s_barrier
s_lshr_b32 s38, s2, 5
s_mul_i32 s39, s38, 128
s_add_u32 s39, s39, 39845888
s_cmp_lg_u32 s28, 0
s_cbranch_scc1 L_sig_5
v_mov_b32 v2, s39
v_mov_b32 v3, 1
s_mov_b64 exec, 1
buffer_atomic_add v3, v2, s[24:27], 0 offen sc1
s_mov_b64 exec, -1
L_sig_5:
s_waitcnt lgkmcnt(4)
v_mfma_f32_16x16x32_bf16 v[192:195], a[36:39], a[68:71], v[192:195]
ds_read_b64_tr_b16 a[0:1], v6 offset:0
ds_read_b64_tr_b16 a[2:3], v6 offset:256
v_mfma_f32_16x16x32_bf16 v[196:199], a[36:39], a[72:75], v[196:199]
ds_read_b128 a[84:87], v36 offset:32768
v_mfma_f32_16x16x32_bf16 v[200:203], a[36:39], a[76:79], v[200:203]
v_mfma_f32_16x16x32_bf16 v[204:207], a[36:39], a[80:83], v[204:207]
ds_read_b128 a[88:91], v36 offset:34816
v_mfma_f32_16x16x32_bf16 v[208:211], a[40:43], a[68:71], v[208:211]
ds_read_b64_tr_b16 a[4:5], v7 offset:0
ds_read_b64_tr_b16 a[6:7], v7 offset:256
v_mfma_f32_16x16x32_bf16 v[212:215], a[40:43], a[72:75], v[212:215]
ds_read_b128 a[92:95], v36 offset:36864
v_mfma_f32_16x16x32_bf16 v[216:219], a[40:43], a[76:79], v[216:219]
v_mfma_f32_16x16x32_bf16 v[220:223], a[40:43], a[80:83], v[220:223]
ds_read_b128 a[96:99], v36 offset:38912
s_waitcnt lgkmcnt(8)
v_mfma_f32_16x16x32_bf16 v[224:227], a[44:47], a[68:71], v[224:227]
ds_read_b64_tr_b16 a[8:9], v6 offset:1024
ds_read_b64_tr_b16 a[10:11], v6 offset:1280
v_mfma_f32_16x16x32_bf16 v[228:231], a[44:47], a[72:75], v[228:231]
ds_read_b128 a[100:103], v37 offset:32768
v_mfma_f32_16x16x32_bf16 v[232:235], a[44:47], a[76:79], v[232:235]
v_mfma_f32_16x16x32_bf16 v[236:239], a[44:47], a[80:83], v[236:239]
v_mfma_f32_16x16x32_bf16 v[240:243], a[48:51], a[68:71], v[240:243]
ds_read_b64_tr_b16 a[12:13], v7 offset:1024
ds_read_b64_tr_b16 a[14:15], v7 offset:1280
v_mfma_f32_16x16x32_bf16 v[244:247], a[48:51], a[72:75], v[244:247]
ds_read_b128 a[104:107], v37 offset:34816
v_mfma_f32_16x16x32_bf16 v[248:251], a[48:51], a[76:79], v[248:251]
v_mfma_f32_16x16x32_bf16 v[252:255], a[48:51], a[80:83], v[252:255]
s_waitcnt lgkmcnt(6)
v_mfma_f32_16x16x32_bf16 v[48:51], a[0:3], a[84:87], v[48:51]
ds_read_b64_tr_b16 a[16:17], v6 offset:2048
ds_read_b64_tr_b16 a[18:19], v6 offset:2304
v_mfma_f32_16x16x32_bf16 v[52:55], a[0:3], a[88:91], v[52:55]
ds_read_b128 a[108:111], v37 offset:36864
s_add_u32 m0, s32, 24576
v_mfma_f32_16x16x32_bf16 v[56:59], a[0:3], a[92:95], v[56:59]
buffer_load_dwordx4 v15, s[8:11], s29 offen offset:0 lds
v_mfma_f32_16x16x32_bf16 v[60:63], a[0:3], a[96:99], v[60:63]
v_mfma_f32_16x16x32_bf16 v[64:67], a[4:7], a[84:87], v[64:67]
ds_read_b64_tr_b16 a[20:21], v7 offset:2048
ds_read_b64_tr_b16 a[22:23], v7 offset:2304
v_mfma_f32_16x16x32_bf16 v[68:71], a[4:7], a[88:91], v[68:71]
ds_read_b128 a[112:115], v37 offset:38912
v_mfma_f32_16x16x32_bf16 v[72:75], a[4:7], a[92:95], v[72:75]
buffer_load_dwordx4 v28, s[8:11], s29 offen offset:1024 lds
v_mfma_f32_16x16x32_bf16 v[76:79], a[4:7], a[96:99], v[76:79]
s_waitcnt lgkmcnt(7)
v_mfma_f32_16x16x32_bf16 v[80:83], a[8:11], a[84:87], v[80:83]
ds_read_b64_tr_b16 a[24:25], v8 offset:0
ds_read_b64_tr_b16 a[26:27], v8 offset:1024
v_mfma_f32_16x16x32_bf16 v[84:87], a[8:11], a[88:91], v[84:87]
v_mfma_f32_16x16x32_bf16 v[88:91], a[8:11], a[92:95], v[88:91]
buffer_load_dwordx4 v29, s[8:11], s29 offen offset:2048 lds
v_mfma_f32_16x16x32_bf16 v[92:95], a[8:11], a[96:99], v[92:95]
s_add_u32 s29, s29, 393216
v_mfma_f32_16x16x32_bf16 v[96:99], a[12:15], a[84:87], v[96:99]
ds_read_b64_tr_b16 a[28:29], v9 offset:0
ds_read_b64_tr_b16 a[30:31], v9 offset:1024
v_mfma_f32_16x16x32_bf16 v[100:103], a[12:15], a[88:91], v[100:103]
s_add_u32 m0, s33, 32768
v_mfma_f32_16x16x32_bf16 v[104:107], a[12:15], a[92:95], v[104:107]
buffer_load_dwordx4 v16, s[20:23], s30 offen offset:0 lds
v_mfma_f32_16x16x32_bf16 v[108:111], a[12:15], a[96:99], v[108:111]
s_waitcnt lgkmcnt(5)
v_mfma_f32_16x16x32_bf16 v[112:115], a[16:19], a[84:87], v[112:115]
ds_read_b64_tr_b16 a[32:33], v10 offset:0
ds_read_b64_tr_b16 a[34:35], v10 offset:1024
v_mfma_f32_16x16x32_bf16 v[116:119], a[16:19], a[88:91], v[116:119]
v_mfma_f32_16x16x32_bf16 v[120:123], a[16:19], a[92:95], v[120:123]
buffer_load_dwordx4 v17, s[20:23], s30 offen offset:1024 lds
v_mfma_f32_16x16x32_bf16 v[124:127], a[16:19], a[96:99], v[124:127]
v_mfma_f32_16x16x32_bf16 v[128:131], a[20:23], a[84:87], v[128:131]
ds_read_b64_tr_b16 a[36:37], v11 offset:0
ds_read_b64_tr_b16 a[38:39], v11 offset:1024
v_mfma_f32_16x16x32_bf16 v[132:135], a[20:23], a[88:91], v[132:135]
v_mfma_f32_16x16x32_bf16 v[136:139], a[20:23], a[92:95], v[136:139]
buffer_load_dwordx4 v18, s[20:23], s30 offen offset:2048 lds
v_mfma_f32_16x16x32_bf16 v[140:143], a[20:23], a[96:99], v[140:143]
s_waitcnt lgkmcnt(4)
v_mfma_f32_16x16x32_bf16 v[144:147], a[24:27], a[84:87], v[144:147]
ds_read_b64_tr_b16 a[40:41], v12 offset:0
ds_read_b64_tr_b16 a[42:43], v12 offset:1024
v_mfma_f32_16x16x32_bf16 v[148:151], a[24:27], a[88:91], v[148:151]
v_mfma_f32_16x16x32_bf16 v[152:155], a[24:27], a[92:95], v[152:155]
buffer_load_dwordx4 v19, s[20:23], s30 offen offset:3072 lds
v_mfma_f32_16x16x32_bf16 v[156:159], a[24:27], a[96:99], v[156:159]
s_add_u32 s30, s30, 458752
v_mfma_f32_16x16x32_bf16 v[160:163], a[28:31], a[84:87], v[160:163]
ds_read_b64_tr_b16 a[44:45], v13 offset:0
ds_read_b64_tr_b16 a[46:47], v13 offset:1024
v_mfma_f32_16x16x32_bf16 v[164:167], a[28:31], a[88:91], v[164:167]
s_add_u32 m0, s35, 32768
v_mfma_f32_16x16x32_bf16 v[168:171], a[28:31], a[92:95], v[168:171]
buffer_load_dwordx4 v20, s[40:43], s31 offen offset:0 lds
v_mfma_f32_16x16x32_bf16 v[172:175], a[28:31], a[96:99], v[172:175]
s_waitcnt lgkmcnt(4)
v_mfma_f32_16x16x32_bf16 v[176:179], a[32:35], a[84:87], v[176:179]
ds_read_b64_tr_b16 a[48:49], v14 offset:0
ds_read_b64_tr_b16 a[50:51], v14 offset:1024
v_mfma_f32_16x16x32_bf16 v[180:183], a[32:35], a[88:91], v[180:183]
v_mfma_f32_16x16x32_bf16 v[184:187], a[32:35], a[92:95], v[184:187]
buffer_load_dwordx4 v21, s[40:43], s31 offen offset:1024 lds
v_mfma_f32_16x16x32_bf16 v[188:191], a[32:35], a[96:99], v[188:191]
v_mfma_f32_16x16x32_bf16 v[192:195], a[36:39], a[84:87], v[192:195]
ds_read_b64_tr_b16 a[0:1], v6 offset:6144
ds_read_b64_tr_b16 a[2:3], v6 offset:6400
v_mfma_f32_16x16x32_bf16 v[196:199], a[36:39], a[88:91], v[196:199]
v_mfma_f32_16x16x32_bf16 v[200:203], a[36:39], a[92:95], v[200:203]
buffer_load_dwordx4 v22, s[40:43], s31 offen offset:2048 lds
v_mfma_f32_16x16x32_bf16 v[204:207], a[36:39], a[96:99], v[204:207]
s_waitcnt lgkmcnt(4)
v_mfma_f32_16x16x32_bf16 v[208:211], a[40:43], a[84:87], v[208:211]
ds_read_b64_tr_b16 a[4:5], v7 offset:6144
ds_read_b64_tr_b16 a[6:7], v7 offset:6400
v_mfma_f32_16x16x32_bf16 v[212:215], a[40:43], a[88:91], v[212:215]
v_mfma_f32_16x16x32_bf16 v[216:219], a[40:43], a[92:95], v[216:219]
buffer_load_dwordx4 v23, s[40:43], s31 offen offset:3072 lds
v_mfma_f32_16x16x32_bf16 v[220:223], a[40:43], a[96:99], v[220:223]
v_mfma_f32_16x16x32_bf16 v[224:227], a[44:47], a[84:87], v[224:227]
ds_read_b64_tr_b16 a[8:9], v6 offset:7168
ds_read_b64_tr_b16 a[10:11], v6 offset:7424
v_mfma_f32_16x16x32_bf16 v[228:231], a[44:47], a[88:91], v[228:231]
s_add_u32 m0, s35, 36864
v_mfma_f32_16x16x32_bf16 v[232:235], a[44:47], a[92:95], v[232:235]
buffer_load_dwordx4 v20, s[40:43], s34 offen offset:0 lds
v_mfma_f32_16x16x32_bf16 v[236:239], a[44:47], a[96:99], v[236:239]
s_waitcnt lgkmcnt(4)
v_mfma_f32_16x16x32_bf16 v[240:243], a[48:51], a[84:87], v[240:243]
ds_read_b64_tr_b16 a[12:13], v7 offset:7168
ds_read_b64_tr_b16 a[14:15], v7 offset:7424
v_mfma_f32_16x16x32_bf16 v[244:247], a[48:51], a[88:91], v[244:247]
v_mfma_f32_16x16x32_bf16 v[248:251], a[48:51], a[92:95], v[248:251]
buffer_load_dwordx4 v21, s[40:43], s34 offen offset:1024 lds
v_mfma_f32_16x16x32_bf16 v[252:255], a[48:51], a[96:99], v[252:255]
v_mfma_f32_16x16x32_bf16 v[48:51], a[0:3], a[100:103], v[48:51]
ds_read_b64_tr_b16 a[16:17], v6 offset:8192
ds_read_b64_tr_b16 a[18:19], v6 offset:8448
v_mfma_f32_16x16x32_bf16 v[52:55], a[0:3], a[104:107], v[52:55]
v_mfma_f32_16x16x32_bf16 v[56:59], a[0:3], a[108:111], v[56:59]
buffer_load_dwordx4 v22, s[40:43], s34 offen offset:2048 lds
v_mfma_f32_16x16x32_bf16 v[60:63], a[0:3], a[112:115], v[60:63]
s_waitcnt lgkmcnt(4)
v_mfma_f32_16x16x32_bf16 v[64:67], a[4:7], a[100:103], v[64:67]
ds_read_b64_tr_b16 a[20:21], v7 offset:8192
ds_read_b64_tr_b16 a[22:23], v7 offset:8448
v_mfma_f32_16x16x32_bf16 v[68:71], a[4:7], a[104:107], v[68:71]
v_mfma_f32_16x16x32_bf16 v[72:75], a[4:7], a[108:111], v[72:75]
buffer_load_dwordx4 v23, s[40:43], s34 offen offset:3072 lds
v_mfma_f32_16x16x32_bf16 v[76:79], a[4:7], a[112:115], v[76:79]
s_add_u32 s31, s31, 128
s_add_u32 s34, s31, 65536
v_mfma_f32_16x16x32_bf16 v[80:83], a[8:11], a[100:103], v[80:83]
ds_read_b64_tr_b16 a[24:25], v8 offset:8192
ds_read_b64_tr_b16 a[26:27], v8 offset:9216
v_mfma_f32_16x16x32_bf16 v[84:87], a[8:11], a[104:107], v[84:87]
v_mfma_f32_16x16x32_bf16 v[88:91], a[8:11], a[108:111], v[88:91]
buffer_load_dword v39, v43, s[8:11], s36 offen
v_mfma_f32_16x16x32_bf16 v[92:95], a[8:11], a[112:115], v[92:95]
s_waitcnt lgkmcnt(4)
v_mfma_f32_16x16x32_bf16 v[96:99], a[12:15], a[100:103], v[96:99]
ds_read_b64_tr_b16 a[28:29], v9 offset:8192
ds_read_b64_tr_b16 a[30:31], v9 offset:9216
v_mfma_f32_16x16x32_bf16 v[100:103], a[12:15], a[104:107], v[100:103]
v_mfma_f32_16x16x32_bf16 v[104:107], a[12:15], a[108:111], v[104:107]
buffer_load_dword v39, v44, s[20:23], s37 offen
v_mfma_f32_16x16x32_bf16 v[108:111], a[12:15], a[112:115], v[108:111]
s_add_u32 s36, s36, 393216
s_add_u32 s37, s37, 458752
v_mfma_f32_16x16x32_bf16 v[112:115], a[16:19], a[100:103], v[112:115]
ds_read_b64_tr_b16 a[32:33], v10 offset:8192
ds_read_b64_tr_b16 a[34:35], v10 offset:9216
v_mfma_f32_16x16x32_bf16 v[116:119], a[16:19], a[104:107], v[116:119]
v_mfma_f32_16x16x32_bf16 v[120:123], a[16:19], a[108:111], v[120:123]
v_mfma_f32_16x16x32_bf16 v[124:127], a[16:19], a[112:115], v[124:127]
s_waitcnt lgkmcnt(4)
v_mfma_f32_16x16x32_bf16 v[128:131], a[20:23], a[100:103], v[128:131]
ds_read_b64_tr_b16 a[36:37], v11 offset:8192
ds_read_b64_tr_b16 a[38:39], v11 offset:9216
v_mfma_f32_16x16x32_bf16 v[132:135], a[20:23], a[104:107], v[132:135]
v_mfma_f32_16x16x32_bf16 v[136:139], a[20:23], a[108:111], v[136:139]
v_mfma_f32_16x16x32_bf16 v[140:143], a[20:23], a[112:115], v[140:143]
v_mfma_f32_16x16x32_bf16 v[144:147], a[24:27], a[100:103], v[144:147]
ds_read_b64_tr_b16 a[40:41], v12 offset:8192
ds_read_b64_tr_b16 a[42:43], v12 offset:9216
v_mfma_f32_16x16x32_bf16 v[148:151], a[24:27], a[104:107], v[148:151]
v_mfma_f32_16x16x32_bf16 v[152:155], a[24:27], a[108:111], v[152:155]
v_mfma_f32_16x16x32_bf16 v[156:159], a[24:27], a[112:115], v[156:159]
s_waitcnt lgkmcnt(4)
v_mfma_f32_16x16x32_bf16 v[160:163], a[28:31], a[100:103], v[160:163]
ds_read_b64_tr_b16 a[44:45], v13 offset:8192
ds_read_b64_tr_b16 a[46:47], v13 offset:9216
v_mfma_f32_16x16x32_bf16 v[164:167], a[28:31], a[104:107], v[164:167]
v_mfma_f32_16x16x32_bf16 v[168:171], a[28:31], a[108:111], v[168:171]
v_mfma_f32_16x16x32_bf16 v[172:175], a[28:31], a[112:115], v[172:175]
v_mfma_f32_16x16x32_bf16 v[176:179], a[32:35], a[100:103], v[176:179]
ds_read_b64_tr_b16 a[48:49], v14 offset:8192
ds_read_b64_tr_b16 a[50:51], v14 offset:9216
v_mfma_f32_16x16x32_bf16 v[180:183], a[32:35], a[104:107], v[180:183]
v_mfma_f32_16x16x32_bf16 v[184:187], a[32:35], a[108:111], v[184:187]
v_mfma_f32_16x16x32_bf16 v[188:191], a[32:35], a[112:115], v[188:191]
s_waitcnt vmcnt(21)
s_barrier
s_mul_i32 s39, s5, 128
s_add_u32 s39, s39, 39856128
s_cmp_lg_u32 s28, 0
s_cbranch_scc1 L_sig_6
v_mov_b32 v2, s39
v_mov_b32 v3, 1
s_mov_b64 exec, 1
buffer_atomic_add v3, v2, s[24:27], 0 offen sc1
s_mov_b64 exec, -1
L_sig_6:
s_waitcnt lgkmcnt(4)
v_mfma_f32_16x16x32_bf16 v[192:195], a[36:39], a[100:103], v[192:195]
ds_read_b64_tr_b16 a[0:1], v6 offset:12288
ds_read_b64_tr_b16 a[2:3], v6 offset:12544
v_mfma_f32_16x16x32_bf16 v[196:199], a[36:39], a[104:107], v[196:199]
ds_read_b128 a[52:55], v36 offset:0
v_mfma_f32_16x16x32_bf16 v[200:203], a[36:39], a[108:111], v[200:203]
v_mfma_f32_16x16x32_bf16 v[204:207], a[36:39], a[112:115], v[204:207]
ds_read_b128 a[56:59], v36 offset:2048
v_mfma_f32_16x16x32_bf16 v[208:211], a[40:43], a[100:103], v[208:211]
ds_read_b64_tr_b16 a[4:5], v7 offset:12288
ds_read_b64_tr_b16 a[6:7], v7 offset:12544
v_mfma_f32_16x16x32_bf16 v[212:215], a[40:43], a[104:107], v[212:215]
ds_read_b128 a[60:63], v36 offset:4096
v_mfma_f32_16x16x32_bf16 v[216:219], a[40:43], a[108:111], v[216:219]
v_mfma_f32_16x16x32_bf16 v[220:223], a[40:43], a[112:115], v[220:223]
ds_read_b128 a[64:67], v36 offset:6144
s_waitcnt lgkmcnt(8)
v_mfma_f32_16x16x32_bf16 v[224:227], a[44:47], a[100:103], v[224:227]
ds_read_b64_tr_b16 a[8:9], v6 offset:13312
ds_read_b64_tr_b16 a[10:11], v6 offset:13568
v_mfma_f32_16x16x32_bf16 v[228:231], a[44:47], a[104:107], v[228:231]
ds_read_b128 a[68:71], v37 offset:0
v_mfma_f32_16x16x32_bf16 v[232:235], a[44:47], a[108:111], v[232:235]
v_mfma_f32_16x16x32_bf16 v[236:239], a[44:47], a[112:115], v[236:239]
v_mfma_f32_16x16x32_bf16 v[240:243], a[48:51], a[100:103], v[240:243]
ds_read_b64_tr_b16 a[12:13], v7 offset:13312
ds_read_b64_tr_b16 a[14:15], v7 offset:13568
v_mfma_f32_16x16x32_bf16 v[244:247], a[48:51], a[104:107], v[244:247]
ds_read_b128 a[72:75], v37 offset:2048
v_mfma_f32_16x16x32_bf16 v[248:251], a[48:51], a[108:111], v[248:251]
v_mfma_f32_16x16x32_bf16 v[252:255], a[48:51], a[112:115], v[252:255]
s_waitcnt lgkmcnt(6)
v_mfma_f32_16x16x32_bf16 v[48:51], a[0:3], a[52:55], v[48:51]
ds_read_b64_tr_b16 a[16:17], v6 offset:14336
ds_read_b64_tr_b16 a[18:19], v6 offset:14592
v_mfma_f32_16x16x32_bf16 v[52:55], a[0:3], a[56:59], v[52:55]
ds_read_b128 a[76:79], v37 offset:4096
s_add_u32 m0, s32, 0
v_mfma_f32_16x16x32_bf16 v[56:59], a[0:3], a[60:63], v[56:59]
buffer_load_dwordx4 v15, s[8:11], s29 offen offset:0 lds
v_mfma_f32_16x16x32_bf16 v[60:63], a[0:3], a[64:67], v[60:63]
v_mfma_f32_16x16x32_bf16 v[64:67], a[4:7], a[52:55], v[64:67]
ds_read_b64_tr_b16 a[20:21], v7 offset:14336
ds_read_b64_tr_b16 a[22:23], v7 offset:14592
v_mfma_f32_16x16x32_bf16 v[68:71], a[4:7], a[56:59], v[68:71]
ds_read_b128 a[80:83], v37 offset:6144
v_mfma_f32_16x16x32_bf16 v[72:75], a[4:7], a[60:63], v[72:75]
buffer_load_dwordx4 v28, s[8:11], s29 offen offset:1024 lds
v_mfma_f32_16x16x32_bf16 v[76:79], a[4:7], a[64:67], v[76:79]
s_waitcnt lgkmcnt(7)
v_mfma_f32_16x16x32_bf16 v[80:83], a[8:11], a[52:55], v[80:83]
ds_read_b64_tr_b16 a[24:25], v8 offset:16384
ds_read_b64_tr_b16 a[26:27], v8 offset:17408
v_mfma_f32_16x16x32_bf16 v[84:87], a[8:11], a[56:59], v[84:87]
v_mfma_f32_16x16x32_bf16 v[88:91], a[8:11], a[60:63], v[88:91]
buffer_load_dwordx4 v29, s[8:11], s29 offen offset:2048 lds
v_mfma_f32_16x16x32_bf16 v[92:95], a[8:11], a[64:67], v[92:95]
s_add_u32 s29, s29, 393216
v_mfma_f32_16x16x32_bf16 v[96:99], a[12:15], a[52:55], v[96:99]
ds_read_b64_tr_b16 a[28:29], v9 offset:16384
ds_read_b64_tr_b16 a[30:31], v9 offset:17408
v_mfma_f32_16x16x32_bf16 v[100:103], a[12:15], a[56:59], v[100:103]
s_add_u32 m0, s33, 0
v_mfma_f32_16x16x32_bf16 v[104:107], a[12:15], a[60:63], v[104:107]
buffer_load_dwordx4 v16, s[20:23], s30 offen offset:0 lds
v_mfma_f32_16x16x32_bf16 v[108:111], a[12:15], a[64:67], v[108:111]
s_waitcnt lgkmcnt(5)
v_mfma_f32_16x16x32_bf16 v[112:115], a[16:19], a[52:55], v[112:115]
ds_read_b64_tr_b16 a[32:33], v10 offset:16384
ds_read_b64_tr_b16 a[34:35], v10 offset:17408
v_mfma_f32_16x16x32_bf16 v[116:119], a[16:19], a[56:59], v[116:119]
v_mfma_f32_16x16x32_bf16 v[120:123], a[16:19], a[60:63], v[120:123]
buffer_load_dwordx4 v17, s[20:23], s30 offen offset:1024 lds
v_mfma_f32_16x16x32_bf16 v[124:127], a[16:19], a[64:67], v[124:127]
v_mfma_f32_16x16x32_bf16 v[128:131], a[20:23], a[52:55], v[128:131]
ds_read_b64_tr_b16 a[36:37], v11 offset:16384
ds_read_b64_tr_b16 a[38:39], v11 offset:17408
v_mfma_f32_16x16x32_bf16 v[132:135], a[20:23], a[56:59], v[132:135]
v_mfma_f32_16x16x32_bf16 v[136:139], a[20:23], a[60:63], v[136:139]
buffer_load_dwordx4 v18, s[20:23], s30 offen offset:2048 lds
v_mfma_f32_16x16x32_bf16 v[140:143], a[20:23], a[64:67], v[140:143]
s_waitcnt lgkmcnt(4)
v_mfma_f32_16x16x32_bf16 v[144:147], a[24:27], a[52:55], v[144:147]
ds_read_b64_tr_b16 a[40:41], v12 offset:16384
ds_read_b64_tr_b16 a[42:43], v12 offset:17408
v_mfma_f32_16x16x32_bf16 v[148:151], a[24:27], a[56:59], v[148:151]
v_mfma_f32_16x16x32_bf16 v[152:155], a[24:27], a[60:63], v[152:155]
buffer_load_dwordx4 v19, s[20:23], s30 offen offset:3072 lds
v_mfma_f32_16x16x32_bf16 v[156:159], a[24:27], a[64:67], v[156:159]
s_add_u32 s30, s30, 458752
v_mfma_f32_16x16x32_bf16 v[160:163], a[28:31], a[52:55], v[160:163]
ds_read_b64_tr_b16 a[44:45], v13 offset:16384
ds_read_b64_tr_b16 a[46:47], v13 offset:17408
v_mfma_f32_16x16x32_bf16 v[164:167], a[28:31], a[56:59], v[164:167]
s_add_u32 m0, s35, 0
v_mfma_f32_16x16x32_bf16 v[168:171], a[28:31], a[60:63], v[168:171]
buffer_load_dwordx4 v20, s[40:43], s31 offen offset:0 lds
v_mfma_f32_16x16x32_bf16 v[172:175], a[28:31], a[64:67], v[172:175]
s_waitcnt lgkmcnt(4)
v_mfma_f32_16x16x32_bf16 v[176:179], a[32:35], a[52:55], v[176:179]
ds_read_b64_tr_b16 a[48:49], v14 offset:16384
ds_read_b64_tr_b16 a[50:51], v14 offset:17408
v_mfma_f32_16x16x32_bf16 v[180:183], a[32:35], a[56:59], v[180:183]
v_mfma_f32_16x16x32_bf16 v[184:187], a[32:35], a[60:63], v[184:187]
buffer_load_dwordx4 v21, s[40:43], s31 offen offset:1024 lds
v_mfma_f32_16x16x32_bf16 v[188:191], a[32:35], a[64:67], v[188:191]
v_mfma_f32_16x16x32_bf16 v[192:195], a[36:39], a[52:55], v[192:195]
ds_read_b64_tr_b16 a[0:1], v6 offset:18432
ds_read_b64_tr_b16 a[2:3], v6 offset:18688
v_mfma_f32_16x16x32_bf16 v[196:199], a[36:39], a[56:59], v[196:199]
v_mfma_f32_16x16x32_bf16 v[200:203], a[36:39], a[60:63], v[200:203]
buffer_load_dwordx4 v22, s[40:43], s31 offen offset:2048 lds
v_mfma_f32_16x16x32_bf16 v[204:207], a[36:39], a[64:67], v[204:207]
s_waitcnt lgkmcnt(4)
v_mfma_f32_16x16x32_bf16 v[208:211], a[40:43], a[52:55], v[208:211]
ds_read_b64_tr_b16 a[4:5], v7 offset:18432
ds_read_b64_tr_b16 a[6:7], v7 offset:18688
v_mfma_f32_16x16x32_bf16 v[212:215], a[40:43], a[56:59], v[212:215]
v_mfma_f32_16x16x32_bf16 v[216:219], a[40:43], a[60:63], v[216:219]
buffer_load_dwordx4 v23, s[40:43], s31 offen offset:3072 lds
v_mfma_f32_16x16x32_bf16 v[220:223], a[40:43], a[64:67], v[220:223]
v_mfma_f32_16x16x32_bf16 v[224:227], a[44:47], a[52:55], v[224:227]
ds_read_b64_tr_b16 a[8:9], v6 offset:19456
ds_read_b64_tr_b16 a[10:11], v6 offset:19712
v_mfma_f32_16x16x32_bf16 v[228:231], a[44:47], a[56:59], v[228:231]
s_add_u32 m0, s35, 4096
v_mfma_f32_16x16x32_bf16 v[232:235], a[44:47], a[60:63], v[232:235]
buffer_load_dwordx4 v20, s[40:43], s34 offen offset:0 lds
v_mfma_f32_16x16x32_bf16 v[236:239], a[44:47], a[64:67], v[236:239]
s_waitcnt lgkmcnt(4)
v_mfma_f32_16x16x32_bf16 v[240:243], a[48:51], a[52:55], v[240:243]
ds_read_b64_tr_b16 a[12:13], v7 offset:19456
ds_read_b64_tr_b16 a[14:15], v7 offset:19712
v_mfma_f32_16x16x32_bf16 v[244:247], a[48:51], a[56:59], v[244:247]
v_mfma_f32_16x16x32_bf16 v[248:251], a[48:51], a[60:63], v[248:251]
buffer_load_dwordx4 v21, s[40:43], s34 offen offset:1024 lds
v_mfma_f32_16x16x32_bf16 v[252:255], a[48:51], a[64:67], v[252:255]
v_mfma_f32_16x16x32_bf16 v[48:51], a[0:3], a[68:71], v[48:51]
ds_read_b64_tr_b16 a[16:17], v6 offset:20480
ds_read_b64_tr_b16 a[18:19], v6 offset:20736
v_mfma_f32_16x16x32_bf16 v[52:55], a[0:3], a[72:75], v[52:55]
v_mfma_f32_16x16x32_bf16 v[56:59], a[0:3], a[76:79], v[56:59]
buffer_load_dwordx4 v22, s[40:43], s34 offen offset:2048 lds
v_mfma_f32_16x16x32_bf16 v[60:63], a[0:3], a[80:83], v[60:63]
s_waitcnt lgkmcnt(4)
v_mfma_f32_16x16x32_bf16 v[64:67], a[4:7], a[68:71], v[64:67]
ds_read_b64_tr_b16 a[20:21], v7 offset:20480
ds_read_b64_tr_b16 a[22:23], v7 offset:20736
v_mfma_f32_16x16x32_bf16 v[68:71], a[4:7], a[72:75], v[68:71]
v_mfma_f32_16x16x32_bf16 v[72:75], a[4:7], a[76:79], v[72:75]
buffer_load_dwordx4 v23, s[40:43], s34 offen offset:3072 lds
v_mfma_f32_16x16x32_bf16 v[76:79], a[4:7], a[80:83], v[76:79]
s_add_u32 s31, s31, 128
s_add_u32 s34, s31, 65536
v_mfma_f32_16x16x32_bf16 v[80:83], a[8:11], a[68:71], v[80:83]
ds_read_b64_tr_b16 a[24:25], v8 offset:24576
ds_read_b64_tr_b16 a[26:27], v8 offset:25600
v_mfma_f32_16x16x32_bf16 v[84:87], a[8:11], a[72:75], v[84:87]
v_mfma_f32_16x16x32_bf16 v[88:91], a[8:11], a[76:79], v[88:91]
buffer_load_dword v39, v43, s[8:11], s36 offen
v_mfma_f32_16x16x32_bf16 v[92:95], a[8:11], a[80:83], v[92:95]
s_waitcnt lgkmcnt(4)
v_mfma_f32_16x16x32_bf16 v[96:99], a[12:15], a[68:71], v[96:99]
ds_read_b64_tr_b16 a[28:29], v9 offset:24576
ds_read_b64_tr_b16 a[30:31], v9 offset:25600
v_mfma_f32_16x16x32_bf16 v[100:103], a[12:15], a[72:75], v[100:103]
v_mfma_f32_16x16x32_bf16 v[104:107], a[12:15], a[76:79], v[104:107]
buffer_load_dword v39, v44, s[20:23], s37 offen
v_mfma_f32_16x16x32_bf16 v[108:111], a[12:15], a[80:83], v[108:111]
s_add_u32 s36, s36, 393216
s_add_u32 s37, s37, 458752
v_mfma_f32_16x16x32_bf16 v[112:115], a[16:19], a[68:71], v[112:115]
ds_read_b64_tr_b16 a[32:33], v10 offset:24576
ds_read_b64_tr_b16 a[34:35], v10 offset:25600
v_mfma_f32_16x16x32_bf16 v[116:119], a[16:19], a[72:75], v[116:119]
v_mfma_f32_16x16x32_bf16 v[120:123], a[16:19], a[76:79], v[120:123]
buffer_load_dword v39, v38, s[92:95], s61 offen
v_mfma_f32_16x16x32_bf16 v[124:127], a[16:19], a[80:83], v[124:127]
s_waitcnt lgkmcnt(4)
v_mfma_f32_16x16x32_bf16 v[128:131], a[20:23], a[68:71], v[128:131]
ds_read_b64_tr_b16 a[36:37], v11 offset:24576
ds_read_b64_tr_b16 a[38:39], v11 offset:25600
v_mfma_f32_16x16x32_bf16 v[132:135], a[20:23], a[72:75], v[132:135]
v_mfma_f32_16x16x32_bf16 v[136:139], a[20:23], a[76:79], v[136:139]
buffer_load_dword v39, v40, s[96:99], s101 offen
v_mfma_f32_16x16x32_bf16 v[140:143], a[20:23], a[80:83], v[140:143]
s_add_u32 s61, s61, 2432
s_add_u32 s101, s101, 768
v_mfma_f32_16x16x32_bf16 v[144:147], a[24:27], a[68:71], v[144:147]
ds_read_b64_tr_b16 a[40:41], v12 offset:24576
ds_read_b64_tr_b16 a[42:43], v12 offset:25600
v_mfma_f32_16x16x32_bf16 v[148:151], a[24:27], a[72:75], v[148:151]
v_mfma_f32_16x16x32_bf16 v[152:155], a[24:27], a[76:79], v[152:155]
v_mfma_f32_16x16x32_bf16 v[156:159], a[24:27], a[80:83], v[156:159]
s_waitcnt lgkmcnt(4)
v_mfma_f32_16x16x32_bf16 v[160:163], a[28:31], a[68:71], v[160:163]
ds_read_b64_tr_b16 a[44:45], v13 offset:24576
ds_read_b64_tr_b16 a[46:47], v13 offset:25600
v_mfma_f32_16x16x32_bf16 v[164:167], a[28:31], a[72:75], v[164:167]
v_mfma_f32_16x16x32_bf16 v[168:171], a[28:31], a[76:79], v[168:171]
v_mfma_f32_16x16x32_bf16 v[172:175], a[28:31], a[80:83], v[172:175]
v_mfma_f32_16x16x32_bf16 v[176:179], a[32:35], a[68:71], v[176:179]
ds_read_b64_tr_b16 a[48:49], v14 offset:24576
ds_read_b64_tr_b16 a[50:51], v14 offset:25600
v_mfma_f32_16x16x32_bf16 v[180:183], a[32:35], a[72:75], v[180:183]
v_mfma_f32_16x16x32_bf16 v[184:187], a[32:35], a[76:79], v[184:187]
v_mfma_f32_16x16x32_bf16 v[188:191], a[32:35], a[80:83], v[188:191]
s_waitcnt vmcnt(21)
s_barrier
s_waitcnt lgkmcnt(4)
v_mfma_f32_16x16x32_bf16 v[192:195], a[36:39], a[68:71], v[192:195]
ds_read_b64_tr_b16 a[0:1], v6 offset:24576
ds_read_b64_tr_b16 a[2:3], v6 offset:24832
v_mfma_f32_16x16x32_bf16 v[196:199], a[36:39], a[72:75], v[196:199]
ds_read_b128 a[84:87], v36 offset:32768
v_mfma_f32_16x16x32_bf16 v[200:203], a[36:39], a[76:79], v[200:203]
v_mfma_f32_16x16x32_bf16 v[204:207], a[36:39], a[80:83], v[204:207]
ds_read_b128 a[88:91], v36 offset:34816
v_mfma_f32_16x16x32_bf16 v[208:211], a[40:43], a[68:71], v[208:211]
ds_read_b64_tr_b16 a[4:5], v7 offset:24576
ds_read_b64_tr_b16 a[6:7], v7 offset:24832
v_mfma_f32_16x16x32_bf16 v[212:215], a[40:43], a[72:75], v[212:215]
ds_read_b128 a[92:95], v36 offset:36864
v_mfma_f32_16x16x32_bf16 v[216:219], a[40:43], a[76:79], v[216:219]
v_mfma_f32_16x16x32_bf16 v[220:223], a[40:43], a[80:83], v[220:223]
ds_read_b128 a[96:99], v36 offset:38912
s_waitcnt lgkmcnt(8)
v_mfma_f32_16x16x32_bf16 v[224:227], a[44:47], a[68:71], v[224:227]
ds_read_b64_tr_b16 a[8:9], v6 offset:25600
ds_read_b64_tr_b16 a[10:11], v6 offset:25856
v_mfma_f32_16x16x32_bf16 v[228:231], a[44:47], a[72:75], v[228:231]
ds_read_b128 a[100:103], v37 offset:32768
v_mfma_f32_16x16x32_bf16 v[232:235], a[44:47], a[76:79], v[232:235]
v_mfma_f32_16x16x32_bf16 v[236:239], a[44:47], a[80:83], v[236:239]
v_mfma_f32_16x16x32_bf16 v[240:243], a[48:51], a[68:71], v[240:243]
ds_read_b64_tr_b16 a[12:13], v7 offset:25600
ds_read_b64_tr_b16 a[14:15], v7 offset:25856
v_mfma_f32_16x16x32_bf16 v[244:247], a[48:51], a[72:75], v[244:247]
ds_read_b128 a[104:107], v37 offset:34816
v_mfma_f32_16x16x32_bf16 v[248:251], a[48:51], a[76:79], v[248:251]
v_mfma_f32_16x16x32_bf16 v[252:255], a[48:51], a[80:83], v[252:255]
s_waitcnt lgkmcnt(6)
v_mfma_f32_16x16x32_bf16 v[48:51], a[0:3], a[84:87], v[48:51]
ds_read_b64_tr_b16 a[16:17], v6 offset:26624
ds_read_b64_tr_b16 a[18:19], v6 offset:26880
v_mfma_f32_16x16x32_bf16 v[52:55], a[0:3], a[88:91], v[52:55]
ds_read_b128 a[108:111], v37 offset:36864
s_add_u32 m0, s32, 12288
v_mfma_f32_16x16x32_bf16 v[56:59], a[0:3], a[92:95], v[56:59]
buffer_load_dwordx4 v15, s[8:11], s29 offen offset:0 lds
v_mfma_f32_16x16x32_bf16 v[60:63], a[0:3], a[96:99], v[60:63]
v_mfma_f32_16x16x32_bf16 v[64:67], a[4:7], a[84:87], v[64:67]
ds_read_b64_tr_b16 a[20:21], v7 offset:26624
ds_read_b64_tr_b16 a[22:23], v7 offset:26880
v_mfma_f32_16x16x32_bf16 v[68:71], a[4:7], a[88:91], v[68:71]
ds_read_b128 a[112:115], v37 offset:38912
v_mfma_f32_16x16x32_bf16 v[72:75], a[4:7], a[92:95], v[72:75]
buffer_load_dwordx4 v28, s[8:11], s29 offen offset:1024 lds
v_mfma_f32_16x16x32_bf16 v[76:79], a[4:7], a[96:99], v[76:79]
s_waitcnt lgkmcnt(7)
v_mfma_f32_16x16x32_bf16 v[80:83], a[8:11], a[84:87], v[80:83]
ds_read_b64_tr_b16 a[24:25], v8 offset:32768
ds_read_b64_tr_b16 a[26:27], v8 offset:33792
v_mfma_f32_16x16x32_bf16 v[84:87], a[8:11], a[88:91], v[84:87]
v_mfma_f32_16x16x32_bf16 v[88:91], a[8:11], a[92:95], v[88:91]
buffer_load_dwordx4 v29, s[8:11], s29 offen offset:2048 lds
v_mfma_f32_16x16x32_bf16 v[92:95], a[8:11], a[96:99], v[92:95]
s_add_u32 s29, s29, 393216
v_mfma_f32_16x16x32_bf16 v[96:99], a[12:15], a[84:87], v[96:99]
ds_read_b64_tr_b16 a[28:29], v9 offset:32768
ds_read_b64_tr_b16 a[30:31], v9 offset:33792
v_mfma_f32_16x16x32_bf16 v[100:103], a[12:15], a[88:91], v[100:103]
s_add_u32 m0, s33, 16384
v_mfma_f32_16x16x32_bf16 v[104:107], a[12:15], a[92:95], v[104:107]
buffer_load_dwordx4 v16, s[20:23], s30 offen offset:0 lds
v_mfma_f32_16x16x32_bf16 v[108:111], a[12:15], a[96:99], v[108:111]
s_waitcnt lgkmcnt(5)
v_mfma_f32_16x16x32_bf16 v[112:115], a[16:19], a[84:87], v[112:115]
ds_read_b64_tr_b16 a[32:33], v10 offset:32768
ds_read_b64_tr_b16 a[34:35], v10 offset:33792
v_mfma_f32_16x16x32_bf16 v[116:119], a[16:19], a[88:91], v[116:119]
v_mfma_f32_16x16x32_bf16 v[120:123], a[16:19], a[92:95], v[120:123]
buffer_load_dwordx4 v17, s[20:23], s30 offen offset:1024 lds
v_mfma_f32_16x16x32_bf16 v[124:127], a[16:19], a[96:99], v[124:127]
v_mfma_f32_16x16x32_bf16 v[128:131], a[20:23], a[84:87], v[128:131]
ds_read_b64_tr_b16 a[36:37], v11 offset:32768
ds_read_b64_tr_b16 a[38:39], v11 offset:33792
v_mfma_f32_16x16x32_bf16 v[132:135], a[20:23], a[88:91], v[132:135]
v_mfma_f32_16x16x32_bf16 v[136:139], a[20:23], a[92:95], v[136:139]
buffer_load_dwordx4 v18, s[20:23], s30 offen offset:2048 lds
v_mfma_f32_16x16x32_bf16 v[140:143], a[20:23], a[96:99], v[140:143]
s_waitcnt lgkmcnt(4)
v_mfma_f32_16x16x32_bf16 v[144:147], a[24:27], a[84:87], v[144:147]
ds_read_b64_tr_b16 a[40:41], v12 offset:32768
ds_read_b64_tr_b16 a[42:43], v12 offset:33792
v_mfma_f32_16x16x32_bf16 v[148:151], a[24:27], a[88:91], v[148:151]
v_mfma_f32_16x16x32_bf16 v[152:155], a[24:27], a[92:95], v[152:155]
buffer_load_dwordx4 v19, s[20:23], s30 offen offset:3072 lds
v_mfma_f32_16x16x32_bf16 v[156:159], a[24:27], a[96:99], v[156:159]
s_add_u32 s30, s30, 458752
v_mfma_f32_16x16x32_bf16 v[160:163], a[28:31], a[84:87], v[160:163]
ds_read_b64_tr_b16 a[44:45], v13 offset:32768
ds_read_b64_tr_b16 a[46:47], v13 offset:33792
v_mfma_f32_16x16x32_bf16 v[164:167], a[28:31], a[88:91], v[164:167]
s_add_u32 m0, s35, 32768
v_mfma_f32_16x16x32_bf16 v[168:171], a[28:31], a[92:95], v[168:171]
buffer_load_dwordx4 v20, s[40:43], s31 offen offset:0 lds
v_mfma_f32_16x16x32_bf16 v[172:175], a[28:31], a[96:99], v[172:175]
s_waitcnt lgkmcnt(4)
v_mfma_f32_16x16x32_bf16 v[176:179], a[32:35], a[84:87], v[176:179]
ds_read_b64_tr_b16 a[48:49], v14 offset:32768
ds_read_b64_tr_b16 a[50:51], v14 offset:33792
v_mfma_f32_16x16x32_bf16 v[180:183], a[32:35], a[88:91], v[180:183]
v_mfma_f32_16x16x32_bf16 v[184:187], a[32:35], a[92:95], v[184:187]
buffer_load_dwordx4 v21, s[40:43], s31 offen offset:1024 lds
v_mfma_f32_16x16x32_bf16 v[188:191], a[32:35], a[96:99], v[188:191]
v_mfma_f32_16x16x32_bf16 v[192:195], a[36:39], a[84:87], v[192:195]
ds_read_b64_tr_b16 a[0:1], v6 offset:30720
ds_read_b64_tr_b16 a[2:3], v6 offset:30976
v_mfma_f32_16x16x32_bf16 v[196:199], a[36:39], a[88:91], v[196:199]
v_mfma_f32_16x16x32_bf16 v[200:203], a[36:39], a[92:95], v[200:203]
buffer_load_dwordx4 v22, s[40:43], s31 offen offset:2048 lds
v_mfma_f32_16x16x32_bf16 v[204:207], a[36:39], a[96:99], v[204:207]
s_waitcnt lgkmcnt(4)
v_mfma_f32_16x16x32_bf16 v[208:211], a[40:43], a[84:87], v[208:211]
ds_read_b64_tr_b16 a[4:5], v7 offset:30720
ds_read_b64_tr_b16 a[6:7], v7 offset:30976
v_mfma_f32_16x16x32_bf16 v[212:215], a[40:43], a[88:91], v[212:215]
v_mfma_f32_16x16x32_bf16 v[216:219], a[40:43], a[92:95], v[216:219]
buffer_load_dwordx4 v23, s[40:43], s31 offen offset:3072 lds
v_mfma_f32_16x16x32_bf16 v[220:223], a[40:43], a[96:99], v[220:223]
v_mfma_f32_16x16x32_bf16 v[224:227], a[44:47], a[84:87], v[224:227]
ds_read_b64_tr_b16 a[8:9], v6 offset:31744
ds_read_b64_tr_b16 a[10:11], v6 offset:32000
v_mfma_f32_16x16x32_bf16 v[228:231], a[44:47], a[88:91], v[228:231]
s_add_u32 m0, s35, 36864
v_mfma_f32_16x16x32_bf16 v[232:235], a[44:47], a[92:95], v[232:235]
buffer_load_dwordx4 v20, s[40:43], s34 offen offset:0 lds
v_mfma_f32_16x16x32_bf16 v[236:239], a[44:47], a[96:99], v[236:239]
s_waitcnt lgkmcnt(4)
v_mfma_f32_16x16x32_bf16 v[240:243], a[48:51], a[84:87], v[240:243]
ds_read_b64_tr_b16 a[12:13], v7 offset:31744
ds_read_b64_tr_b16 a[14:15], v7 offset:32000
v_mfma_f32_16x16x32_bf16 v[244:247], a[48:51], a[88:91], v[244:247]
v_mfma_f32_16x16x32_bf16 v[248:251], a[48:51], a[92:95], v[248:251]
buffer_load_dwordx4 v21, s[40:43], s34 offen offset:1024 lds
v_mfma_f32_16x16x32_bf16 v[252:255], a[48:51], a[96:99], v[252:255]
v_mfma_f32_16x16x32_bf16 v[48:51], a[0:3], a[100:103], v[48:51]
ds_read_b64_tr_b16 a[16:17], v6 offset:32768
ds_read_b64_tr_b16 a[18:19], v6 offset:33024
v_mfma_f32_16x16x32_bf16 v[52:55], a[0:3], a[104:107], v[52:55]
v_mfma_f32_16x16x32_bf16 v[56:59], a[0:3], a[108:111], v[56:59]
buffer_load_dwordx4 v22, s[40:43], s34 offen offset:2048 lds
v_mfma_f32_16x16x32_bf16 v[60:63], a[0:3], a[112:115], v[60:63]
s_waitcnt lgkmcnt(4)
v_mfma_f32_16x16x32_bf16 v[64:67], a[4:7], a[100:103], v[64:67]
ds_read_b64_tr_b16 a[20:21], v7 offset:32768
ds_read_b64_tr_b16 a[22:23], v7 offset:33024
v_mfma_f32_16x16x32_bf16 v[68:71], a[4:7], a[104:107], v[68:71]
v_mfma_f32_16x16x32_bf16 v[72:75], a[4:7], a[108:111], v[72:75]
buffer_load_dwordx4 v23, s[40:43], s34 offen offset:3072 lds
v_mfma_f32_16x16x32_bf16 v[76:79], a[4:7], a[112:115], v[76:79]
s_add_u32 s31, s31, 128
s_add_u32 s34, s31, 65536
v_mfma_f32_16x16x32_bf16 v[80:83], a[8:11], a[100:103], v[80:83]
ds_read_b64_tr_b16 a[24:25], v8 offset:40960
ds_read_b64_tr_b16 a[26:27], v8 offset:41984
v_mfma_f32_16x16x32_bf16 v[84:87], a[8:11], a[104:107], v[84:87]
v_mfma_f32_16x16x32_bf16 v[88:91], a[8:11], a[108:111], v[88:91]
buffer_load_dword v39, v43, s[8:11], s36 offen
v_mfma_f32_16x16x32_bf16 v[92:95], a[8:11], a[112:115], v[92:95]
s_waitcnt lgkmcnt(4)
v_mfma_f32_16x16x32_bf16 v[96:99], a[12:15], a[100:103], v[96:99]
ds_read_b64_tr_b16 a[28:29], v9 offset:40960
ds_read_b64_tr_b16 a[30:31], v9 offset:41984
v_mfma_f32_16x16x32_bf16 v[100:103], a[12:15], a[104:107], v[100:103]
v_mfma_f32_16x16x32_bf16 v[104:107], a[12:15], a[108:111], v[104:107]
buffer_load_dword v39, v44, s[20:23], s37 offen
v_mfma_f32_16x16x32_bf16 v[108:111], a[12:15], a[112:115], v[108:111]
s_add_u32 s36, s36, 393216
s_add_u32 s37, s37, 458752
v_mfma_f32_16x16x32_bf16 v[112:115], a[16:19], a[100:103], v[112:115]
ds_read_b64_tr_b16 a[32:33], v10 offset:40960
ds_read_b64_tr_b16 a[34:35], v10 offset:41984
v_mfma_f32_16x16x32_bf16 v[116:119], a[16:19], a[104:107], v[116:119]
v_mfma_f32_16x16x32_bf16 v[120:123], a[16:19], a[108:111], v[120:123]
v_mfma_f32_16x16x32_bf16 v[124:127], a[16:19], a[112:115], v[124:127]
s_waitcnt lgkmcnt(4)
v_mfma_f32_16x16x32_bf16 v[128:131], a[20:23], a[100:103], v[128:131]
ds_read_b64_tr_b16 a[36:37], v11 offset:40960
ds_read_b64_tr_b16 a[38:39], v11 offset:41984
v_mfma_f32_16x16x32_bf16 v[132:135], a[20:23], a[104:107], v[132:135]
v_mfma_f32_16x16x32_bf16 v[136:139], a[20:23], a[108:111], v[136:139]
v_mfma_f32_16x16x32_bf16 v[140:143], a[20:23], a[112:115], v[140:143]
v_mfma_f32_16x16x32_bf16 v[144:147], a[24:27], a[100:103], v[144:147]
ds_read_b64_tr_b16 a[40:41], v12 offset:40960
ds_read_b64_tr_b16 a[42:43], v12 offset:41984
v_mfma_f32_16x16x32_bf16 v[148:151], a[24:27], a[104:107], v[148:151]
v_mfma_f32_16x16x32_bf16 v[152:155], a[24:27], a[108:111], v[152:155]
v_mfma_f32_16x16x32_bf16 v[156:159], a[24:27], a[112:115], v[156:159]
s_waitcnt lgkmcnt(4)
v_mfma_f32_16x16x32_bf16 v[160:163], a[28:31], a[100:103], v[160:163]
ds_read_b64_tr_b16 a[44:45], v13 offset:40960
ds_read_b64_tr_b16 a[46:47], v13 offset:41984
v_mfma_f32_16x16x32_bf16 v[164:167], a[28:31], a[104:107], v[164:167]
v_mfma_f32_16x16x32_bf16 v[168:171], a[28:31], a[108:111], v[168:171]
v_mfma_f32_16x16x32_bf16 v[172:175], a[28:31], a[112:115], v[172:175]
v_mfma_f32_16x16x32_bf16 v[176:179], a[32:35], a[100:103], v[176:179]
ds_read_b64_tr_b16 a[48:49], v14 offset:40960
ds_read_b64_tr_b16 a[50:51], v14 offset:41984
v_mfma_f32_16x16x32_bf16 v[180:183], a[32:35], a[104:107], v[180:183]
v_mfma_f32_16x16x32_bf16 v[184:187], a[32:35], a[108:111], v[184:187]
v_mfma_f32_16x16x32_bf16 v[188:191], a[32:35], a[112:115], v[188:191]
s_waitcnt vmcnt(21)
s_barrier
s_waitcnt lgkmcnt(4)
v_mfma_f32_16x16x32_bf16 v[192:195], a[36:39], a[100:103], v[192:195]
ds_read_b64_tr_b16 a[0:1], v6 offset:0
ds_read_b64_tr_b16 a[2:3], v6 offset:256
v_mfma_f32_16x16x32_bf16 v[196:199], a[36:39], a[104:107], v[196:199]
ds_read_b128 a[52:55], v36 offset:0
v_mfma_f32_16x16x32_bf16 v[200:203], a[36:39], a[108:111], v[200:203]
v_mfma_f32_16x16x32_bf16 v[204:207], a[36:39], a[112:115], v[204:207]
ds_read_b128 a[56:59], v36 offset:2048
v_mfma_f32_16x16x32_bf16 v[208:211], a[40:43], a[100:103], v[208:211]
ds_read_b64_tr_b16 a[4:5], v7 offset:0
ds_read_b64_tr_b16 a[6:7], v7 offset:256
v_mfma_f32_16x16x32_bf16 v[212:215], a[40:43], a[104:107], v[212:215]
ds_read_b128 a[60:63], v36 offset:4096
v_mfma_f32_16x16x32_bf16 v[216:219], a[40:43], a[108:111], v[216:219]
v_mfma_f32_16x16x32_bf16 v[220:223], a[40:43], a[112:115], v[220:223]
ds_read_b128 a[64:67], v36 offset:6144
s_waitcnt lgkmcnt(8)
v_mfma_f32_16x16x32_bf16 v[224:227], a[44:47], a[100:103], v[224:227]
ds_read_b64_tr_b16 a[8:9], v6 offset:1024
ds_read_b64_tr_b16 a[10:11], v6 offset:1280
v_mfma_f32_16x16x32_bf16 v[228:231], a[44:47], a[104:107], v[228:231]
ds_read_b128 a[68:71], v37 offset:0
v_mfma_f32_16x16x32_bf16 v[232:235], a[44:47], a[108:111], v[232:235]
v_mfma_f32_16x16x32_bf16 v[236:239], a[44:47], a[112:115], v[236:239]
v_mfma_f32_16x16x32_bf16 v[240:243], a[48:51], a[100:103], v[240:243]
ds_read_b64_tr_b16 a[12:13], v7 offset:1024
ds_read_b64_tr_b16 a[14:15], v7 offset:1280
v_mfma_f32_16x16x32_bf16 v[244:247], a[48:51], a[104:107], v[244:247]
ds_read_b128 a[72:75], v37 offset:2048
v_mfma_f32_16x16x32_bf16 v[248:251], a[48:51], a[108:111], v[248:251]
v_mfma_f32_16x16x32_bf16 v[252:255], a[48:51], a[112:115], v[252:255]
s_waitcnt lgkmcnt(6)
v_mfma_f32_16x16x32_bf16 v[48:51], a[0:3], a[52:55], v[48:51]
ds_read_b64_tr_b16 a[16:17], v6 offset:2048
ds_read_b64_tr_b16 a[18:19], v6 offset:2304
v_mfma_f32_16x16x32_bf16 v[52:55], a[0:3], a[56:59], v[52:55]
ds_read_b128 a[76:79], v37 offset:4096
s_add_u32 m0, s32, 24576
v_mfma_f32_16x16x32_bf16 v[56:59], a[0:3], a[60:63], v[56:59]
buffer_load_dwordx4 v15, s[8:11], s29 offen offset:0 lds
v_mfma_f32_16x16x32_bf16 v[60:63], a[0:3], a[64:67], v[60:63]
v_mfma_f32_16x16x32_bf16 v[64:67], a[4:7], a[52:55], v[64:67]
ds_read_b64_tr_b16 a[20:21], v7 offset:2048
ds_read_b64_tr_b16 a[22:23], v7 offset:2304
v_mfma_f32_16x16x32_bf16 v[68:71], a[4:7], a[56:59], v[68:71]
ds_read_b128 a[80:83], v37 offset:6144
v_mfma_f32_16x16x32_bf16 v[72:75], a[4:7], a[60:63], v[72:75]
buffer_load_dwordx4 v28, s[8:11], s29 offen offset:1024 lds
v_mfma_f32_16x16x32_bf16 v[76:79], a[4:7], a[64:67], v[76:79]
s_waitcnt lgkmcnt(7)
v_mfma_f32_16x16x32_bf16 v[80:83], a[8:11], a[52:55], v[80:83]
ds_read_b64_tr_b16 a[24:25], v8 offset:0
ds_read_b64_tr_b16 a[26:27], v8 offset:1024
v_mfma_f32_16x16x32_bf16 v[84:87], a[8:11], a[56:59], v[84:87]
s_mul_i32 s38, s54, 3670016
s_lshl_b32 s39, s7, 8
v_mfma_f32_16x16x32_bf16 v[88:91], a[8:11], a[60:63], v[88:91]
buffer_load_dwordx4 v29, s[8:11], s29 offen offset:2048 lds
v_mfma_f32_16x16x32_bf16 v[92:95], a[8:11], a[64:67], v[92:95]
s_add_u32 s29, s29, 393216
s_add_u32 s38, s38, s39
v_mfma_f32_16x16x32_bf16 v[96:99], a[12:15], a[52:55], v[96:99]
ds_read_b64_tr_b16 a[28:29], v9 offset:0
ds_read_b64_tr_b16 a[30:31], v9 offset:1024
v_mfma_f32_16x16x32_bf16 v[100:103], a[12:15], a[56:59], v[100:103]
s_add_u32 m0, s33, 32768
s_add_u32 s12, s78, s38
s_addc_u32 s13, s79, 0
v_mfma_f32_16x16x32_bf16 v[104:107], a[12:15], a[60:63], v[104:107]
buffer_load_dwordx4 v16, s[20:23], s30 offen offset:0 lds
v_mfma_f32_16x16x32_bf16 v[108:111], a[12:15], a[64:67], v[108:111]
s_sub_u32 s14, 7340032, s38
s_mov_b32 s15, 0x20000
s_waitcnt lgkmcnt(5)
v_mfma_f32_16x16x32_bf16 v[112:115], a[16:19], a[52:55], v[112:115]
ds_read_b64_tr_b16 a[32:33], v10 offset:0
ds_read_b64_tr_b16 a[34:35], v10 offset:1024
v_mfma_f32_16x16x32_bf16 v[116:119], a[16:19], a[56:59], v[116:119]
s_mov_b32 s39, 11
v_lshrrev_b32 v2, 4, v1
v_mfma_f32_16x16x32_bf16 v[120:123], a[16:19], a[60:63], v[120:123]
buffer_load_dwordx4 v17, s[20:23], s30 offen offset:1024 lds
v_mfma_f32_16x16x32_bf16 v[124:127], a[16:19], a[64:67], v[124:127]
v_and_b32 v3, 15, v1
s_lshl_b32 s38, 8, s39
v_mfma_f32_16x16x32_bf16 v[128:131], a[20:23], a[52:55], v[128:131]
ds_read_b64_tr_b16 a[36:37], v11 offset:0
ds_read_b64_tr_b16 a[38:39], v11 offset:1024
v_mfma_f32_16x16x32_bf16 v[132:135], a[20:23], a[56:59], v[132:135]
s_lshl_b32 s18, 64, s39
v_add_u32 v4, 0, v2
v_mfma_f32_16x16x32_bf16 v[136:139], a[20:23], a[60:63], v[136:139]
buffer_load_dwordx4 v18, s[20:23], s30 offen offset:2048 lds
v_mfma_f32_16x16x32_bf16 v[140:143], a[20:23], a[64:67], v[140:143]
v_lshlrev_b32 v5, 1, v4
v_xor_b32 v5, v3, v5
s_waitcnt lgkmcnt(4)
v_mfma_f32_16x16x32_bf16 v[144:147], a[24:27], a[52:55], v[144:147]
ds_read_b64_tr_b16 a[40:41], v12 offset:0
ds_read_b64_tr_b16 a[42:43], v12 offset:1024
v_mfma_f32_16x16x32_bf16 v[148:151], a[24:27], a[56:59], v[148:151]
v_lshlrev_b32 v5, 4, v5
v_lshl_add_u32 v32, v4, s39, v5
v_mfma_f32_16x16x32_bf16 v[152:155], a[24:27], a[60:63], v[152:155]
buffer_load_dwordx4 v19, s[20:23], s30 offen offset:3072 lds
v_mfma_f32_16x16x32_bf16 v[156:159], a[24:27], a[64:67], v[156:159]
s_add_u32 s30, s30, 458752
s_sub_u32 s49, s38, 2048
v_mfma_f32_16x16x32_bf16 v[160:163], a[28:31], a[52:55], v[160:163]
ds_read_b64_tr_b16 a[44:45], v13 offset:0
ds_read_b64_tr_b16 a[46:47], v13 offset:1024
v_mfma_f32_16x16x32_bf16 v[164:167], a[28:31], a[56:59], v[164:167]
s_add_u32 m0, s35, 0
v_add_u32 v34, s49, v32
v_mfma_f32_16x16x32_bf16 v[168:171], a[28:31], a[60:63], v[168:171]
buffer_load_dwordx4 v20, s[40:43], s31 offen offset:0 lds
v_mfma_f32_16x16x32_bf16 v[172:175], a[28:31], a[64:67], v[172:175]
v_add_u32 v4, 4, v2
v_lshlrev_b32 v5, 1, v4
s_waitcnt lgkmcnt(4)
v_mfma_f32_16x16x32_bf16 v[176:179], a[32:35], a[52:55], v[176:179]
ds_read_b64_tr_b16 a[48:49], v14 offset:0
ds_read_b64_tr_b16 a[50:51], v14 offset:1024
v_mfma_f32_16x16x32_bf16 v[180:183], a[32:35], a[56:59], v[180:183]
v_xor_b32 v5, v3, v5
v_lshlrev_b32 v5, 4, v5
v_mfma_f32_16x16x32_bf16 v[184:187], a[32:35], a[60:63], v[184:187]
buffer_load_dwordx4 v21, s[40:43], s31 offen offset:1024 lds
v_mfma_f32_16x16x32_bf16 v[188:191], a[32:35], a[64:67], v[188:191]
v_lshl_add_u32 v33, v4, s39, v5
s_sub_u32 s49, s38, 3072
v_mfma_f32_16x16x32_bf16 v[192:195], a[36:39], a[52:55], v[192:195]
ds_read_b64_tr_b16 a[0:1], v6 offset:6144
ds_read_b64_tr_b16 a[2:3], v6 offset:6400
v_mfma_f32_16x16x32_bf16 v[196:199], a[36:39], a[56:59], v[196:199]
v_add_u32 v35, s49, v33
v_subrev_u32 v33, 1024, v33
v_mfma_f32_16x16x32_bf16 v[200:203], a[36:39], a[60:63], v[200:203]
buffer_load_dwordx4 v22, s[40:43], s31 offen offset:2048 lds
v_mfma_f32_16x16x32_bf16 v[204:207], a[36:39], a[64:67], v[204:207]
s_add_u32 s39, s39, 4
s_lshl_b32 s16, s28, s39
s_waitcnt lgkmcnt(4)
v_mfma_f32_16x16x32_bf16 v[208:211], a[40:43], a[52:55], v[208:211]
ds_read_b64_tr_b16 a[4:5], v7 offset:6144
ds_read_b64_tr_b16 a[6:7], v7 offset:6400
v_mfma_f32_16x16x32_bf16 v[212:215], a[40:43], a[56:59], v[212:215]
s_lshl_b32 s17, s28, 12
s_add_u32 s17, s17, 49152
v_mfma_f32_16x16x32_bf16 v[216:219], a[40:43], a[60:63], v[216:219]
buffer_load_dwordx4 v23, s[40:43], s31 offen offset:3072 lds
v_mfma_f32_16x16x32_bf16 v[220:223], a[40:43], a[64:67], v[220:223]
v_mfma_f32_16x16x32_bf16 v[224:227], a[44:47], a[52:55], v[224:227]
ds_read_b64_tr_b16 a[8:9], v6 offset:7168
ds_read_b64_tr_b16 a[10:11], v6 offset:7424
v_mfma_f32_16x16x32_bf16 v[228:231], a[44:47], a[56:59], v[228:231]
s_add_u32 m0, s35, 4096
v_mfma_f32_16x16x32_bf16 v[232:235], a[44:47], a[60:63], v[232:235]
buffer_load_dwordx4 v20, s[40:43], s34 offen offset:0 lds
v_mfma_f32_16x16x32_bf16 v[236:239], a[44:47], a[64:67], v[236:239]
s_waitcnt lgkmcnt(4)
v_mfma_f32_16x16x32_bf16 v[240:243], a[48:51], a[52:55], v[240:243]
ds_read_b64_tr_b16 a[12:13], v7 offset:7168
ds_read_b64_tr_b16 a[14:15], v7 offset:7424
v_mfma_f32_16x16x32_bf16 v[244:247], a[48:51], a[56:59], v[244:247]
v_mfma_f32_16x16x32_bf16 v[248:251], a[48:51], a[60:63], v[248:251]
buffer_load_dwordx4 v21, s[40:43], s34 offen offset:1024 lds
v_mfma_f32_16x16x32_bf16 v[252:255], a[48:51], a[64:67], v[252:255]
v_mfma_f32_16x16x32_bf16 v[48:51], a[0:3], a[68:71], v[48:51]
ds_read_b64_tr_b16 a[16:17], v6 offset:8192
ds_read_b64_tr_b16 a[18:19], v6 offset:8448
v_mfma_f32_16x16x32_bf16 v[52:55], a[0:3], a[72:75], v[52:55]
v_mfma_f32_16x16x32_bf16 v[56:59], a[0:3], a[76:79], v[56:59]
buffer_load_dwordx4 v22, s[40:43], s34 offen offset:2048 lds
v_mfma_f32_16x16x32_bf16 v[60:63], a[0:3], a[80:83], v[60:63]
s_waitcnt lgkmcnt(4)
v_mfma_f32_16x16x32_bf16 v[64:67], a[4:7], a[68:71], v[64:67]
ds_read_b64_tr_b16 a[20:21], v7 offset:8192
ds_read_b64_tr_b16 a[22:23], v7 offset:8448
v_mfma_f32_16x16x32_bf16 v[68:71], a[4:7], a[72:75], v[68:71]
v_mfma_f32_16x16x32_bf16 v[72:75], a[4:7], a[76:79], v[72:75]
buffer_load_dwordx4 v23, s[40:43], s34 offen offset:3072 lds
v_mfma_f32_16x16x32_bf16 v[76:79], a[4:7], a[80:83], v[76:79]
s_add_u32 s31, s31, 128
s_add_u32 s34, s31, 65536
v_mfma_f32_16x16x32_bf16 v[80:83], a[8:11], a[68:71], v[80:83]
ds_read_b64_tr_b16 a[24:25], v8 offset:8192
ds_read_b64_tr_b16 a[26:27], v8 offset:9216
v_mfma_f32_16x16x32_bf16 v[84:87], a[8:11], a[72:75], v[84:87]
s_mul_i32 s39, s4, 128
s_add_u32 s39, s39, 39845888
v_mfma_f32_16x16x32_bf16 v[88:91], a[8:11], a[76:79], v[88:91]
v_mfma_f32_16x16x32_bf16 v[92:95], a[8:11], a[80:83], v[92:95]
v_mov_b32 v30, s39
s_waitcnt lgkmcnt(4)
v_mfma_f32_16x16x32_bf16 v[96:99], a[12:15], a[68:71], v[96:99]
ds_read_b64_tr_b16 a[28:29], v9 offset:8192
ds_read_b64_tr_b16 a[30:31], v9 offset:9216
v_mfma_f32_16x16x32_bf16 v[100:103], a[12:15], a[72:75], v[100:103]
v_mfma_f32_16x16x32_bf16 v[104:107], a[12:15], a[76:79], v[104:107]
buffer_load_dword v31, v30, s[24:27], 0 offen sc1
v_mfma_f32_16x16x32_bf16 v[108:111], a[12:15], a[80:83], v[108:111]
s_mul_i32 s39, s5, 128
s_add_u32 s39, s39, 39856128
v_mfma_f32_16x16x32_bf16 v[112:115], a[16:19], a[68:71], v[112:115]
ds_read_b64_tr_b16 a[32:33], v10 offset:8192
ds_read_b64_tr_b16 a[34:35], v10 offset:9216
v_mfma_f32_16x16x32_bf16 v[116:119], a[16:19], a[72:75], v[116:119]
v_mov_b32 v45, s39
v_mfma_f32_16x16x32_bf16 v[120:123], a[16:19], a[76:79], v[120:123]
buffer_load_dword v46, v45, s[24:27], 0 offen sc1
v_mfma_f32_16x16x32_bf16 v[124:127], a[16:19], a[80:83], v[124:127]
s_waitcnt lgkmcnt(4)
v_mfma_f32_16x16x32_bf16 v[128:131], a[20:23], a[68:71], v[128:131]
ds_read_b64_tr_b16 a[36:37], v11 offset:8192
ds_read_b64_tr_b16 a[38:39], v11 offset:9216
v_mfma_f32_16x16x32_bf16 v[132:135], a[20:23], a[72:75], v[132:135]
v_mfma_f32_16x16x32_bf16 v[136:139], a[20:23], a[76:79], v[136:139]
v_mfma_f32_16x16x32_bf16 v[140:143], a[20:23], a[80:83], v[140:143]
v_mfma_f32_16x16x32_bf16 v[144:147], a[24:27], a[68:71], v[144:147]
ds_read_b64_tr_b16 a[40:41], v12 offset:8192
ds_read_b64_tr_b16 a[42:43], v12 offset:9216
v_mfma_f32_16x16x32_bf16 v[148:151], a[24:27], a[72:75], v[148:151]
v_mfma_f32_16x16x32_bf16 v[152:155], a[24:27], a[76:79], v[152:155]
v_mfma_f32_16x16x32_bf16 v[156:159], a[24:27], a[80:83], v[156:159]
s_waitcnt lgkmcnt(4)
v_mfma_f32_16x16x32_bf16 v[160:163], a[28:31], a[68:71], v[160:163]
ds_read_b64_tr_b16 a[44:45], v13 offset:8192
ds_read_b64_tr_b16 a[46:47], v13 offset:9216
v_mfma_f32_16x16x32_bf16 v[164:167], a[28:31], a[72:75], v[164:167]
v_mfma_f32_16x16x32_bf16 v[168:171], a[28:31], a[76:79], v[168:171]
v_mfma_f32_16x16x32_bf16 v[172:175], a[28:31], a[80:83], v[172:175]
v_mfma_f32_16x16x32_bf16 v[176:179], a[32:35], a[68:71], v[176:179]
ds_read_b64_tr_b16 a[48:49], v14 offset:8192
ds_read_b64_tr_b16 a[50:51], v14 offset:9216
v_mfma_f32_16x16x32_bf16 v[180:183], a[32:35], a[72:75], v[180:183]
v_mfma_f32_16x16x32_bf16 v[184:187], a[32:35], a[76:79], v[184:187]
v_mfma_f32_16x16x32_bf16 v[188:191], a[32:35], a[80:83], v[188:191]
s_waitcnt vmcnt(19)
s_barrier
s_waitcnt lgkmcnt(4)
v_mfma_f32_16x16x32_bf16 v[192:195], a[36:39], a[68:71], v[192:195]
ds_read_b64_tr_b16 a[0:1], v6 offset:12288
ds_read_b64_tr_b16 a[2:3], v6 offset:12544
v_mfma_f32_16x16x32_bf16 v[196:199], a[36:39], a[72:75], v[196:199]
ds_read_b128 a[84:87], v36 offset:32768
v_mfma_f32_16x16x32_bf16 v[200:203], a[36:39], a[76:79], v[200:203]
v_mfma_f32_16x16x32_bf16 v[204:207], a[36:39], a[80:83], v[204:207]
ds_read_b128 a[88:91], v36 offset:34816
v_mfma_f32_16x16x32_bf16 v[208:211], a[40:43], a[68:71], v[208:211]
ds_read_b64_tr_b16 a[4:5], v7 offset:12288
ds_read_b64_tr_b16 a[6:7], v7 offset:12544
v_mfma_f32_16x16x32_bf16 v[212:215], a[40:43], a[72:75], v[212:215]
ds_read_b128 a[92:95], v36 offset:36864
v_mfma_f32_16x16x32_bf16 v[216:219], a[40:43], a[76:79], v[216:219]
v_mfma_f32_16x16x32_bf16 v[220:223], a[40:43], a[80:83], v[220:223]
ds_read_b128 a[96:99], v36 offset:38912
s_waitcnt lgkmcnt(8)
v_mfma_f32_16x16x32_bf16 v[224:227], a[44:47], a[68:71], v[224:227]
ds_read_b64_tr_b16 a[8:9], v6 offset:13312
ds_read_b64_tr_b16 a[10:11], v6 offset:13568
v_mfma_f32_16x16x32_bf16 v[228:231], a[44:47], a[72:75], v[228:231]
ds_read_b128 a[100:103], v37 offset:32768
v_mfma_f32_16x16x32_bf16 v[232:235], a[44:47], a[76:79], v[232:235]
v_mfma_f32_16x16x32_bf16 v[236:239], a[44:47], a[80:83], v[236:239]
v_mfma_f32_16x16x32_bf16 v[240:243], a[48:51], a[68:71], v[240:243]
ds_read_b64_tr_b16 a[12:13], v7 offset:13312
ds_read_b64_tr_b16 a[14:15], v7 offset:13568
v_mfma_f32_16x16x32_bf16 v[244:247], a[48:51], a[72:75], v[244:247]
ds_read_b128 a[104:107], v37 offset:34816
v_mfma_f32_16x16x32_bf16 v[248:251], a[48:51], a[76:79], v[248:251]
v_mfma_f32_16x16x32_bf16 v[252:255], a[48:51], a[80:83], v[252:255]
s_waitcnt lgkmcnt(6)
v_mfma_f32_16x16x32_bf16 v[48:51], a[0:3], a[84:87], v[48:51]
ds_read_b64_tr_b16 a[16:17], v6 offset:14336
ds_read_b64_tr_b16 a[18:19], v6 offset:14592
v_mfma_f32_16x16x32_bf16 v[52:55], a[0:3], a[88:91], v[52:55]
ds_read_b128 a[108:111], v37 offset:36864
s_add_u32 m0, s32, 0
v_mfma_f32_16x16x32_bf16 v[56:59], a[0:3], a[92:95], v[56:59]
buffer_load_dwordx4 v15, s[8:11], s29 offen offset:0 lds
v_mfma_f32_16x16x32_bf16 v[60:63], a[0:3], a[96:99], v[60:63]
v_mfma_f32_16x16x32_bf16 v[64:67], a[4:7], a[84:87], v[64:67]
ds_read_b64_tr_b16 a[20:21], v7 offset:14336
ds_read_b64_tr_b16 a[22:23], v7 offset:14592
v_mfma_f32_16x16x32_bf16 v[68:71], a[4:7], a[88:91], v[68:71]
ds_read_b128 a[112:115], v37 offset:38912
v_mfma_f32_16x16x32_bf16 v[72:75], a[4:7], a[92:95], v[72:75]
buffer_load_dwordx4 v28, s[8:11], s29 offen offset:1024 lds
v_mfma_f32_16x16x32_bf16 v[76:79], a[4:7], a[96:99], v[76:79]
s_waitcnt lgkmcnt(7)
v_mfma_f32_16x16x32_bf16 v[80:83], a[8:11], a[84:87], v[80:83]
ds_read_b64_tr_b16 a[24:25], v8 offset:16384
ds_read_b64_tr_b16 a[26:27], v8 offset:17408
v_mfma_f32_16x16x32_bf16 v[84:87], a[8:11], a[88:91], v[84:87]
v_mfma_f32_16x16x32_bf16 v[88:91], a[8:11], a[92:95], v[88:91]
buffer_load_dwordx4 v29, s[8:11], s29 offen offset:2048 lds
v_mfma_f32_16x16x32_bf16 v[92:95], a[8:11], a[96:99], v[92:95]
s_add_u32 s29, s29, 393216
v_mfma_f32_16x16x32_bf16 v[96:99], a[12:15], a[84:87], v[96:99]
ds_read_b64_tr_b16 a[28:29], v9 offset:16384
ds_read_b64_tr_b16 a[30:31], v9 offset:17408
v_mfma_f32_16x16x32_bf16 v[100:103], a[12:15], a[88:91], v[100:103]
s_add_u32 m0, s33, 0
v_mfma_f32_16x16x32_bf16 v[104:107], a[12:15], a[92:95], v[104:107]
buffer_load_dwordx4 v16, s[20:23], s30 offen offset:0 lds
v_mfma_f32_16x16x32_bf16 v[108:111], a[12:15], a[96:99], v[108:111]
s_waitcnt lgkmcnt(5)
v_mfma_f32_16x16x32_bf16 v[112:115], a[16:19], a[84:87], v[112:115]
ds_read_b64_tr_b16 a[32:33], v10 offset:16384
ds_read_b64_tr_b16 a[34:35], v10 offset:17408
v_mfma_f32_16x16x32_bf16 v[116:119], a[16:19], a[88:91], v[116:119]
v_mfma_f32_16x16x32_bf16 v[120:123], a[16:19], a[92:95], v[120:123]
buffer_load_dwordx4 v17, s[20:23], s30 offen offset:1024 lds
v_mfma_f32_16x16x32_bf16 v[124:127], a[16:19], a[96:99], v[124:127]
v_mfma_f32_16x16x32_bf16 v[128:131], a[20:23], a[84:87], v[128:131]
ds_read_b64_tr_b16 a[36:37], v11 offset:16384
ds_read_b64_tr_b16 a[38:39], v11 offset:17408
v_mfma_f32_16x16x32_bf16 v[132:135], a[20:23], a[88:91], v[132:135]
v_mfma_f32_16x16x32_bf16 v[136:139], a[20:23], a[92:95], v[136:139]
buffer_load_dwordx4 v18, s[20:23], s30 offen offset:2048 lds
v_mfma_f32_16x16x32_bf16 v[140:143], a[20:23], a[96:99], v[140:143]
s_waitcnt lgkmcnt(4)
v_mfma_f32_16x16x32_bf16 v[144:147], a[24:27], a[84:87], v[144:147]
ds_read_b64_tr_b16 a[40:41], v12 offset:16384
ds_read_b64_tr_b16 a[42:43], v12 offset:17408
v_mfma_f32_16x16x32_bf16 v[148:151], a[24:27], a[88:91], v[148:151]
v_mfma_f32_16x16x32_bf16 v[152:155], a[24:27], a[92:95], v[152:155]
buffer_load_dwordx4 v19, s[20:23], s30 offen offset:3072 lds
v_mfma_f32_16x16x32_bf16 v[156:159], a[24:27], a[96:99], v[156:159]
s_add_u32 s30, s30, 458752
v_mfma_f32_16x16x32_bf16 v[160:163], a[28:31], a[84:87], v[160:163]
ds_read_b64_tr_b16 a[44:45], v13 offset:16384
ds_read_b64_tr_b16 a[46:47], v13 offset:17408
v_mfma_f32_16x16x32_bf16 v[164:167], a[28:31], a[88:91], v[164:167]
s_add_u32 m0, s35, 32768
v_mfma_f32_16x16x32_bf16 v[168:171], a[28:31], a[92:95], v[168:171]
buffer_load_dwordx4 v20, s[40:43], s31 offen offset:0 lds
v_mfma_f32_16x16x32_bf16 v[172:175], a[28:31], a[96:99], v[172:175]
s_waitcnt lgkmcnt(4)
v_mfma_f32_16x16x32_bf16 v[176:179], a[32:35], a[84:87], v[176:179]
ds_read_b64_tr_b16 a[48:49], v14 offset:16384
ds_read_b64_tr_b16 a[50:51], v14 offset:17408
v_mfma_f32_16x16x32_bf16 v[180:183], a[32:35], a[88:91], v[180:183]
v_mfma_f32_16x16x32_bf16 v[184:187], a[32:35], a[92:95], v[184:187]
buffer_load_dwordx4 v21, s[40:43], s31 offen offset:1024 lds
v_mfma_f32_16x16x32_bf16 v[188:191], a[32:35], a[96:99], v[188:191]
v_mfma_f32_16x16x32_bf16 v[192:195], a[36:39], a[84:87], v[192:195]
ds_read_b64_tr_b16 a[0:1], v6 offset:18432
ds_read_b64_tr_b16 a[2:3], v6 offset:18688
v_mfma_f32_16x16x32_bf16 v[196:199], a[36:39], a[88:91], v[196:199]
v_mfma_f32_16x16x32_bf16 v[200:203], a[36:39], a[92:95], v[200:203]
buffer_load_dwordx4 v22, s[40:43], s31 offen offset:2048 lds
v_mfma_f32_16x16x32_bf16 v[204:207], a[36:39], a[96:99], v[204:207]
s_waitcnt lgkmcnt(4)
v_mfma_f32_16x16x32_bf16 v[208:211], a[40:43], a[84:87], v[208:211]
ds_read_b64_tr_b16 a[4:5], v7 offset:18432
ds_read_b64_tr_b16 a[6:7], v7 offset:18688
v_mfma_f32_16x16x32_bf16 v[212:215], a[40:43], a[88:91], v[212:215]
v_mfma_f32_16x16x32_bf16 v[216:219], a[40:43], a[92:95], v[216:219]
buffer_load_dwordx4 v23, s[40:43], s31 offen offset:3072 lds
v_mfma_f32_16x16x32_bf16 v[220:223], a[40:43], a[96:99], v[220:223]
v_mfma_f32_16x16x32_bf16 v[224:227], a[44:47], a[84:87], v[224:227]
ds_read_b64_tr_b16 a[8:9], v6 offset:19456
ds_read_b64_tr_b16 a[10:11], v6 offset:19712
v_mfma_f32_16x16x32_bf16 v[228:231], a[44:47], a[88:91], v[228:231]
s_add_u32 m0, s35, 36864
v_mfma_f32_16x16x32_bf16 v[232:235], a[44:47], a[92:95], v[232:235]
buffer_load_dwordx4 v20, s[40:43], s34 offen offset:0 lds
v_mfma_f32_16x16x32_bf16 v[236:239], a[44:47], a[96:99], v[236:239]
s_waitcnt lgkmcnt(4)
v_mfma_f32_16x16x32_bf16 v[240:243], a[48:51], a[84:87], v[240:243]
ds_read_b64_tr_b16 a[12:13], v7 offset:19456
ds_read_b64_tr_b16 a[14:15], v7 offset:19712
v_mfma_f32_16x16x32_bf16 v[244:247], a[48:51], a[88:91], v[244:247]
v_mfma_f32_16x16x32_bf16 v[248:251], a[48:51], a[92:95], v[248:251]
buffer_load_dwordx4 v21, s[40:43], s34 offen offset:1024 lds
v_mfma_f32_16x16x32_bf16 v[252:255], a[48:51], a[96:99], v[252:255]
v_mfma_f32_16x16x32_bf16 v[48:51], a[0:3], a[100:103], v[48:51]
ds_read_b64_tr_b16 a[16:17], v6 offset:20480
ds_read_b64_tr_b16 a[18:19], v6 offset:20736
v_mfma_f32_16x16x32_bf16 v[52:55], a[0:3], a[104:107], v[52:55]
v_mfma_f32_16x16x32_bf16 v[56:59], a[0:3], a[108:111], v[56:59]
buffer_load_dwordx4 v22, s[40:43], s34 offen offset:2048 lds
v_mfma_f32_16x16x32_bf16 v[60:63], a[0:3], a[112:115], v[60:63]
s_waitcnt lgkmcnt(4)
v_mfma_f32_16x16x32_bf16 v[64:67], a[4:7], a[100:103], v[64:67]
ds_read_b64_tr_b16 a[20:21], v7 offset:20480
ds_read_b64_tr_b16 a[22:23], v7 offset:20736
v_mfma_f32_16x16x32_bf16 v[68:71], a[4:7], a[104:107], v[68:71]
v_mfma_f32_16x16x32_bf16 v[72:75], a[4:7], a[108:111], v[72:75]
buffer_load_dwordx4 v23, s[40:43], s34 offen offset:3072 lds
v_mfma_f32_16x16x32_bf16 v[76:79], a[4:7], a[112:115], v[76:79]
s_add_u32 s31, s31, 128
s_add_u32 s34, s31, 65536
v_mfma_f32_16x16x32_bf16 v[80:83], a[8:11], a[100:103], v[80:83]
ds_read_b64_tr_b16 a[24:25], v8 offset:24576
ds_read_b64_tr_b16 a[26:27], v8 offset:25600
v_mfma_f32_16x16x32_bf16 v[84:87], a[8:11], a[104:107], v[84:87]
v_mfma_f32_16x16x32_bf16 v[88:91], a[8:11], a[108:111], v[88:91]
v_mfma_f32_16x16x32_bf16 v[92:95], a[8:11], a[112:115], v[92:95]
s_waitcnt lgkmcnt(4)
v_mfma_f32_16x16x32_bf16 v[96:99], a[12:15], a[100:103], v[96:99]
ds_read_b64_tr_b16 a[28:29], v9 offset:24576
ds_read_b64_tr_b16 a[30:31], v9 offset:25600
v_mfma_f32_16x16x32_bf16 v[100:103], a[12:15], a[104:107], v[100:103]
v_mfma_f32_16x16x32_bf16 v[104:107], a[12:15], a[108:111], v[104:107]
v_mfma_f32_16x16x32_bf16 v[108:111], a[12:15], a[112:115], v[108:111]
v_mfma_f32_16x16x32_bf16 v[112:115], a[16:19], a[100:103], v[112:115]
ds_read_b64_tr_b16 a[32:33], v10 offset:24576
ds_read_b64_tr_b16 a[34:35], v10 offset:25600
v_mfma_f32_16x16x32_bf16 v[116:119], a[16:19], a[104:107], v[116:119]
v_mfma_f32_16x16x32_bf16 v[120:123], a[16:19], a[108:111], v[120:123]
v_mfma_f32_16x16x32_bf16 v[124:127], a[16:19], a[112:115], v[124:127]
s_waitcnt lgkmcnt(4)
v_mfma_f32_16x16x32_bf16 v[128:131], a[20:23], a[100:103], v[128:131]
ds_read_b64_tr_b16 a[36:37], v11 offset:24576
ds_read_b64_tr_b16 a[38:39], v11 offset:25600
v_mfma_f32_16x16x32_bf16 v[132:135], a[20:23], a[104:107], v[132:135]
v_mfma_f32_16x16x32_bf16 v[136:139], a[20:23], a[108:111], v[136:139]
v_mfma_f32_16x16x32_bf16 v[140:143], a[20:23], a[112:115], v[140:143]
v_mfma_f32_16x16x32_bf16 v[144:147], a[24:27], a[100:103], v[144:147]
ds_read_b64_tr_b16 a[40:41], v12 offset:24576
ds_read_b64_tr_b16 a[42:43], v12 offset:25600
v_mfma_f32_16x16x32_bf16 v[148:151], a[24:27], a[104:107], v[148:151]
v_mfma_f32_16x16x32_bf16 v[152:155], a[24:27], a[108:111], v[152:155]
v_mfma_f32_16x16x32_bf16 v[156:159], a[24:27], a[112:115], v[156:159]
s_waitcnt lgkmcnt(4)
v_mfma_f32_16x16x32_bf16 v[160:163], a[28:31], a[100:103], v[160:163]
ds_read_b64_tr_b16 a[44:45], v13 offset:24576
ds_read_b64_tr_b16 a[46:47], v13 offset:25600
v_mfma_f32_16x16x32_bf16 v[164:167], a[28:31], a[104:107], v[164:167]
v_mfma_f32_16x16x32_bf16 v[168:171], a[28:31], a[108:111], v[168:171]
v_mfma_f32_16x16x32_bf16 v[172:175], a[28:31], a[112:115], v[172:175]
v_mfma_f32_16x16x32_bf16 v[176:179], a[32:35], a[100:103], v[176:179]
ds_read_b64_tr_b16 a[48:49], v14 offset:24576
ds_read_b64_tr_b16 a[50:51], v14 offset:25600
v_mfma_f32_16x16x32_bf16 v[180:183], a[32:35], a[104:107], v[180:183]
v_mfma_f32_16x16x32_bf16 v[184:187], a[32:35], a[108:111], v[184:187]
v_mfma_f32_16x16x32_bf16 v[188:191], a[32:35], a[112:115], v[188:191]
s_waitcnt vmcnt(15)
s_cmp_lg_u32 s28, 0
s_cbranch_scc1 L_adone_7
v_readfirstlane_b32 s53, v31
s_nop 3
s_cmp_ge_u32 s53, 32
s_cbranch_scc1 L_adone_7
s_mov_b32 s52, 0
L_poll_8:
buffer_load_dword v31, v30, s[24:27], 0 offen sc1
s_waitcnt vmcnt(0)
v_readfirstlane_b32 s53, v31
s_add_u32 s52, s52, 1
s_nop 2
s_cmp_ge_u32 s53, 32
s_cbranch_scc1 L_adone_7
s_cmp_lt_u32 s52, 20000
s_cbranch_scc1 L_poll_8
L_adone_7:
s_cmp_lg_u32 s28, 0
s_cbranch_scc1 L_adone_9
v_readfirstlane_b32 s53, v46
s_nop 3
s_cmp_ge_u32 s53, 8
s_cbranch_scc1 L_adone_9
s_mov_b32 s52, 0
L_poll_10:
buffer_load_dword v46, v45, s[24:27], 0 offen sc1
s_waitcnt vmcnt(0)
v_readfirstlane_b32 s53, v46
s_add_u32 s52, s52, 1
s_nop 2
s_cmp_ge_u32 s53, 8
s_cbranch_scc1 L_adone_9
s_cmp_lt_u32 s52, 20000
s_cbranch_scc1 L_poll_10
L_adone_9:
s_barrier
s_waitcnt lgkmcnt(4)
v_mfma_f32_16x16x32_bf16 v[192:195], a[36:39], a[100:103], v[192:195]
ds_read_b64_tr_b16 a[0:1], v6 offset:24576
ds_read_b64_tr_b16 a[2:3], v6 offset:24832
v_mfma_f32_16x16x32_bf16 v[196:199], a[36:39], a[104:107], v[196:199]
ds_read_b128 a[52:55], v36 offset:0
v_mfma_f32_16x16x32_bf16 v[200:203], a[36:39], a[108:111], v[200:203]
v_mfma_f32_16x16x32_bf16 v[204:207], a[36:39], a[112:115], v[204:207]
ds_read_b128 a[56:59], v36 offset:2048
v_mfma_f32_16x16x32_bf16 v[208:211], a[40:43], a[100:103], v[208:211]
ds_read_b64_tr_b16 a[4:5], v7 offset:24576
ds_read_b64_tr_b16 a[6:7], v7 offset:24832
v_mfma_f32_16x16x32_bf16 v[212:215], a[40:43], a[104:107], v[212:215]
ds_read_b128 a[60:63], v36 offset:4096
v_mfma_f32_16x16x32_bf16 v[216:219], a[40:43], a[108:111], v[216:219]
v_mfma_f32_16x16x32_bf16 v[220:223], a[40:43], a[112:115], v[220:223]
ds_read_b128 a[64:67], v36 offset:6144
s_waitcnt lgkmcnt(8)
v_mfma_f32_16x16x32_bf16 v[224:227], a[44:47], a[100:103], v[224:227]
ds_read_b64_tr_b16 a[8:9], v6 offset:25600
ds_read_b64_tr_b16 a[10:11], v6 offset:25856
v_mfma_f32_16x16x32_bf16 v[228:231], a[44:47], a[104:107], v[228:231]
ds_read_b128 a[68:71], v37 offset:0
v_mfma_f32_16x16x32_bf16 v[232:235], a[44:47], a[108:111], v[232:235]
v_mfma_f32_16x16x32_bf16 v[236:239], a[44:47], a[112:115], v[236:239]
v_mfma_f32_16x16x32_bf16 v[240:243], a[48:51], a[100:103], v[240:243]
ds_read_b64_tr_b16 a[12:13], v7 offset:25600
ds_read_b64_tr_b16 a[14:15], v7 offset:25856
v_mfma_f32_16x16x32_bf16 v[244:247], a[48:51], a[104:107], v[244:247]
ds_read_b128 a[72:75], v37 offset:2048
v_mfma_f32_16x16x32_bf16 v[248:251], a[48:51], a[108:111], v[248:251]
v_mfma_f32_16x16x32_bf16 v[252:255], a[48:51], a[112:115], v[252:255]
s_waitcnt lgkmcnt(6)
v_mfma_f32_16x16x32_bf16 v[48:51], a[0:3], a[52:55], v[48:51]
ds_read_b64_tr_b16 a[16:17], v6 offset:26624
ds_read_b64_tr_b16 a[18:19], v6 offset:26880
v_mfma_f32_16x16x32_bf16 v[52:55], a[0:3], a[56:59], v[52:55]
ds_read_b128 a[76:79], v37 offset:4096
v_lshlrev_b32 v44, 4, v1
v_mfma_f32_16x16x32_bf16 v[56:59], a[0:3], a[60:63], v[56:59]
v_mfma_f32_16x16x32_bf16 v[60:63], a[0:3], a[64:67], v[60:63]
s_lshl_b32 s59, s5, 11
s_add_u32 s59, s59, 38797312
v_mfma_f32_16x16x32_bf16 v[64:67], a[4:7], a[52:55], v[64:67]
ds_read_b64_tr_b16 a[20:21], v7 offset:26624
ds_read_b64_tr_b16 a[22:23], v7 offset:26880
v_mfma_f32_16x16x32_bf16 v[68:71], a[4:7], a[56:59], v[68:71]
ds_read_b128 a[80:83], v37 offset:6144
v_mfma_f32_16x16x32_bf16 v[72:75], a[4:7], a[60:63], v[72:75]
buffer_load_dwordx4 v[24:27], v44, s[24:27], s59 offen offset:0 sc1
v_mfma_f32_16x16x32_bf16 v[76:79], a[4:7], a[64:67], v[76:79]
s_waitcnt lgkmcnt(7)
v_mfma_f32_16x16x32_bf16 v[80:83], a[8:11], a[52:55], v[80:83]
ds_read_b64_tr_b16 a[24:25], v8 offset:32768
ds_read_b64_tr_b16 a[26:27], v8 offset:33792
v_mfma_f32_16x16x32_bf16 v[84:87], a[8:11], a[56:59], v[84:87]
v_mfma_f32_16x16x32_bf16 v[88:91], a[8:11], a[60:63], v[88:91]
buffer_load_dwordx4 v[28:31], v44, s[24:27], s59 offen offset:1024 sc1
v_mfma_f32_16x16x32_bf16 v[92:95], a[8:11], a[64:67], v[92:95]
s_lshl_b32 s60, s4, 2
s_add_u32 s60, s60, s28
v_mfma_f32_16x16x32_bf16 v[96:99], a[12:15], a[52:55], v[96:99]
ds_read_b64_tr_b16 a[28:29], v9 offset:32768
ds_read_b64_tr_b16 a[30:31], v9 offset:33792
v_mfma_f32_16x16x32_bf16 v[100:103], a[12:15], a[56:59], v[100:103]
s_lshl_b32 s60, s60, 10
s_add_u32 s60, s60, 37748736
v_mfma_f32_16x16x32_bf16 v[104:107], a[12:15], a[60:63], v[104:107]
v_mfma_f32_16x16x32_bf16 v[108:111], a[12:15], a[64:67], v[108:111]
v_bfe_u32 v45, v1, 3, 1
v_lshlrev_b32 v45, 7, v45
s_waitcnt lgkmcnt(5)
v_mfma_f32_16x16x32_bf16 v[112:115], a[16:19], a[52:55], v[112:115]
ds_read_b64_tr_b16 a[32:33], v10 offset:32768
ds_read_b64_tr_b16 a[34:35], v10 offset:33792
v_mfma_f32_16x16x32_bf16 v[116:119], a[16:19], a[56:59], v[116:119]
v_and_b32 v46, 7, v1
v_lshl_add_u32 v45, v46, 3, v45
v_mfma_f32_16x16x32_bf16 v[120:123], a[16:19], a[60:63], v[120:123]
buffer_load_dwordx2 v[16:17], v45, s[24:27], s60 offen offset:0 sc1
v_mfma_f32_16x16x32_bf16 v[124:127], a[16:19], a[64:67], v[124:127]
v_mfma_f32_16x16x32_bf16 v[128:131], a[20:23], a[52:55], v[128:131]
ds_read_b64_tr_b16 a[36:37], v11 offset:32768
ds_read_b64_tr_b16 a[38:39], v11 offset:33792
v_mfma_f32_16x16x32_bf16 v[132:135], a[20:23], a[56:59], v[132:135]
v_mfma_f32_16x16x32_bf16 v[136:139], a[20:23], a[60:63], v[136:139]
buffer_load_dwordx2 v[18:19], v45, s[24:27], s60 offen offset:256 sc1
v_mfma_f32_16x16x32_bf16 v[140:143], a[20:23], a[64:67], v[140:143]
s_waitcnt lgkmcnt(4)
s_barrier
v_mfma_f32_16x16x32_bf16 v[144:147], a[24:27], a[52:55], v[144:147]
ds_read_b64_tr_b16 a[40:41], v12 offset:32768
ds_read_b64_tr_b16 a[42:43], v12 offset:33792
v_mfma_f32_16x16x32_bf16 v[148:151], a[24:27], a[56:59], v[148:151]
v_mfma_f32_16x16x32_bf16 v[152:155], a[24:27], a[60:63], v[152:155]
buffer_load_dwordx2 v[20:21], v45, s[24:27], s60 offen offset:512 sc1
v_mfma_f32_16x16x32_bf16 v[156:159], a[24:27], a[64:67], v[156:159]
v_mfma_f32_16x16x32_bf16 v[160:163], a[28:31], a[52:55], v[160:163]
ds_read_b64_tr_b16 a[44:45], v13 offset:32768
ds_read_b64_tr_b16 a[46:47], v13 offset:33792
v_mfma_f32_16x16x32_bf16 v[164:167], a[28:31], a[56:59], v[164:167]
s_add_u32 m0, s17, 49152
v_mfma_f32_16x16x32_bf16 v[168:171], a[28:31], a[60:63], v[168:171]
buffer_load_dwordx4 v32, s[12:15], s16 offen offset:0 lds
v_mfma_f32_16x16x32_bf16 v[172:175], a[28:31], a[64:67], v[172:175]
s_waitcnt lgkmcnt(4)
v_mfma_f32_16x16x32_bf16 v[176:179], a[32:35], a[52:55], v[176:179]
ds_read_b64_tr_b16 a[48:49], v14 offset:32768
ds_read_b64_tr_b16 a[50:51], v14 offset:33792
v_mfma_f32_16x16x32_bf16 v[180:183], a[32:35], a[56:59], v[180:183]
v_mfma_f32_16x16x32_bf16 v[184:187], a[32:35], a[60:63], v[184:187]
buffer_load_dwordx4 v33, s[12:15], s16 offen offset:1024 lds
v_mfma_f32_16x16x32_bf16 v[188:191], a[32:35], a[64:67], v[188:191]
v_mfma_f32_16x16x32_bf16 v[192:195], a[36:39], a[52:55], v[192:195]
ds_read_b64_tr_b16 a[0:1], v6 offset:30720
ds_read_b64_tr_b16 a[2:3], v6 offset:30976
v_mfma_f32_16x16x32_bf16 v[196:199], a[36:39], a[56:59], v[196:199]
v_mfma_f32_16x16x32_bf16 v[200:203], a[36:39], a[60:63], v[200:203]
buffer_load_dwordx4 v34, s[12:15], s16 offen offset:2048 lds
v_mfma_f32_16x16x32_bf16 v[204:207], a[36:39], a[64:67], v[204:207]
s_waitcnt lgkmcnt(4)
v_mfma_f32_16x16x32_bf16 v[208:211], a[40:43], a[52:55], v[208:211]
ds_read_b64_tr_b16 a[4:5], v7 offset:30720
ds_read_b64_tr_b16 a[6:7], v7 offset:30976
v_mfma_f32_16x16x32_bf16 v[212:215], a[40:43], a[56:59], v[212:215]
v_mfma_f32_16x16x32_bf16 v[216:219], a[40:43], a[60:63], v[216:219]
buffer_load_dwordx4 v35, s[12:15], s16 offen offset:3072 lds
v_mfma_f32_16x16x32_bf16 v[220:223], a[40:43], a[64:67], v[220:223]
s_add_u32 s16, s16, s18
v_mfma_f32_16x16x32_bf16 v[224:227], a[44:47], a[52:55], v[224:227]
ds_read_b64_tr_b16 a[8:9], v6 offset:31744
ds_read_b64_tr_b16 a[10:11], v6 offset:32000
v_mfma_f32_16x16x32_bf16 v[228:231], a[44:47], a[56:59], v[228:231]
s_add_u32 m0, s17, 65536
v_mfma_f32_16x16x32_bf16 v[232:235], a[44:47], a[60:63], v[232:235]
buffer_load_dwordx4 v32, s[12:15], s16 offen offset:0 lds
v_mfma_f32_16x16x32_bf16 v[236:239], a[44:47], a[64:67], v[236:239]
s_waitcnt lgkmcnt(4)
v_mfma_f32_16x16x32_bf16 v[240:243], a[48:51], a[52:55], v[240:243]
ds_read_b64_tr_b16 a[12:13], v7 offset:31744
ds_read_b64_tr_b16 a[14:15], v7 offset:32000
v_mfma_f32_16x16x32_bf16 v[244:247], a[48:51], a[56:59], v[244:247]
v_mfma_f32_16x16x32_bf16 v[248:251], a[48:51], a[60:63], v[248:251]
buffer_load_dwordx4 v33, s[12:15], s16 offen offset:1024 lds
v_mfma_f32_16x16x32_bf16 v[252:255], a[48:51], a[64:67], v[252:255]
v_mfma_f32_16x16x32_bf16 v[48:51], a[0:3], a[68:71], v[48:51]
ds_read_b64_tr_b16 a[16:17], v6 offset:32768
ds_read_b64_tr_b16 a[18:19], v6 offset:33024
v_mfma_f32_16x16x32_bf16 v[52:55], a[0:3], a[72:75], v[52:55]
v_mfma_f32_16x16x32_bf16 v[56:59], a[0:3], a[76:79], v[56:59]
buffer_load_dwordx4 v34, s[12:15], s16 offen offset:2048 lds
v_mfma_f32_16x16x32_bf16 v[60:63], a[0:3], a[80:83], v[60:63]
s_waitcnt lgkmcnt(4)
v_mfma_f32_16x16x32_bf16 v[64:67], a[4:7], a[68:71], v[64:67]
ds_read_b64_tr_b16 a[20:21], v7 offset:32768
ds_read_b64_tr_b16 a[22:23], v7 offset:33024
v_mfma_f32_16x16x32_bf16 v[68:71], a[4:7], a[72:75], v[68:71]
v_mfma_f32_16x16x32_bf16 v[72:75], a[4:7], a[76:79], v[72:75]
buffer_load_dwordx4 v35, s[12:15], s16 offen offset:3072 lds
v_mfma_f32_16x16x32_bf16 v[76:79], a[4:7], a[80:83], v[76:79]
s_add_u32 s16, s16, s18
v_mfma_f32_16x16x32_bf16 v[80:83], a[8:11], a[68:71], v[80:83]
ds_read_b64_tr_b16 a[24:25], v8 offset:40960
ds_read_b64_tr_b16 a[26:27], v8 offset:41984
v_mfma_f32_16x16x32_bf16 v[84:87], a[8:11], a[72:75], v[84:87]
v_mfma_f32_16x16x32_bf16 v[88:91], a[8:11], a[76:79], v[88:91]
buffer_load_dwordx2 v[22:23], v45, s[24:27], s60 offen offset:768 sc1
v_mfma_f32_16x16x32_bf16 v[92:95], a[8:11], a[80:83], v[92:95]
s_waitcnt lgkmcnt(4)
v_mfma_f32_16x16x32_bf16 v[96:99], a[12:15], a[68:71], v[96:99]
ds_read_b64_tr_b16 a[28:29], v9 offset:40960
ds_read_b64_tr_b16 a[30:31], v9 offset:41984
v_mfma_f32_16x16x32_bf16 v[100:103], a[12:15], a[72:75], v[100:103]
v_mfma_f32_16x16x32_bf16 v[104:107], a[12:15], a[76:79], v[104:107]
v_mfma_f32_16x16x32_bf16 v[108:111], a[12:15], a[80:83], v[108:111]
v_mfma_f32_16x16x32_bf16 v[112:115], a[16:19], a[68:71], v[112:115]
ds_read_b64_tr_b16 a[32:33], v10 offset:40960
ds_read_b64_tr_b16 a[34:35], v10 offset:41984
v_mfma_f32_16x16x32_bf16 v[116:119], a[16:19], a[72:75], v[116:119]
v_mfma_f32_16x16x32_bf16 v[120:123], a[16:19], a[76:79], v[120:123]
v_mfma_f32_16x16x32_bf16 v[124:127], a[16:19], a[80:83], v[124:127]
s_waitcnt lgkmcnt(4)
v_mfma_f32_16x16x32_bf16 v[128:131], a[20:23], a[68:71], v[128:131]
ds_read_b64_tr_b16 a[36:37], v11 offset:40960
ds_read_b64_tr_b16 a[38:39], v11 offset:41984
v_mfma_f32_16x16x32_bf16 v[132:135], a[20:23], a[72:75], v[132:135]
v_mfma_f32_16x16x32_bf16 v[136:139], a[20:23], a[76:79], v[136:139]
v_mfma_f32_16x16x32_bf16 v[140:143], a[20:23], a[80:83], v[140:143]
v_mfma_f32_16x16x32_bf16 v[144:147], a[24:27], a[68:71], v[144:147]
ds_read_b64_tr_b16 a[40:41], v12 offset:40960
ds_read_b64_tr_b16 a[42:43], v12 offset:41984
v_mfma_f32_16x16x32_bf16 v[148:151], a[24:27], a[72:75], v[148:151]
v_mfma_f32_16x16x32_bf16 v[152:155], a[24:27], a[76:79], v[152:155]
v_mfma_f32_16x16x32_bf16 v[156:159], a[24:27], a[80:83], v[156:159]
s_waitcnt lgkmcnt(4)
v_mfma_f32_16x16x32_bf16 v[160:163], a[28:31], a[68:71], v[160:163]
ds_read_b64_tr_b16 a[44:45], v13 offset:40960
ds_read_b64_tr_b16 a[46:47], v13 offset:41984
v_mfma_f32_16x16x32_bf16 v[164:167], a[28:31], a[72:75], v[164:167]
v_mfma_f32_16x16x32_bf16 v[168:171], a[28:31], a[76:79], v[168:171]
v_mfma_f32_16x16x32_bf16 v[172:175], a[28:31], a[80:83], v[172:175]
v_mfma_f32_16x16x32_bf16 v[176:179], a[32:35], a[68:71], v[176:179]
ds_read_b64_tr_b16 a[48:49], v14 offset:40960
ds_read_b64_tr_b16 a[50:51], v14 offset:41984
v_mfma_f32_16x16x32_bf16 v[180:183], a[32:35], a[72:75], v[180:183]
v_mfma_f32_16x16x32_bf16 v[184:187], a[32:35], a[76:79], v[184:187]
v_mfma_f32_16x16x32_bf16 v[188:191], a[32:35], a[80:83], v[188:191]
s_waitcnt vmcnt(14)
s_barrier
s_waitcnt lgkmcnt(4)
v_mfma_f32_16x16x32_bf16 v[192:195], a[36:39], a[68:71], v[192:195]
ds_read_b64_tr_b16 a[0:1], v6 offset:0
ds_read_b64_tr_b16 a[2:3], v6 offset:256
v_mfma_f32_16x16x32_bf16 v[196:199], a[36:39], a[72:75], v[196:199]
ds_read_b128 a[84:87], v36 offset:32768
v_mfma_f32_16x16x32_bf16 v[200:203], a[36:39], a[76:79], v[200:203]
v_mfma_f32_16x16x32_bf16 v[204:207], a[36:39], a[80:83], v[204:207]
ds_read_b128 a[88:91], v36 offset:34816
v_mfma_f32_16x16x32_bf16 v[208:211], a[40:43], a[68:71], v[208:211]
ds_read_b64_tr_b16 a[4:5], v7 offset:0
ds_read_b64_tr_b16 a[6:7], v7 offset:256
v_mfma_f32_16x16x32_bf16 v[212:215], a[40:43], a[72:75], v[212:215]
ds_read_b128 a[92:95], v36 offset:36864
v_mfma_f32_16x16x32_bf16 v[216:219], a[40:43], a[76:79], v[216:219]
v_mfma_f32_16x16x32_bf16 v[220:223], a[40:43], a[80:83], v[220:223]
ds_read_b128 a[96:99], v36 offset:38912
s_waitcnt lgkmcnt(8)
v_mfma_f32_16x16x32_bf16 v[224:227], a[44:47], a[68:71], v[224:227]
ds_read_b64_tr_b16 a[8:9], v6 offset:1024
ds_read_b64_tr_b16 a[10:11], v6 offset:1280
v_mfma_f32_16x16x32_bf16 v[228:231], a[44:47], a[72:75], v[228:231]
ds_read_b128 a[100:103], v37 offset:32768
v_mfma_f32_16x16x32_bf16 v[232:235], a[44:47], a[76:79], v[232:235]
v_mfma_f32_16x16x32_bf16 v[236:239], a[44:47], a[80:83], v[236:239]
v_mfma_f32_16x16x32_bf16 v[240:243], a[48:51], a[68:71], v[240:243]
ds_read_b64_tr_b16 a[12:13], v7 offset:1024
ds_read_b64_tr_b16 a[14:15], v7 offset:1280
v_mfma_f32_16x16x32_bf16 v[244:247], a[48:51], a[72:75], v[244:247]
ds_read_b128 a[104:107], v37 offset:34816
v_mfma_f32_16x16x32_bf16 v[248:251], a[48:51], a[76:79], v[248:251]
v_mfma_f32_16x16x32_bf16 v[252:255], a[48:51], a[80:83], v[252:255]
s_waitcnt lgkmcnt(6)
v_mfma_f32_16x16x32_bf16 v[48:51], a[0:3], a[84:87], v[48:51]
ds_read_b64_tr_b16 a[16:17], v6 offset:2048
ds_read_b64_tr_b16 a[18:19], v6 offset:2304
v_mfma_f32_16x16x32_bf16 v[52:55], a[0:3], a[88:91], v[52:55]
ds_read_b128 a[108:111], v37 offset:36864
v_mfma_f32_16x16x32_bf16 v[56:59], a[0:3], a[92:95], v[56:59]
v_mfma_f32_16x16x32_bf16 v[60:63], a[0:3], a[96:99], v[60:63]
s_waitcnt vmcnt(12)
v_pk_add_f32 v[24:25], v[24:25], v[28:29]
v_pk_add_f32 v[26:27], v[26:27], v[30:31]
v_add_u32 v47, 89088, v44
ds_write_b128 v47, v[24:27]
v_mfma_f32_16x16x32_bf16 v[64:67], a[4:7], a[84:87], v[64:67]
ds_read_b64_tr_b16 a[20:21], v7 offset:2048
ds_read_b64_tr_b16 a[22:23], v7 offset:2304
v_mfma_f32_16x16x32_bf16 v[68:71], a[4:7], a[88:91], v[68:71]
ds_read_b128 a[112:115], v37 offset:38912
v_mfma_f32_16x16x32_bf16 v[72:75], a[4:7], a[92:95], v[72:75]
v_mfma_f32_16x16x32_bf16 v[76:79], a[4:7], a[96:99], v[76:79]
s_waitcnt lgkmcnt(8)
v_mfma_f32_16x16x32_bf16 v[80:83], a[8:11], a[84:87], v[80:83]
ds_read_b64_tr_b16 a[24:25], v8 offset:0
ds_read_b64_tr_b16 a[26:27], v8 offset:1024
v_mfma_f32_16x16x32_bf16 v[84:87], a[8:11], a[88:91], v[84:87]
v_mfma_f32_16x16x32_bf16 v[88:91], a[8:11], a[92:95], v[88:91]
v_mfma_f32_16x16x32_bf16 v[92:95], a[8:11], a[96:99], v[92:95]
v_mfma_f32_16x16x32_bf16 v[96:99], a[12:15], a[84:87], v[96:99]
ds_read_b64_tr_b16 a[28:29], v9 offset:0
ds_read_b64_tr_b16 a[30:31], v9 offset:1024
v_mfma_f32_16x16x32_bf16 v[100:103], a[12:15], a[88:91], v[100:103]
s_lshl_b32 s38, s4, 4
s_lshl_b32 s39, s28, 2
v_mfma_f32_16x16x32_bf16 v[104:107], a[12:15], a[92:95], v[104:107]
v_mfma_f32_16x16x32_bf16 v[108:111], a[12:15], a[96:99], v[108:111]
s_add_u32 s38, s38, s39
s_mul_i32 s38, s38, 114688
s_waitcnt lgkmcnt(5)
v_mfma_f32_16x16x32_bf16 v[112:115], a[16:19], a[84:87], v[112:115]
ds_read_b64_tr_b16 a[32:33], v10 offset:0
ds_read_b64_tr_b16 a[34:35], v10 offset:1024
v_mfma_f32_16x16x32_bf16 v[116:119], a[16:19], a[88:91], v[116:119]
s_add_u32 s38, s38, 4194304
s_mul_i32 s39, s5, 7
v_mfma_f32_16x16x32_bf16 v[120:123], a[16:19], a[92:95], v[120:123]
v_mfma_f32_16x16x32_bf16 v[124:127], a[16:19], a[96:99], v[124:127]
s_add_u32 s39, s39, 1
s_lshr_b32 s39, s39, 1
v_mfma_f32_16x16x32_bf16 v[128:131], a[20:23], a[84:87], v[128:131]
ds_read_b64_tr_b16 a[36:37], v11 offset:0
ds_read_b64_tr_b16 a[38:39], v11 offset:1024
v_mfma_f32_16x16x32_bf16 v[132:135], a[20:23], a[88:91], v[132:135]
s_cmp_eq_u32 s48, 0
s_cselect_b32 s49, 3, -1
v_mfma_f32_16x16x32_bf16 v[136:139], a[20:23], a[92:95], v[136:139]
v_mfma_f32_16x16x32_bf16 v[140:143], a[20:23], a[96:99], v[140:143]
s_add_u32 s49, s39, s49
s_lshl_b32 s39, s39, 10
s_waitcnt lgkmcnt(4)
s_barrier
v_mfma_f32_16x16x32_bf16 v[144:147], a[24:27], a[84:87], v[144:147]
ds_read_b64_tr_b16 a[40:41], v12 offset:0
ds_read_b64_tr_b16 a[42:43], v12 offset:1024
v_mfma_f32_16x16x32_bf16 v[148:151], a[24:27], a[88:91], v[148:151]
s_lshl_b32 s49, s49, 10
s_add_u32 s92, s38, s39
v_mfma_f32_16x16x32_bf16 v[152:155], a[24:27], a[92:95], v[152:155]
v_mfma_f32_16x16x32_bf16 v[156:159], a[24:27], a[96:99], v[156:159]
s_add_u32 s96, s38, s49
s_add_u32 s38, s38, 114688
v_mfma_f32_16x16x32_bf16 v[160:163], a[28:31], a[84:87], v[160:163]
ds_read_b64_tr_b16 a[44:45], v13 offset:0
ds_read_b64_tr_b16 a[46:47], v13 offset:1024
v_mfma_f32_16x16x32_bf16 v[164:167], a[28:31], a[88:91], v[164:167]
s_add_u32 m0, s17, 81920
s_add_u32 s93, s38, s39
v_mfma_f32_16x16x32_bf16 v[168:171], a[28:31], a[92:95], v[168:171]
buffer_load_dwordx4 v32, s[12:15], s16 offen offset:0 lds
v_mfma_f32_16x16x32_bf16 v[172:175], a[28:31], a[96:99], v[172:175]
s_add_u32 s97, s38, s49
s_add_u32 s38, s38, 114688
s_waitcnt lgkmcnt(4)
v_mfma_f32_16x16x32_bf16 v[176:179], a[32:35], a[84:87], v[176:179]
ds_read_b64_tr_b16 a[48:49], v14 offset:0
ds_read_b64_tr_b16 a[50:51], v14 offset:1024
v_mfma_f32_16x16x32_bf16 v[180:183], a[32:35], a[88:91], v[180:183]
s_add_u32 s94, s38, s39
s_add_u32 s98, s38, s49
v_mfma_f32_16x16x32_bf16 v[184:187], a[32:35], a[92:95], v[184:187]
buffer_load_dwordx4 v33, s[12:15], s16 offen offset:1024 lds
v_mfma_f32_16x16x32_bf16 v[188:191], a[32:35], a[96:99], v[188:191]
s_add_u32 s38, s38, 114688
s_add_u32 s95, s38, s39
v_mfma_f32_16x16x32_bf16 v[192:195], a[36:39], a[84:87], v[192:195]
ds_read_b64_tr_b16 a[0:1], v6 offset:6144
ds_read_b64_tr_b16 a[2:3], v6 offset:6400
v_mfma_f32_16x16x32_bf16 v[196:199], a[36:39], a[88:91], v[196:199]
s_add_u32 s99, s38, s49
v_lshrrev_b32 v2, 4, v1
v_mfma_f32_16x16x32_bf16 v[200:203], a[36:39], a[92:95], v[200:203]
buffer_load_dwordx4 v34, s[12:15], s16 offen offset:2048 lds
v_mfma_f32_16x16x32_bf16 v[204:207], a[36:39], a[96:99], v[204:207]
v_bfe_u32 v3, v1, 2, 2
v_and_b32 v4, 3, v1
s_waitcnt lgkmcnt(4)
v_mfma_f32_16x16x32_bf16 v[208:211], a[40:43], a[84:87], v[208:211]
ds_read_b64_tr_b16 a[4:5], v7 offset:6144
ds_read_b64_tr_b16 a[6:7], v7 offset:6400
v_mfma_f32_16x16x32_bf16 v[212:215], a[40:43], a[88:91], v[212:215]
v_lshl_add_u32 v5, v2, 2, v3
v_bfe_u32 v46, v5, 1, 2
v_mfma_f32_16x16x32_bf16 v[216:219], a[40:43], a[92:95], v[216:219]
buffer_load_dwordx4 v35, s[12:15], s16 offen offset:3072 lds
v_mfma_f32_16x16x32_bf16 v[220:223], a[40:43], a[96:99], v[220:223]
s_add_u32 s16, s16, s18
v_and_b32 v47, 1, v5
v_mfma_f32_16x16x32_bf16 v[224:227], a[44:47], a[84:87], v[224:227]
ds_read_b64_tr_b16 a[8:9], v6 offset:7168
ds_read_b64_tr_b16 a[10:11], v6 offset:7424
v_mfma_f32_16x16x32_bf16 v[228:231], a[44:47], a[88:91], v[228:231]
s_add_u32 m0, s17, 98304
v_lshlrev_b32 v47, 1, v47
v_mfma_f32_16x16x32_bf16 v[232:235], a[44:47], a[92:95], v[232:235]
buffer_load_dwordx4 v32, s[12:15], s16 offen offset:0 lds
v_mfma_f32_16x16x32_bf16 v[236:239], a[44:47], a[96:99], v[236:239]
v_lshl_add_u32 v46, v46, 2, v47
v_bfe_u32 v47, v5, 3, 1
s_waitcnt lgkmcnt(4)
v_mfma_f32_16x16x32_bf16 v[240:243], a[48:51], a[84:87], v[240:243]
ds_read_b64_tr_b16 a[12:13], v7 offset:7168
ds_read_b64_tr_b16 a[14:15], v7 offset:7424
v_mfma_f32_16x16x32_bf16 v[244:247], a[48:51], a[88:91], v[244:247]
v_add_u32 v46, v46, v47
s_lshl_b32 s38, s28, 2
v_mfma_f32_16x16x32_bf16 v[248:251], a[48:51], a[92:95], v[248:251]
buffer_load_dwordx4 v33, s[12:15], s16 offen offset:1024 lds
v_mfma_f32_16x16x32_bf16 v[252:255], a[48:51], a[96:99], v[252:255]
v_xor_b32 v46, v46, v4
v_xor_b32 v46, s38, v46
v_mfma_f32_16x16x32_bf16 v[48:51], a[0:3], a[100:103], v[48:51]
ds_read_b64_tr_b16 a[16:17], v6 offset:8192
ds_read_b64_tr_b16 a[18:19], v6 offset:8448
v_mfma_f32_16x16x32_bf16 v[52:55], a[0:3], a[104:107], v[52:55]
v_lshlrev_b32 v46, 3, v46
v_lshl_add_u32 v42, v5, 7, v46
v_mfma_f32_16x16x32_bf16 v[56:59], a[0:3], a[108:111], v[56:59]
buffer_load_dwordx4 v34, s[12:15], s16 offen offset:2048 lds
v_mfma_f32_16x16x32_bf16 v[60:63], a[0:3], a[112:115], v[60:63]
v_bfe_u32 v46, v5, 2, 1
v_bfe_u32 v47, v5, 3, 1
s_waitcnt lgkmcnt(4)
v_mfma_f32_16x16x32_bf16 v[64:67], a[4:7], a[100:103], v[64:67]
ds_read_b64_tr_b16 a[20:21], v7 offset:8192
ds_read_b64_tr_b16 a[22:23], v7 offset:8448
v_mfma_f32_16x16x32_bf16 v[68:71], a[4:7], a[104:107], v[68:71]
v_lshl_add_u32 v46, v46, 1, v47
v_bfe_u32 v47, v5, 1, 1
v_mfma_f32_16x16x32_bf16 v[72:75], a[4:7], a[108:111], v[72:75]
buffer_load_dwordx4 v35, s[12:15], s16 offen offset:3072 lds
v_mfma_f32_16x16x32_bf16 v[76:79], a[4:7], a[112:115], v[76:79]
s_add_u32 s16, s16, s18
v_lshl_add_u32 v46, v46, 1, v47
v_mfma_f32_16x16x32_bf16 v[80:83], a[8:11], a[100:103], v[80:83]
ds_read_b64_tr_b16 a[24:25], v8 offset:8192
ds_read_b64_tr_b16 a[26:27], v8 offset:9216
v_mfma_f32_16x16x32_bf16 v[84:87], a[8:11], a[104:107], v[84:87]
v_xor_b32 v46, v46, v4
v_lshlrev_b32 v46, 3, v46
v_mfma_f32_16x16x32_bf16 v[88:91], a[8:11], a[108:111], v[88:91]
v_mfma_f32_16x16x32_bf16 v[92:95], a[8:11], a[112:115], v[92:95]
v_lshl_add_u32 v46, v5, 6, v46
v_add_u32 v43, 32768, v46
s_waitcnt lgkmcnt(4)
v_mfma_f32_16x16x32_bf16 v[96:99], a[12:15], a[100:103], v[96:99]
ds_read_b64_tr_b16 a[28:29], v9 offset:8192
ds_read_b64_tr_b16 a[30:31], v9 offset:9216
v_mfma_f32_16x16x32_bf16 v[100:103], a[12:15], a[104:107], v[100:103]
v_and_b32 v3, 15, v1
s_lshl_b32 s38, s28, 6
v_mfma_f32_16x16x32_bf16 v[104:107], a[12:15], a[108:111], v[104:107]
v_mfma_f32_16x16x32_bf16 v[108:111], a[12:15], a[112:115], v[108:111]
v_add_u32 v5, s38, v3
v_bfe_u32 v46, v3, 1, 2
v_mfma_f32_16x16x32_bf16 v[112:115], a[16:19], a[100:103], v[112:115]
ds_read_b64_tr_b16 a[32:33], v10 offset:8192
ds_read_b64_tr_b16 a[34:35], v10 offset:9216
v_mfma_f32_16x16x32_bf16 v[116:119], a[16:19], a[104:107], v[116:119]
v_and_b32 v47, 1, v3
v_lshlrev_b32 v47, 1, v47
v_mfma_f32_16x16x32_bf16 v[120:123], a[16:19], a[108:111], v[120:123]
v_mfma_f32_16x16x32_bf16 v[124:127], a[16:19], a[112:115], v[124:127]
v_lshl_add_u32 v46, v46, 2, v47
v_bfe_u32 v47, v3, 3, 1
s_waitcnt lgkmcnt(4)
v_mfma_f32_16x16x32_bf16 v[128:131], a[20:23], a[100:103], v[128:131]
ds_read_b64_tr_b16 a[36:37], v11 offset:8192
ds_read_b64_tr_b16 a[38:39], v11 offset:9216
v_mfma_f32_16x16x32_bf16 v[132:135], a[20:23], a[104:107], v[132:135]
v_add_u32 v46, v46, v47
v_xor_b32 v46, v46, v2
v_mfma_f32_16x16x32_bf16 v[136:139], a[20:23], a[108:111], v[136:139]
v_mfma_f32_16x16x32_bf16 v[140:143], a[20:23], a[112:115], v[140:143]
v_lshlrev_b32 v46, 3, v46
v_lshl_add_u32 v40, v5, 7, v46
v_mfma_f32_16x16x32_bf16 v[144:147], a[24:27], a[100:103], v[144:147]
ds_read_b64_tr_b16 a[40:41], v12 offset:8192
ds_read_b64_tr_b16 a[42:43], v12 offset:9216
v_mfma_f32_16x16x32_bf16 v[148:151], a[24:27], a[104:107], v[148:151]
v_bfe_u32 v46, v3, 2, 1
v_bfe_u32 v47, v3, 3, 1
v_mfma_f32_16x16x32_bf16 v[152:155], a[24:27], a[108:111], v[152:155]
v_mfma_f32_16x16x32_bf16 v[156:159], a[24:27], a[112:115], v[156:159]
v_lshl_add_u32 v46, v46, 1, v47
v_bfe_u32 v47, v3, 1, 1
s_waitcnt lgkmcnt(4)
v_mfma_f32_16x16x32_bf16 v[160:163], a[28:31], a[100:103], v[160:163]
ds_read_b64_tr_b16 a[44:45], v13 offset:8192
ds_read_b64_tr_b16 a[46:47], v13 offset:9216
v_mfma_f32_16x16x32_bf16 v[164:167], a[28:31], a[104:107], v[164:167]
v_lshl_add_u32 v46, v46, 1, v47
v_xor_b32 v46, v46, v2
v_mfma_f32_16x16x32_bf16 v[168:171], a[28:31], a[108:111], v[168:171]
v_mfma_f32_16x16x32_bf16 v[172:175], a[28:31], a[112:115], v[172:175]
v_lshlrev_b32 v46, 3, v46
v_lshl_add_u32 v46, v5, 6, v46
v_mfma_f32_16x16x32_bf16 v[176:179], a[32:35], a[100:103], v[176:179]
ds_read_b64_tr_b16 a[48:49], v14 offset:8192
ds_read_b64_tr_b16 a[50:51], v14 offset:9216
v_mfma_f32_16x16x32_bf16 v[180:183], a[32:35], a[104:107], v[180:183]
v_add_u32 v41, 32768, v46
s_mov_b32 s58, 0x3fb8aa3b
v_mfma_f32_16x16x32_bf16 v[184:187], a[32:35], a[108:111], v[184:187]
v_mfma_f32_16x16x32_bf16 v[188:191], a[32:35], a[112:115], v[188:191]
s_waitcnt lgkmcnt(4)
v_mfma_f32_16x16x32_bf16 v[192:195], a[36:39], a[100:103], v[192:195]
v_mfma_f32_16x16x32_bf16 v[196:199], a[36:39], a[104:107], v[196:199]
v_lshlrev_b32 v44, 4, v1
s_lshl_b32 s38, s48, 9
v_mfma_f32_16x16x32_bf16 v[200:203], a[36:39], a[108:111], v[200:203]
v_mfma_f32_16x16x32_bf16 v[204:207], a[36:39], a[112:115], v[204:207]
v_lshlrev_b32 v7, 3, v1
v_add_u32 v7, s38, v7
v_mfma_f32_16x16x32_bf16 v[208:211], a[40:43], a[100:103], v[208:211]
v_lshrrev_b32 v6, 4, v1
v_lshlrev_b32 v6, 4, v6
v_mfma_f32_16x16x32_bf16 v[212:215], a[40:43], a[104:107], v[212:215]
v_add_u32 v6, 88064, v6
v_mfma_f32_16x16x32_bf16 v[216:219], a[40:43], a[108:111], v[216:219]
v_mfma_f32_16x16x32_bf16 v[220:223], a[40:43], a[112:115], v[220:223]
s_waitcnt lgkmcnt(0)
v_mfma_f32_16x16x32_bf16 v[224:227], a[44:47], a[100:103], v[224:227]
v_mfma_f32_16x16x32_bf16 v[228:231], a[44:47], a[104:107], v[228:231]
v_mfma_f32_16x16x32_bf16 v[232:235], a[44:47], a[108:111], v[232:235]
v_mfma_f32_16x16x32_bf16 v[236:239], a[44:47], a[112:115], v[236:239]
v_mfma_f32_16x16x32_bf16 v[240:243], a[48:51], a[100:103], v[240:243]
v_mfma_f32_16x16x32_bf16 v[244:247], a[48:51], a[104:107], v[244:247]
v_mfma_f32_16x16x32_bf16 v[248:251], a[48:51], a[108:111], v[248:251]
v_mfma_f32_16x16x32_bf16 v[252:255], a[48:51], a[112:115], v[252:255]
s_waitcnt lgkmcnt(0)
ds_read_b128 v[2:5], v6 offset:1408
ds_read_b128 v[12:15], v6 offset:0
ds_read_b128 v[8:11], v6 offset:1472
ds_read_b128 v[36:39], v6 offset:64
ds_read_b128 v[24:27], v6 offset:1152
ds_read_b128 v[28:31], v6 offset:1216
s_waitcnt vmcnt(8)
s_barrier
s_waitcnt lgkmcnt(0)
v_pk_fma_f32 v[144:145], v[2:3], v[16:17], v[144:145] op_sel:[0,0,0] op_sel_hi:[1,0,1]
v_pk_fma_f32 v[146:147], v[4:5], v[16:17], v[146:147] op_sel:[0,0,0] op_sel_hi:[1,0,1]
v_pk_fma_f32 v[144:145], v[144:145], v[16:17], v[12:13] op_sel:[0,1,0] op_sel_hi:[1,1,1]
v_pk_fma_f32 v[146:147], v[146:147], v[16:17], v[14:15] op_sel:[0,1,0] op_sel_hi:[1,1,1]
v_pk_fma_f32 v[160:161], v[8:9], v[16:17], v[160:161] op_sel:[0,0,0] op_sel_hi:[1,0,1]
v_pk_fma_f32 v[162:163], v[10:11], v[16:17], v[162:163] op_sel:[0,0,0] op_sel_hi:[1,0,1]
v_pk_fma_f32 v[160:161], v[160:161], v[16:17], v[36:37] op_sel:[0,1,0] op_sel_hi:[1,1,1]
v_pk_fma_f32 v[162:163], v[162:163], v[16:17], v[38:39] op_sel:[0,1,0] op_sel_hi:[1,1,1]
v_pk_fma_f32 v[148:149], v[2:3], v[18:19], v[148:149] op_sel:[0,0,0] op_sel_hi:[1,0,1]
v_pk_fma_f32 v[150:151], v[4:5], v[18:19], v[150:151] op_sel:[0,0,0] op_sel_hi:[1,0,1]
v_pk_fma_f32 v[148:149], v[148:149], v[18:19], v[12:13] op_sel:[0,1,0] op_sel_hi:[1,1,1]
v_pk_fma_f32 v[150:151], v[150:151], v[18:19], v[14:15] op_sel:[0,1,0] op_sel_hi:[1,1,1]
v_pk_fma_f32 v[164:165], v[8:9], v[18:19], v[164:165] op_sel:[0,0,0] op_sel_hi:[1,0,1]
v_pk_fma_f32 v[166:167], v[10:11], v[18:19], v[166:167] op_sel:[0,0,0] op_sel_hi:[1,0,1]
v_pk_fma_f32 v[164:165], v[164:165], v[18:19], v[36:37] op_sel:[0,1,0] op_sel_hi:[1,1,1]
v_pk_fma_f32 v[166:167], v[166:167], v[18:19], v[38:39] op_sel:[0,1,0] op_sel_hi:[1,1,1]
v_pk_fma_f32 v[152:153], v[2:3], v[20:21], v[152:153] op_sel:[0,0,0] op_sel_hi:[1,0,1]
v_pk_fma_f32 v[154:155], v[4:5], v[20:21], v[154:155] op_sel:[0,0,0] op_sel_hi:[1,0,1]
v_pk_fma_f32 v[152:153], v[152:153], v[20:21], v[12:13] op_sel:[0,1,0] op_sel_hi:[1,1,1]
v_pk_fma_f32 v[154:155], v[154:155], v[20:21], v[14:15] op_sel:[0,1,0] op_sel_hi:[1,1,1]
v_pk_fma_f32 v[168:169], v[8:9], v[20:21], v[168:169] op_sel:[0,0,0] op_sel_hi:[1,0,1]
v_pk_fma_f32 v[170:171], v[10:11], v[20:21], v[170:171] op_sel:[0,0,0] op_sel_hi:[1,0,1]
v_pk_fma_f32 v[168:169], v[168:169], v[20:21], v[36:37] op_sel:[0,1,0] op_sel_hi:[1,1,1]
v_pk_fma_f32 v[170:171], v[170:171], v[20:21], v[38:39] op_sel:[0,1,0] op_sel_hi:[1,1,1]
v_pk_fma_f32 v[156:157], v[2:3], v[22:23], v[156:157] op_sel:[0,0,0] op_sel_hi:[1,0,1]
v_pk_fma_f32 v[158:159], v[4:5], v[22:23], v[158:159] op_sel:[0,0,0] op_sel_hi:[1,0,1]
v_pk_fma_f32 v[156:157], v[156:157], v[22:23], v[12:13] op_sel:[0,1,0] op_sel_hi:[1,1,1]
v_pk_fma_f32 v[158:159], v[158:159], v[22:23], v[14:15] op_sel:[0,1,0] op_sel_hi:[1,1,1]
v_pk_fma_f32 v[172:173], v[8:9], v[22:23], v[172:173] op_sel:[0,0,0] op_sel_hi:[1,0,1]
v_pk_fma_f32 v[174:175], v[10:11], v[22:23], v[174:175] op_sel:[0,0,0] op_sel_hi:[1,0,1]
v_pk_fma_f32 v[172:173], v[172:173], v[22:23], v[36:37] op_sel:[0,1,0] op_sel_hi:[1,1,1]
v_pk_fma_f32 v[174:175], v[174:175], v[22:23], v[38:39] op_sel:[0,1,0] op_sel_hi:[1,1,1]
ds_read_b128 v[2:5], v6 offset:1536
ds_read_b128 v[12:15], v6 offset:128
ds_read_b128 v[8:11], v6 offset:1600
ds_read_b128 v[36:39], v6 offset:192
s_waitcnt lgkmcnt(0)
v_pk_fma_f32 v[80:81], v[24:25], v[16:17], v[80:81] op_sel:[0,0,0] op_sel_hi:[1,0,1]
v_pk_fma_f32 v[82:83], v[26:27], v[16:17], v[82:83] op_sel:[0,0,0] op_sel_hi:[1,0,1]
v_pk_mul_f32 v[80:81], v[80:81], v[16:17] op_sel:[0,1] op_sel_hi:[1,1]
v_pk_mul_f32 v[82:83], v[82:83], v[16:17] op_sel:[0,1] op_sel_hi:[1,1]
v_pk_fma_f32 v[84:85], v[24:25], v[18:19], v[84:85] op_sel:[0,0,0] op_sel_hi:[1,0,1]
v_pk_fma_f32 v[86:87], v[26:27], v[18:19], v[86:87] op_sel:[0,0,0] op_sel_hi:[1,0,1]
v_pk_mul_f32 v[84:85], v[84:85], v[18:19] op_sel:[0,1] op_sel_hi:[1,1]
v_pk_mul_f32 v[86:87], v[86:87], v[18:19] op_sel:[0,1] op_sel_hi:[1,1]
v_pk_fma_f32 v[88:89], v[24:25], v[20:21], v[88:89] op_sel:[0,0,0] op_sel_hi:[1,0,1]
v_pk_fma_f32 v[90:91], v[26:27], v[20:21], v[90:91] op_sel:[0,0,0] op_sel_hi:[1,0,1]
v_pk_mul_f32 v[88:89], v[88:89], v[20:21] op_sel:[0,1] op_sel_hi:[1,1]
v_pk_mul_f32 v[90:91], v[90:91], v[20:21] op_sel:[0,1] op_sel_hi:[1,1]
v_pk_fma_f32 v[92:93], v[24:25], v[22:23], v[92:93] op_sel:[0,0,0] op_sel_hi:[1,0,1]
v_pk_fma_f32 v[94:95], v[26:27], v[22:23], v[94:95] op_sel:[0,0,0] op_sel_hi:[1,0,1]
v_pk_mul_f32 v[92:93], v[92:93], v[22:23] op_sel:[0,1] op_sel_hi:[1,1]
v_pk_mul_f32 v[94:95], v[94:95], v[22:23] op_sel:[0,1] op_sel_hi:[1,1]
v_pk_fma_f32 v[96:97], v[28:29], v[16:17], v[96:97] op_sel:[0,0,0] op_sel_hi:[1,0,1]
v_pk_fma_f32 v[98:99], v[30:31], v[16:17], v[98:99] op_sel:[0,0,0] op_sel_hi:[1,0,1]
v_max_f32 v144, 0, v144
v_max_f32 v145, 0, v145
v_max_f32 v146, 0, v146
v_max_f32 v147, 0, v147
v_max_f32 v160, 0, v160
v_max_f32 v161, 0, v161
v_max_f32 v162, 0, v162
v_max_f32 v163, 0, v163
v_pk_mul_f32 v[144:145], v[144:145], v[144:145]
v_pk_mul_f32 v[146:147], v[146:147], v[146:147]
v_pk_mul_f32 v[160:161], v[160:161], v[160:161]
v_pk_mul_f32 v[162:163], v[162:163], v[162:163]
v_cvt_pk_bf16_f32 v144, v144, v145
v_cvt_pk_bf16_f32 v145, v146, v147
v_cvt_pk_bf16_f32 v146, v160, v161
v_cvt_pk_bf16_f32 v147, v162, v163
buffer_store_dwordx4 v[144:147], v44, s[24:27], s92 offen offset:0 sc1
v_pk_mul_f32 v[96:97], v[96:97], v[16:17] op_sel:[0,1] op_sel_hi:[1,1]
v_pk_mul_f32 v[98:99], v[98:99], v[16:17] op_sel:[0,1] op_sel_hi:[1,1]
v_pk_fma_f32 v[100:101], v[28:29], v[18:19], v[100:101] op_sel:[0,0,0] op_sel_hi:[1,0,1]
v_pk_fma_f32 v[102:103], v[30:31], v[18:19], v[102:103] op_sel:[0,0,0] op_sel_hi:[1,0,1]
v_pk_mul_f32 v[100:101], v[100:101], v[18:19] op_sel:[0,1] op_sel_hi:[1,1]
v_pk_mul_f32 v[102:103], v[102:103], v[18:19] op_sel:[0,1] op_sel_hi:[1,1]
v_pk_fma_f32 v[104:105], v[28:29], v[20:21], v[104:105] op_sel:[0,0,0] op_sel_hi:[1,0,1]
v_pk_fma_f32 v[106:107], v[30:31], v[20:21], v[106:107] op_sel:[0,0,0] op_sel_hi:[1,0,1]
v_pk_mul_f32 v[104:105], v[104:105], v[20:21] op_sel:[0,1] op_sel_hi:[1,1]
v_pk_mul_f32 v[106:107], v[106:107], v[20:21] op_sel:[0,1] op_sel_hi:[1,1]
v_pk_fma_f32 v[108:109], v[28:29], v[22:23], v[108:109] op_sel:[0,0,0] op_sel_hi:[1,0,1]
v_pk_fma_f32 v[110:111], v[30:31], v[22:23], v[110:111] op_sel:[0,0,0] op_sel_hi:[1,0,1]
v_pk_mul_f32 v[108:109], v[108:109], v[22:23] op_sel:[0,1] op_sel_hi:[1,1]
v_pk_mul_f32 v[110:111], v[110:111], v[22:23] op_sel:[0,1] op_sel_hi:[1,1]
ds_read_b128 v[24:27], v6 offset:1024
ds_read_b128 v[28:31], v6 offset:1088
v_cvt_pk_bf16_f32 v80, v80, v81
v_cvt_pk_bf16_f32 v81, v82, v83
v_cvt_pk_bf16_f32 v82, v96, v97
v_max_f32 v148, 0, v148
v_max_f32 v149, 0, v149
v_max_f32 v150, 0, v150
v_max_f32 v151, 0, v151
v_max_f32 v164, 0, v164
v_max_f32 v165, 0, v165
v_max_f32 v166, 0, v166
v_max_f32 v167, 0, v167
v_pk_mul_f32 v[148:149], v[148:149], v[148:149]
v_pk_mul_f32 v[150:151], v[150:151], v[150:151]
v_pk_mul_f32 v[164:165], v[164:165], v[164:165]
v_pk_mul_f32 v[166:167], v[166:167], v[166:167]
v_cvt_pk_bf16_f32 v148, v148, v149
v_cvt_pk_bf16_f32 v149, v150, v151
v_cvt_pk_bf16_f32 v150, v164, v165
v_cvt_pk_bf16_f32 v151, v166, v167
buffer_store_dwordx4 v[148:151], v44, s[24:27], s93 offen offset:0 sc1
v_cvt_pk_bf16_f32 v83, v98, v99
v_cvt_pk_bf16_f32 v84, v84, v85
v_cvt_pk_bf16_f32 v85, v86, v87
v_cvt_pk_bf16_f32 v86, v100, v101
v_cvt_pk_bf16_f32 v87, v102, v103
v_cvt_pk_bf16_f32 v88, v88, v89
v_cvt_pk_bf16_f32 v89, v90, v91
v_cvt_pk_bf16_f32 v90, v104, v105
v_cvt_pk_bf16_f32 v91, v106, v107
v_cvt_pk_bf16_f32 v92, v92, v93
v_cvt_pk_bf16_f32 v93, v94, v95
v_cvt_pk_bf16_f32 v94, v108, v109
v_cvt_pk_bf16_f32 v95, v110, v111
s_waitcnt lgkmcnt(0)
v_pk_fma_f32 v[48:49], v[24:25], v[16:17], v[48:49] op_sel:[0,0,0] op_sel_hi:[1,0,1]
v_pk_fma_f32 v[50:51], v[26:27], v[16:17], v[50:51] op_sel:[0,0,0] op_sel_hi:[1,0,1]
v_pk_mul_f32 v[48:49], v[48:49], v[16:17] op_sel:[0,1] op_sel_hi:[1,1]
v_pk_mul_f32 v[50:51], v[50:51], v[16:17] op_sel:[0,1] op_sel_hi:[1,1]
v_pk_fma_f32 v[52:53], v[24:25], v[18:19], v[52:53] op_sel:[0,0,0] op_sel_hi:[1,0,1]
v_max_f32 v152, 0, v152
v_max_f32 v153, 0, v153
v_max_f32 v154, 0, v154
v_max_f32 v155, 0, v155
v_max_f32 v168, 0, v168
v_max_f32 v169, 0, v169
v_max_f32 v170, 0, v170
v_max_f32 v171, 0, v171
v_pk_mul_f32 v[152:153], v[152:153], v[152:153]
v_pk_mul_f32 v[154:155], v[154:155], v[154:155]
v_pk_mul_f32 v[168:169], v[168:169], v[168:169]
v_pk_mul_f32 v[170:171], v[170:171], v[170:171]
v_cvt_pk_bf16_f32 v152, v152, v153
v_cvt_pk_bf16_f32 v153, v154, v155
v_cvt_pk_bf16_f32 v154, v168, v169
v_cvt_pk_bf16_f32 v155, v170, v171
buffer_store_dwordx4 v[152:155], v44, s[24:27], s94 offen offset:0 sc1
v_pk_fma_f32 v[54:55], v[26:27], v[18:19], v[54:55] op_sel:[0,0,0] op_sel_hi:[1,0,1]
v_pk_mul_f32 v[52:53], v[52:53], v[18:19] op_sel:[0,1] op_sel_hi:[1,1]
v_pk_mul_f32 v[54:55], v[54:55], v[18:19] op_sel:[0,1] op_sel_hi:[1,1]
v_pk_fma_f32 v[56:57], v[24:25], v[20:21], v[56:57] op_sel:[0,0,0] op_sel_hi:[1,0,1]
v_pk_fma_f32 v[58:59], v[26:27], v[20:21], v[58:59] op_sel:[0,0,0] op_sel_hi:[1,0,1]
v_pk_mul_f32 v[56:57], v[56:57], v[20:21] op_sel:[0,1] op_sel_hi:[1,1]
v_pk_mul_f32 v[58:59], v[58:59], v[20:21] op_sel:[0,1] op_sel_hi:[1,1]
v_pk_fma_f32 v[60:61], v[24:25], v[22:23], v[60:61] op_sel:[0,0,0] op_sel_hi:[1,0,1]
v_pk_fma_f32 v[62:63], v[26:27], v[22:23], v[62:63] op_sel:[0,0,0] op_sel_hi:[1,0,1]
v_pk_mul_f32 v[60:61], v[60:61], v[22:23] op_sel:[0,1] op_sel_hi:[1,1]
v_pk_mul_f32 v[62:63], v[62:63], v[22:23] op_sel:[0,1] op_sel_hi:[1,1]
v_pk_fma_f32 v[64:65], v[28:29], v[16:17], v[64:65] op_sel:[0,0,0] op_sel_hi:[1,0,1]
v_pk_fma_f32 v[66:67], v[30:31], v[16:17], v[66:67] op_sel:[0,0,0] op_sel_hi:[1,0,1]
v_pk_mul_f32 v[64:65], v[64:65], v[16:17] op_sel:[0,1] op_sel_hi:[1,1]
v_pk_mul_f32 v[66:67], v[66:67], v[16:17] op_sel:[0,1] op_sel_hi:[1,1]
v_pk_fma_f32 v[68:69], v[28:29], v[18:19], v[68:69] op_sel:[0,0,0] op_sel_hi:[1,0,1]
v_pk_fma_f32 v[70:71], v[30:31], v[18:19], v[70:71] op_sel:[0,0,0] op_sel_hi:[1,0,1]
v_pk_mul_f32 v[68:69], v[68:69], v[18:19] op_sel:[0,1] op_sel_hi:[1,1]
v_pk_mul_f32 v[70:71], v[70:71], v[18:19] op_sel:[0,1] op_sel_hi:[1,1]
v_max_f32 v156, 0, v156
v_max_f32 v157, 0, v157
v_max_f32 v158, 0, v158
v_max_f32 v159, 0, v159
v_max_f32 v172, 0, v172
v_max_f32 v173, 0, v173
v_max_f32 v174, 0, v174
v_max_f32 v175, 0, v175
v_pk_mul_f32 v[156:157], v[156:157], v[156:157]
v_pk_mul_f32 v[158:159], v[158:159], v[158:159]
v_pk_mul_f32 v[172:173], v[172:173], v[172:173]
v_pk_mul_f32 v[174:175], v[174:175], v[174:175]
v_cvt_pk_bf16_f32 v156, v156, v157
v_cvt_pk_bf16_f32 v157, v158, v159
v_cvt_pk_bf16_f32 v158, v172, v173
v_cvt_pk_bf16_f32 v159, v174, v175
buffer_store_dwordx4 v[156:159], v44, s[24:27], s95 offen offset:0 sc1
v_pk_fma_f32 v[72:73], v[28:29], v[20:21], v[72:73] op_sel:[0,0,0] op_sel_hi:[1,0,1]
v_pk_fma_f32 v[74:75], v[30:31], v[20:21], v[74:75] op_sel:[0,0,0] op_sel_hi:[1,0,1]
v_pk_mul_f32 v[72:73], v[72:73], v[20:21] op_sel:[0,1] op_sel_hi:[1,1]
v_pk_mul_f32 v[74:75], v[74:75], v[20:21] op_sel:[0,1] op_sel_hi:[1,1]
v_pk_fma_f32 v[76:77], v[28:29], v[22:23], v[76:77] op_sel:[0,0,0] op_sel_hi:[1,0,1]
v_pk_fma_f32 v[78:79], v[30:31], v[22:23], v[78:79] op_sel:[0,0,0] op_sel_hi:[1,0,1]
v_pk_mul_f32 v[76:77], v[76:77], v[22:23] op_sel:[0,1] op_sel_hi:[1,1]
v_pk_mul_f32 v[78:79], v[78:79], v[22:23] op_sel:[0,1] op_sel_hi:[1,1]
ds_read_b128 v[24:27], v6 offset:1280
ds_read_b128 v[28:31], v6 offset:1344
v_cvt_pk_bf16_f32 v48, v48, v49
v_cvt_pk_bf16_f32 v49, v50, v51
v_cvt_pk_bf16_f32 v50, v64, v65
v_cvt_pk_bf16_f32 v51, v66, v67
v_cvt_pk_bf16_f32 v52, v52, v53
v_cvt_pk_bf16_f32 v53, v54, v55
v_cvt_pk_bf16_f32 v54, v68, v69
v_cvt_pk_bf16_f32 v55, v70, v71
v_cvt_pk_bf16_f32 v56, v56, v57
s_waitcnt lgkmcnt(0)
v_pk_fma_f32 v[176:177], v[2:3], v[16:17], v[176:177] op_sel:[0,0,0] op_sel_hi:[1,0,1]
v_pk_fma_f32 v[178:179], v[4:5], v[16:17], v[178:179] op_sel:[0,0,0] op_sel_hi:[1,0,1]
v_pk_fma_f32 v[176:177], v[176:177], v[16:17], v[12:13] op_sel:[0,1,0] op_sel_hi:[1,1,1]
v_pk_fma_f32 v[178:179], v[178:179], v[16:17], v[14:15] op_sel:[0,1,0] op_sel_hi:[1,1,1]
v_pk_fma_f32 v[192:193], v[8:9], v[16:17], v[192:193] op_sel:[0,0,0] op_sel_hi:[1,0,1]
v_pk_fma_f32 v[194:195], v[10:11], v[16:17], v[194:195] op_sel:[0,0,0] op_sel_hi:[1,0,1]
v_pk_fma_f32 v[192:193], v[192:193], v[16:17], v[36:37] op_sel:[0,1,0] op_sel_hi:[1,1,1]
v_pk_fma_f32 v[194:195], v[194:195], v[16:17], v[38:39] op_sel:[0,1,0] op_sel_hi:[1,1,1]
v_pk_fma_f32 v[180:181], v[2:3], v[18:19], v[180:181] op_sel:[0,0,0] op_sel_hi:[1,0,1]
v_pk_fma_f32 v[182:183], v[4:5], v[18:19], v[182:183] op_sel:[0,0,0] op_sel_hi:[1,0,1]
v_pk_fma_f32 v[180:181], v[180:181], v[18:19], v[12:13] op_sel:[0,1,0] op_sel_hi:[1,1,1]
v_pk_fma_f32 v[182:183], v[182:183], v[18:19], v[14:15] op_sel:[0,1,0] op_sel_hi:[1,1,1]
v_pk_fma_f32 v[196:197], v[8:9], v[18:19], v[196:197] op_sel:[0,0,0] op_sel_hi:[1,0,1]
v_pk_fma_f32 v[198:199], v[10:11], v[18:19], v[198:199] op_sel:[0,0,0] op_sel_hi:[1,0,1]
v_pk_fma_f32 v[196:197], v[196:197], v[18:19], v[36:37] op_sel:[0,1,0] op_sel_hi:[1,1,1]
v_pk_fma_f32 v[198:199], v[198:199], v[18:19], v[38:39] op_sel:[0,1,0] op_sel_hi:[1,1,1]
v_pk_fma_f32 v[184:185], v[2:3], v[20:21], v[184:185] op_sel:[0,0,0] op_sel_hi:[1,0,1]
v_pk_fma_f32 v[186:187], v[4:5], v[20:21], v[186:187] op_sel:[0,0,0] op_sel_hi:[1,0,1]
v_pk_fma_f32 v[184:185], v[184:185], v[20:21], v[12:13] op_sel:[0,1,0] op_sel_hi:[1,1,1]
v_pk_fma_f32 v[186:187], v[186:187], v[20:21], v[14:15] op_sel:[0,1,0] op_sel_hi:[1,1,1]
v_pk_fma_f32 v[200:201], v[8:9], v[20:21], v[200:201] op_sel:[0,0,0] op_sel_hi:[1,0,1]
v_pk_fma_f32 v[202:203], v[10:11], v[20:21], v[202:203] op_sel:[0,0,0] op_sel_hi:[1,0,1]
v_pk_fma_f32 v[200:201], v[200:201], v[20:21], v[36:37] op_sel:[0,1,0] op_sel_hi:[1,1,1]
v_pk_fma_f32 v[202:203], v[202:203], v[20:21], v[38:39] op_sel:[0,1,0] op_sel_hi:[1,1,1]
v_pk_fma_f32 v[188:189], v[2:3], v[22:23], v[188:189] op_sel:[0,0,0] op_sel_hi:[1,0,1]
v_pk_fma_f32 v[190:191], v[4:5], v[22:23], v[190:191] op_sel:[0,0,0] op_sel_hi:[1,0,1]
v_pk_fma_f32 v[188:189], v[188:189], v[22:23], v[12:13] op_sel:[0,1,0] op_sel_hi:[1,1,1]
v_pk_fma_f32 v[190:191], v[190:191], v[22:23], v[14:15] op_sel:[0,1,0] op_sel_hi:[1,1,1]
v_pk_fma_f32 v[204:205], v[8:9], v[22:23], v[204:205] op_sel:[0,0,0] op_sel_hi:[1,0,1]
v_pk_fma_f32 v[206:207], v[10:11], v[22:23], v[206:207] op_sel:[0,0,0] op_sel_hi:[1,0,1]
v_pk_fma_f32 v[204:205], v[204:205], v[22:23], v[36:37] op_sel:[0,1,0] op_sel_hi:[1,1,1]
v_pk_fma_f32 v[206:207], v[206:207], v[22:23], v[38:39] op_sel:[0,1,0] op_sel_hi:[1,1,1]
ds_read_b128 v[2:5], v6 offset:1664
ds_read_b128 v[12:15], v6 offset:256
ds_read_b128 v[8:11], v6 offset:1728
ds_read_b128 v[36:39], v6 offset:320
v_cvt_pk_bf16_f32 v57, v58, v59
v_cvt_pk_bf16_f32 v58, v72, v73
v_cvt_pk_bf16_f32 v59, v74, v75
v_cvt_pk_bf16_f32 v60, v60, v61
v_cvt_pk_bf16_f32 v61, v62, v63
v_cvt_pk_bf16_f32 v62, v76, v77
v_cvt_pk_bf16_f32 v63, v78, v79
v_mfma_f32_16x16x32_bf16 v[64:67], a[184:187], v[80:83], 0
v_mfma_f32_16x16x32_bf16 v[96:99], a[188:191], v[80:83], 0
v_mfma_f32_16x16x32_bf16 v[68:71], a[184:187], v[84:87], 0
v_mfma_f32_16x16x32_bf16 v[100:103], a[188:191], v[84:87], 0
v_mfma_f32_16x16x32_bf16 v[72:75], a[184:187], v[88:91], 0
v_mfma_f32_16x16x32_bf16 v[104:107], a[188:191], v[88:91], 0
v_mfma_f32_16x16x32_bf16 v[76:79], a[184:187], v[92:95], 0
v_mfma_f32_16x16x32_bf16 v[108:111], a[188:191], v[92:95], 0
s_waitcnt lgkmcnt(0)
v_pk_fma_f32 v[112:113], v[24:25], v[16:17], v[112:113] op_sel:[0,0,0] op_sel_hi:[1,0,1]
v_pk_fma_f32 v[114:115], v[26:27], v[16:17], v[114:115] op_sel:[0,0,0] op_sel_hi:[1,0,1]
v_pk_mul_f32 v[112:113], v[112:113], v[16:17] op_sel:[0,1] op_sel_hi:[1,1]
v_max_f32 v176, 0, v176
v_max_f32 v177, 0, v177
v_max_f32 v178, 0, v178
v_max_f32 v179, 0, v179
v_max_f32 v192, 0, v192
v_max_f32 v193, 0, v193
v_max_f32 v194, 0, v194
v_max_f32 v195, 0, v195
v_pk_mul_f32 v[176:177], v[176:177], v[176:177]
v_pk_mul_f32 v[178:179], v[178:179], v[178:179]
v_pk_mul_f32 v[192:193], v[192:193], v[192:193]
v_pk_mul_f32 v[194:195], v[194:195], v[194:195]
v_cvt_pk_bf16_f32 v176, v176, v177
v_cvt_pk_bf16_f32 v177, v178, v179
v_cvt_pk_bf16_f32 v178, v192, v193
v_cvt_pk_bf16_f32 v179, v194, v195
buffer_store_dwordx4 v[176:179], v44, s[24:27], s92 offen offset:1024 sc1
v_pk_mul_f32 v[114:115], v[114:115], v[16:17] op_sel:[0,1] op_sel_hi:[1,1]
v_pk_fma_f32 v[116:117], v[24:25], v[18:19], v[116:117] op_sel:[0,0,0] op_sel_hi:[1,0,1]
v_pk_fma_f32 v[118:119], v[26:27], v[18:19], v[118:119] op_sel:[0,0,0] op_sel_hi:[1,0,1]
v_pk_mul_f32 v[116:117], v[116:117], v[18:19] op_sel:[0,1] op_sel_hi:[1,1]
v_pk_mul_f32 v[118:119], v[118:119], v[18:19] op_sel:[0,1] op_sel_hi:[1,1]
v_pk_fma_f32 v[120:121], v[24:25], v[20:21], v[120:121] op_sel:[0,0,0] op_sel_hi:[1,0,1]
v_pk_fma_f32 v[122:123], v[26:27], v[20:21], v[122:123] op_sel:[0,0,0] op_sel_hi:[1,0,1]
v_pk_mul_f32 v[120:121], v[120:121], v[20:21] op_sel:[0,1] op_sel_hi:[1,1]
v_pk_mul_f32 v[122:123], v[122:123], v[20:21] op_sel:[0,1] op_sel_hi:[1,1]
v_pk_fma_f32 v[124:125], v[24:25], v[22:23], v[124:125] op_sel:[0,0,0] op_sel_hi:[1,0,1]
v_pk_fma_f32 v[126:127], v[26:27], v[22:23], v[126:127] op_sel:[0,0,0] op_sel_hi:[1,0,1]
v_pk_mul_f32 v[124:125], v[124:125], v[22:23] op_sel:[0,1] op_sel_hi:[1,1]
v_pk_mul_f32 v[126:127], v[126:127], v[22:23] op_sel:[0,1] op_sel_hi:[1,1]
v_pk_fma_f32 v[128:129], v[28:29], v[16:17], v[128:129] op_sel:[0,0,0] op_sel_hi:[1,0,1]
v_pk_fma_f32 v[130:131], v[30:31], v[16:17], v[130:131] op_sel:[0,0,0] op_sel_hi:[1,0,1]
v_pk_mul_f32 v[128:129], v[128:129], v[16:17] op_sel:[0,1] op_sel_hi:[1,1]
v_pk_mul_f32 v[130:131], v[130:131], v[16:17] op_sel:[0,1] op_sel_hi:[1,1]
v_pk_fma_f32 v[132:133], v[28:29], v[18:19], v[132:133] op_sel:[0,0,0] op_sel_hi:[1,0,1]
v_pk_fma_f32 v[134:135], v[30:31], v[18:19], v[134:135] op_sel:[0,0,0] op_sel_hi:[1,0,1]
v_max_f32 v180, 0, v180
v_max_f32 v181, 0, v181
v_max_f32 v182, 0, v182
v_max_f32 v183, 0, v183
v_max_f32 v196, 0, v196
v_max_f32 v197, 0, v197
v_max_f32 v198, 0, v198
v_max_f32 v199, 0, v199
v_pk_mul_f32 v[180:181], v[180:181], v[180:181]
v_pk_mul_f32 v[182:183], v[182:183], v[182:183]
v_pk_mul_f32 v[196:197], v[196:197], v[196:197]
v_pk_mul_f32 v[198:199], v[198:199], v[198:199]
v_cvt_pk_bf16_f32 v180, v180, v181
v_cvt_pk_bf16_f32 v181, v182, v183
v_cvt_pk_bf16_f32 v182, v196, v197
v_cvt_pk_bf16_f32 v183, v198, v199
buffer_store_dwordx4 v[180:183], v44, s[24:27], s93 offen offset:1024 sc1
v_pk_mul_f32 v[132:133], v[132:133], v[18:19] op_sel:[0,1] op_sel_hi:[1,1]
v_pk_mul_f32 v[134:135], v[134:135], v[18:19] op_sel:[0,1] op_sel_hi:[1,1]
v_pk_fma_f32 v[136:137], v[28:29], v[20:21], v[136:137] op_sel:[0,0,0] op_sel_hi:[1,0,1]
v_pk_fma_f32 v[138:139], v[30:31], v[20:21], v[138:139] op_sel:[0,0,0] op_sel_hi:[1,0,1]
v_pk_mul_f32 v[136:137], v[136:137], v[20:21] op_sel:[0,1] op_sel_hi:[1,1]
v_pk_mul_f32 v[138:139], v[138:139], v[20:21] op_sel:[0,1] op_sel_hi:[1,1]
v_pk_fma_f32 v[140:141], v[28:29], v[22:23], v[140:141] op_sel:[0,0,0] op_sel_hi:[1,0,1]
v_pk_fma_f32 v[142:143], v[30:31], v[22:23], v[142:143] op_sel:[0,0,0] op_sel_hi:[1,0,1]
v_pk_mul_f32 v[140:141], v[140:141], v[22:23] op_sel:[0,1] op_sel_hi:[1,1]
v_pk_mul_f32 v[142:143], v[142:143], v[22:23] op_sel:[0,1] op_sel_hi:[1,1]
v_xor_b32 v46, 32, v41
v_cvt_pk_bf16_f32 v112, v112, v113
v_cvt_pk_bf16_f32 v113, v114, v115
v_cvt_pk_bf16_f32 v116, v116, v117
v_cvt_pk_bf16_f32 v117, v118, v119
v_cvt_pk_bf16_f32 v120, v120, v121
v_cvt_pk_bf16_f32 v121, v122, v123
v_cvt_pk_bf16_f32 v124, v124, v125
v_cvt_pk_bf16_f32 v125, v126, v127
v_max_f32 v184, 0, v184
v_max_f32 v185, 0, v185
v_max_f32 v186, 0, v186
v_max_f32 v187, 0, v187
v_max_f32 v200, 0, v200
v_max_f32 v201, 0, v201
v_max_f32 v202, 0, v202
v_max_f32 v203, 0, v203
v_pk_mul_f32 v[184:185], v[184:185], v[184:185]
v_pk_mul_f32 v[186:187], v[186:187], v[186:187]
v_pk_mul_f32 v[200:201], v[200:201], v[200:201]
v_pk_mul_f32 v[202:203], v[202:203], v[202:203]
v_cvt_pk_bf16_f32 v184, v184, v185
v_cvt_pk_bf16_f32 v185, v186, v187
v_cvt_pk_bf16_f32 v186, v200, v201
v_cvt_pk_bf16_f32 v187, v202, v203
buffer_store_dwordx4 v[184:187], v44, s[24:27], s94 offen offset:1024 sc1
v_cvt_pk_bf16_f32 v128, v128, v129
v_cvt_pk_bf16_f32 v129, v130, v131
v_cvt_pk_bf16_f32 v132, v132, v133
v_cvt_pk_bf16_f32 v133, v134, v135
v_cvt_pk_bf16_f32 v136, v136, v137
v_cvt_pk_bf16_f32 v137, v138, v139
v_cvt_pk_bf16_f32 v140, v140, v141
v_cvt_pk_bf16_f32 v141, v142, v143
ds_write_b64 v41, v[112:113] offset:0
ds_write_b64 v41, v[116:117] offset:1024
ds_write_b64 v41, v[120:121] offset:2048
ds_write_b64 v41, v[124:125] offset:3072
ds_write_b64 v46, v[128:129] offset:0
ds_write_b64 v46, v[132:133] offset:1024
ds_write_b64 v46, v[136:137] offset:2048
ds_write_b64 v46, v[140:141] offset:3072
v_max3_f32 v24, v64, v65, v66
v_max3_f32 v25, -v64, -v65, -v66
v_max3_f32 v24, v24, v67, v96
v_max_f32 v188, 0, v188
v_max_f32 v189, 0, v189
v_max_f32 v190, 0, v190
v_max_f32 v191, 0, v191
v_max_f32 v204, 0, v204
v_max_f32 v205, 0, v205
v_max_f32 v206, 0, v206
v_max_f32 v207, 0, v207
v_pk_mul_f32 v[188:189], v[188:189], v[188:189]
v_pk_mul_f32 v[190:191], v[190:191], v[190:191]
v_pk_mul_f32 v[204:205], v[204:205], v[204:205]
v_pk_mul_f32 v[206:207], v[206:207], v[206:207]
v_cvt_pk_bf16_f32 v188, v188, v189
v_cvt_pk_bf16_f32 v189, v190, v191
v_cvt_pk_bf16_f32 v190, v204, v205
v_cvt_pk_bf16_f32 v191, v206, v207
buffer_store_dwordx4 v[188:191], v44, s[24:27], s95 offen offset:1024 sc1
v_max3_f32 v25, v25, -v67, -v96
v_max3_f32 v24, v24, v97, v98
v_max3_f32 v25, v25, -v97, -v98
v_max_f32 v24, v24, v99
v_max_f32 v25, v25, -v99
v_max3_f32 v26, v68, v69, v70
v_max3_f32 v27, -v68, -v69, -v70
v_max3_f32 v26, v26, v71, v100
v_max3_f32 v27, v27, -v71, -v100
v_max3_f32 v26, v26, v101, v102
v_max3_f32 v27, v27, -v101, -v102
v_max_f32 v26, v26, v103
v_max_f32 v27, v27, -v103
v_permlane32_swap_b32 v24, v25
s_nop 0
v_permlane32_swap_b32 v26, v27
v_max_f32 v24, v24, v25
v_max_f32 v26, v26, v27
s_nop 1
v_permlane16_swap_b32 v24, v26
v_max_f32 v24, v24, v26
s_waitcnt lgkmcnt(0)
v_pk_fma_f32 v[208:209], v[2:3], v[16:17], v[208:209] op_sel:[0,0,0] op_sel_hi:[1,0,1]
v_pk_fma_f32 v[210:211], v[4:5], v[16:17], v[210:211] op_sel:[0,0,0] op_sel_hi:[1,0,1]
v_pk_fma_f32 v[208:209], v[208:209], v[16:17], v[12:13] op_sel:[0,1,0] op_sel_hi:[1,1,1]
v_pk_fma_f32 v[210:211], v[210:211], v[16:17], v[14:15] op_sel:[0,1,0] op_sel_hi:[1,1,1]
v_pk_fma_f32 v[224:225], v[8:9], v[16:17], v[224:225] op_sel:[0,0,0] op_sel_hi:[1,0,1]
v_pk_fma_f32 v[226:227], v[10:11], v[16:17], v[226:227] op_sel:[0,0,0] op_sel_hi:[1,0,1]
v_pk_fma_f32 v[224:225], v[224:225], v[16:17], v[36:37] op_sel:[0,1,0] op_sel_hi:[1,1,1]
v_pk_fma_f32 v[226:227], v[226:227], v[16:17], v[38:39] op_sel:[0,1,0] op_sel_hi:[1,1,1]
v_pk_fma_f32 v[212:213], v[2:3], v[18:19], v[212:213] op_sel:[0,0,0] op_sel_hi:[1,0,1]
v_pk_fma_f32 v[214:215], v[4:5], v[18:19], v[214:215] op_sel:[0,0,0] op_sel_hi:[1,0,1]
v_pk_fma_f32 v[212:213], v[212:213], v[18:19], v[12:13] op_sel:[0,1,0] op_sel_hi:[1,1,1]
v_pk_fma_f32 v[214:215], v[214:215], v[18:19], v[14:15] op_sel:[0,1,0] op_sel_hi:[1,1,1]
v_pk_fma_f32 v[228:229], v[8:9], v[18:19], v[228:229] op_sel:[0,0,0] op_sel_hi:[1,0,1]
v_pk_fma_f32 v[230:231], v[10:11], v[18:19], v[230:231] op_sel:[0,0,0] op_sel_hi:[1,0,1]
v_pk_fma_f32 v[228:229], v[228:229], v[18:19], v[36:37] op_sel:[0,1,0] op_sel_hi:[1,1,1]
v_pk_fma_f32 v[230:231], v[230:231], v[18:19], v[38:39] op_sel:[0,1,0] op_sel_hi:[1,1,1]
v_pk_fma_f32 v[216:217], v[2:3], v[20:21], v[216:217] op_sel:[0,0,0] op_sel_hi:[1,0,1]
v_pk_fma_f32 v[218:219], v[4:5], v[20:21], v[218:219] op_sel:[0,0,0] op_sel_hi:[1,0,1]
v_pk_fma_f32 v[216:217], v[216:217], v[20:21], v[12:13] op_sel:[0,1,0] op_sel_hi:[1,1,1]
v_pk_fma_f32 v[218:219], v[218:219], v[20:21], v[14:15] op_sel:[0,1,0] op_sel_hi:[1,1,1]
v_pk_fma_f32 v[232:233], v[8:9], v[20:21], v[232:233] op_sel:[0,0,0] op_sel_hi:[1,0,1]
v_pk_fma_f32 v[234:235], v[10:11], v[20:21], v[234:235] op_sel:[0,0,0] op_sel_hi:[1,0,1]
v_pk_fma_f32 v[232:233], v[232:233], v[20:21], v[36:37] op_sel:[0,1,0] op_sel_hi:[1,1,1]
v_pk_fma_f32 v[234:235], v[234:235], v[20:21], v[38:39] op_sel:[0,1,0] op_sel_hi:[1,1,1]
v_pk_fma_f32 v[220:221], v[2:3], v[22:23], v[220:221] op_sel:[0,0,0] op_sel_hi:[1,0,1]
v_pk_fma_f32 v[222:223], v[4:5], v[22:23], v[222:223] op_sel:[0,0,0] op_sel_hi:[1,0,1]
v_pk_fma_f32 v[220:221], v[220:221], v[22:23], v[12:13] op_sel:[0,1,0] op_sel_hi:[1,1,1]
v_pk_fma_f32 v[222:223], v[222:223], v[22:23], v[14:15] op_sel:[0,1,0] op_sel_hi:[1,1,1]
v_pk_fma_f32 v[236:237], v[8:9], v[22:23], v[236:237] op_sel:[0,0,0] op_sel_hi:[1,0,1]
v_pk_fma_f32 v[238:239], v[10:11], v[22:23], v[238:239] op_sel:[0,0,0] op_sel_hi:[1,0,1]
v_pk_fma_f32 v[236:237], v[236:237], v[22:23], v[36:37] op_sel:[0,1,0] op_sel_hi:[1,1,1]
v_pk_fma_f32 v[238:239], v[238:239], v[22:23], v[38:39] op_sel:[0,1,0] op_sel_hi:[1,1,1]
ds_read_b128 v[2:5], v6 offset:1792
ds_read_b128 v[12:15], v6 offset:384
v_mov_b32 v26, v24
s_nop 1
v_permlane16_swap_b32 v24, v26
v_mov_b32 v25, v24
v_mov_b32 v27, v26
s_nop 0
v_permlane32_swap_b32 v24, v25
v_permlane32_swap_b32 v26, v27
v_pk_mul_f32 v[24:25], v[24:25], s[58:59] op_sel:[0,0] op_sel_hi:[1,0]
v_pk_mul_f32 v[26:27], v[26:27], s[58:59] op_sel:[0,0] op_sel_hi:[1,0]
v_pk_fma_f32 v[80:81], v[64:65], s[58:59], v[24:25] op_sel:[0,0,0] op_sel_hi:[1,0,0] neg_lo:[0,0,1] neg_hi:[0,0,1]
v_pk_fma_f32 v[82:83], v[66:67], s[58:59], v[24:25] op_sel:[0,0,0] op_sel_hi:[1,0,0] neg_lo:[0,0,1] neg_hi:[0,0,1]
v_pk_fma_f32 v[84:85], v[96:97], s[58:59], v[24:25] op_sel:[0,0,0] op_sel_hi:[1,0,0] neg_lo:[0,0,1] neg_hi:[0,0,1]
v_pk_fma_f32 v[86:87], v[98:99], s[58:59], v[24:25] op_sel:[0,0,0] op_sel_hi:[1,0,0] neg_lo:[0,0,1] neg_hi:[0,0,1]
v_pk_fma_f32 v[64:65], v[64:65], s[58:59], v[24:25] op_sel:[0,0,1] op_sel_hi:[1,0,1] neg_lo:[1,0,1] neg_hi:[1,0,1]
v_pk_fma_f32 v[66:67], v[66:67], s[58:59], v[24:25] op_sel:[0,0,1] op_sel_hi:[1,0,1] neg_lo:[1,0,1] neg_hi:[1,0,1]
v_pk_fma_f32 v[96:97], v[96:97], s[58:59], v[24:25] op_sel:[0,0,1] op_sel_hi:[1,0,1] neg_lo:[1,0,1] neg_hi:[1,0,1]
v_pk_fma_f32 v[98:99], v[98:99], s[58:59], v[24:25] op_sel:[0,0,1] op_sel_hi:[1,0,1] neg_lo:[1,0,1] neg_hi:[1,0,1]
v_pk_fma_f32 v[88:89], v[68:69], s[58:59], v[26:27] op_sel:[0,0,0] op_sel_hi:[1,0,0] neg_lo:[0,0,1] neg_hi:[0,0,1]
v_pk_fma_f32 v[90:91], v[70:71], s[58:59], v[26:27] op_sel:[0,0,0] op_sel_hi:[1,0,0] neg_lo:[0,0,1] neg_hi:[0,0,1]
v_pk_fma_f32 v[92:93], v[100:101], s[58:59], v[26:27] op_sel:[0,0,0] op_sel_hi:[1,0,0] neg_lo:[0,0,1] neg_hi:[0,0,1]
v_max_f32 v208, 0, v208
v_max_f32 v209, 0, v209
v_max_f32 v210, 0, v210
v_max_f32 v211, 0, v211
v_max_f32 v224, 0, v224
v_max_f32 v225, 0, v225
v_max_f32 v226, 0, v226
v_max_f32 v227, 0, v227
v_pk_mul_f32 v[208:209], v[208:209], v[208:209]
v_pk_mul_f32 v[210:211], v[210:211], v[210:211]
v_pk_mul_f32 v[224:225], v[224:225], v[224:225]
v_pk_mul_f32 v[226:227], v[226:227], v[226:227]
v_cvt_pk_bf16_f32 v208, v208, v209
v_cvt_pk_bf16_f32 v209, v210, v211
v_cvt_pk_bf16_f32 v210, v224, v225
v_cvt_pk_bf16_f32 v211, v226, v227
buffer_store_dwordx4 v[208:211], v44, s[24:27], s92 offen offset:2048 sc1
v_pk_fma_f32 v[94:95], v[102:103], s[58:59], v[26:27] op_sel:[0,0,0] op_sel_hi:[1,0,0] neg_lo:[0,0,1] neg_hi:[0,0,1]
v_pk_fma_f32 v[68:69], v[68:69], s[58:59], v[26:27] op_sel:[0,0,1] op_sel_hi:[1,0,1] neg_lo:[1,0,1] neg_hi:[1,0,1]
v_pk_fma_f32 v[70:71], v[70:71], s[58:59], v[26:27] op_sel:[0,0,1] op_sel_hi:[1,0,1] neg_lo:[1,0,1] neg_hi:[1,0,1]
v_pk_fma_f32 v[100:101], v[100:101], s[58:59], v[26:27] op_sel:[0,0,1] op_sel_hi:[1,0,1] neg_lo:[1,0,1] neg_hi:[1,0,1]
v_pk_fma_f32 v[102:103], v[102:103], s[58:59], v[26:27] op_sel:[0,0,1] op_sel_hi:[1,0,1] neg_lo:[1,0,1] neg_hi:[1,0,1]
v_exp_f32 v80, v80
v_exp_f32 v81, v81
v_exp_f32 v82, v82
v_exp_f32 v83, v83
v_exp_f32 v84, v84
v_exp_f32 v85, v85
v_exp_f32 v86, v86
v_exp_f32 v87, v87
v_exp_f32 v64, v64
v_exp_f32 v65, v65
v_exp_f32 v66, v66
v_exp_f32 v67, v67
v_exp_f32 v96, v96
v_exp_f32 v97, v97
v_max_f32 v212, 0, v212
v_max_f32 v213, 0, v213
v_max_f32 v214, 0, v214
v_max_f32 v215, 0, v215
v_max_f32 v228, 0, v228
v_max_f32 v229, 0, v229
v_max_f32 v230, 0, v230
v_max_f32 v231, 0, v231
v_pk_mul_f32 v[212:213], v[212:213], v[212:213]
v_pk_mul_f32 v[214:215], v[214:215], v[214:215]
v_pk_mul_f32 v[228:229], v[228:229], v[228:229]
v_pk_mul_f32 v[230:231], v[230:231], v[230:231]
v_cvt_pk_bf16_f32 v212, v212, v213
v_cvt_pk_bf16_f32 v213, v214, v215
v_cvt_pk_bf16_f32 v214, v228, v229
v_cvt_pk_bf16_f32 v215, v230, v231
buffer_store_dwordx4 v[212:215], v44, s[24:27], s93 offen offset:2048 sc1
v_exp_f32 v98, v98
v_exp_f32 v99, v99
v_exp_f32 v88, v88
v_exp_f32 v89, v89
v_exp_f32 v90, v90
v_exp_f32 v91, v91
v_exp_f32 v92, v92
v_exp_f32 v93, v93
v_exp_f32 v94, v94
v_exp_f32 v95, v95
v_exp_f32 v68, v68
v_exp_f32 v69, v69
v_exp_f32 v70, v70
v_exp_f32 v71, v71
v_exp_f32 v100, v100
v_exp_f32 v101, v101
v_exp_f32 v102, v102
v_exp_f32 v103, v103
v_pk_add_f32 v[28:29], v[80:81], v[82:83]
v_max_f32 v216, 0, v216
v_max_f32 v217, 0, v217
v_max_f32 v218, 0, v218
v_max_f32 v219, 0, v219
v_max_f32 v232, 0, v232
v_max_f32 v233, 0, v233
v_max_f32 v234, 0, v234
v_max_f32 v235, 0, v235
v_pk_mul_f32 v[216:217], v[216:217], v[216:217]
v_pk_mul_f32 v[218:219], v[218:219], v[218:219]
v_pk_mul_f32 v[232:233], v[232:233], v[232:233]
v_pk_mul_f32 v[234:235], v[234:235], v[234:235]
v_cvt_pk_bf16_f32 v216, v216, v217
v_cvt_pk_bf16_f32 v217, v218, v219
v_cvt_pk_bf16_f32 v218, v232, v233
v_cvt_pk_bf16_f32 v219, v234, v235
buffer_store_dwordx4 v[216:219], v44, s[24:27], s94 offen offset:2048 sc1
v_pk_add_f32 v[30:31], v[84:85], v[86:87]
v_pk_add_f32 v[28:29], v[28:29], v[30:31]
v_add_f32 v24, v28, v29
v_pk_add_f32 v[28:29], v[64:65], v[66:67]
v_pk_add_f32 v[30:31], v[96:97], v[98:99]
v_pk_add_f32 v[28:29], v[28:29], v[30:31]
v_add_f32 v25, v28, v29
v_pk_add_f32 v[28:29], v[88:89], v[90:91]
v_pk_add_f32 v[30:31], v[92:93], v[94:95]
v_pk_add_f32 v[28:29], v[28:29], v[30:31]
v_add_f32 v26, v28, v29
v_pk_add_f32 v[28:29], v[68:69], v[70:71]
v_pk_add_f32 v[30:31], v[100:101], v[102:103]
v_pk_add_f32 v[28:29], v[28:29], v[30:31]
v_add_f32 v27, v28, v29
v_permlane32_swap_b32 v24, v25
s_nop 0
v_permlane32_swap_b32 v26, v27
v_add_f32 v24, v24, v25
v_add_f32 v26, v26, v27
v_max_f32 v220, 0, v220
v_max_f32 v221, 0, v221
v_max_f32 v222, 0, v222
v_max_f32 v223, 0, v223
v_max_f32 v236, 0, v236
v_max_f32 v237, 0, v237
v_max_f32 v238, 0, v238
v_max_f32 v239, 0, v239
v_pk_mul_f32 v[220:221], v[220:221], v[220:221]
v_pk_mul_f32 v[222:223], v[222:223], v[222:223]
v_pk_mul_f32 v[236:237], v[236:237], v[236:237]
v_pk_mul_f32 v[238:239], v[238:239], v[238:239]
v_cvt_pk_bf16_f32 v220, v220, v221
v_cvt_pk_bf16_f32 v221, v222, v223
v_cvt_pk_bf16_f32 v222, v236, v237
v_cvt_pk_bf16_f32 v223, v238, v239
buffer_store_dwordx4 v[220:223], v44, s[24:27], s95 offen offset:2048 sc1
v_permlane16_swap_b32 v24, v26
v_add_f32 v24, v24, v26
v_mov_b32 v26, v24
s_nop 1
v_permlane16_swap_b32 v24, v26
v_mov_b32 v25, v24
v_mov_b32 v27, v26
s_nop 0
v_permlane32_swap_b32 v24, v25
v_permlane32_swap_b32 v26, v27
v_rcp_f32 v24, v24
v_rcp_f32 v25, v25
v_rcp_f32 v26, v26
v_rcp_f32 v27, v27
v_pk_mul_f32 v[80:81], v[80:81], v[24:25] op_sel:[0,0] op_sel_hi:[1,0]
v_pk_mul_f32 v[82:83], v[82:83], v[24:25] op_sel:[0,0] op_sel_hi:[1,0]
v_pk_mul_f32 v[84:85], v[84:85], v[24:25] op_sel:[0,0] op_sel_hi:[1,0]
v_pk_mul_f32 v[86:87], v[86:87], v[24:25] op_sel:[0,0] op_sel_hi:[1,0]
v_cvt_pk_bf16_f32 v112, v80, v81
v_cvt_pk_bf16_f32 v113, v82, v83
v_cvt_pk_bf16_f32 v114, v84, v85
s_waitcnt lgkmcnt(0)
v_pk_fma_f32 v[240:241], v[2:3], v[16:17], v[240:241] op_sel:[0,0,0] op_sel_hi:[1,0,1]
v_pk_fma_f32 v[242:243], v[4:5], v[16:17], v[242:243] op_sel:[0,0,0] op_sel_hi:[1,0,1]
v_pk_fma_f32 v[240:241], v[240:241], v[16:17], v[12:13] op_sel:[0,1,0] op_sel_hi:[1,1,1]
v_pk_fma_f32 v[242:243], v[242:243], v[16:17], v[14:15] op_sel:[0,1,0] op_sel_hi:[1,1,1]
v_pk_fma_f32 v[244:245], v[2:3], v[18:19], v[244:245] op_sel:[0,0,0] op_sel_hi:[1,0,1]
v_pk_fma_f32 v[246:247], v[4:5], v[18:19], v[246:247] op_sel:[0,0,0] op_sel_hi:[1,0,1]
v_pk_fma_f32 v[244:245], v[244:245], v[18:19], v[12:13] op_sel:[0,1,0] op_sel_hi:[1,1,1]
v_pk_fma_f32 v[246:247], v[246:247], v[18:19], v[14:15] op_sel:[0,1,0] op_sel_hi:[1,1,1]
v_pk_fma_f32 v[248:249], v[2:3], v[20:21], v[248:249] op_sel:[0,0,0] op_sel_hi:[1,0,1]
v_pk_fma_f32 v[250:251], v[4:5], v[20:21], v[250:251] op_sel:[0,0,0] op_sel_hi:[1,0,1]
v_pk_fma_f32 v[248:249], v[248:249], v[20:21], v[12:13] op_sel:[0,1,0] op_sel_hi:[1,1,1]
v_pk_fma_f32 v[250:251], v[250:251], v[20:21], v[14:15] op_sel:[0,1,0] op_sel_hi:[1,1,1]
v_pk_fma_f32 v[252:253], v[2:3], v[22:23], v[252:253] op_sel:[0,0,0] op_sel_hi:[1,0,1]
v_pk_fma_f32 v[254:255], v[4:5], v[22:23], v[254:255] op_sel:[0,0,0] op_sel_hi:[1,0,1]
v_pk_fma_f32 v[252:253], v[252:253], v[22:23], v[12:13] op_sel:[0,1,0] op_sel_hi:[1,1,1]
v_pk_fma_f32 v[254:255], v[254:255], v[22:23], v[14:15] op_sel:[0,1,0] op_sel_hi:[1,1,1]
v_cvt_pk_bf16_f32 v115, v86, v87
v_pk_mul_f32 v[64:65], v[64:65], v[24:25] op_sel:[0,1] op_sel_hi:[1,1]
v_pk_mul_f32 v[66:67], v[66:67], v[24:25] op_sel:[0,1] op_sel_hi:[1,1]
v_pk_mul_f32 v[96:97], v[96:97], v[24:25] op_sel:[0,1] op_sel_hi:[1,1]
v_pk_mul_f32 v[98:99], v[98:99], v[24:25] op_sel:[0,1] op_sel_hi:[1,1]
v_cvt_pk_bf16_f32 v116, v64, v65
v_cvt_pk_bf16_f32 v117, v66, v67
v_cvt_pk_bf16_f32 v118, v96, v97
v_cvt_pk_bf16_f32 v119, v98, v99
v_pk_mul_f32 v[88:89], v[88:89], v[26:27] op_sel:[0,0] op_sel_hi:[1,0]
v_pk_mul_f32 v[90:91], v[90:91], v[26:27] op_sel:[0,0] op_sel_hi:[1,0]
v_pk_mul_f32 v[92:93], v[92:93], v[26:27] op_sel:[0,0] op_sel_hi:[1,0]
v_pk_mul_f32 v[94:95], v[94:95], v[26:27] op_sel:[0,0] op_sel_hi:[1,0]
v_cvt_pk_bf16_f32 v120, v88, v89
v_cvt_pk_bf16_f32 v121, v90, v91
v_cvt_pk_bf16_f32 v122, v92, v93
v_cvt_pk_bf16_f32 v123, v94, v95
v_pk_mul_f32 v[68:69], v[68:69], v[26:27] op_sel:[0,1] op_sel_hi:[1,1]
v_pk_mul_f32 v[70:71], v[70:71], v[26:27] op_sel:[0,1] op_sel_hi:[1,1]
v_max_f32 v240, 0, v240
v_max_f32 v241, 0, v241
v_max_f32 v242, 0, v242
v_max_f32 v243, 0, v243
v_pk_mul_f32 v[240:241], v[240:241], v[240:241]
v_pk_mul_f32 v[242:243], v[242:243], v[242:243]
v_cvt_pk_bf16_f32 v240, v240, v241
v_cvt_pk_bf16_f32 v241, v242, v243
buffer_store_dwordx2 v[240:241], v7, s[24:27], s96 offen sc1
v_pk_mul_f32 v[100:101], v[100:101], v[26:27] op_sel:[0,1] op_sel_hi:[1,1]
v_pk_mul_f32 v[102:103], v[102:103], v[26:27] op_sel:[0,1] op_sel_hi:[1,1]
v_cvt_pk_bf16_f32 v124, v68, v69
v_cvt_pk_bf16_f32 v125, v70, v71
v_cvt_pk_bf16_f32 v126, v100, v101
v_cvt_pk_bf16_f32 v127, v102, v103
ds_write_b64 v40, v[112:113] offset:0
ds_write_b64 v40, v[120:121] offset:2048
v_xor_b32 v46, 32, v40
ds_write_b64 v46, v[114:115] offset:0
ds_write_b64 v46, v[122:123] offset:2048
v_xor_b32 v46, 64, v40
ds_write_b64 v46, v[116:117] offset:0
ds_write_b64 v46, v[124:125] offset:2048
v_xor_b32 v46, 96, v40
ds_write_b64 v46, v[118:119] offset:0
ds_write_b64 v46, v[126:127] offset:2048
v_max3_f32 v24, v72, v73, v74
v_max3_f32 v25, -v72, -v73, -v74
v_max_f32 v244, 0, v244
v_max_f32 v245, 0, v245
v_max_f32 v246, 0, v246
v_max_f32 v247, 0, v247
v_pk_mul_f32 v[244:245], v[244:245], v[244:245]
v_pk_mul_f32 v[246:247], v[246:247], v[246:247]
v_cvt_pk_bf16_f32 v244, v244, v245
v_cvt_pk_bf16_f32 v245, v246, v247
buffer_store_dwordx2 v[244:245], v7, s[24:27], s97 offen sc1
v_max3_f32 v24, v24, v75, v104
v_max3_f32 v25, v25, -v75, -v104
v_max3_f32 v24, v24, v105, v106
v_max3_f32 v25, v25, -v105, -v106
v_max_f32 v24, v24, v107
v_max_f32 v25, v25, -v107
v_max3_f32 v26, v76, v77, v78
v_max3_f32 v27, -v76, -v77, -v78
v_max3_f32 v26, v26, v79, v108
v_max3_f32 v27, v27, -v79, -v108
v_max3_f32 v26, v26, v109, v110
v_max3_f32 v27, v27, -v109, -v110
v_max_f32 v26, v26, v111
v_max_f32 v27, v27, -v111
v_permlane32_swap_b32 v24, v25
s_nop 0
v_permlane32_swap_b32 v26, v27
v_max_f32 v24, v24, v25
v_max_f32 v26, v26, v27
s_nop 1
v_permlane16_swap_b32 v24, v26
v_max_f32 v248, 0, v248
v_max_f32 v249, 0, v249
v_max_f32 v250, 0, v250
v_max_f32 v251, 0, v251
v_pk_mul_f32 v[248:249], v[248:249], v[248:249]
v_pk_mul_f32 v[250:251], v[250:251], v[250:251]
v_cvt_pk_bf16_f32 v248, v248, v249
v_cvt_pk_bf16_f32 v249, v250, v251
buffer_store_dwordx2 v[248:249], v7, s[24:27], s98 offen sc1
v_max_f32 v24, v24, v26
v_mov_b32 v26, v24
s_nop 1
v_permlane16_swap_b32 v24, v26
v_mov_b32 v25, v24
v_mov_b32 v27, v26
s_nop 0
v_permlane32_swap_b32 v24, v25
v_permlane32_swap_b32 v26, v27
v_pk_mul_f32 v[24:25], v[24:25], s[58:59] op_sel:[0,0] op_sel_hi:[1,0]
v_pk_mul_f32 v[26:27], v[26:27], s[58:59] op_sel:[0,0] op_sel_hi:[1,0]
v_pk_fma_f32 v[80:81], v[72:73], s[58:59], v[24:25] op_sel:[0,0,0] op_sel_hi:[1,0,0] neg_lo:[0,0,1] neg_hi:[0,0,1]
v_pk_fma_f32 v[82:83], v[74:75], s[58:59], v[24:25] op_sel:[0,0,0] op_sel_hi:[1,0,0] neg_lo:[0,0,1] neg_hi:[0,0,1]
v_pk_fma_f32 v[84:85], v[104:105], s[58:59], v[24:25] op_sel:[0,0,0] op_sel_hi:[1,0,0] neg_lo:[0,0,1] neg_hi:[0,0,1]
v_pk_fma_f32 v[86:87], v[106:107], s[58:59], v[24:25] op_sel:[0,0,0] op_sel_hi:[1,0,0] neg_lo:[0,0,1] neg_hi:[0,0,1]
v_pk_fma_f32 v[72:73], v[72:73], s[58:59], v[24:25] op_sel:[0,0,1] op_sel_hi:[1,0,1] neg_lo:[1,0,1] neg_hi:[1,0,1]
v_pk_fma_f32 v[74:75], v[74:75], s[58:59], v[24:25] op_sel:[0,0,1] op_sel_hi:[1,0,1] neg_lo:[1,0,1] neg_hi:[1,0,1]
v_pk_fma_f32 v[104:105], v[104:105], s[58:59], v[24:25] op_sel:[0,0,1] op_sel_hi:[1,0,1] neg_lo:[1,0,1] neg_hi:[1,0,1]
v_pk_fma_f32 v[106:107], v[106:107], s[58:59], v[24:25] op_sel:[0,0,1] op_sel_hi:[1,0,1] neg_lo:[1,0,1] neg_hi:[1,0,1]
v_pk_fma_f32 v[88:89], v[76:77], s[58:59], v[26:27] op_sel:[0,0,0] op_sel_hi:[1,0,0] neg_lo:[0,0,1] neg_hi:[0,0,1]
v_pk_fma_f32 v[90:91], v[78:79], s[58:59], v[26:27] op_sel:[0,0,0] op_sel_hi:[1,0,0] neg_lo:[0,0,1] neg_hi:[0,0,1]
v_max_f32 v252, 0, v252
v_max_f32 v253, 0, v253
v_max_f32 v254, 0, v254
v_max_f32 v255, 0, v255
v_pk_mul_f32 v[252:253], v[252:253], v[252:253]
v_pk_mul_f32 v[254:255], v[254:255], v[254:255]
v_cvt_pk_bf16_f32 v252, v252, v253
v_cvt_pk_bf16_f32 v253, v254, v255
buffer_store_dwordx2 v[252:253], v7, s[24:27], s99 offen sc1
v_pk_fma_f32 v[92:93], v[108:109], s[58:59], v[26:27] op_sel:[0,0,0] op_sel_hi:[1,0,0] neg_lo:[0,0,1] neg_hi:[0,0,1]
v_pk_fma_f32 v[94:95], v[110:111], s[58:59], v[26:27] op_sel:[0,0,0] op_sel_hi:[1,0,0] neg_lo:[0,0,1] neg_hi:[0,0,1]
v_pk_fma_f32 v[76:77], v[76:77], s[58:59], v[26:27] op_sel:[0,0,1] op_sel_hi:[1,0,1] neg_lo:[1,0,1] neg_hi:[1,0,1]
v_pk_fma_f32 v[78:79], v[78:79], s[58:59], v[26:27] op_sel:[0,0,1] op_sel_hi:[1,0,1] neg_lo:[1,0,1] neg_hi:[1,0,1]
v_pk_fma_f32 v[108:109], v[108:109], s[58:59], v[26:27] op_sel:[0,0,1] op_sel_hi:[1,0,1] neg_lo:[1,0,1] neg_hi:[1,0,1]
v_pk_fma_f32 v[110:111], v[110:111], s[58:59], v[26:27] op_sel:[0,0,1] op_sel_hi:[1,0,1] neg_lo:[1,0,1] neg_hi:[1,0,1]
v_exp_f32 v80, v80
v_exp_f32 v81, v81
v_exp_f32 v82, v82
v_exp_f32 v83, v83
v_exp_f32 v84, v84
v_exp_f32 v85, v85
v_exp_f32 v86, v86
v_exp_f32 v87, v87
v_exp_f32 v72, v72
v_exp_f32 v73, v73
v_exp_f32 v74, v74
v_exp_f32 v75, v75
v_exp_f32 v104, v104
v_exp_f32 v105, v105
v_exp_f32 v106, v106
v_exp_f32 v107, v107
v_exp_f32 v88, v88
v_exp_f32 v89, v89
v_exp_f32 v90, v90
v_exp_f32 v91, v91
v_exp_f32 v92, v92
v_exp_f32 v93, v93
v_exp_f32 v94, v94
v_exp_f32 v95, v95
v_exp_f32 v76, v76
v_exp_f32 v77, v77
v_exp_f32 v78, v78
v_exp_f32 v79, v79
v_exp_f32 v108, v108
v_exp_f32 v109, v109
v_exp_f32 v110, v110
v_exp_f32 v111, v111
v_pk_add_f32 v[28:29], v[80:81], v[82:83]
v_pk_add_f32 v[30:31], v[84:85], v[86:87]
v_pk_add_f32 v[28:29], v[28:29], v[30:31]
v_add_f32 v24, v28, v29
v_pk_add_f32 v[28:29], v[72:73], v[74:75]
v_pk_add_f32 v[30:31], v[104:105], v[106:107]
v_pk_add_f32 v[28:29], v[28:29], v[30:31]
v_add_f32 v25, v28, v29
v_pk_add_f32 v[28:29], v[88:89], v[90:91]
v_pk_add_f32 v[30:31], v[92:93], v[94:95]
v_pk_add_f32 v[28:29], v[28:29], v[30:31]
v_add_f32 v26, v28, v29
v_pk_add_f32 v[28:29], v[76:77], v[78:79]
v_pk_add_f32 v[30:31], v[108:109], v[110:111]
v_pk_add_f32 v[28:29], v[28:29], v[30:31]
v_add_f32 v27, v28, v29
v_permlane32_swap_b32 v24, v25
s_nop 0
v_permlane32_swap_b32 v26, v27
v_add_f32 v24, v24, v25
v_add_f32 v26, v26, v27
s_nop 1
v_permlane16_swap_b32 v24, v26
v_add_f32 v24, v24, v26
v_mov_b32 v26, v24
s_nop 1
v_permlane16_swap_b32 v24, v26
v_mov_b32 v25, v24
v_mov_b32 v27, v26
s_nop 0
v_permlane32_swap_b32 v24, v25
v_permlane32_swap_b32 v26, v27
v_rcp_f32 v24, v24
v_rcp_f32 v25, v25
v_rcp_f32 v26, v26
v_rcp_f32 v27, v27
v_pk_mul_f32 v[80:81], v[80:81], v[24:25] op_sel:[0,0] op_sel_hi:[1,0]
v_pk_mul_f32 v[82:83], v[82:83], v[24:25] op_sel:[0,0] op_sel_hi:[1,0]
v_pk_mul_f32 v[84:85], v[84:85], v[24:25] op_sel:[0,0] op_sel_hi:[1,0]
v_pk_mul_f32 v[86:87], v[86:87], v[24:25] op_sel:[0,0] op_sel_hi:[1,0]
v_cvt_pk_bf16_f32 v128, v80, v81
v_cvt_pk_bf16_f32 v129, v82, v83
v_cvt_pk_bf16_f32 v130, v84, v85
v_cvt_pk_bf16_f32 v131, v86, v87
v_pk_mul_f32 v[72:73], v[72:73], v[24:25] op_sel:[0,1] op_sel_hi:[1,1]
v_pk_mul_f32 v[74:75], v[74:75], v[24:25] op_sel:[0,1] op_sel_hi:[1,1]
v_pk_mul_f32 v[104:105], v[104:105], v[24:25] op_sel:[0,1] op_sel_hi:[1,1]
v_pk_mul_f32 v[106:107], v[106:107], v[24:25] op_sel:[0,1] op_sel_hi:[1,1]
v_cvt_pk_bf16_f32 v132, v72, v73
v_cvt_pk_bf16_f32 v133, v74, v75
v_cvt_pk_bf16_f32 v134, v104, v105
v_cvt_pk_bf16_f32 v135, v106, v107
v_pk_mul_f32 v[88:89], v[88:89], v[26:27] op_sel:[0,0] op_sel_hi:[1,0]
v_pk_mul_f32 v[90:91], v[90:91], v[26:27] op_sel:[0,0] op_sel_hi:[1,0]
v_pk_mul_f32 v[92:93], v[92:93], v[26:27] op_sel:[0,0] op_sel_hi:[1,0]
v_pk_mul_f32 v[94:95], v[94:95], v[26:27] op_sel:[0,0] op_sel_hi:[1,0]
v_cvt_pk_bf16_f32 v136, v88, v89
v_cvt_pk_bf16_f32 v137, v90, v91
v_cvt_pk_bf16_f32 v138, v92, v93
v_cvt_pk_bf16_f32 v139, v94, v95
v_pk_mul_f32 v[76:77], v[76:77], v[26:27] op_sel:[0,1] op_sel_hi:[1,1]
v_pk_mul_f32 v[78:79], v[78:79], v[26:27] op_sel:[0,1] op_sel_hi:[1,1]
v_pk_mul_f32 v[108:109], v[108:109], v[26:27] op_sel:[0,1] op_sel_hi:[1,1]
v_pk_mul_f32 v[110:111], v[110:111], v[26:27] op_sel:[0,1] op_sel_hi:[1,1]
v_cvt_pk_bf16_f32 v140, v76, v77
v_cvt_pk_bf16_f32 v141, v78, v79
v_cvt_pk_bf16_f32 v142, v108, v109
v_cvt_pk_bf16_f32 v143, v110, v111
ds_write_b64 v40, v[128:129] offset:4096
ds_write_b64 v40, v[136:137] offset:6144
v_xor_b32 v46, 32, v40
ds_write_b64 v46, v[130:131] offset:4096
ds_write_b64 v46, v[138:139] offset:6144
v_xor_b32 v46, 64, v40
ds_write_b64 v46, v[132:133] offset:4096
ds_write_b64 v46, v[140:141] offset:6144
v_xor_b32 v46, 96, v40
ds_write_b64 v46, v[134:135] offset:4096
ds_write_b64 v46, v[142:143] offset:6144
v_xor_b32 v47, 32, v43
v_mov_b32 v28, 0x3f803f80
v_mov_b32 v29, 0x3f803f80
v_mov_b32 v30, 0x3f803f80
v_mov_b32 v31, 0x3f803f80
s_waitcnt vmcnt(0)
s_waitcnt lgkmcnt(0)
s_barrier
s_lshr_b32 s38, s5, 4
s_lshl_b32 s39, s4, 1
s_add_u32 s39, s39, s38
s_mul_i32 s39, s39, 128
s_add_u32 s39, s39, 39846912
s_cmp_lg_u32 s28, 0
s_cbranch_scc1 L_sig_11
v_mov_b32 v2, s39
v_mov_b32 v3, 1
s_mov_b64 exec, 1
buffer_atomic_add v3, v2, s[24:27], 0 offen sc1
s_mov_b64 exec, -1
L_sig_11:
s_add_u32 m0, s17, 0
s_nop 0
buffer_load_dwordx4 v32, s[12:15], s16 offen offset:0 lds
buffer_load_dwordx4 v33, s[12:15], s16 offen offset:1024 lds
buffer_load_dwordx4 v34, s[12:15], s16 offen offset:2048 lds
buffer_load_dwordx4 v35, s[12:15], s16 offen offset:3072 lds
s_add_u32 s16, s16, s18
ds_read_b64_tr_b16 a[72:73], v42 offset:0
ds_read_b64_tr_b16 a[74:75], v42 offset:2048
ds_read_b64_tr_b16 a[76:77], v43 offset:0
ds_read_b64_tr_b16 a[78:79], v43 offset:1024
ds_read_b64_tr_b16 a[80:81], v47 offset:0
ds_read_b64_tr_b16 a[82:83], v47 offset:1024
ds_read_b64_tr_b16 a[84:85], v42 offset:4096
ds_read_b64_tr_b16 a[86:87], v42 offset:6144
ds_read_b64_tr_b16 a[88:89], v43 offset:2048
ds_read_b64_tr_b16 a[90:91], v43 offset:3072
ds_read_b64_tr_b16 a[92:93], v47 offset:2048
ds_read_b64_tr_b16 a[94:95], v47 offset:3072
v_mfma_f32_16x16x32_bf16 v[160:163], a[184:187], v[48:51], 0
v_mfma_f32_16x16x32_bf16 v[176:179], a[188:191], v[48:51], 0
v_mfma_f32_16x16x32_bf16 v[164:167], a[184:187], v[52:55], 0
v_mfma_f32_16x16x32_bf16 v[180:183], a[188:191], v[52:55], 0
v_mfma_f32_16x16x32_bf16 v[168:171], a[184:187], v[56:59], 0
v_mfma_f32_16x16x32_bf16 v[184:187], a[188:191], v[56:59], 0
v_mfma_f32_16x16x32_bf16 v[172:175], a[184:187], v[60:63], 0
v_mfma_f32_16x16x32_bf16 v[188:191], a[188:191], v[60:63], 0
s_waitcnt lgkmcnt(6)
ds_read_b64_tr_b16 a[96:97], v42 offset:8192
ds_read_b64_tr_b16 a[98:99], v42 offset:10240
ds_read_b64_tr_b16 a[100:101], v43 offset:4096
ds_read_b64_tr_b16 a[102:103], v43 offset:5120
ds_read_b64_tr_b16 a[104:105], v47 offset:4096
ds_read_b64_tr_b16 a[106:107], v47 offset:5120
v_mfma_f32_16x16x32_bf16 v[112:115], a[72:75], a[76:79], 0
v_mfma_f32_16x16x32_bf16 v[116:119], a[72:75], a[80:83], 0
v_mfma_f32_16x16x32_bf16 v[120:123], a[72:75], v[28:31], 0
s_waitcnt lgkmcnt(6)
ds_read_b64_tr_b16 a[108:109], v42 offset:12288
ds_read_b64_tr_b16 a[110:111], v42 offset:14336
ds_read_b64_tr_b16 a[112:113], v43 offset:6144
ds_read_b64_tr_b16 a[114:115], v43 offset:7168
ds_read_b64_tr_b16 a[116:117], v47 offset:6144
ds_read_b64_tr_b16 a[118:119], v47 offset:7168
v_mfma_f32_16x16x32_bf16 v[112:115], a[84:87], a[88:91], v[112:115]
v_mfma_f32_16x16x32_bf16 v[116:119], a[84:87], a[92:95], v[116:119]
v_mfma_f32_16x16x32_bf16 v[120:123], a[84:87], v[28:31], v[120:123]
s_waitcnt lgkmcnt(6)
ds_read_b64_tr_b16 a[72:73], v42 offset:16384
ds_read_b64_tr_b16 a[74:75], v42 offset:18432
ds_read_b64_tr_b16 a[76:77], v43 offset:8192
ds_read_b64_tr_b16 a[78:79], v43 offset:9216
ds_read_b64_tr_b16 a[80:81], v47 offset:8192
ds_read_b64_tr_b16 a[82:83], v47 offset:9216
v_mfma_f32_16x16x32_bf16 v[112:115], a[96:99], a[100:103], v[112:115]
v_mfma_f32_16x16x32_bf16 v[116:119], a[96:99], a[104:107], v[116:119]
v_mfma_f32_16x16x32_bf16 v[120:123], a[96:99], v[28:31], v[120:123]
s_waitcnt lgkmcnt(6)
ds_read_b64_tr_b16 a[84:85], v42 offset:20480
ds_read_b64_tr_b16 a[86:87], v42 offset:22528
ds_read_b64_tr_b16 a[88:89], v43 offset:10240
ds_read_b64_tr_b16 a[90:91], v43 offset:11264
ds_read_b64_tr_b16 a[92:93], v47 offset:10240
ds_read_b64_tr_b16 a[94:95], v47 offset:11264
v_mfma_f32_16x16x32_bf16 v[112:115], a[108:111], a[112:115], v[112:115]
v_mfma_f32_16x16x32_bf16 v[116:119], a[108:111], a[116:119], v[116:119]
v_mfma_f32_16x16x32_bf16 v[120:123], a[108:111], v[28:31], v[120:123]
s_waitcnt lgkmcnt(6)
ds_read_b64_tr_b16 a[96:97], v42 offset:24576
ds_read_b64_tr_b16 a[98:99], v42 offset:26624
ds_read_b64_tr_b16 a[100:101], v43 offset:12288
ds_read_b64_tr_b16 a[102:103], v43 offset:13312
ds_read_b64_tr_b16 a[104:105], v47 offset:12288
ds_read_b64_tr_b16 a[106:107], v47 offset:13312
v_mfma_f32_16x16x32_bf16 v[112:115], a[72:75], a[76:79], v[112:115]
v_mfma_f32_16x16x32_bf16 v[116:119], a[72:75], a[80:83], v[116:119]
v_mfma_f32_16x16x32_bf16 v[120:123], a[72:75], v[28:31], v[120:123]
s_waitcnt lgkmcnt(6)
ds_read_b64_tr_b16 a[108:109], v42 offset:28672
ds_read_b64_tr_b16 a[110:111], v42 offset:30720
ds_read_b64_tr_b16 a[112:113], v43 offset:14336
ds_read_b64_tr_b16 a[114:115], v43 offset:15360
ds_read_b64_tr_b16 a[116:117], v47 offset:14336
ds_read_b64_tr_b16 a[118:119], v47 offset:15360
v_mfma_f32_16x16x32_bf16 v[112:115], a[84:87], a[88:91], v[112:115]
v_mfma_f32_16x16x32_bf16 v[116:119], a[84:87], a[92:95], v[116:119]
v_mfma_f32_16x16x32_bf16 v[120:123], a[84:87], v[28:31], v[120:123]
s_waitcnt lgkmcnt(6)
v_mfma_f32_16x16x32_bf16 v[112:115], a[96:99], a[100:103], v[112:115]
v_mfma_f32_16x16x32_bf16 v[116:119], a[96:99], a[104:107], v[116:119]
v_mfma_f32_16x16x32_bf16 v[120:123], a[96:99], v[28:31], v[120:123]
s_waitcnt lgkmcnt(0)
v_mfma_f32_16x16x32_bf16 v[112:115], a[108:111], a[112:115], v[112:115]
v_mfma_f32_16x16x32_bf16 v[116:119], a[108:111], a[116:119], v[116:119]
v_mfma_f32_16x16x32_bf16 v[120:123], a[108:111], v[28:31], v[120:123]
s_lshl_b32 s38, s5, 3
s_add_u32 s38, s38, s4
s_lshl_b32 s38, s38, 2
s_add_u32 s38, s38, s28
s_lshl_b32 s39, s38, 7
s_add_u32 s39, s39, 28311552
s_lshl_b32 s38, s38, 11
s_add_u32 s38, s38, 25165824
v_lshrrev_b32 v45, 4, v1
v_lshlrev_b32 v45, 5, v45
v_and_b32 v46, 1, v1
v_lshl_add_u32 v45, v46, 4, v45
buffer_store_dwordx4 v[112:115], v44, s[24:27], s38 offen offset:0 sc1
buffer_store_dwordx4 v[116:119], v44, s[24:27], s38 offen offset:1024 sc1
s_mov_b32 exec_lo, 0x00030003
s_mov_b32 exec_hi, 0x00030003
buffer_store_dwordx4 v[120:123], v45, s[24:27], s39 offen sc1
s_mov_b64 exec, -1
v_max3_f32 v240, v160, v161, v162
v_max3_f32 v241, -v160, -v161, -v162
v_max3_f32 v240, v240, v163, v176
v_max3_f32 v241, v241, -v163, -v176
v_max3_f32 v240, v240, v177, v178
v_max3_f32 v241, v241, -v177, -v178
v_max_f32 v240, v240, v179
v_max_f32 v241, v241, -v179
v_max3_f32 v242, v164, v165, v166
v_max3_f32 v243, -v164, -v165, -v166
v_max3_f32 v242, v242, v167, v180
v_max3_f32 v243, v243, -v167, -v180
v_max3_f32 v242, v242, v181, v182
v_max3_f32 v243, v243, -v181, -v182
v_max_f32 v242, v242, v183
v_max_f32 v243, v243, -v183
v_permlane32_swap_b32 v240, v241
s_nop 0
v_permlane32_swap_b32 v242, v243
v_max_f32 v240, v240, v241
v_max_f32 v242, v242, v243
s_nop 1
v_permlane16_swap_b32 v240, v242
v_max_f32 v240, v240, v242
v_mov_b32 v242, v240
s_nop 1
v_permlane16_swap_b32 v240, v242
v_mov_b32 v241, v240
v_mov_b32 v243, v242
s_nop 0
v_permlane32_swap_b32 v240, v241
v_permlane32_swap_b32 v242, v243
v_pk_mul_f32 v[240:241], v[240:241], s[58:59] op_sel:[0,0] op_sel_hi:[1,0]
v_pk_mul_f32 v[242:243], v[242:243], s[58:59] op_sel:[0,0] op_sel_hi:[1,0]
v_pk_fma_f32 v[128:129], v[160:161], s[58:59], v[240:241] op_sel:[0,0,0] op_sel_hi:[1,0,0] neg_lo:[0,0,1] neg_hi:[0,0,1]
v_pk_fma_f32 v[130:131], v[162:163], s[58:59], v[240:241] op_sel:[0,0,0] op_sel_hi:[1,0,0] neg_lo:[0,0,1] neg_hi:[0,0,1]
v_pk_fma_f32 v[132:133], v[176:177], s[58:59], v[240:241] op_sel:[0,0,0] op_sel_hi:[1,0,0] neg_lo:[0,0,1] neg_hi:[0,0,1]
v_pk_fma_f32 v[134:135], v[178:179], s[58:59], v[240:241] op_sel:[0,0,0] op_sel_hi:[1,0,0] neg_lo:[0,0,1] neg_hi:[0,0,1]
v_pk_fma_f32 v[160:161], v[160:161], s[58:59], v[240:241] op_sel:[0,0,1] op_sel_hi:[1,0,1] neg_lo:[1,0,1] neg_hi:[1,0,1]
v_pk_fma_f32 v[162:163], v[162:163], s[58:59], v[240:241] op_sel:[0,0,1] op_sel_hi:[1,0,1] neg_lo:[1,0,1] neg_hi:[1,0,1]
v_pk_fma_f32 v[176:177], v[176:177], s[58:59], v[240:241] op_sel:[0,0,1] op_sel_hi:[1,0,1] neg_lo:[1,0,1] neg_hi:[1,0,1]
v_pk_fma_f32 v[178:179], v[178:179], s[58:59], v[240:241] op_sel:[0,0,1] op_sel_hi:[1,0,1] neg_lo:[1,0,1] neg_hi:[1,0,1]
v_pk_fma_f32 v[136:137], v[164:165], s[58:59], v[242:243] op_sel:[0,0,0] op_sel_hi:[1,0,0] neg_lo:[0,0,1] neg_hi:[0,0,1]
v_pk_fma_f32 v[138:139], v[166:167], s[58:59], v[242:243] op_sel:[0,0,0] op_sel_hi:[1,0,0] neg_lo:[0,0,1] neg_hi:[0,0,1]
v_pk_fma_f32 v[140:141], v[180:181], s[58:59], v[242:243] op_sel:[0,0,0] op_sel_hi:[1,0,0] neg_lo:[0,0,1] neg_hi:[0,0,1]
v_pk_fma_f32 v[142:143], v[182:183], s[58:59], v[242:243] op_sel:[0,0,0] op_sel_hi:[1,0,0] neg_lo:[0,0,1] neg_hi:[0,0,1]
v_pk_fma_f32 v[164:165], v[164:165], s[58:59], v[242:243] op_sel:[0,0,1] op_sel_hi:[1,0,1] neg_lo:[1,0,1] neg_hi:[1,0,1]
v_pk_fma_f32 v[166:167], v[166:167], s[58:59], v[242:243] op_sel:[0,0,1] op_sel_hi:[1,0,1] neg_lo:[1,0,1] neg_hi:[1,0,1]
v_pk_fma_f32 v[180:181], v[180:181], s[58:59], v[242:243] op_sel:[0,0,1] op_sel_hi:[1,0,1] neg_lo:[1,0,1] neg_hi:[1,0,1]
v_pk_fma_f32 v[182:183], v[182:183], s[58:59], v[242:243] op_sel:[0,0,1] op_sel_hi:[1,0,1] neg_lo:[1,0,1] neg_hi:[1,0,1]
v_exp_f32 v128, v128
v_exp_f32 v129, v129
v_exp_f32 v130, v130
v_exp_f32 v131, v131
v_exp_f32 v132, v132
v_exp_f32 v133, v133
v_exp_f32 v134, v134
v_exp_f32 v135, v135
v_exp_f32 v160, v160
v_exp_f32 v161, v161
v_exp_f32 v162, v162
v_exp_f32 v163, v163
v_exp_f32 v176, v176
v_exp_f32 v177, v177
v_exp_f32 v178, v178
v_exp_f32 v179, v179
v_exp_f32 v136, v136
v_exp_f32 v137, v137
v_exp_f32 v138, v138
v_exp_f32 v139, v139
v_exp_f32 v140, v140
v_exp_f32 v141, v141
v_exp_f32 v142, v142
v_exp_f32 v143, v143
v_exp_f32 v164, v164
s_lshr_b32 s34, s6, 1
s_lshl_b32 s39, s34, 1
s_add_u32 s39, s39, s54
s_mul_i32 s39, s39, 128
s_add_u32 s39, s39, 39846912
v_mov_b32 v40, s39
buffer_load_dword v41, v40, s[24:27], 0 offen sc1
v_exp_f32 v165, v165
v_exp_f32 v166, v166
v_exp_f32 v167, v167
v_exp_f32 v180, v180
v_exp_f32 v181, v181
v_exp_f32 v182, v182
v_exp_f32 v183, v183
v_pk_add_f32 v[244:245], v[128:129], v[130:131]
v_pk_add_f32 v[246:247], v[132:133], v[134:135]
v_pk_add_f32 v[244:245], v[244:245], v[246:247]
v_add_f32 v240, v244, v245
v_pk_add_f32 v[244:245], v[160:161], v[162:163]
v_pk_add_f32 v[246:247], v[176:177], v[178:179]
v_pk_add_f32 v[244:245], v[244:245], v[246:247]
v_add_f32 v241, v244, v245
v_pk_add_f32 v[244:245], v[136:137], v[138:139]
v_pk_add_f32 v[246:247], v[140:141], v[142:143]
v_pk_add_f32 v[244:245], v[244:245], v[246:247]
v_add_f32 v242, v244, v245
v_pk_add_f32 v[244:245], v[164:165], v[166:167]
v_pk_add_f32 v[246:247], v[180:181], v[182:183]
v_pk_add_f32 v[244:245], v[244:245], v[246:247]
v_add_f32 v243, v244, v245
v_permlane32_swap_b32 v240, v241
s_nop 0
v_permlane32_swap_b32 v242, v243
v_add_f32 v240, v240, v241
v_add_f32 v242, v242, v243
s_nop 1
v_permlane16_swap_b32 v240, v242
v_add_f32 v240, v240, v242
v_mov_b32 v242, v240
s_nop 1
v_permlane16_swap_b32 v240, v242
v_mov_b32 v241, v240
v_mov_b32 v243, v242
s_nop 0
v_permlane32_swap_b32 v240, v241
v_permlane32_swap_b32 v242, v243
v_rcp_f32 v240, v240
v_rcp_f32 v241, v241
v_rcp_f32 v242, v242
v_rcp_f32 v243, v243
v_pk_mul_f32 v[128:129], v[128:129], v[240:241] op_sel:[0,0] op_sel_hi:[1,0]
v_pk_mul_f32 v[130:131], v[130:131], v[240:241] op_sel:[0,0] op_sel_hi:[1,0]
v_pk_mul_f32 v[132:133], v[132:133], v[240:241] op_sel:[0,0] op_sel_hi:[1,0]
v_pk_mul_f32 v[134:135], v[134:135], v[240:241] op_sel:[0,0] op_sel_hi:[1,0]
v_cvt_pk_bf16_f32 v192, v128, v129
v_cvt_pk_bf16_f32 v193, v130, v131
v_cvt_pk_bf16_f32 v194, v132, v133
v_cvt_pk_bf16_f32 v195, v134, v135
v_pk_mul_f32 v[160:161], v[160:161], v[240:241] op_sel:[0,1] op_sel_hi:[1,1]
v_pk_mul_f32 v[162:163], v[162:163], v[240:241] op_sel:[0,1] op_sel_hi:[1,1]
v_pk_mul_f32 v[176:177], v[176:177], v[240:241] op_sel:[0,1] op_sel_hi:[1,1]
v_pk_mul_f32 v[178:179], v[178:179], v[240:241] op_sel:[0,1] op_sel_hi:[1,1]
v_cvt_pk_bf16_f32 v196, v160, v161
v_cvt_pk_bf16_f32 v197, v162, v163
v_cvt_pk_bf16_f32 v198, v176, v177
v_cvt_pk_bf16_f32 v199, v178, v179
v_pk_mul_f32 v[136:137], v[136:137], v[242:243] op_sel:[0,0] op_sel_hi:[1,0]
v_pk_mul_f32 v[138:139], v[138:139], v[242:243] op_sel:[0,0] op_sel_hi:[1,0]
v_pk_mul_f32 v[140:141], v[140:141], v[242:243] op_sel:[0,0] op_sel_hi:[1,0]
v_pk_mul_f32 v[142:143], v[142:143], v[242:243] op_sel:[0,0] op_sel_hi:[1,0]
v_cvt_pk_bf16_f32 v200, v136, v137
v_cvt_pk_bf16_f32 v201, v138, v139
v_cvt_pk_bf16_f32 v202, v140, v141
v_cvt_pk_bf16_f32 v203, v142, v143
v_pk_mul_f32 v[164:165], v[164:165], v[242:243] op_sel:[0,1] op_sel_hi:[1,1]
v_pk_mul_f32 v[166:167], v[166:167], v[242:243] op_sel:[0,1] op_sel_hi:[1,1]
v_pk_mul_f32 v[180:181], v[180:181], v[242:243] op_sel:[0,1] op_sel_hi:[1,1]
v_pk_mul_f32 v[182:183], v[182:183], v[242:243] op_sel:[0,1] op_sel_hi:[1,1]
v_cvt_pk_bf16_f32 v204, v164, v165
v_cvt_pk_bf16_f32 v205, v166, v167
v_cvt_pk_bf16_f32 v206, v180, v181
v_cvt_pk_bf16_f32 v207, v182, v183
s_waitcnt vmcnt(1)
s_barrier
s_mul_i32 s39, s5, 128
s_add_u32 s39, s39, 39848960
s_cmp_lg_u32 s28, 0
s_cbranch_scc1 L_sig_12
v_mov_b32 v2, s39
v_mov_b32 v3, 1
s_mov_b64 exec, 1
buffer_atomic_add v3, v2, s[24:27], 0 offen sc1
s_mov_b64 exec, -1
L_sig_12:
v_lshlrev_b32 v6, 4, v1
v_add_u32 v7, 114688, v6
v_lshlrev_b32 v42, 3, v1
v_add_u32 v43, 114688, v42
s_lshl_b32 s38, s6, 3
s_lshl_b32 s39, s28, 1
s_add_u32 s38, s38, s39
s_mul_i32 s29, s38, 114688
s_mul_i32 s39, s54, 57344
s_add_u32 s29, s29, s39
s_add_u32 s29, s29, 4194304
s_lshl_b32 s33, s38, 15
s_add_u32 s33, s33, 20971520
v_lshrrev_b32 v2, 4, v1
v_bfe_u32 v3, v1, 2, 2
v_and_b32 v4, 3, v1
v_lshl_add_u32 v5, v2, 2, v3
v_and_b32 v46, 7, v5
s_lshl_b32 s39, s54, 2
v_xor_b32 v46, s39, v46
v_lshlrev_b32 v46, 5, v46
v_lshl_add_u32 v46, v5, 8, v46
v_lshl_add_u32 v46, v4, 3, v46
v_add_u32 v46, 49152, v46
v_mov_b32 v10, v46
v_xor_b32 v11, 32, v46
v_xor_b32 v12, 64, v46
v_xor_b32 v13, 96, v46
v_xor_b32 v14, 128, v46
v_xor_b32 v15, 160, v46
v_xor_b32 v16, 192, v46
v_xor_b32 v17, 224, v46
v_add_u32 v18, 0x10000, v10
v_add_u32 v19, 0x10000, v11
v_add_u32 v20, 0x10000, v12
v_add_u32 v21, 0x10000, v13
v_add_u32 v22, 0x10000, v14
v_add_u32 v23, 0x10000, v15
v_add_u32 v24, 0x10000, v16
v_add_u32 v25, 0x10000, v17
v_lshrrev_b32 v46, 1, v5
v_and_b32 v46, 3, v46
v_lshlrev_b32 v46, 5, v46
v_lshl_add_u32 v46, v5, 7, v46
v_lshl_add_u32 v46, v4, 3, v46
v_add_u32 v46, 49152, v46
v_mov_b32 v26, v46
v_xor_b32 v27, 32, v46
v_xor_b32 v28, 64, v46
v_xor_b32 v29, 96, v46
v_add_u32 v30, 0x10000, v26
v_add_u32 v31, 0x10000, v27
v_add_u32 v36, 0x10000, v28
v_add_u32 v37, 0x10000, v29
v_lshrrev_b32 v46, 3, v1
v_and_b32 v47, 7, v1
v_and_b32 v45, 6, v46
v_xor_b32 v47, v47, v45
v_lshlrev_b32 v47, 4, v47
v_lshl_add_u32 v8, v46, 11, v47
v_add_u32 v9, 15360, v8
s_lshl_b32 s32, s28, 11
s_add_u32 s32, s32, 49152
s_lshl_b32 s38, s38, 4
v_and_b32 v3, 15, v1
v_add_u32 v3, s38, v3
v_lshlrev_b32 v3, 11, v3
v_and_b32 v46, 1, v2
v_lshl_add_u32 v3, v46, 5, v3
v_lshrrev_b32 v46, 1, v2
v_lshl_add_u32 v3, v46, 4, v3
s_lshl_b32 s39, s7, 1
s_add_u32 s39, s39, s54
s_lshl_b32 s39, s39, 7
v_add_u32 v38, s39, v3
v_add_u32 v39, 32768, v38
s_add_u32 s44, s80, s39
s_addc_u32 s45, s81, 0
s_sub_u32 s46, 2048, s39
s_mov_b32 s47, 0x20000
v_lshlrev_b32 v2, 3, v2
buffer_load_dwordx2 v[224:225], v2, s[44:47], 0 offen offset:0
buffer_load_dwordx2 v[226:227], v2, s[44:47], 0 offen offset:32
buffer_load_dwordx2 v[228:229], v2, s[44:47], 0 offen offset:64
buffer_load_dwordx2 v[230:231], v2, s[44:47], 0 offen offset:96
s_lshl_b32 s35, s6, 3
s_add_u32 s35, s35, s7
s_lshl_b32 s35, s35, 1
s_add_u32 s35, s35, s54
s_lshl_b32 s35, s35, 15
s_lshl_b32 s38, s28, 13
s_add_u32 s35, s35, s38
s_add_u32 s35, s35, 29360128
s_waitcnt vmcnt(4)
s_cmp_lg_u32 s28, 0
s_cbranch_scc1 L_adone_13
v_readfirstlane_b32 s53, v41
s_nop 3
s_cmp_ge_u32 s53, 16
s_cbranch_scc1 L_adone_13
s_mov_b32 s52, 0
L_poll_14:
buffer_load_dword v41, v40, s[24:27], 0 offen sc1
s_waitcnt vmcnt(0)
v_readfirstlane_b32 s53, v41
s_add_u32 s52, s52, 1
s_nop 2
s_cmp_ge_u32 s53, 16
s_cbranch_scc1 L_adone_13
s_cmp_lt_u32 s52, 20000
s_cbranch_scc1 L_poll_14
L_adone_13:
s_barrier
buffer_load_dwordx4 a[72:75], v6, s[24:27], s29 offen sc1
v_max3_f32 v240, v168, v169, v170
v_max3_f32 v241, -v168, -v169, -v170
v_max3_f32 v240, v240, v171, v184
v_max3_f32 v241, v241, -v171, -v184
v_max3_f32 v240, v240, v185, v186
buffer_load_dwordx4 a[76:79], v7, s[24:27], s29 offen sc1
v_max3_f32 v241, v241, -v185, -v186
v_max_f32 v240, v240, v187
v_max_f32 v241, v241, -v187
v_max3_f32 v242, v172, v173, v174
v_max3_f32 v243, -v172, -v173, -v174
v_max3_f32 v242, v242, v175, v188
buffer_load_dwordx4 a[80:83], v6, s[24:27], s29 offen offset:1024 sc1
v_max3_f32 v243, v243, -v175, -v188
v_max3_f32 v242, v242, v189, v190
v_max3_f32 v243, v243, -v189, -v190
v_max_f32 v242, v242, v191
v_max_f32 v243, v243, -v191
buffer_load_dwordx4 a[84:87], v7, s[24:27], s29 offen offset:1024 sc1
s_add_u32 s29, s29, 2048
v_permlane32_swap_b32 v240, v241
v_permlane32_swap_b32 v242, v243
v_max_f32 v240, v240, v241
v_max_f32 v242, v242, v243
s_nop 1
v_permlane16_swap_b32 v240, v242
v_max_f32 v240, v240, v242
buffer_load_dwordx4 a[88:91], v6, s[24:27], s29 offen sc1
v_mov_b32 v242, v240
s_nop 1
v_permlane16_swap_b32 v240, v242
v_mov_b32 v241, v240
v_mov_b32 v243, v242
s_nop 0
v_permlane32_swap_b32 v240, v241
buffer_load_dwordx4 a[92:95], v7, s[24:27], s29 offen sc1
v_permlane32_swap_b32 v242, v243
v_pk_mul_f32 v[240:241], v[240:241], s[58:59] op_sel:[0,0] op_sel_hi:[1,0]
v_pk_mul_f32 v[242:243], v[242:243], s[58:59] op_sel:[0,0] op_sel_hi:[1,0]
v_pk_fma_f32 v[128:129], v[168:169], s[58:59], v[240:241] op_sel:[0,0,0] op_sel_hi:[1,0,0] neg_lo:[0,0,1] neg_hi:[0,0,1]
v_pk_fma_f32 v[130:131], v[170:171], s[58:59], v[240:241] op_sel:[0,0,0] op_sel_hi:[1,0,0] neg_lo:[0,0,1] neg_hi:[0,0,1]
v_pk_fma_f32 v[132:133], v[184:185], s[58:59], v[240:241] op_sel:[0,0,0] op_sel_hi:[1,0,0] neg_lo:[0,0,1] neg_hi:[0,0,1]
buffer_load_dwordx2 a[96:97], v42, s[24:27], s29 offen offset:1024 sc1
v_pk_fma_f32 v[134:135], v[186:187], s[58:59], v[240:241] op_sel:[0,0,0] op_sel_hi:[1,0,0] neg_lo:[0,0,1] neg_hi:[0,0,1]
v_pk_fma_f32 v[168:169], v[168:169], s[58:59], v[240:241] op_sel:[0,0,1] op_sel_hi:[1,0,1] neg_lo:[1,0,1] neg_hi:[1,0,1]
v_pk_fma_f32 v[170:171], v[170:171], s[58:59], v[240:241] op_sel:[0,0,1] op_sel_hi:[1,0,1] neg_lo:[1,0,1] neg_hi:[1,0,1]
v_pk_fma_f32 v[184:185], v[184:185], s[58:59], v[240:241] op_sel:[0,0,1] op_sel_hi:[1,0,1] neg_lo:[1,0,1] neg_hi:[1,0,1]
v_pk_fma_f32 v[186:187], v[186:187], s[58:59], v[240:241] op_sel:[0,0,1] op_sel_hi:[1,0,1] neg_lo:[1,0,1] neg_hi:[1,0,1]
buffer_load_dwordx2 a[98:99], v42, s[24:27], s29 offen offset:1536 sc1
v_pk_fma_f32 v[136:137], v[172:173], s[58:59], v[242:243] op_sel:[0,0,0] op_sel_hi:[1,0,0] neg_lo:[0,0,1] neg_hi:[0,0,1]
v_pk_fma_f32 v[138:139], v[174:175], s[58:59], v[242:243] op_sel:[0,0,0] op_sel_hi:[1,0,0] neg_lo:[0,0,1] neg_hi:[0,0,1]
v_pk_fma_f32 v[140:141], v[188:189], s[58:59], v[242:243] op_sel:[0,0,0] op_sel_hi:[1,0,0] neg_lo:[0,0,1] neg_hi:[0,0,1]
v_pk_fma_f32 v[142:143], v[190:191], s[58:59], v[242:243] op_sel:[0,0,0] op_sel_hi:[1,0,0] neg_lo:[0,0,1] neg_hi:[0,0,1]
v_pk_fma_f32 v[172:173], v[172:173], s[58:59], v[242:243] op_sel:[0,0,1] op_sel_hi:[1,0,1] neg_lo:[1,0,1] neg_hi:[1,0,1]
v_pk_fma_f32 v[174:175], v[174:175], s[58:59], v[242:243] op_sel:[0,0,1] op_sel_hi:[1,0,1] neg_lo:[1,0,1] neg_hi:[1,0,1]
buffer_load_dwordx2 a[100:101], v43, s[24:27], s29 offen offset:1024 sc1
v_pk_fma_f32 v[188:189], v[188:189], s[58:59], v[242:243] op_sel:[0,0,1] op_sel_hi:[1,0,1] neg_lo:[1,0,1] neg_hi:[1,0,1]
v_pk_fma_f32 v[190:191], v[190:191], s[58:59], v[242:243] op_sel:[0,0,1] op_sel_hi:[1,0,1] neg_lo:[1,0,1] neg_hi:[1,0,1]
v_exp_f32 v128, v128
v_exp_f32 v129, v129
v_exp_f32 v130, v130
buffer_load_dwordx2 a[102:103], v43, s[24:27], s29 offen offset:1536 sc1
s_add_u32 s29, s29, 2048
v_exp_f32 v131, v131
v_exp_f32 v132, v132
v_exp_f32 v133, v133
v_exp_f32 v134, v134
v_exp_f32 v135, v135
v_exp_f32 v168, v168
buffer_load_dwordx4 a[104:107], v6, s[24:27], s29 offen sc1
v_exp_f32 v169, v169
v_exp_f32 v170, v170
v_exp_f32 v171, v171
v_exp_f32 v184, v184
v_exp_f32 v185, v185
buffer_load_dwordx4 a[108:111], v7, s[24:27], s29 offen sc1
v_exp_f32 v186, v186
v_exp_f32 v187, v187
v_exp_f32 v136, v136
v_exp_f32 v137, v137
v_exp_f32 v138, v138
v_exp_f32 v139, v139
buffer_load_dwordx4 a[112:115], v6, s[24:27], s29 offen offset:1024 sc1
v_exp_f32 v140, v140
v_exp_f32 v141, v141
v_exp_f32 v142, v142
v_exp_f32 v143, v143
v_exp_f32 v172, v172
buffer_load_dwordx4 a[116:119], v7, s[24:27], s29 offen offset:1024 sc1
s_add_u32 s29, s29, 2048
v_exp_f32 v173, v173
v_exp_f32 v174, v174
v_exp_f32 v175, v175
v_exp_f32 v188, v188
v_exp_f32 v189, v189
v_exp_f32 v190, v190
buffer_load_dwordx4 a[120:123], v6, s[24:27], s29 offen sc1
v_exp_f32 v191, v191
v_pk_add_f32 v[244:245], v[128:129], v[130:131]
v_pk_add_f32 v[246:247], v[132:133], v[134:135]
v_pk_add_f32 v[244:245], v[244:245], v[246:247]
v_add_f32 v240, v244, v245
buffer_load_dwordx4 a[124:127], v7, s[24:27], s29 offen sc1
v_pk_add_f32 v[244:245], v[168:169], v[170:171]
v_pk_add_f32 v[246:247], v[184:185], v[186:187]
v_pk_add_f32 v[244:245], v[244:245], v[246:247]
v_add_f32 v241, v244, v245
v_pk_add_f32 v[244:245], v[136:137], v[138:139]
v_pk_add_f32 v[246:247], v[140:141], v[142:143]
buffer_load_dwordx4 a[128:131], v6, s[24:27], s29 offen offset:1024 sc1
v_pk_add_f32 v[244:245], v[244:245], v[246:247]
v_add_f32 v242, v244, v245
v_pk_add_f32 v[244:245], v[172:173], v[174:175]
v_pk_add_f32 v[246:247], v[188:189], v[190:191]
v_pk_add_f32 v[244:245], v[244:245], v[246:247]
buffer_load_dwordx4 a[132:135], v7, s[24:27], s29 offen offset:1024 sc1
s_add_u32 s29, s29, 2048
v_add_f32 v243, v244, v245
v_permlane32_swap_b32 v240, v241
s_nop 0
v_permlane32_swap_b32 v242, v243
v_add_f32 v240, v240, v241
v_add_f32 v242, v242, v243
s_nop 1
v_permlane16_swap_b32 v240, v242
v_add_f32 v240, v240, v242
v_mov_b32 v242, v240
s_nop 1
v_permlane16_swap_b32 v240, v242
v_mov_b32 v241, v240
v_mov_b32 v243, v242
s_nop 0
v_permlane32_swap_b32 v240, v241
v_permlane32_swap_b32 v242, v243
v_rcp_f32 v240, v240
v_rcp_f32 v241, v241
v_rcp_f32 v242, v242
v_rcp_f32 v243, v243
v_pk_mul_f32 v[128:129], v[128:129], v[240:241] op_sel:[0,0] op_sel_hi:[1,0]
v_pk_mul_f32 v[130:131], v[130:131], v[240:241] op_sel:[0,0] op_sel_hi:[1,0]
v_pk_mul_f32 v[132:133], v[132:133], v[240:241] op_sel:[0,0] op_sel_hi:[1,0]
v_pk_mul_f32 v[134:135], v[134:135], v[240:241] op_sel:[0,0] op_sel_hi:[1,0]
v_cvt_pk_bf16_f32 v208, v128, v129
v_cvt_pk_bf16_f32 v209, v130, v131
v_cvt_pk_bf16_f32 v210, v132, v133
v_cvt_pk_bf16_f32 v211, v134, v135
v_pk_mul_f32 v[168:169], v[168:169], v[240:241] op_sel:[0,1] op_sel_hi:[1,1]
v_pk_mul_f32 v[170:171], v[170:171], v[240:241] op_sel:[0,1] op_sel_hi:[1,1]
v_pk_mul_f32 v[184:185], v[184:185], v[240:241] op_sel:[0,1] op_sel_hi:[1,1]
v_pk_mul_f32 v[186:187], v[186:187], v[240:241] op_sel:[0,1] op_sel_hi:[1,1]
v_cvt_pk_bf16_f32 v212, v168, v169
v_cvt_pk_bf16_f32 v213, v170, v171
v_cvt_pk_bf16_f32 v214, v184, v185
v_cvt_pk_bf16_f32 v215, v186, v187
v_pk_mul_f32 v[136:137], v[136:137], v[242:243] op_sel:[0,0] op_sel_hi:[1,0]
v_pk_mul_f32 v[138:139], v[138:139], v[242:243] op_sel:[0,0] op_sel_hi:[1,0]
v_pk_mul_f32 v[140:141], v[140:141], v[242:243] op_sel:[0,0] op_sel_hi:[1,0]
v_pk_mul_f32 v[142:143], v[142:143], v[242:243] op_sel:[0,0] op_sel_hi:[1,0]
v_cvt_pk_bf16_f32 v216, v136, v137
v_cvt_pk_bf16_f32 v217, v138, v139
v_cvt_pk_bf16_f32 v218, v140, v141
v_cvt_pk_bf16_f32 v219, v142, v143
v_pk_mul_f32 v[172:173], v[172:173], v[242:243] op_sel:[0,1] op_sel_hi:[1,1]
v_pk_mul_f32 v[174:175], v[174:175], v[242:243] op_sel:[0,1] op_sel_hi:[1,1]
v_pk_mul_f32 v[188:189], v[188:189], v[242:243] op_sel:[0,1] op_sel_hi:[1,1]
v_pk_mul_f32 v[190:191], v[190:191], v[242:243] op_sel:[0,1] op_sel_hi:[1,1]
v_cvt_pk_bf16_f32 v220, v172, v173
v_cvt_pk_bf16_f32 v221, v174, v175
v_cvt_pk_bf16_f32 v222, v188, v189
v_cvt_pk_bf16_f32 v223, v190, v191
s_waitcnt vmcnt(18)
v_lshlrev_b32 v48, 16, v224
v_and_b32 v49, 0xffff0000, v224
v_lshlrev_b32 v50, 16, v225
v_and_b32 v51, 0xffff0000, v225
v_mov_b32 v52, v48
v_mov_b32 v53, v49
v_mov_b32 v54, v50
v_mov_b32 v55, v51
v_lshlrev_b32 v56, 16, v226
v_and_b32 v57, 0xffff0000, v226
v_lshlrev_b32 v58, 16, v227
v_and_b32 v59, 0xffff0000, v227
v_mov_b32 v60, v56
v_mov_b32 v61, v57
v_mov_b32 v62, v58
v_mov_b32 v63, v59
v_lshlrev_b32 v64, 16, v228
v_and_b32 v65, 0xffff0000, v228
v_lshlrev_b32 v66, 16, v229
v_and_b32 v67, 0xffff0000, v229
v_mov_b32 v68, v64
v_mov_b32 v69, v65
v_mov_b32 v70, v66
v_mov_b32 v71, v67
v_lshlrev_b32 v72, 16, v230
v_and_b32 v73, 0xffff0000, v230
v_lshlrev_b32 v74, 16, v231
v_and_b32 v75, 0xffff0000, v231
v_mov_b32 v76, v72
v_mov_b32 v77, v73
v_mov_b32 v78, v74
v_mov_b32 v79, v75
ds_read_b64_tr_b16 a[0:1], v10 offset:49152
ds_read_b64_tr_b16 a[2:3], v10 offset:53248
ds_read_b64_tr_b16 a[4:5], v11 offset:49152
ds_read_b64_tr_b16 a[6:7], v11 offset:53248
ds_read_b64_tr_b16 a[8:9], v12 offset:49152
ds_read_b64_tr_b16 a[10:11], v12 offset:53248
ds_read_b64_tr_b16 a[12:13], v13 offset:49152
ds_read_b64_tr_b16 a[14:15], v13 offset:53248
ds_read_b64_tr_b16 a[16:17], v14 offset:49152
ds_read_b64_tr_b16 a[18:19], v14 offset:53248
ds_read_b64_tr_b16 a[20:21], v15 offset:49152
ds_read_b64_tr_b16 a[22:23], v15 offset:53248
s_waitcnt vmcnt(14)
s_waitcnt lgkmcnt(8)
v_mfma_f32_16x16x32_bf16 v[48:51], a[0:3], a[72:75], v[48:51]
ds_read_b64_tr_b16 a[24:25], v16 offset:49152
ds_read_b64_tr_b16 a[26:27], v16 offset:53248
v_mfma_f32_16x16x32_bf16 v[52:55], a[0:3], a[76:79], v[52:55]
buffer_load_dwordx4 a[136:139], v6, s[24:27], s29 offen sc1
s_mul_i32 s39, s5, 128
s_add_u32 s39, s39, 39848960
v_mov_b32 v40, s39
buffer_load_dword v41, v40, s[24:27], 0 offen sc1
v_mfma_f32_16x16x32_bf16 v[56:59], a[4:7], a[72:75], v[56:59]
ds_read_b64_tr_b16 a[28:29], v17 offset:49152
ds_read_b64_tr_b16 a[30:31], v17 offset:53248
s_add_u32 m0, s17, 16384
v_mfma_f32_16x16x32_bf16 v[60:63], a[4:7], a[76:79], v[60:63]
s_waitcnt lgkmcnt(8)
v_mfma_f32_16x16x32_bf16 v[64:67], a[8:11], a[72:75], v[64:67]
ds_read_b64_tr_b16 a[32:33], v10 offset:57344
ds_read_b64_tr_b16 a[34:35], v10 offset:61440
v_mfma_f32_16x16x32_bf16 v[68:71], a[8:11], a[76:79], v[68:71]
buffer_load_dwordx4 v32, s[12:15], s16 offen offset:0 lds
v_mfma_f32_16x16x32_bf16 v[72:75], a[12:15], a[72:75], v[72:75]
ds_read_b64_tr_b16 a[36:37], v11 offset:57344
ds_read_b64_tr_b16 a[38:39], v11 offset:61440
v_mfma_f32_16x16x32_bf16 v[76:79], a[12:15], a[76:79], v[76:79]
s_waitcnt lgkmcnt(8)
v_mfma_f32_16x16x32_bf16 v[80:83], a[16:19], a[72:75], 0
ds_read_b64_tr_b16 a[40:41], v12 offset:57344
ds_read_b64_tr_b16 a[42:43], v12 offset:61440
v_mfma_f32_16x16x32_bf16 v[84:87], a[16:19], a[76:79], 0
buffer_load_dwordx4 a[140:143], v7, s[24:27], s29 offen sc1
v_mfma_f32_16x16x32_bf16 v[88:91], a[20:23], a[72:75], 0
ds_read_b64_tr_b16 a[44:45], v13 offset:57344
ds_read_b64_tr_b16 a[46:47], v13 offset:61440
v_mfma_f32_16x16x32_bf16 v[92:95], a[20:23], a[76:79], 0
s_waitcnt lgkmcnt(8)
v_mfma_f32_16x16x32_bf16 v[96:99], a[24:27], a[72:75], 0
ds_read_b64_tr_b16 a[48:49], v14 offset:57344
ds_read_b64_tr_b16 a[50:51], v14 offset:61440
v_mfma_f32_16x16x32_bf16 v[100:103], a[24:27], a[76:79], 0
buffer_load_dwordx4 v33, s[12:15], s16 offen offset:1024 lds
v_mfma_f32_16x16x32_bf16 v[104:107], a[28:31], a[72:75], 0
ds_read_b64_tr_b16 a[52:53], v15 offset:57344
ds_read_b64_tr_b16 a[54:55], v15 offset:61440
v_mfma_f32_16x16x32_bf16 v[108:111], a[28:31], a[76:79], 0
s_waitcnt lgkmcnt(8)
v_mfma_f32_16x16x32_bf16 v[48:51], a[32:35], a[80:83], v[48:51]
ds_read_b64_tr_b16 a[56:57], v16 offset:57344
ds_read_b64_tr_b16 a[58:59], v16 offset:61440
v_mfma_f32_16x16x32_bf16 v[52:55], a[32:35], a[84:87], v[52:55]
buffer_load_dwordx4 a[144:147], v6, s[24:27], s29 offen offset:1024 sc1
v_mfma_f32_16x16x32_bf16 v[56:59], a[36:39], a[80:83], v[56:59]
ds_read_b64_tr_b16 a[60:61], v17 offset:57344
ds_read_b64_tr_b16 a[62:63], v17 offset:61440
v_mfma_f32_16x16x32_bf16 v[60:63], a[36:39], a[84:87], v[60:63]
s_waitcnt vmcnt(14)
s_barrier
s_waitcnt lgkmcnt(8)
v_mfma_f32_16x16x32_bf16 v[64:67], a[40:43], a[80:83], v[64:67]
ds_read_b64_tr_b16 a[0:1], v18 offset:0
ds_read_b64_tr_b16 a[2:3], v18 offset:4096
v_mfma_f32_16x16x32_bf16 v[68:71], a[40:43], a[84:87], v[68:71]
buffer_load_dwordx4 v34, s[12:15], s16 offen offset:2048 lds
v_mfma_f32_16x16x32_bf16 v[72:75], a[44:47], a[80:83], v[72:75]
ds_read_b64_tr_b16 a[4:5], v19 offset:0
ds_read_b64_tr_b16 a[6:7], v19 offset:4096
v_mfma_f32_16x16x32_bf16 v[76:79], a[44:47], a[84:87], v[76:79]
s_waitcnt lgkmcnt(8)
v_mfma_f32_16x16x32_bf16 v[80:83], a[48:51], a[80:83], v[80:83]
ds_read_b64_tr_b16 a[8:9], v20 offset:0
ds_read_b64_tr_b16 a[10:11], v20 offset:4096
v_mfma_f32_16x16x32_bf16 v[84:87], a[48:51], a[84:87], v[84:87]
buffer_load_dwordx4 a[148:151], v7, s[24:27], s29 offen offset:1024 sc1
v_mfma_f32_16x16x32_bf16 v[88:91], a[52:55], a[80:83], v[88:91]
ds_read_b64_tr_b16 a[12:13], v21 offset:0
ds_read_b64_tr_b16 a[14:15], v21 offset:4096
v_mfma_f32_16x16x32_bf16 v[92:95], a[52:55], a[84:87], v[92:95]
s_waitcnt lgkmcnt(8)
v_mfma_f32_16x16x32_bf16 v[96:99], a[56:59], a[80:83], v[96:99]
ds_read_b64_tr_b16 a[16:17], v22 offset:0
ds_read_b64_tr_b16 a[18:19], v22 offset:4096
v_mfma_f32_16x16x32_bf16 v[100:103], a[56:59], a[84:87], v[100:103]
buffer_load_dwordx4 v35, s[12:15], s16 offen offset:3072 lds
v_mfma_f32_16x16x32_bf16 v[104:107], a[60:63], a[80:83], v[104:107]
ds_read_b64_tr_b16 a[20:21], v23 offset:0
ds_read_b64_tr_b16 a[22:23], v23 offset:4096
v_mfma_f32_16x16x32_bf16 v[108:111], a[60:63], a[84:87], v[108:111]
s_add_u32 s29, s29, 2048
s_add_u32 s16, s16, s18
s_waitcnt lgkmcnt(8)
v_mfma_f32_16x16x32_bf16 v[48:51], a[0:3], a[88:91], v[48:51]
ds_read_b64_tr_b16 a[24:25], v24 offset:0
ds_read_b64_tr_b16 a[26:27], v24 offset:4096
v_mfma_f32_16x16x32_bf16 v[52:55], a[0:3], a[92:95], v[52:55]
buffer_load_dwordx2 a[152:153], v42, s[24:27], s29 offen offset:0 sc1
v_mfma_f32_16x16x32_bf16 v[56:59], a[4:7], a[88:91], v[56:59]
ds_read_b64_tr_b16 a[28:29], v25 offset:0
ds_read_b64_tr_b16 a[30:31], v25 offset:4096
v_mfma_f32_16x16x32_bf16 v[60:63], a[4:7], a[92:95], v[60:63]
buffer_load_dwordx2 a[154:155], v42, s[24:27], s29 offen offset:512 sc1
s_lshr_b32 s50, s4, 1
s_and_b32 s50, s50, 1
s_lshl_b32 s50, s50, 12
s_lshl_b32 s59, s5, 16
s_add_u32 s59, s59, s50
s_waitcnt lgkmcnt(8)
v_mfma_f32_16x16x32_bf16 v[64:67], a[8:11], a[88:91], v[64:67]
ds_read_b64_tr_b16 a[32:33], v18 offset:8192
ds_read_b64_tr_b16 a[34:35], v18 offset:12288
s_add_u32 m0, s17, 32768
v_mfma_f32_16x16x32_bf16 v[68:71], a[8:11], a[92:95], v[68:71]
v_mfma_f32_16x16x32_bf16 v[72:75], a[12:15], a[88:91], v[72:75]
ds_read_b64_tr_b16 a[36:37], v19 offset:8192
ds_read_b64_tr_b16 a[38:39], v19 offset:12288
v_mfma_f32_16x16x32_bf16 v[76:79], a[12:15], a[92:95], v[76:79]
buffer_load_dwordx4 v32, s[12:15], s16 offen offset:0 lds
s_lshr_b32 s50, s4, 2
s_lshl_b32 s50, s50, 10
s_add_u32 s59, s59, s50
s_and_b32 s50, s4, 1
s_lshl_b32 s50, s50, 2
s_waitcnt lgkmcnt(8)
v_mfma_f32_16x16x32_bf16 v[80:83], a[16:19], a[88:91], v[80:83]
ds_read_b64_tr_b16 a[40:41], v20 offset:8192
ds_read_b64_tr_b16 a[42:43], v20 offset:12288
v_mfma_f32_16x16x32_bf16 v[84:87], a[16:19], a[92:95], v[84:87]
buffer_load_dwordx2 a[156:157], v43, s[24:27], s29 offen offset:0 sc1
v_mfma_f32_16x16x32_bf16 v[88:91], a[20:23], a[88:91], v[88:91]
ds_read_b64_tr_b16 a[44:45], v21 offset:8192
ds_read_b64_tr_b16 a[46:47], v21 offset:12288
v_mfma_f32_16x16x32_bf16 v[92:95], a[20:23], a[92:95], v[92:95]
s_add_u32 s50, s50, s28
s_lshl_b32 s50, s50, 7
s_add_u32 s59, s59, s50
s_add_u32 s59, s59, 25165824
s_lshl_b32 s60, s5, 5
s_waitcnt lgkmcnt(8)
v_mfma_f32_16x16x32_bf16 v[96:99], a[24:27], a[88:91], v[96:99]
ds_read_b64_tr_b16 a[48:49], v22 offset:8192
ds_read_b64_tr_b16 a[50:51], v22 offset:12288
v_mfma_f32_16x16x32_bf16 v[100:103], a[24:27], a[92:95], v[100:103]
buffer_load_dwordx4 v33, s[12:15], s16 offen offset:1024 lds
v_mfma_f32_16x16x32_bf16 v[104:107], a[28:31], a[88:91], v[104:107]
ds_read_b64_tr_b16 a[52:53], v23 offset:8192
ds_read_b64_tr_b16 a[54:55], v23 offset:12288
v_mfma_f32_16x16x32_bf16 v[108:111], a[28:31], a[92:95], v[108:111]
s_add_u32 s60, s60, s28
s_lshl_b32 s60, s60, 7
s_add_u32 s60, s60, 28311552
s_lshl_b32 s51, s5, 3
s_add_u32 s51, s51, s4
s_waitcnt lgkmcnt(8)
v_mfma_f32_16x16x32_bf16 v[48:51], a[32:35], a[96:99], v[48:51]
ds_read_b64_tr_b16 a[56:57], v24 offset:8192
ds_read_b64_tr_b16 a[58:59], v24 offset:12288
v_mfma_f32_16x16x32_bf16 v[52:55], a[32:35], a[100:103], v[52:55]
buffer_load_dwordx2 a[158:159], v43, s[24:27], s29 offen offset:512 sc1
v_mfma_f32_16x16x32_bf16 v[56:59], a[36:39], a[96:99], v[56:59]
ds_read_b64_tr_b16 a[60:61], v25 offset:8192
ds_read_b64_tr_b16 a[62:63], v25 offset:12288
v_mfma_f32_16x16x32_bf16 v[60:63], a[36:39], a[100:103], v[60:63]
buffer_load_dwordx4 v34, s[12:15], s16 offen offset:2048 lds
s_lshl_b32 s51, s51, 2
s_add_u32 s51, s51, s28
s_lshl_b32 s51, s51, 7
s_add_u32 s51, s51, 27262976
v_lshrrev_b32 v47, 4, v1
s_waitcnt vmcnt(20)
s_barrier
s_waitcnt lgkmcnt(8)
v_mfma_f32_16x16x32_bf16 v[64:67], a[40:43], a[96:99], v[64:67]
ds_read_b64_tr_b16 a[0:1], v18 offset:16384
ds_read_b64_tr_b16 a[2:3], v18 offset:20480
v_mfma_f32_16x16x32_bf16 v[68:71], a[40:43], a[100:103], v[68:71]
v_mfma_f32_16x16x32_bf16 v[72:75], a[44:47], a[96:99], v[72:75]
ds_read_b64_tr_b16 a[4:5], v19 offset:16384
ds_read_b64_tr_b16 a[6:7], v19 offset:20480
v_mfma_f32_16x16x32_bf16 v[76:79], a[44:47], a[100:103], v[76:79]
buffer_load_dwordx4 a[160:163], v6, s[24:27], s29 offen offset:1024 sc1
v_lshlrev_b32 v47, 5, v47
v_and_b32 v46, 7, v1
v_mul_u32_u24 v46, 512, v46
v_add_u32 v47, v47, v46
v_lshrrev_b32 v46, 5, v1
s_waitcnt lgkmcnt(8)
v_mfma_f32_16x16x32_bf16 v[80:83], a[48:51], a[96:99], v[80:83]
ds_read_b64_tr_b16 a[8:9], v20 offset:16384
ds_read_b64_tr_b16 a[10:11], v20 offset:20480
v_mfma_f32_16x16x32_bf16 v[84:87], a[48:51], a[100:103], v[84:87]
buffer_load_dwordx4 v35, s[12:15], s16 offen offset:3072 lds
v_mfma_f32_16x16x32_bf16 v[88:91], a[52:55], a[96:99], v[88:91]
ds_read_b64_tr_b16 a[12:13], v21 offset:16384
ds_read_b64_tr_b16 a[14:15], v21 offset:20480
v_mfma_f32_16x16x32_bf16 v[92:95], a[52:55], a[100:103], v[92:95]
v_and_b32 v45, 31, v1
v_lshlrev_b32 v45, 2, v45
v_lshl_add_u32 v45, v46, 11, v45
v_lshlrev_b32 v46, 3, v46
v_bfe_u32 v2, v1, 2, 3
s_waitcnt lgkmcnt(8)
v_mfma_f32_16x16x32_bf16 v[96:99], a[56:59], a[96:99], v[96:99]
ds_read_b64_tr_b16 a[16:17], v22 offset:16384
ds_read_b64_tr_b16 a[18:19], v22 offset:20480
v_mfma_f32_16x16x32_bf16 v[100:103], a[56:59], a[100:103], v[100:103]
buffer_load_dwordx4 a[164:167], v7, s[24:27], s29 offen offset:1024 sc1
v_mfma_f32_16x16x32_bf16 v[104:107], a[60:63], a[96:99], v[104:107]
ds_read_b64_tr_b16 a[20:21], v23 offset:16384
ds_read_b64_tr_b16 a[22:23], v23 offset:20480
v_mfma_f32_16x16x32_bf16 v[108:111], a[60:63], a[100:103], v[108:111]
s_add_u32 s29, s29, 2048
s_add_u32 s16, s16, s18
v_lshl_add_u32 v46, v2, 4, v46
v_and_b32 v2, 3, v1
v_lshl_add_u32 v46, v2, 1, v46
s_waitcnt lgkmcnt(8)
v_mfma_f32_16x16x32_bf16 v[48:51], a[0:3], a[104:107], v[48:51]
ds_read_b64_tr_b16 a[24:25], v24 offset:16384
ds_read_b64_tr_b16 a[26:27], v24 offset:20480
v_mfma_f32_16x16x32_bf16 v[52:55], a[0:3], a[108:111], v[52:55]
buffer_load_dwordx4 a[168:171], v6, s[24:27], s29 offen sc1
v_mfma_f32_16x16x32_bf16 v[56:59], a[4:7], a[104:107], v[56:59]
ds_read_b64_tr_b16 a[28:29], v25 offset:16384
ds_read_b64_tr_b16 a[30:31], v25 offset:20480
s_add_u32 m0, s17, 49152
v_mfma_f32_16x16x32_bf16 v[60:63], a[4:7], a[108:111], v[60:63]
s_waitcnt lgkmcnt(8)
v_mfma_f32_16x16x32_bf16 v[64:67], a[8:11], a[104:107], v[64:67]
ds_read_b64_tr_b16 a[32:33], v18 offset:24576
ds_read_b64_tr_b16 a[34:35], v18 offset:28672
v_mfma_f32_16x16x32_bf16 v[68:71], a[8:11], a[108:111], v[68:71]
buffer_load_dwordx4 v32, s[12:15], s16 offen offset:0 lds
v_mfma_f32_16x16x32_bf16 v[72:75], a[12:15], a[104:107], v[72:75]
ds_read_b64_tr_b16 a[36:37], v19 offset:24576
ds_read_b64_tr_b16 a[38:39], v19 offset:28672
v_mfma_f32_16x16x32_bf16 v[76:79], a[12:15], a[108:111], v[76:79]
s_waitcnt lgkmcnt(8)
v_mfma_f32_16x16x32_bf16 v[80:83], a[16:19], a[104:107], v[80:83]
ds_read_b64_tr_b16 a[40:41], v20 offset:24576
ds_read_b64_tr_b16 a[42:43], v20 offset:28672
v_mfma_f32_16x16x32_bf16 v[84:87], a[16:19], a[108:111], v[84:87]
buffer_load_dwordx4 a[172:175], v7, s[24:27], s29 offen sc1
v_mfma_f32_16x16x32_bf16 v[88:91], a[20:23], a[104:107], v[88:91]
ds_read_b64_tr_b16 a[44:45], v21 offset:24576
ds_read_b64_tr_b16 a[46:47], v21 offset:28672
v_mfma_f32_16x16x32_bf16 v[92:95], a[20:23], a[108:111], v[92:95]
s_waitcnt lgkmcnt(8)
v_mfma_f32_16x16x32_bf16 v[96:99], a[24:27], a[104:107], v[96:99]
ds_read_b64_tr_b16 a[48:49], v22 offset:24576
ds_read_b64_tr_b16 a[50:51], v22 offset:28672
v_mfma_f32_16x16x32_bf16 v[100:103], a[24:27], a[108:111], v[100:103]
buffer_load_dwordx4 v33, s[12:15], s16 offen offset:1024 lds
v_mfma_f32_16x16x32_bf16 v[104:107], a[28:31], a[104:107], v[104:107]
ds_read_b64_tr_b16 a[52:53], v23 offset:24576
ds_read_b64_tr_b16 a[54:55], v23 offset:28672
v_mfma_f32_16x16x32_bf16 v[108:111], a[28:31], a[108:111], v[108:111]
s_waitcnt lgkmcnt(8)
v_mfma_f32_16x16x32_bf16 v[48:51], a[32:35], a[112:115], v[48:51]
ds_read_b64_tr_b16 a[56:57], v24 offset:24576
ds_read_b64_tr_b16 a[58:59], v24 offset:28672
v_mfma_f32_16x16x32_bf16 v[52:55], a[32:35], a[116:119], v[52:55]
buffer_load_dwordx4 a[176:179], v6, s[24:27], s29 offen offset:1024 sc1
v_mfma_f32_16x16x32_bf16 v[56:59], a[36:39], a[112:115], v[56:59]
ds_read_b64_tr_b16 a[60:61], v25 offset:24576
ds_read_b64_tr_b16 a[62:63], v25 offset:28672
v_mfma_f32_16x16x32_bf16 v[60:63], a[36:39], a[116:119], v[60:63]
s_waitcnt vmcnt(22)
s_cmp_lg_u32 s28, 0
s_cbranch_scc1 L_adone_15
v_readfirstlane_b32 s53, v41
s_nop 3
s_cmp_ge_u32 s53, 8
s_cbranch_scc1 L_adone_15
s_mov_b32 s52, 0
L_poll_16:
buffer_load_dword v41, v40, s[24:27], 0 offen sc1
s_waitcnt vmcnt(0)
v_readfirstlane_b32 s53, v41
s_add_u32 s52, s52, 1
s_nop 2
s_cmp_ge_u32 s53, 8
s_cbranch_scc1 L_adone_15
s_cmp_lt_u32 s52, 20000
s_cbranch_scc1 L_poll_16
L_adone_15:
s_barrier
s_waitcnt lgkmcnt(8)
v_mfma_f32_16x16x32_bf16 v[64:67], a[40:43], a[112:115], v[64:67]
ds_read_b64_tr_b16 a[0:1], v18 offset:32768
ds_read_b64_tr_b16 a[2:3], v18 offset:36864
v_mfma_f32_16x16x32_bf16 v[68:71], a[40:43], a[116:119], v[68:71]
buffer_load_dwordx4 v34, s[12:15], s16 offen offset:2048 lds
v_mfma_f32_16x16x32_bf16 v[72:75], a[44:47], a[112:115], v[72:75]
ds_read_b64_tr_b16 a[4:5], v19 offset:32768
ds_read_b64_tr_b16 a[6:7], v19 offset:36864
v_mfma_f32_16x16x32_bf16 v[76:79], a[44:47], a[116:119], v[76:79]
buffer_load_dwordx4 v[120:123], v47, s[24:27], s60 offen sc1
buffer_load_dword v112, v45, s[24:27], s59 offen sc1
s_add_u32 s59, s59, 8192
buffer_load_dword v113, v45, s[24:27], s59 offen sc1
s_waitcnt lgkmcnt(8)
v_mfma_f32_16x16x32_bf16 v[80:83], a[48:51], a[112:115], v[80:83]
ds_read_b64_tr_b16 a[8:9], v20 offset:32768
ds_read_b64_tr_b16 a[10:11], v20 offset:36864
v_mfma_f32_16x16x32_bf16 v[84:87], a[48:51], a[116:119], v[84:87]
buffer_load_dwordx4 a[180:183], v7, s[24:27], s29 offen offset:1024 sc1
s_add_u32 s59, s59, 8192
buffer_load_dword v114, v45, s[24:27], s59 offen sc1
s_add_u32 s59, s59, 8192
buffer_load_dword v115, v45, s[24:27], s59 offen sc1
v_mfma_f32_16x16x32_bf16 v[88:91], a[52:55], a[112:115], v[88:91]
ds_read_b64_tr_b16 a[12:13], v21 offset:32768
ds_read_b64_tr_b16 a[14:15], v21 offset:36864
v_mfma_f32_16x16x32_bf16 v[92:95], a[52:55], a[116:119], v[92:95]
s_add_u32 s59, s59, 8192
buffer_load_dword v116, v45, s[24:27], s59 offen sc1
s_add_u32 s59, s59, 8192
buffer_load_dword v117, v45, s[24:27], s59 offen sc1
s_waitcnt lgkmcnt(8)
v_mfma_f32_16x16x32_bf16 v[96:99], a[56:59], a[112:115], v[96:99]
ds_read_b64_tr_b16 a[16:17], v22 offset:32768
ds_read_b64_tr_b16 a[18:19], v22 offset:36864
v_mfma_f32_16x16x32_bf16 v[100:103], a[56:59], a[116:119], v[100:103]
buffer_load_dwordx4 v35, s[12:15], s16 offen offset:3072 lds
s_add_u32 s59, s59, 8192
buffer_load_dword v118, v45, s[24:27], s59 offen sc1
s_add_u32 s59, s59, 8192
buffer_load_dword v119, v45, s[24:27], s59 offen sc1
v_mfma_f32_16x16x32_bf16 v[104:107], a[60:63], a[112:115], v[104:107]
ds_read_b64_tr_b16 a[20:21], v23 offset:32768
ds_read_b64_tr_b16 a[22:23], v23 offset:36864
v_mfma_f32_16x16x32_bf16 v[108:111], a[60:63], a[116:119], v[108:111]
s_add_u32 s29, s29, 2048
s_add_u32 s16, s16, s18
s_waitcnt lgkmcnt(8)
v_mfma_f32_16x16x32_bf16 v[48:51], a[0:3], a[120:123], v[48:51]
ds_read_b64_tr_b16 a[24:25], v24 offset:32768
ds_read_b64_tr_b16 a[26:27], v24 offset:36864
v_mfma_f32_16x16x32_bf16 v[52:55], a[0:3], a[124:127], v[52:55]
buffer_load_dwordx4 a[72:75], v6, s[24:27], s29 offen sc1
v_mfma_f32_16x16x32_bf16 v[56:59], a[4:7], a[120:123], v[56:59]
ds_read_b64_tr_b16 a[28:29], v25 offset:32768
ds_read_b64_tr_b16 a[30:31], v25 offset:36864
s_add_u32 m0, s17, 65536
v_mfma_f32_16x16x32_bf16 v[60:63], a[4:7], a[124:127], v[60:63]
s_waitcnt lgkmcnt(8)
v_mfma_f32_16x16x32_bf16 v[64:67], a[8:11], a[120:123], v[64:67]
ds_read_b64_tr_b16 a[32:33], v18 offset:40960
ds_read_b64_tr_b16 a[34:35], v18 offset:45056
v_mfma_f32_16x16x32_bf16 v[68:71], a[8:11], a[124:127], v[68:71]
buffer_load_dwordx4 v32, s[12:15], s16 offen offset:0 lds
v_mfma_f32_16x16x32_bf16 v[72:75], a[12:15], a[120:123], v[72:75]
ds_read_b64_tr_b16 a[36:37], v19 offset:40960
ds_read_b64_tr_b16 a[38:39], v19 offset:45056
v_mfma_f32_16x16x32_bf16 v[76:79], a[12:15], a[124:127], v[76:79]
s_waitcnt lgkmcnt(8)
v_mfma_f32_16x16x32_bf16 v[80:83], a[16:19], a[120:123], v[80:83]
ds_read_b64_tr_b16 a[40:41], v20 offset:40960
ds_read_b64_tr_b16 a[42:43], v20 offset:45056
v_mfma_f32_16x16x32_bf16 v[84:87], a[16:19], a[124:127], v[84:87]
buffer_load_dwordx4 a[76:79], v7, s[24:27], s29 offen sc1
v_mfma_f32_16x16x32_bf16 v[88:91], a[20:23], a[120:123], v[88:91]
ds_read_b64_tr_b16 a[44:45], v21 offset:40960
ds_read_b64_tr_b16 a[46:47], v21 offset:45056
v_mfma_f32_16x16x32_bf16 v[92:95], a[20:23], a[124:127], v[92:95]
s_waitcnt lgkmcnt(8)
v_mfma_f32_16x16x32_bf16 v[96:99], a[24:27], a[120:123], v[96:99]
ds_read_b64_tr_b16 a[48:49], v22 offset:40960
ds_read_b64_tr_b16 a[50:51], v22 offset:45056
v_mfma_f32_16x16x32_bf16 v[100:103], a[24:27], a[124:127], v[100:103]
buffer_load_dwordx4 v33, s[12:15], s16 offen offset:1024 lds
v_mfma_f32_16x16x32_bf16 v[104:107], a[28:31], a[120:123], v[104:107]
ds_read_b64_tr_b16 a[52:53], v23 offset:40960
ds_read_b64_tr_b16 a[54:55], v23 offset:45056
v_mfma_f32_16x16x32_bf16 v[108:111], a[28:31], a[124:127], v[108:111]
s_waitcnt lgkmcnt(8)
v_mfma_f32_16x16x32_bf16 v[48:51], a[32:35], a[128:131], v[48:51]
ds_read_b64_tr_b16 a[56:57], v24 offset:40960
ds_read_b64_tr_b16 a[58:59], v24 offset:45056
v_mfma_f32_16x16x32_bf16 v[52:55], a[32:35], a[132:135], v[52:55]
buffer_load_dwordx4 a[80:83], v6, s[24:27], s29 offen offset:1024 sc1
v_mfma_f32_16x16x32_bf16 v[56:59], a[36:39], a[128:131], v[56:59]
ds_read_b64_tr_b16 a[60:61], v25 offset:40960
ds_read_b64_tr_b16 a[62:63], v25 offset:45056
v_mfma_f32_16x16x32_bf16 v[60:63], a[36:39], a[132:135], v[60:63]
s_waitcnt vmcnt(33)
s_barrier
s_waitcnt lgkmcnt(8)
v_mfma_f32_16x16x32_bf16 v[64:67], a[40:43], a[128:131], v[64:67]
ds_read_b64_tr_b16 a[0:1], v10 offset:0
ds_read_b64_tr_b16 a[2:3], v10 offset:4096
v_mfma_f32_16x16x32_bf16 v[68:71], a[40:43], a[132:135], v[68:71]
buffer_load_dwordx4 v34, s[12:15], s16 offen offset:2048 lds
v_mfma_f32_16x16x32_bf16 v[72:75], a[44:47], a[128:131], v[72:75]
ds_read_b64_tr_b16 a[4:5], v11 offset:0
ds_read_b64_tr_b16 a[6:7], v11 offset:4096
v_mfma_f32_16x16x32_bf16 v[76:79], a[44:47], a[132:135], v[76:79]
s_waitcnt lgkmcnt(8)
v_mfma_f32_16x16x32_bf16 v[80:83], a[48:51], a[128:131], v[80:83]
ds_read_b64_tr_b16 a[8:9], v12 offset:0
ds_read_b64_tr_b16 a[10:11], v12 offset:4096
v_mfma_f32_16x16x32_bf16 v[84:87], a[48:51], a[132:135], v[84:87]
buffer_load_dwordx4 a[84:87], v7, s[24:27], s29 offen offset:1024 sc1
v_mfma_f32_16x16x32_bf16 v[88:91], a[52:55], a[128:131], v[88:91]
ds_read_b64_tr_b16 a[12:13], v13 offset:0
ds_read_b64_tr_b16 a[14:15], v13 offset:4096
v_mfma_f32_16x16x32_bf16 v[92:95], a[52:55], a[132:135], v[92:95]
s_waitcnt lgkmcnt(8)
v_mfma_f32_16x16x32_bf16 v[96:99], a[56:59], a[128:131], v[96:99]
ds_read_b64_tr_b16 a[16:17], v14 offset:0
ds_read_b64_tr_b16 a[18:19], v14 offset:4096
v_mfma_f32_16x16x32_bf16 v[100:103], a[56:59], a[132:135], v[100:103]
buffer_load_dwordx4 v35, s[12:15], s16 offen offset:3072 lds
v_mfma_f32_16x16x32_bf16 v[104:107], a[60:63], a[128:131], v[104:107]
ds_read_b64_tr_b16 a[20:21], v15 offset:0
ds_read_b64_tr_b16 a[22:23], v15 offset:4096
v_mfma_f32_16x16x32_bf16 v[108:111], a[60:63], a[132:135], v[108:111]
s_add_u32 s29, s29, 2048
s_add_u32 s16, s16, s18
s_waitcnt lgkmcnt(8)
v_mfma_f32_16x16x32_bf16 v[48:51], a[0:3], a[136:139], v[48:51]
ds_read_b64_tr_b16 a[24:25], v16 offset:0
ds_read_b64_tr_b16 a[26:27], v16 offset:4096
v_mfma_f32_16x16x32_bf16 v[52:55], a[0:3], a[140:143], v[52:55]
buffer_load_dwordx4 a[88:91], v6, s[24:27], s29 offen sc1
v_mfma_f32_16x16x32_bf16 v[56:59], a[4:7], a[136:139], v[56:59]
ds_read_b64_tr_b16 a[28:29], v17 offset:0
ds_read_b64_tr_b16 a[30:31], v17 offset:4096
v_mfma_f32_16x16x32_bf16 v[60:63], a[4:7], a[140:143], v[60:63]
buffer_load_dwordx4 a[92:95], v7, s[24:27], s29 offen sc1
s_waitcnt lgkmcnt(8)
v_mfma_f32_16x16x32_bf16 v[64:67], a[8:11], a[136:139], v[64:67]
ds_read_b64_tr_b16 a[32:33], v10 offset:8192
ds_read_b64_tr_b16 a[34:35], v10 offset:12288
s_add_u32 m0, s17, 81920
v_mfma_f32_16x16x32_bf16 v[68:71], a[8:11], a[140:143], v[68:71]
v_mfma_f32_16x16x32_bf16 v[72:75], a[12:15], a[136:139], v[72:75]
ds_read_b64_tr_b16 a[36:37], v11 offset:8192
ds_read_b64_tr_b16 a[38:39], v11 offset:12288
v_mfma_f32_16x16x32_bf16 v[76:79], a[12:15], a[140:143], v[76:79]
buffer_load_dwordx4 v32, s[12:15], s16 offen offset:0 lds
s_waitcnt lgkmcnt(8)
v_mfma_f32_16x16x32_bf16 v[80:83], a[16:19], a[136:139], v[80:83]
ds_read_b64_tr_b16 a[40:41], v12 offset:8192
ds_read_b64_tr_b16 a[42:43], v12 offset:12288
v_mfma_f32_16x16x32_bf16 v[84:87], a[16:19], a[140:143], v[84:87]
buffer_load_dwordx2 a[96:97], v42, s[24:27], s29 offen offset:1024 sc1
v_mfma_f32_16x16x32_bf16 v[88:91], a[20:23], a[136:139], v[88:91]
ds_read_b64_tr_b16 a[44:45], v13 offset:8192
ds_read_b64_tr_b16 a[46:47], v13 offset:12288
v_mfma_f32_16x16x32_bf16 v[92:95], a[20:23], a[140:143], v[92:95]
s_waitcnt lgkmcnt(8)
v_mfma_f32_16x16x32_bf16 v[96:99], a[24:27], a[136:139], v[96:99]
ds_read_b64_tr_b16 a[48:49], v14 offset:8192
ds_read_b64_tr_b16 a[50:51], v14 offset:12288
v_mfma_f32_16x16x32_bf16 v[100:103], a[24:27], a[140:143], v[100:103]
buffer_load_dwordx4 v33, s[12:15], s16 offen offset:1024 lds
v_mfma_f32_16x16x32_bf16 v[104:107], a[28:31], a[136:139], v[104:107]
ds_read_b64_tr_b16 a[52:53], v15 offset:8192
ds_read_b64_tr_b16 a[54:55], v15 offset:12288
v_mfma_f32_16x16x32_bf16 v[108:111], a[28:31], a[140:143], v[108:111]
s_waitcnt lgkmcnt(8)
v_mfma_f32_16x16x32_bf16 v[48:51], a[32:35], a[144:147], v[48:51]
ds_read_b64_tr_b16 a[56:57], v16 offset:8192
ds_read_b64_tr_b16 a[58:59], v16 offset:12288
v_mfma_f32_16x16x32_bf16 v[52:55], a[32:35], a[148:151], v[52:55]
buffer_load_dwordx2 a[98:99], v42, s[24:27], s29 offen offset:1536 sc1
v_mfma_f32_16x16x32_bf16 v[56:59], a[36:39], a[144:147], v[56:59]
ds_read_b64_tr_b16 a[60:61], v17 offset:8192
ds_read_b64_tr_b16 a[62:63], v17 offset:12288
v_mfma_f32_16x16x32_bf16 v[60:63], a[36:39], a[148:151], v[60:63]
buffer_load_dwordx4 v34, s[12:15], s16 offen offset:2048 lds
s_waitcnt vmcnt(15)
s_barrier
s_waitcnt lgkmcnt(8)
v_mfma_f32_16x16x32_bf16 v[64:67], a[40:43], a[144:147], v[64:67]
ds_read_b64_tr_b16 a[0:1], v10 offset:16384
ds_read_b64_tr_b16 a[2:3], v10 offset:20480
v_mfma_f32_16x16x32_bf16 v[68:71], a[40:43], a[148:151], v[68:71]
v_mfma_f32_16x16x32_bf16 v[72:75], a[44:47], a[144:147], v[72:75]
ds_read_b64_tr_b16 a[4:5], v11 offset:16384
ds_read_b64_tr_b16 a[6:7], v11 offset:20480
v_add_f32 v112, v112, v113
v_add_f32 v112, v112, v114
v_mfma_f32_16x16x32_bf16 v[76:79], a[44:47], a[148:151], v[76:79]
buffer_load_dwordx2 a[100:101], v43, s[24:27], s29 offen offset:1024 sc1
v_add_f32 v112, v112, v115
v_add_f32 v112, v112, v116
s_waitcnt lgkmcnt(8)
v_mfma_f32_16x16x32_bf16 v[80:83], a[48:51], a[144:147], v[80:83]
ds_read_b64_tr_b16 a[8:9], v12 offset:16384
ds_read_b64_tr_b16 a[10:11], v12 offset:20480
v_add_f32 v112, v112, v117
v_mfma_f32_16x16x32_bf16 v[84:87], a[48:51], a[148:151], v[84:87]
buffer_load_dwordx4 v35, s[12:15], s16 offen offset:3072 lds
v_mfma_f32_16x16x32_bf16 v[88:91], a[52:55], a[144:147], v[88:91]
ds_read_b64_tr_b16 a[12:13], v13 offset:16384
ds_read_b64_tr_b16 a[14:15], v13 offset:20480
v_add_f32 v112, v112, v118
v_add_f32 v112, v112, v119
v_mfma_f32_16x16x32_bf16 v[92:95], a[52:55], a[148:151], v[92:95]
v_cvt_pk_bf16_f32 v112, v112, v112
buffer_store_short v112, v46, s[24:27], s51 offen sc1
s_waitcnt lgkmcnt(8)
v_mfma_f32_16x16x32_bf16 v[96:99], a[56:59], a[144:147], v[96:99]
ds_read_b64_tr_b16 a[16:17], v14 offset:16384
ds_read_b64_tr_b16 a[18:19], v14 offset:20480
v_mfma_f32_16x16x32_bf16 v[100:103], a[56:59], a[148:151], v[100:103]
buffer_load_dwordx2 a[102:103], v43, s[24:27], s29 offen offset:1536 sc1
v_mfma_f32_16x16x32_bf16 v[104:107], a[60:63], a[144:147], v[104:107]
ds_read_b64_tr_b16 a[20:21], v15 offset:16384
ds_read_b64_tr_b16 a[22:23], v15 offset:20480
v_mfma_f32_16x16x32_bf16 v[108:111], a[60:63], a[148:151], v[108:111]
s_add_u32 s29, s29, 2048
s_add_u32 s16, s16, s18
s_waitcnt lgkmcnt(8)
v_mfma_f32_16x16x32_bf16 v[48:51], a[0:3], a[152:155], v[48:51]
ds_read_b64_tr_b16 a[24:25], v16 offset:16384
ds_read_b64_tr_b16 a[26:27], v16 offset:20480
v_mfma_f32_16x16x32_bf16 v[52:55], a[0:3], a[156:159], v[52:55]
buffer_load_dwordx4 a[104:107], v6, s[24:27], s29 offen sc1
v_mfma_f32_16x16x32_bf16 v[56:59], a[4:7], a[152:155], v[56:59]
ds_read_b64_tr_b16 a[28:29], v17 offset:16384
ds_read_b64_tr_b16 a[30:31], v17 offset:20480
s_add_u32 m0, s17, 98304
v_mfma_f32_16x16x32_bf16 v[60:63], a[4:7], a[156:159], v[60:63]
v_add_f32_dpp v120, v120, v120 row_ror:4 row_mask:0xf bank_mask:0xf
v_add_f32_dpp v121, v121, v121 row_ror:4 row_mask:0xf bank_mask:0xf
v_add_f32_dpp v122, v122, v122 row_ror:4 row_mask:0xf bank_mask:0xf
v_add_f32_dpp v123, v123, v123 row_ror:4 row_mask:0xf bank_mask:0xf
s_waitcnt lgkmcnt(8)
v_mfma_f32_16x16x32_bf16 v[64:67], a[8:11], a[152:155], v[64:67]
ds_read_b64_tr_b16 a[32:33], v10 offset:24576
ds_read_b64_tr_b16 a[34:35], v10 offset:28672
v_mfma_f32_16x16x32_bf16 v[68:71], a[8:11], a[156:159], v[68:71]
buffer_load_dwordx4 v32, s[12:15], s16 offen offset:0 lds
v_mfma_f32_16x16x32_bf16 v[72:75], a[12:15], a[152:155], v[72:75]
ds_read_b64_tr_b16 a[36:37], v11 offset:24576
ds_read_b64_tr_b16 a[38:39], v11 offset:28672
v_mfma_f32_16x16x32_bf16 v[76:79], a[12:15], a[156:159], v[76:79]
v_add_f32_dpp v120, v120, v120 row_ror:2 row_mask:0xf bank_mask:0xf
v_add_f32_dpp v121, v121, v121 row_ror:2 row_mask:0xf bank_mask:0xf
v_add_f32_dpp v122, v122, v122 row_ror:2 row_mask:0xf bank_mask:0xf
v_add_f32_dpp v123, v123, v123 row_ror:2 row_mask:0xf bank_mask:0xf
s_waitcnt lgkmcnt(8)
v_mfma_f32_16x16x32_bf16 v[80:83], a[16:19], a[152:155], v[80:83]
ds_read_b64_tr_b16 a[40:41], v12 offset:24576
ds_read_b64_tr_b16 a[42:43], v12 offset:28672
v_mfma_f32_16x16x32_bf16 v[84:87], a[16:19], a[156:159], v[84:87]
buffer_load_dwordx4 a[108:111], v7, s[24:27], s29 offen sc1
v_mfma_f32_16x16x32_bf16 v[88:91], a[20:23], a[152:155], v[88:91]
ds_read_b64_tr_b16 a[44:45], v13 offset:24576
ds_read_b64_tr_b16 a[46:47], v13 offset:28672
v_mfma_f32_16x16x32_bf16 v[92:95], a[20:23], a[156:159], v[92:95]
v_add_f32_dpp v120, v120, v120 row_ror:1 row_mask:0xf bank_mask:0xf
v_add_f32_dpp v121, v121, v121 row_ror:1 row_mask:0xf bank_mask:0xf
v_add_f32_dpp v122, v122, v122 row_ror:1 row_mask:0xf bank_mask:0xf
v_add_f32_dpp v123, v123, v123 row_ror:1 row_mask:0xf bank_mask:0xf
s_waitcnt lgkmcnt(8)
v_mfma_f32_16x16x32_bf16 v[96:99], a[24:27], a[152:155], v[96:99]
ds_read_b64_tr_b16 a[48:49], v14 offset:24576
ds_read_b64_tr_b16 a[50:51], v14 offset:28672
v_mfma_f32_16x16x32_bf16 v[100:103], a[24:27], a[156:159], v[100:103]
buffer_load_dwordx4 v33, s[12:15], s16 offen offset:1024 lds
v_mfma_f32_16x16x32_bf16 v[104:107], a[28:31], a[152:155], v[104:107]
ds_read_b64_tr_b16 a[52:53], v15 offset:24576
ds_read_b64_tr_b16 a[54:55], v15 offset:28672
v_mfma_f32_16x16x32_bf16 v[108:111], a[28:31], a[156:159], v[108:111]
v_cvt_pk_bf16_f32 v244, v120, v121
v_cvt_pk_bf16_f32 v245, v122, v123
s_lshr_b32 s50, s28, 1
s_lshl_b32 s50, s50, 10
s_waitcnt lgkmcnt(8)
v_mfma_f32_16x16x32_bf16 v[48:51], a[32:35], a[160:163], v[48:51]
ds_read_b64_tr_b16 a[56:57], v16 offset:24576
ds_read_b64_tr_b16 a[58:59], v16 offset:28672
v_mfma_f32_16x16x32_bf16 v[52:55], a[32:35], a[164:167], v[52:55]
buffer_load_dwordx4 a[112:115], v6, s[24:27], s29 offen offset:1024 sc1
v_mfma_f32_16x16x32_bf16 v[56:59], a[36:39], a[160:163], v[56:59]
ds_read_b64_tr_b16 a[60:61], v17 offset:24576
ds_read_b64_tr_b16 a[62:63], v17 offset:28672
v_mfma_f32_16x16x32_bf16 v[60:63], a[36:39], a[164:167], v[60:63]
s_and_b32 s59, s28, 1
s_lshl_b32 s59, s59, 3
s_add_u32 s50, s50, s59
v_add_u32 v47, s50, v44
s_barrier
s_waitcnt lgkmcnt(8)
v_mfma_f32_16x16x32_bf16 v[64:67], a[40:43], a[160:163], v[64:67]
ds_read_b64_tr_b16 a[0:1], v10 offset:32768
ds_read_b64_tr_b16 a[2:3], v10 offset:36864
v_mfma_f32_16x16x32_bf16 v[68:71], a[40:43], a[164:167], v[68:71]
buffer_load_dwordx4 v34, s[12:15], s16 offen offset:2048 lds
v_mfma_f32_16x16x32_bf16 v[72:75], a[44:47], a[160:163], v[72:75]
ds_read_b64_tr_b16 a[4:5], v11 offset:32768
ds_read_b64_tr_b16 a[6:7], v11 offset:36864
v_mfma_f32_16x16x32_bf16 v[76:79], a[44:47], a[164:167], v[76:79]
ds_write_b64 v47, v[244:245] offset:4096
s_lshl_b32 s50, s28, 10
s_lshl_b32 s59, s5, 12
s_add_u32 s59, s59, s50
s_waitcnt lgkmcnt(8)
v_mfma_f32_16x16x32_bf16 v[80:83], a[48:51], a[160:163], v[80:83]
ds_read_b64_tr_b16 a[8:9], v12 offset:32768
ds_read_b64_tr_b16 a[10:11], v12 offset:36864
v_mfma_f32_16x16x32_bf16 v[84:87], a[48:51], a[164:167], v[84:87]
buffer_load_dwordx4 a[116:119], v7, s[24:27], s29 offen offset:1024 sc1
v_mfma_f32_16x16x32_bf16 v[88:91], a[52:55], a[160:163], v[88:91]
ds_read_b64_tr_b16 a[12:13], v13 offset:32768
ds_read_b64_tr_b16 a[14:15], v13 offset:36864
v_mfma_f32_16x16x32_bf16 v[92:95], a[52:55], a[164:167], v[92:95]
s_add_u32 s59, s59, 27262976
s_waitcnt lgkmcnt(8)
v_mfma_f32_16x16x32_bf16 v[96:99], a[56:59], a[160:163], v[96:99]
ds_read_b64_tr_b16 a[16:17], v14 offset:32768
ds_read_b64_tr_b16 a[18:19], v14 offset:36864
v_mfma_f32_16x16x32_bf16 v[100:103], a[56:59], a[164:167], v[100:103]
buffer_load_dwordx4 v35, s[12:15], s16 offen offset:3072 lds
v_mfma_f32_16x16x32_bf16 v[104:107], a[60:63], a[160:163], v[104:107]
ds_read_b64_tr_b16 a[20:21], v15 offset:32768
ds_read_b64_tr_b16 a[22:23], v15 offset:36864
v_mfma_f32_16x16x32_bf16 v[108:111], a[60:63], a[164:167], v[108:111]
s_add_u32 s29, s29, 2048
s_add_u32 s16, s16, s18
s_waitcnt lgkmcnt(8)
v_mfma_f32_16x16x32_bf16 v[48:51], a[0:3], a[168:171], v[48:51]
ds_read_b64_tr_b16 a[24:25], v16 offset:32768
ds_read_b64_tr_b16 a[26:27], v16 offset:36864
v_mfma_f32_16x16x32_bf16 v[52:55], a[0:3], a[172:175], v[52:55]
buffer_load_dwordx4 a[120:123], v6, s[24:27], s29 offen sc1
v_mfma_f32_16x16x32_bf16 v[56:59], a[4:7], a[168:171], v[56:59]
ds_read_b64_tr_b16 a[28:29], v17 offset:32768
ds_read_b64_tr_b16 a[30:31], v17 offset:36864
s_add_u32 m0, s17, 0
v_mfma_f32_16x16x32_bf16 v[60:63], a[4:7], a[172:175], v[60:63]
s_waitcnt lgkmcnt(8)
v_mfma_f32_16x16x32_bf16 v[64:67], a[8:11], a[168:171], v[64:67]
ds_read_b64_tr_b16 a[32:33], v10 offset:40960
ds_read_b64_tr_b16 a[34:35], v10 offset:45056
v_mfma_f32_16x16x32_bf16 v[68:71], a[8:11], a[172:175], v[68:71]
buffer_load_dwordx4 v32, s[12:15], s16 offen offset:0 lds
v_mfma_f32_16x16x32_bf16 v[72:75], a[12:15], a[168:171], v[72:75]
ds_read_b64_tr_b16 a[36:37], v11 offset:40960
ds_read_b64_tr_b16 a[38:39], v11 offset:45056
v_mfma_f32_16x16x32_bf16 v[76:79], a[12:15], a[172:175], v[76:79]
s_waitcnt lgkmcnt(8)
v_mfma_f32_16x16x32_bf16 v[80:83], a[16:19], a[168:171], v[80:83]
ds_read_b64_tr_b16 a[40:41], v12 offset:40960
ds_read_b64_tr_b16 a[42:43], v12 offset:45056
v_mfma_f32_16x16x32_bf16 v[84:87], a[16:19], a[172:175], v[84:87]
buffer_load_dwordx4 a[124:127], v7, s[24:27], s29 offen sc1
v_mfma_f32_16x16x32_bf16 v[88:91], a[20:23], a[168:171], v[88:91]
ds_read_b64_tr_b16 a[44:45], v13 offset:40960
ds_read_b64_tr_b16 a[46:47], v13 offset:45056
v_mfma_f32_16x16x32_bf16 v[92:95], a[20:23], a[172:175], v[92:95]
s_waitcnt lgkmcnt(8)
v_mfma_f32_16x16x32_bf16 v[96:99], a[24:27], a[168:171], v[96:99]
ds_read_b64_tr_b16 a[48:49], v14 offset:40960
ds_read_b64_tr_b16 a[50:51], v14 offset:45056
v_mfma_f32_16x16x32_bf16 v[100:103], a[24:27], a[172:175], v[100:103]
buffer_load_dwordx4 v33, s[12:15], s16 offen offset:1024 lds
v_mfma_f32_16x16x32_bf16 v[104:107], a[28:31], a[168:171], v[104:107]
ds_read_b64_tr_b16 a[52:53], v15 offset:40960
ds_read_b64_tr_b16 a[54:55], v15 offset:45056
v_mfma_f32_16x16x32_bf16 v[108:111], a[28:31], a[172:175], v[108:111]
s_waitcnt lgkmcnt(8)
v_mfma_f32_16x16x32_bf16 v[48:51], a[32:35], a[176:179], v[48:51]
ds_read_b64_tr_b16 a[56:57], v16 offset:40960
ds_read_b64_tr_b16 a[58:59], v16 offset:45056
v_mfma_f32_16x16x32_bf16 v[52:55], a[32:35], a[180:183], v[52:55]
buffer_load_dwordx4 a[128:131], v6, s[24:27], s29 offen offset:1024 sc1
v_mfma_f32_16x16x32_bf16 v[56:59], a[36:39], a[176:179], v[56:59]
ds_read_b64_tr_b16 a[60:61], v17 offset:40960
ds_read_b64_tr_b16 a[62:63], v17 offset:45056
v_mfma_f32_16x16x32_bf16 v[60:63], a[36:39], a[180:183], v[60:63]
s_waitcnt vmcnt(14)
s_barrier
s_mul_i32 s39, s5, 128
s_add_u32 s39, s39, 39848960
s_add_u32 s39, s39, 4
s_cmp_lg_u32 s28, 0
s_cbranch_scc1 L_sig_17
v_mov_b32 v2, s39
v_mov_b32 v3, 1
s_mov_b64 exec, 1
buffer_atomic_add v3, v2, s[24:27], 0 offen sc1
s_mov_b64 exec, -1
L_sig_17:
s_waitcnt lgkmcnt(8)
v_mfma_f32_16x16x32_bf16 v[64:67], a[40:43], a[176:179], v[64:67]
ds_read_b64_tr_b16 a[0:1], v10 offset:49152
ds_read_b64_tr_b16 a[2:3], v10 offset:53248
v_mfma_f32_16x16x32_bf16 v[68:71], a[40:43], a[180:183], v[68:71]
buffer_load_dwordx4 v34, s[12:15], s16 offen offset:2048 lds
v_mfma_f32_16x16x32_bf16 v[72:75], a[44:47], a[176:179], v[72:75]
ds_read_b64_tr_b16 a[4:5], v11 offset:49152
ds_read_b64_tr_b16 a[6:7], v11 offset:53248
v_mfma_f32_16x16x32_bf16 v[76:79], a[44:47], a[180:183], v[76:79]
s_waitcnt lgkmcnt(8)
v_mfma_f32_16x16x32_bf16 v[80:83], a[48:51], a[176:179], v[80:83]
ds_read_b64_tr_b16 a[8:9], v12 offset:49152
ds_read_b64_tr_b16 a[10:11], v12 offset:53248
v_mfma_f32_16x16x32_bf16 v[84:87], a[48:51], a[180:183], v[84:87]
buffer_load_dwordx4 a[132:135], v7, s[24:27], s29 offen offset:1024 sc1
v_mfma_f32_16x16x32_bf16 v[88:91], a[52:55], a[176:179], v[88:91]
ds_read_b64_tr_b16 a[12:13], v13 offset:49152
ds_read_b64_tr_b16 a[14:15], v13 offset:53248
v_mfma_f32_16x16x32_bf16 v[92:95], a[52:55], a[180:183], v[92:95]
s_waitcnt lgkmcnt(8)
v_mfma_f32_16x16x32_bf16 v[96:99], a[56:59], a[176:179], v[96:99]
ds_read_b64_tr_b16 a[16:17], v14 offset:49152
ds_read_b64_tr_b16 a[18:19], v14 offset:53248
v_mfma_f32_16x16x32_bf16 v[100:103], a[56:59], a[180:183], v[100:103]
buffer_load_dwordx4 v35, s[12:15], s16 offen offset:3072 lds
v_mfma_f32_16x16x32_bf16 v[104:107], a[60:63], a[176:179], v[104:107]
ds_read_b64_tr_b16 a[20:21], v15 offset:49152
ds_read_b64_tr_b16 a[22:23], v15 offset:53248
v_mfma_f32_16x16x32_bf16 v[108:111], a[60:63], a[180:183], v[108:111]
s_add_u32 s29, s29, 2048
s_add_u32 s16, s16, s18
s_waitcnt lgkmcnt(8)
v_mfma_f32_16x16x32_bf16 v[48:51], a[0:3], a[72:75], v[48:51]
ds_read_b64_tr_b16 a[24:25], v16 offset:49152
ds_read_b64_tr_b16 a[26:27], v16 offset:53248
v_mfma_f32_16x16x32_bf16 v[52:55], a[0:3], a[76:79], v[52:55]
buffer_load_dwordx4 a[136:139], v6, s[24:27], s29 offen sc1
v_mfma_f32_16x16x32_bf16 v[56:59], a[4:7], a[72:75], v[56:59]
ds_read_b64_tr_b16 a[28:29], v17 offset:49152
ds_read_b64_tr_b16 a[30:31], v17 offset:53248
s_add_u32 m0, s17, 16384
v_mfma_f32_16x16x32_bf16 v[60:63], a[4:7], a[76:79], v[60:63]
s_waitcnt lgkmcnt(8)
v_mfma_f32_16x16x32_bf16 v[64:67], a[8:11], a[72:75], v[64:67]
ds_read_b64_tr_b16 a[32:33], v10 offset:57344
ds_read_b64_tr_b16 a[34:35], v10 offset:61440
v_mfma_f32_16x16x32_bf16 v[68:71], a[8:11], a[76:79], v[68:71]
buffer_load_dwordx4 v32, s[12:15], s16 offen offset:0 lds
v_mfma_f32_16x16x32_bf16 v[72:75], a[12:15], a[72:75], v[72:75]
ds_read_b64_tr_b16 a[36:37], v11 offset:57344
ds_read_b64_tr_b16 a[38:39], v11 offset:61440
v_mfma_f32_16x16x32_bf16 v[76:79], a[12:15], a[76:79], v[76:79]
s_waitcnt lgkmcnt(8)
v_mfma_f32_16x16x32_bf16 v[80:83], a[16:19], a[72:75], v[80:83]
ds_read_b64_tr_b16 a[40:41], v12 offset:57344
ds_read_b64_tr_b16 a[42:43], v12 offset:61440
v_mfma_f32_16x16x32_bf16 v[84:87], a[16:19], a[76:79], v[84:87]
buffer_load_dwordx4 a[140:143], v7, s[24:27], s29 offen sc1
v_mfma_f32_16x16x32_bf16 v[88:91], a[20:23], a[72:75], v[88:91]
ds_read_b64_tr_b16 a[44:45], v13 offset:57344
ds_read_b64_tr_b16 a[46:47], v13 offset:61440
v_mfma_f32_16x16x32_bf16 v[92:95], a[20:23], a[76:79], v[92:95]
s_waitcnt lgkmcnt(8)
v_mfma_f32_16x16x32_bf16 v[96:99], a[24:27], a[72:75], v[96:99]
ds_read_b64_tr_b16 a[48:49], v14 offset:57344
ds_read_b64_tr_b16 a[50:51], v14 offset:61440
v_mfma_f32_16x16x32_bf16 v[100:103], a[24:27], a[76:79], v[100:103]
buffer_load_dwordx4 v33, s[12:15], s16 offen offset:1024 lds
v_mfma_f32_16x16x32_bf16 v[104:107], a[28:31], a[72:75], v[104:107]
ds_read_b64_tr_b16 a[52:53], v15 offset:57344
ds_read_b64_tr_b16 a[54:55], v15 offset:61440
v_mfma_f32_16x16x32_bf16 v[108:111], a[28:31], a[76:79], v[108:111]
s_waitcnt lgkmcnt(8)
v_mfma_f32_16x16x32_bf16 v[48:51], a[32:35], a[80:83], v[48:51]
ds_read_b64_tr_b16 a[56:57], v16 offset:57344
ds_read_b64_tr_b16 a[58:59], v16 offset:61440
v_mfma_f32_16x16x32_bf16 v[52:55], a[32:35], a[84:87], v[52:55]
buffer_load_dwordx4 a[144:147], v6, s[24:27], s29 offen offset:1024 sc1
v_mfma_f32_16x16x32_bf16 v[56:59], a[36:39], a[80:83], v[56:59]
ds_read_b64_tr_b16 a[60:61], v17 offset:57344
ds_read_b64_tr_b16 a[62:63], v17 offset:61440
v_mfma_f32_16x16x32_bf16 v[60:63], a[36:39], a[84:87], v[60:63]
s_waitcnt vmcnt(21)
s_barrier
s_waitcnt lgkmcnt(8)
v_mfma_f32_16x16x32_bf16 v[64:67], a[40:43], a[80:83], v[64:67]
ds_read_b64_tr_b16 a[0:1], v18 offset:0
ds_read_b64_tr_b16 a[2:3], v18 offset:4096
v_mfma_f32_16x16x32_bf16 v[68:71], a[40:43], a[84:87], v[68:71]
buffer_load_dwordx4 v34, s[12:15], s16 offen offset:2048 lds
v_mfma_f32_16x16x32_bf16 v[72:75], a[44:47], a[80:83], v[72:75]
ds_read_b64_tr_b16 a[4:5], v19 offset:0
ds_read_b64_tr_b16 a[6:7], v19 offset:4096
v_mfma_f32_16x16x32_bf16 v[76:79], a[44:47], a[84:87], v[76:79]
s_waitcnt lgkmcnt(8)
v_mfma_f32_16x16x32_bf16 v[80:83], a[48:51], a[80:83], v[80:83]
ds_read_b64_tr_b16 a[8:9], v20 offset:0
ds_read_b64_tr_b16 a[10:11], v20 offset:4096
v_mfma_f32_16x16x32_bf16 v[84:87], a[48:51], a[84:87], v[84:87]
buffer_load_dwordx4 a[148:151], v7, s[24:27], s29 offen offset:1024 sc1
v_mfma_f32_16x16x32_bf16 v[88:91], a[52:55], a[80:83], v[88:91]
ds_read_b64_tr_b16 a[12:13], v21 offset:0
ds_read_b64_tr_b16 a[14:15], v21 offset:4096
v_mfma_f32_16x16x32_bf16 v[92:95], a[52:55], a[84:87], v[92:95]
s_waitcnt lgkmcnt(8)
v_mfma_f32_16x16x32_bf16 v[96:99], a[56:59], a[80:83], v[96:99]
ds_read_b64_tr_b16 a[16:17], v22 offset:0
ds_read_b64_tr_b16 a[18:19], v22 offset:4096
v_mfma_f32_16x16x32_bf16 v[100:103], a[56:59], a[84:87], v[100:103]
buffer_load_dwordx4 v35, s[12:15], s16 offen offset:3072 lds
v_mfma_f32_16x16x32_bf16 v[104:107], a[60:63], a[80:83], v[104:107]
ds_read_b64_tr_b16 a[20:21], v23 offset:0
ds_read_b64_tr_b16 a[22:23], v23 offset:4096
v_mfma_f32_16x16x32_bf16 v[108:111], a[60:63], a[84:87], v[108:111]
s_add_u32 s29, s29, 2048
s_add_u32 s16, s16, s18
s_waitcnt lgkmcnt(8)
v_mfma_f32_16x16x32_bf16 v[48:51], a[0:3], a[88:91], v[48:51]
ds_read_b64_tr_b16 a[24:25], v24 offset:0
ds_read_b64_tr_b16 a[26:27], v24 offset:4096
v_mfma_f32_16x16x32_bf16 v[52:55], a[0:3], a[92:95], v[52:55]
buffer_load_dwordx2 a[152:153], v42, s[24:27], s29 offen offset:0 sc1
v_mfma_f32_16x16x32_bf16 v[56:59], a[4:7], a[88:91], v[56:59]
ds_read_b64_tr_b16 a[28:29], v25 offset:0
ds_read_b64_tr_b16 a[30:31], v25 offset:4096
v_mfma_f32_16x16x32_bf16 v[60:63], a[4:7], a[92:95], v[60:63]
buffer_load_dwordx2 a[154:155], v42, s[24:27], s29 offen offset:512 sc1
s_waitcnt lgkmcnt(8)
v_mfma_f32_16x16x32_bf16 v[64:67], a[8:11], a[88:91], v[64:67]
ds_read_b64_tr_b16 a[32:33], v18 offset:8192
ds_read_b64_tr_b16 a[34:35], v18 offset:12288
s_add_u32 m0, s17, 32768
v_mfma_f32_16x16x32_bf16 v[68:71], a[8:11], a[92:95], v[68:71]
v_mfma_f32_16x16x32_bf16 v[72:75], a[12:15], a[88:91], v[72:75]
ds_read_b64_tr_b16 a[36:37], v19 offset:8192
ds_read_b64_tr_b16 a[38:39], v19 offset:12288
v_mfma_f32_16x16x32_bf16 v[76:79], a[12:15], a[92:95], v[76:79]
buffer_load_dwordx4 v32, s[12:15], s16 offen offset:0 lds
s_waitcnt lgkmcnt(8)
v_mfma_f32_16x16x32_bf16 v[80:83], a[16:19], a[88:91], v[80:83]
ds_read_b64_tr_b16 a[40:41], v20 offset:8192
ds_read_b64_tr_b16 a[42:43], v20 offset:12288
v_mfma_f32_16x16x32_bf16 v[84:87], a[16:19], a[92:95], v[84:87]
buffer_load_dwordx2 a[156:157], v43, s[24:27], s29 offen offset:0 sc1
v_mfma_f32_16x16x32_bf16 v[88:91], a[20:23], a[88:91], v[88:91]
ds_read_b64_tr_b16 a[44:45], v21 offset:8192
ds_read_b64_tr_b16 a[46:47], v21 offset:12288
v_mfma_f32_16x16x32_bf16 v[92:95], a[20:23], a[92:95], v[92:95]
s_waitcnt lgkmcnt(8)
v_mfma_f32_16x16x32_bf16 v[96:99], a[24:27], a[88:91], v[96:99]
ds_read_b64_tr_b16 a[48:49], v22 offset:8192
ds_read_b64_tr_b16 a[50:51], v22 offset:12288
v_mfma_f32_16x16x32_bf16 v[100:103], a[24:27], a[92:95], v[100:103]
buffer_load_dwordx4 v33, s[12:15], s16 offen offset:1024 lds
v_mfma_f32_16x16x32_bf16 v[104:107], a[28:31], a[88:91], v[104:107]
ds_read_b64_tr_b16 a[52:53], v23 offset:8192
ds_read_b64_tr_b16 a[54:55], v23 offset:12288
v_mfma_f32_16x16x32_bf16 v[108:111], a[28:31], a[92:95], v[108:111]
s_waitcnt lgkmcnt(8)
v_mfma_f32_16x16x32_bf16 v[48:51], a[32:35], a[96:99], v[48:51]
ds_read_b64_tr_b16 a[56:57], v24 offset:8192
ds_read_b64_tr_b16 a[58:59], v24 offset:12288
v_mfma_f32_16x16x32_bf16 v[52:55], a[32:35], a[100:103], v[52:55]
buffer_load_dwordx2 a[158:159], v43, s[24:27], s29 offen offset:512 sc1
v_mfma_f32_16x16x32_bf16 v[56:59], a[36:39], a[96:99], v[56:59]
ds_read_b64_tr_b16 a[60:61], v25 offset:8192
ds_read_b64_tr_b16 a[62:63], v25 offset:12288
v_mfma_f32_16x16x32_bf16 v[60:63], a[36:39], a[100:103], v[60:63]
buffer_load_dwordx4 v34, s[12:15], s16 offen offset:2048 lds
s_waitcnt vmcnt(24)
s_barrier
s_waitcnt lgkmcnt(8)
v_mfma_f32_16x16x32_bf16 v[64:67], a[40:43], a[96:99], v[64:67]
ds_read_b64_tr_b16 a[0:1], v18 offset:16384
ds_read_b64_tr_b16 a[2:3], v18 offset:20480
v_mfma_f32_16x16x32_bf16 v[68:71], a[40:43], a[100:103], v[68:71]
v_mfma_f32_16x16x32_bf16 v[72:75], a[44:47], a[96:99], v[72:75]
ds_read_b64_tr_b16 a[4:5], v19 offset:16384
ds_read_b64_tr_b16 a[6:7], v19 offset:20480
v_mfma_f32_16x16x32_bf16 v[76:79], a[44:47], a[100:103], v[76:79]
buffer_load_dwordx4 a[160:163], v6, s[24:27], s29 offen offset:1024 sc1
s_waitcnt lgkmcnt(8)
v_mfma_f32_16x16x32_bf16 v[80:83], a[48:51], a[96:99], v[80:83]
ds_read_b64_tr_b16 a[8:9], v20 offset:16384
ds_read_b64_tr_b16 a[10:11], v20 offset:20480
v_mfma_f32_16x16x32_bf16 v[84:87], a[48:51], a[100:103], v[84:87]
buffer_load_dwordx4 v35, s[12:15], s16 offen offset:3072 lds
v_mfma_f32_16x16x32_bf16 v[88:91], a[52:55], a[96:99], v[88:91]
ds_read_b64_tr_b16 a[12:13], v21 offset:16384
ds_read_b64_tr_b16 a[14:15], v21 offset:20480
v_mfma_f32_16x16x32_bf16 v[92:95], a[52:55], a[100:103], v[92:95]
s_waitcnt lgkmcnt(8)
v_mfma_f32_16x16x32_bf16 v[96:99], a[56:59], a[96:99], v[96:99]
ds_read_b64_tr_b16 a[16:17], v22 offset:16384
ds_read_b64_tr_b16 a[18:19], v22 offset:20480
v_mfma_f32_16x16x32_bf16 v[100:103], a[56:59], a[100:103], v[100:103]
buffer_load_dwordx4 a[164:167], v7, s[24:27], s29 offen offset:1024 sc1
v_mfma_f32_16x16x32_bf16 v[104:107], a[60:63], a[96:99], v[104:107]
ds_read_b64_tr_b16 a[20:21], v23 offset:16384
ds_read_b64_tr_b16 a[22:23], v23 offset:20480
v_mfma_f32_16x16x32_bf16 v[108:111], a[60:63], a[100:103], v[108:111]
s_add_u32 s29, s29, 2048
s_add_u32 s16, s16, s18
s_waitcnt lgkmcnt(8)
v_mfma_f32_16x16x32_bf16 v[48:51], a[0:3], a[104:107], v[48:51]
ds_read_b64_tr_b16 a[24:25], v24 offset:16384
ds_read_b64_tr_b16 a[26:27], v24 offset:20480
v_mfma_f32_16x16x32_bf16 v[52:55], a[0:3], a[108:111], v[52:55]
buffer_load_dwordx4 a[168:171], v6, s[24:27], s29 offen sc1
v_mfma_f32_16x16x32_bf16 v[56:59], a[4:7], a[104:107], v[56:59]
ds_read_b64_tr_b16 a[28:29], v25 offset:16384
ds_read_b64_tr_b16 a[30:31], v25 offset:20480
s_add_u32 m0, s17, 49152
v_mfma_f32_16x16x32_bf16 v[60:63], a[4:7], a[108:111], v[60:63]
s_waitcnt lgkmcnt(8)
v_mfma_f32_16x16x32_bf16 v[64:67], a[8:11], a[104:107], v[64:67]
ds_read_b64_tr_b16 a[32:33], v18 offset:24576
ds_read_b64_tr_b16 a[34:35], v18 offset:28672
v_mfma_f32_16x16x32_bf16 v[68:71], a[8:11], a[108:111], v[68:71]
buffer_load_dwordx4 v32, s[12:15], s16 offen offset:0 lds
v_mfma_f32_16x16x32_bf16 v[72:75], a[12:15], a[104:107], v[72:75]
ds_read_b64_tr_b16 a[36:37], v19 offset:24576
ds_read_b64_tr_b16 a[38:39], v19 offset:28672
v_mfma_f32_16x16x32_bf16 v[76:79], a[12:15], a[108:111], v[76:79]
s_waitcnt lgkmcnt(8)
v_mfma_f32_16x16x32_bf16 v[80:83], a[16:19], a[104:107], v[80:83]
ds_read_b64_tr_b16 a[40:41], v20 offset:24576
ds_read_b64_tr_b16 a[42:43], v20 offset:28672
v_mfma_f32_16x16x32_bf16 v[84:87], a[16:19], a[108:111], v[84:87]
buffer_load_dwordx4 a[172:175], v7, s[24:27], s29 offen sc1
v_mfma_f32_16x16x32_bf16 v[88:91], a[20:23], a[104:107], v[88:91]
ds_read_b64_tr_b16 a[44:45], v21 offset:24576
ds_read_b64_tr_b16 a[46:47], v21 offset:28672
v_mfma_f32_16x16x32_bf16 v[92:95], a[20:23], a[108:111], v[92:95]
s_waitcnt lgkmcnt(8)
v_mfma_f32_16x16x32_bf16 v[96:99], a[24:27], a[104:107], v[96:99]
ds_read_b64_tr_b16 a[48:49], v22 offset:24576
ds_read_b64_tr_b16 a[50:51], v22 offset:28672
v_mfma_f32_16x16x32_bf16 v[100:103], a[24:27], a[108:111], v[100:103]
buffer_load_dwordx4 v33, s[12:15], s16 offen offset:1024 lds
v_mfma_f32_16x16x32_bf16 v[104:107], a[28:31], a[104:107], v[104:107]
ds_read_b64_tr_b16 a[52:53], v23 offset:24576
ds_read_b64_tr_b16 a[54:55], v23 offset:28672
v_mfma_f32_16x16x32_bf16 v[108:111], a[28:31], a[108:111], v[108:111]
s_waitcnt lgkmcnt(8)
v_mfma_f32_16x16x32_bf16 v[48:51], a[32:35], a[112:115], v[48:51]
ds_read_b64_tr_b16 a[56:57], v24 offset:24576
ds_read_b64_tr_b16 a[58:59], v24 offset:28672
v_mfma_f32_16x16x32_bf16 v[52:55], a[32:35], a[116:119], v[52:55]
buffer_load_dwordx4 a[176:179], v6, s[24:27], s29 offen offset:1024 sc1
v_mfma_f32_16x16x32_bf16 v[56:59], a[36:39], a[112:115], v[56:59]
ds_read_b64_tr_b16 a[60:61], v25 offset:24576
ds_read_b64_tr_b16 a[62:63], v25 offset:28672
v_mfma_f32_16x16x32_bf16 v[60:63], a[36:39], a[116:119], v[60:63]
s_waitcnt vmcnt(24)
s_barrier
s_waitcnt lgkmcnt(8)
v_mfma_f32_16x16x32_bf16 v[64:67], a[40:43], a[112:115], v[64:67]
ds_read_b64_tr_b16 a[0:1], v18 offset:32768
ds_read_b64_tr_b16 a[2:3], v18 offset:36864
v_mfma_f32_16x16x32_bf16 v[68:71], a[40:43], a[116:119], v[68:71]
buffer_load_dwordx4 v34, s[12:15], s16 offen offset:2048 lds
v_mfma_f32_16x16x32_bf16 v[72:75], a[44:47], a[112:115], v[72:75]
ds_read_b64_tr_b16 a[4:5], v19 offset:32768
ds_read_b64_tr_b16 a[6:7], v19 offset:36864
v_mfma_f32_16x16x32_bf16 v[76:79], a[44:47], a[116:119], v[76:79]
s_mul_i32 s39, s5, 128
s_add_u32 s39, s39, 39848960
s_add_u32 s39, s39, 4
v_mov_b32 v40, s39
buffer_load_dword v41, v40, s[24:27], 0 offen sc1
s_waitcnt lgkmcnt(8)
v_mfma_f32_16x16x32_bf16 v[80:83], a[48:51], a[112:115], v[80:83]
ds_read_b64_tr_b16 a[8:9], v20 offset:32768
ds_read_b64_tr_b16 a[10:11], v20 offset:36864
v_mfma_f32_16x16x32_bf16 v[84:87], a[48:51], a[116:119], v[84:87]
buffer_load_dwordx4 a[180:183], v7, s[24:27], s29 offen offset:1024 sc1
v_mfma_f32_16x16x32_bf16 v[88:91], a[52:55], a[112:115], v[88:91]
ds_read_b64_tr_b16 a[12:13], v21 offset:32768
ds_read_b64_tr_b16 a[14:15], v21 offset:36864
v_mfma_f32_16x16x32_bf16 v[92:95], a[52:55], a[116:119], v[92:95]
s_waitcnt lgkmcnt(8)
v_mfma_f32_16x16x32_bf16 v[96:99], a[56:59], a[112:115], v[96:99]
ds_read_b64_tr_b16 a[16:17], v22 offset:32768
ds_read_b64_tr_b16 a[18:19], v22 offset:36864
v_mfma_f32_16x16x32_bf16 v[100:103], a[56:59], a[116:119], v[100:103]
buffer_load_dwordx4 v35, s[12:15], s16 offen offset:3072 lds
v_mfma_f32_16x16x32_bf16 v[104:107], a[60:63], a[112:115], v[104:107]
ds_read_b64_tr_b16 a[20:21], v23 offset:32768
ds_read_b64_tr_b16 a[22:23], v23 offset:36864
v_mfma_f32_16x16x32_bf16 v[108:111], a[60:63], a[116:119], v[108:111]
s_add_u32 s29, s29, 2048
s_add_u32 s16, s16, s18
s_waitcnt lgkmcnt(8)
v_mfma_f32_16x16x32_bf16 v[48:51], a[0:3], a[120:123], v[48:51]
ds_read_b64_tr_b16 a[24:25], v24 offset:32768
ds_read_b64_tr_b16 a[26:27], v24 offset:36864
v_mfma_f32_16x16x32_bf16 v[52:55], a[0:3], a[124:127], v[52:55]
buffer_load_dwordx4 a[72:75], v6, s[24:27], s29 offen sc1
v_mfma_f32_16x16x32_bf16 v[56:59], a[4:7], a[120:123], v[56:59]
ds_read_b64_tr_b16 a[28:29], v25 offset:32768
ds_read_b64_tr_b16 a[30:31], v25 offset:36864
s_add_u32 m0, s17, 65536
v_mfma_f32_16x16x32_bf16 v[60:63], a[4:7], a[124:127], v[60:63]
s_waitcnt lgkmcnt(8)
v_mfma_f32_16x16x32_bf16 v[64:67], a[8:11], a[120:123], v[64:67]
ds_read_b64_tr_b16 a[32:33], v18 offset:40960
ds_read_b64_tr_b16 a[34:35], v18 offset:45056
v_mfma_f32_16x16x32_bf16 v[68:71], a[8:11], a[124:127], v[68:71]
buffer_load_dwordx4 v32, s[12:15], s16 offen offset:0 lds
v_mfma_f32_16x16x32_bf16 v[72:75], a[12:15], a[120:123], v[72:75]
ds_read_b64_tr_b16 a[36:37], v19 offset:40960
ds_read_b64_tr_b16 a[38:39], v19 offset:45056
v_mfma_f32_16x16x32_bf16 v[76:79], a[12:15], a[124:127], v[76:79]
s_waitcnt lgkmcnt(8)
v_mfma_f32_16x16x32_bf16 v[80:83], a[16:19], a[120:123], v[80:83]
ds_read_b64_tr_b16 a[40:41], v20 offset:40960
ds_read_b64_tr_b16 a[42:43], v20 offset:45056
v_mfma_f32_16x16x32_bf16 v[84:87], a[16:19], a[124:127], v[84:87]
buffer_load_dwordx4 a[76:79], v7, s[24:27], s29 offen sc1
v_mfma_f32_16x16x32_bf16 v[88:91], a[20:23], a[120:123], v[88:91]
ds_read_b64_tr_b16 a[44:45], v21 offset:40960
ds_read_b64_tr_b16 a[46:47], v21 offset:45056
v_mfma_f32_16x16x32_bf16 v[92:95], a[20:23], a[124:127], v[92:95]
s_waitcnt lgkmcnt(8)
v_mfma_f32_16x16x32_bf16 v[96:99], a[24:27], a[120:123], v[96:99]
ds_read_b64_tr_b16 a[48:49], v22 offset:40960
ds_read_b64_tr_b16 a[50:51], v22 offset:45056
v_mfma_f32_16x16x32_bf16 v[100:103], a[24:27], a[124:127], v[100:103]
buffer_load_dwordx4 v33, s[12:15], s16 offen offset:1024 lds
v_mfma_f32_16x16x32_bf16 v[104:107], a[28:31], a[120:123], v[104:107]
ds_read_b64_tr_b16 a[52:53], v23 offset:40960
ds_read_b64_tr_b16 a[54:55], v23 offset:45056
v_mfma_f32_16x16x32_bf16 v[108:111], a[28:31], a[124:127], v[108:111]
s_waitcnt lgkmcnt(8)
v_mfma_f32_16x16x32_bf16 v[48:51], a[32:35], a[128:131], v[48:51]
ds_read_b64_tr_b16 a[56:57], v24 offset:40960
ds_read_b64_tr_b16 a[58:59], v24 offset:45056
v_mfma_f32_16x16x32_bf16 v[52:55], a[32:35], a[132:135], v[52:55]
buffer_load_dwordx4 a[80:83], v6, s[24:27], s29 offen offset:1024 sc1
v_mfma_f32_16x16x32_bf16 v[56:59], a[36:39], a[128:131], v[56:59]
ds_read_b64_tr_b16 a[60:61], v25 offset:40960
ds_read_b64_tr_b16 a[62:63], v25 offset:45056
v_mfma_f32_16x16x32_bf16 v[60:63], a[36:39], a[132:135], v[60:63]
s_waitcnt vmcnt(25)
s_barrier
s_waitcnt lgkmcnt(8)
v_mfma_f32_16x16x32_bf16 v[64:67], a[40:43], a[128:131], v[64:67]
ds_read_b64_tr_b16 a[0:1], v10 offset:0
ds_read_b64_tr_b16 a[2:3], v10 offset:4096
v_mfma_f32_16x16x32_bf16 v[68:71], a[40:43], a[132:135], v[68:71]
buffer_load_dwordx4 v34, s[12:15], s16 offen offset:2048 lds
v_mfma_f32_16x16x32_bf16 v[72:75], a[44:47], a[128:131], v[72:75]
ds_read_b64_tr_b16 a[4:5], v11 offset:0
ds_read_b64_tr_b16 a[6:7], v11 offset:4096
v_mfma_f32_16x16x32_bf16 v[76:79], a[44:47], a[132:135], v[76:79]
s_waitcnt lgkmcnt(8)
v_mfma_f32_16x16x32_bf16 v[80:83], a[48:51], a[128:131], v[80:83]
ds_read_b64_tr_b16 a[8:9], v12 offset:0
ds_read_b64_tr_b16 a[10:11], v12 offset:4096
v_mfma_f32_16x16x32_bf16 v[84:87], a[48:51], a[132:135], v[84:87]
buffer_load_dwordx4 a[84:87], v7, s[24:27], s29 offen offset:1024 sc1
v_mfma_f32_16x16x32_bf16 v[88:91], a[52:55], a[128:131], v[88:91]
ds_read_b64_tr_b16 a[12:13], v13 offset:0
ds_read_b64_tr_b16 a[14:15], v13 offset:4096
v_mfma_f32_16x16x32_bf16 v[92:95], a[52:55], a[132:135], v[92:95]
s_waitcnt lgkmcnt(8)
v_mfma_f32_16x16x32_bf16 v[96:99], a[56:59], a[128:131], v[96:99]
ds_read_b64_tr_b16 a[16:17], v14 offset:0
ds_read_b64_tr_b16 a[18:19], v14 offset:4096
v_mfma_f32_16x16x32_bf16 v[100:103], a[56:59], a[132:135], v[100:103]
buffer_load_dwordx4 v35, s[12:15], s16 offen offset:3072 lds
v_mfma_f32_16x16x32_bf16 v[104:107], a[60:63], a[128:131], v[104:107]
ds_read_b64_tr_b16 a[20:21], v15 offset:0
ds_read_b64_tr_b16 a[22:23], v15 offset:4096
v_mfma_f32_16x16x32_bf16 v[108:111], a[60:63], a[132:135], v[108:111]
s_add_u32 s29, s29, 2048
s_add_u32 s16, s16, s18
s_waitcnt lgkmcnt(8)
v_mfma_f32_16x16x32_bf16 v[48:51], a[0:3], a[136:139], v[48:51]
ds_read_b64_tr_b16 a[24:25], v16 offset:0
ds_read_b64_tr_b16 a[26:27], v16 offset:4096
v_mfma_f32_16x16x32_bf16 v[52:55], a[0:3], a[140:143], v[52:55]
buffer_load_dwordx4 a[88:91], v6, s[24:27], s29 offen sc1
v_mfma_f32_16x16x32_bf16 v[56:59], a[4:7], a[136:139], v[56:59]
ds_read_b64_tr_b16 a[28:29], v17 offset:0
ds_read_b64_tr_b16 a[30:31], v17 offset:4096
v_mfma_f32_16x16x32_bf16 v[60:63], a[4:7], a[140:143], v[60:63]
buffer_load_dwordx4 a[92:95], v7, s[24:27], s29 offen sc1
s_waitcnt lgkmcnt(8)
v_mfma_f32_16x16x32_bf16 v[64:67], a[8:11], a[136:139], v[64:67]
ds_read_b64_tr_b16 a[32:33], v10 offset:8192
ds_read_b64_tr_b16 a[34:35], v10 offset:12288
s_add_u32 m0, s17, 81920
v_mfma_f32_16x16x32_bf16 v[68:71], a[8:11], a[140:143], v[68:71]
v_mfma_f32_16x16x32_bf16 v[72:75], a[12:15], a[136:139], v[72:75]
ds_read_b64_tr_b16 a[36:37], v11 offset:8192
ds_read_b64_tr_b16 a[38:39], v11 offset:12288
v_mfma_f32_16x16x32_bf16 v[76:79], a[12:15], a[140:143], v[76:79]
buffer_load_dwordx4 v32, s[12:15], s16 offen offset:0 lds
s_waitcnt lgkmcnt(8)
v_mfma_f32_16x16x32_bf16 v[80:83], a[16:19], a[136:139], v[80:83]
ds_read_b64_tr_b16 a[40:41], v12 offset:8192
ds_read_b64_tr_b16 a[42:43], v12 offset:12288
v_mfma_f32_16x16x32_bf16 v[84:87], a[16:19], a[140:143], v[84:87]
buffer_load_dwordx2 a[96:97], v42, s[24:27], s29 offen offset:1024 sc1
v_mfma_f32_16x16x32_bf16 v[88:91], a[20:23], a[136:139], v[88:91]
ds_read_b64_tr_b16 a[44:45], v13 offset:8192
ds_read_b64_tr_b16 a[46:47], v13 offset:12288
v_mfma_f32_16x16x32_bf16 v[92:95], a[20:23], a[140:143], v[92:95]
s_waitcnt lgkmcnt(8)
v_mfma_f32_16x16x32_bf16 v[96:99], a[24:27], a[136:139], v[96:99]
ds_read_b64_tr_b16 a[48:49], v14 offset:8192
ds_read_b64_tr_b16 a[50:51], v14 offset:12288
v_mfma_f32_16x16x32_bf16 v[100:103], a[24:27], a[140:143], v[100:103]
buffer_load_dwordx4 v33, s[12:15], s16 offen offset:1024 lds
v_mfma_f32_16x16x32_bf16 v[104:107], a[28:31], a[136:139], v[104:107]
ds_read_b64_tr_b16 a[52:53], v15 offset:8192
ds_read_b64_tr_b16 a[54:55], v15 offset:12288
v_mfma_f32_16x16x32_bf16 v[108:111], a[28:31], a[140:143], v[108:111]
s_waitcnt lgkmcnt(8)
v_mfma_f32_16x16x32_bf16 v[48:51], a[32:35], a[144:147], v[48:51]
ds_read_b64_tr_b16 a[56:57], v16 offset:8192
ds_read_b64_tr_b16 a[58:59], v16 offset:12288
v_mfma_f32_16x16x32_bf16 v[52:55], a[32:35], a[148:151], v[52:55]
buffer_load_dwordx2 a[98:99], v42, s[24:27], s29 offen offset:1536 sc1
v_mfma_f32_16x16x32_bf16 v[56:59], a[36:39], a[144:147], v[56:59]
ds_read_b64_tr_b16 a[60:61], v17 offset:8192
ds_read_b64_tr_b16 a[62:63], v17 offset:12288
v_mfma_f32_16x16x32_bf16 v[60:63], a[36:39], a[148:151], v[60:63]
buffer_load_dwordx4 v34, s[12:15], s16 offen offset:2048 lds
s_waitcnt vmcnt(17)
s_cmp_lg_u32 s28, 0
s_cbranch_scc1 L_adone_18
v_readfirstlane_b32 s53, v41
s_nop 3
s_cmp_ge_u32 s53, 8
s_cbranch_scc1 L_adone_18
s_mov_b32 s52, 0
L_poll_19:
buffer_load_dword v41, v40, s[24:27], 0 offen sc1
s_waitcnt vmcnt(0)
v_readfirstlane_b32 s53, v41
s_add_u32 s52, s52, 1
s_nop 2
s_cmp_ge_u32 s53, 8
s_cbranch_scc1 L_adone_18
s_cmp_lt_u32 s52, 20000
s_cbranch_scc1 L_poll_19
L_adone_18:
s_barrier
s_waitcnt lgkmcnt(8)
v_mfma_f32_16x16x32_bf16 v[64:67], a[40:43], a[144:147], v[64:67]
ds_read_b64_tr_b16 a[0:1], v10 offset:16384
ds_read_b64_tr_b16 a[2:3], v10 offset:20480
v_mfma_f32_16x16x32_bf16 v[68:71], a[40:43], a[148:151], v[68:71]
v_mfma_f32_16x16x32_bf16 v[72:75], a[44:47], a[144:147], v[72:75]
ds_read_b64_tr_b16 a[4:5], v11 offset:16384
ds_read_b64_tr_b16 a[6:7], v11 offset:20480
v_mfma_f32_16x16x32_bf16 v[76:79], a[44:47], a[148:151], v[76:79]
buffer_load_dwordx2 a[100:101], v43, s[24:27], s29 offen offset:1024 sc1
s_waitcnt lgkmcnt(8)
v_mfma_f32_16x16x32_bf16 v[80:83], a[48:51], a[144:147], v[80:83]
ds_read_b64_tr_b16 a[8:9], v12 offset:16384
ds_read_b64_tr_b16 a[10:11], v12 offset:20480
v_mfma_f32_16x16x32_bf16 v[84:87], a[48:51], a[148:151], v[84:87]
buffer_load_dwordx4 v35, s[12:15], s16 offen offset:3072 lds
v_mfma_f32_16x16x32_bf16 v[88:91], a[52:55], a[144:147], v[88:91]
ds_read_b64_tr_b16 a[12:13], v13 offset:16384
ds_read_b64_tr_b16 a[14:15], v13 offset:20480
v_mfma_f32_16x16x32_bf16 v[92:95], a[52:55], a[148:151], v[92:95]
s_waitcnt lgkmcnt(8)
v_mfma_f32_16x16x32_bf16 v[96:99], a[56:59], a[144:147], v[96:99]
ds_read_b64_tr_b16 a[16:17], v14 offset:16384
ds_read_b64_tr_b16 a[18:19], v14 offset:20480
v_mfma_f32_16x16x32_bf16 v[100:103], a[56:59], a[148:151], v[100:103]
buffer_load_dwordx2 a[102:103], v43, s[24:27], s29 offen offset:1536 sc1
v_mfma_f32_16x16x32_bf16 v[104:107], a[60:63], a[144:147], v[104:107]
ds_read_b64_tr_b16 a[20:21], v15 offset:16384
ds_read_b64_tr_b16 a[22:23], v15 offset:20480
v_mfma_f32_16x16x32_bf16 v[108:111], a[60:63], a[148:151], v[108:111]
s_add_u32 s29, s29, 2048
s_add_u32 s16, s16, s18
s_add_u32 m0, s50, 0
s_nop 0
buffer_load_dwordx4 v44, s[24:27], s59 offen sc1 lds
s_waitcnt lgkmcnt(8)
v_mfma_f32_16x16x32_bf16 v[48:51], a[0:3], a[152:155], v[48:51]
ds_read_b64_tr_b16 a[24:25], v16 offset:16384
ds_read_b64_tr_b16 a[26:27], v16 offset:20480
v_mfma_f32_16x16x32_bf16 v[52:55], a[0:3], a[156:159], v[52:55]
buffer_load_dwordx4 a[104:107], v6, s[24:27], s29 offen sc1
v_mfma_f32_16x16x32_bf16 v[56:59], a[4:7], a[152:155], v[56:59]
ds_read_b64_tr_b16 a[28:29], v17 offset:16384
ds_read_b64_tr_b16 a[30:31], v17 offset:20480
s_add_u32 m0, s17, 98304
v_mfma_f32_16x16x32_bf16 v[60:63], a[4:7], a[156:159], v[60:63]
s_waitcnt lgkmcnt(8)
v_mfma_f32_16x16x32_bf16 v[64:67], a[8:11], a[152:155], v[64:67]
ds_read_b64_tr_b16 a[32:33], v10 offset:24576
ds_read_b64_tr_b16 a[34:35], v10 offset:28672
v_mfma_f32_16x16x32_bf16 v[68:71], a[8:11], a[156:159], v[68:71]
buffer_load_dwordx4 v32, s[12:15], s16 offen offset:0 lds
v_mfma_f32_16x16x32_bf16 v[72:75], a[12:15], a[152:155], v[72:75]
ds_read_b64_tr_b16 a[36:37], v11 offset:24576
ds_read_b64_tr_b16 a[38:39], v11 offset:28672
v_mfma_f32_16x16x32_bf16 v[76:79], a[12:15], a[156:159], v[76:79]
s_waitcnt lgkmcnt(8)
v_mfma_f32_16x16x32_bf16 v[80:83], a[16:19], a[152:155], v[80:83]
ds_read_b64_tr_b16 a[40:41], v12 offset:24576
ds_read_b64_tr_b16 a[42:43], v12 offset:28672
v_mfma_f32_16x16x32_bf16 v[84:87], a[16:19], a[156:159], v[84:87]
buffer_load_dwordx4 a[108:111], v7, s[24:27], s29 offen sc1
v_mfma_f32_16x16x32_bf16 v[88:91], a[20:23], a[152:155], v[88:91]
ds_read_b64_tr_b16 a[44:45], v13 offset:24576
ds_read_b64_tr_b16 a[46:47], v13 offset:28672
v_mfma_f32_16x16x32_bf16 v[92:95], a[20:23], a[156:159], v[92:95]
s_waitcnt lgkmcnt(8)
v_mfma_f32_16x16x32_bf16 v[96:99], a[24:27], a[152:155], v[96:99]
ds_read_b64_tr_b16 a[48:49], v14 offset:24576
ds_read_b64_tr_b16 a[50:51], v14 offset:28672
v_mfma_f32_16x16x32_bf16 v[100:103], a[24:27], a[156:159], v[100:103]
buffer_load_dwordx4 v33, s[12:15], s16 offen offset:1024 lds
v_mfma_f32_16x16x32_bf16 v[104:107], a[28:31], a[152:155], v[104:107]
ds_read_b64_tr_b16 a[52:53], v15 offset:24576
ds_read_b64_tr_b16 a[54:55], v15 offset:28672
v_mfma_f32_16x16x32_bf16 v[108:111], a[28:31], a[156:159], v[108:111]
s_waitcnt lgkmcnt(8)
v_mfma_f32_16x16x32_bf16 v[48:51], a[32:35], a[160:163], v[48:51]
ds_read_b64_tr_b16 a[56:57], v16 offset:24576
ds_read_b64_tr_b16 a[58:59], v16 offset:28672
v_mfma_f32_16x16x32_bf16 v[52:55], a[32:35], a[164:167], v[52:55]
buffer_load_dwordx4 a[112:115], v6, s[24:27], s29 offen offset:1024 sc1
v_mfma_f32_16x16x32_bf16 v[56:59], a[36:39], a[160:163], v[56:59]
ds_read_b64_tr_b16 a[60:61], v17 offset:24576
ds_read_b64_tr_b16 a[62:63], v17 offset:28672
v_mfma_f32_16x16x32_bf16 v[60:63], a[36:39], a[164:167], v[60:63]
s_waitcnt vmcnt(25)
s_barrier
s_waitcnt lgkmcnt(8)
v_mfma_f32_16x16x32_bf16 v[64:67], a[40:43], a[160:163], v[64:67]
ds_read_b64_tr_b16 a[0:1], v10 offset:32768
ds_read_b64_tr_b16 a[2:3], v10 offset:36864
v_mfma_f32_16x16x32_bf16 v[68:71], a[40:43], a[164:167], v[68:71]
buffer_load_dwordx4 v34, s[12:15], s16 offen offset:2048 lds
v_mfma_f32_16x16x32_bf16 v[72:75], a[44:47], a[160:163], v[72:75]
ds_read_b64_tr_b16 a[4:5], v11 offset:32768
ds_read_b64_tr_b16 a[6:7], v11 offset:36864
v_mfma_f32_16x16x32_bf16 v[76:79], a[44:47], a[164:167], v[76:79]
s_waitcnt lgkmcnt(8)
v_mfma_f32_16x16x32_bf16 v[80:83], a[48:51], a[160:163], v[80:83]
ds_read_b64_tr_b16 a[8:9], v12 offset:32768
ds_read_b64_tr_b16 a[10:11], v12 offset:36864
v_mfma_f32_16x16x32_bf16 v[84:87], a[48:51], a[164:167], v[84:87]
buffer_load_dwordx4 a[116:119], v7, s[24:27], s29 offen offset:1024 sc1
v_mfma_f32_16x16x32_bf16 v[88:91], a[52:55], a[160:163], v[88:91]
ds_read_b64_tr_b16 a[12:13], v13 offset:32768
ds_read_b64_tr_b16 a[14:15], v13 offset:36864
v_mfma_f32_16x16x32_bf16 v[92:95], a[52:55], a[164:167], v[92:95]
s_waitcnt lgkmcnt(8)
v_mfma_f32_16x16x32_bf16 v[96:99], a[56:59], a[160:163], v[96:99]
ds_read_b64_tr_b16 a[16:17], v14 offset:32768
ds_read_b64_tr_b16 a[18:19], v14 offset:36864
v_mfma_f32_16x16x32_bf16 v[100:103], a[56:59], a[164:167], v[100:103]
buffer_load_dwordx4 v35, s[12:15], s16 offen offset:3072 lds
v_mfma_f32_16x16x32_bf16 v[104:107], a[60:63], a[160:163], v[104:107]
ds_read_b64_tr_b16 a[20:21], v15 offset:32768
ds_read_b64_tr_b16 a[22:23], v15 offset:36864
v_mfma_f32_16x16x32_bf16 v[108:111], a[60:63], a[164:167], v[108:111]
s_add_u32 s29, s29, 2048
s_add_u32 s16, s16, s18
s_waitcnt lgkmcnt(8)
v_mfma_f32_16x16x32_bf16 v[48:51], a[0:3], a[168:171], v[48:51]
ds_read_b64_tr_b16 a[24:25], v16 offset:32768
ds_read_b64_tr_b16 a[26:27], v16 offset:36864
v_mfma_f32_16x16x32_bf16 v[52:55], a[0:3], a[172:175], v[52:55]
buffer_load_dwordx4 a[120:123], v6, s[24:27], s29 offen sc1
v_mfma_f32_16x16x32_bf16 v[56:59], a[4:7], a[168:171], v[56:59]
ds_read_b64_tr_b16 a[28:29], v17 offset:32768
ds_read_b64_tr_b16 a[30:31], v17 offset:36864
s_add_u32 m0, s17, 0
v_mfma_f32_16x16x32_bf16 v[60:63], a[4:7], a[172:175], v[60:63]
s_waitcnt lgkmcnt(8)
v_mfma_f32_16x16x32_bf16 v[64:67], a[8:11], a[168:171], v[64:67]
ds_read_b64_tr_b16 a[32:33], v10 offset:40960
ds_read_b64_tr_b16 a[34:35], v10 offset:45056
v_mfma_f32_16x16x32_bf16 v[68:71], a[8:11], a[172:175], v[68:71]
buffer_load_dwordx4 v32, s[12:15], s16 offen offset:0 lds
v_mfma_f32_16x16x32_bf16 v[72:75], a[12:15], a[168:171], v[72:75]
ds_read_b64_tr_b16 a[36:37], v11 offset:40960
ds_read_b64_tr_b16 a[38:39], v11 offset:45056
v_mfma_f32_16x16x32_bf16 v[76:79], a[12:15], a[172:175], v[76:79]
s_waitcnt lgkmcnt(8)
v_mfma_f32_16x16x32_bf16 v[80:83], a[16:19], a[168:171], v[80:83]
ds_read_b64_tr_b16 a[40:41], v12 offset:40960
ds_read_b64_tr_b16 a[42:43], v12 offset:45056
v_mfma_f32_16x16x32_bf16 v[84:87], a[16:19], a[172:175], v[84:87]
buffer_load_dwordx4 a[124:127], v7, s[24:27], s29 offen sc1
v_mfma_f32_16x16x32_bf16 v[88:91], a[20:23], a[168:171], v[88:91]
ds_read_b64_tr_b16 a[44:45], v13 offset:40960
ds_read_b64_tr_b16 a[46:47], v13 offset:45056
v_mfma_f32_16x16x32_bf16 v[92:95], a[20:23], a[172:175], v[92:95]
s_waitcnt lgkmcnt(8)
v_mfma_f32_16x16x32_bf16 v[96:99], a[24:27], a[168:171], v[96:99]
ds_read_b64_tr_b16 a[48:49], v14 offset:40960
ds_read_b64_tr_b16 a[50:51], v14 offset:45056
v_mfma_f32_16x16x32_bf16 v[100:103], a[24:27], a[172:175], v[100:103]
buffer_load_dwordx4 v33, s[12:15], s16 offen offset:1024 lds
v_mfma_f32_16x16x32_bf16 v[104:107], a[28:31], a[168:171], v[104:107]
ds_read_b64_tr_b16 a[52:53], v15 offset:40960
ds_read_b64_tr_b16 a[54:55], v15 offset:45056
v_mfma_f32_16x16x32_bf16 v[108:111], a[28:31], a[172:175], v[108:111]
s_waitcnt lgkmcnt(8)
v_mfma_f32_16x16x32_bf16 v[48:51], a[32:35], a[176:179], v[48:51]
ds_read_b64_tr_b16 a[56:57], v16 offset:40960
ds_read_b64_tr_b16 a[58:59], v16 offset:45056
v_mfma_f32_16x16x32_bf16 v[52:55], a[32:35], a[180:183], v[52:55]
buffer_load_dwordx4 a[128:131], v6, s[24:27], s29 offen offset:1024 sc1
v_mfma_f32_16x16x32_bf16 v[56:59], a[36:39], a[176:179], v[56:59]
ds_read_b64_tr_b16 a[60:61], v17 offset:40960
ds_read_b64_tr_b16 a[62:63], v17 offset:45056
v_mfma_f32_16x16x32_bf16 v[60:63], a[36:39], a[180:183], v[60:63]
s_waitcnt vmcnt(13)
s_barrier
s_waitcnt lgkmcnt(8)
v_mfma_f32_16x16x32_bf16 v[64:67], a[40:43], a[176:179], v[64:67]
ds_read_b64_tr_b16 a[0:1], v10 offset:49152
ds_read_b64_tr_b16 a[2:3], v10 offset:53248
v_mfma_f32_16x16x32_bf16 v[68:71], a[40:43], a[180:183], v[68:71]
buffer_load_dwordx4 v34, s[12:15], s16 offen offset:2048 lds
v_mfma_f32_16x16x32_bf16 v[72:75], a[44:47], a[176:179], v[72:75]
ds_read_b64_tr_b16 a[4:5], v11 offset:49152
ds_read_b64_tr_b16 a[6:7], v11 offset:53248
v_mfma_f32_16x16x32_bf16 v[76:79], a[44:47], a[180:183], v[76:79]
ds_read_b128 v[128:131], v44 offset:4096
ds_read_b128 v[112:115], v44 offset:0
s_waitcnt lgkmcnt(8)
v_mfma_f32_16x16x32_bf16 v[80:83], a[48:51], a[176:179], v[80:83]
ds_read_b64_tr_b16 a[8:9], v12 offset:49152
ds_read_b64_tr_b16 a[10:11], v12 offset:53248
v_mfma_f32_16x16x32_bf16 v[84:87], a[48:51], a[180:183], v[84:87]
buffer_load_dwordx4 a[132:135], v7, s[24:27], s29 offen offset:1024 sc1
ds_read_b128 v[120:123], v44 offset:2048
ds_read_b128 v[132:135], v44 offset:5120
v_mfma_f32_16x16x32_bf16 v[88:91], a[52:55], a[176:179], v[88:91]
ds_read_b64_tr_b16 a[12:13], v13 offset:49152
ds_read_b64_tr_b16 a[14:15], v13 offset:53248
v_mfma_f32_16x16x32_bf16 v[92:95], a[52:55], a[180:183], v[92:95]
ds_read_b128 v[116:119], v44 offset:1024
ds_read_b128 v[124:127], v44 offset:3072
s_waitcnt lgkmcnt(8)
v_mfma_f32_16x16x32_bf16 v[96:99], a[56:59], a[176:179], v[96:99]
ds_read_b64_tr_b16 a[16:17], v14 offset:49152
ds_read_b64_tr_b16 a[18:19], v14 offset:53248
v_mfma_f32_16x16x32_bf16 v[100:103], a[56:59], a[180:183], v[100:103]
buffer_load_dwordx4 v35, s[12:15], s16 offen offset:3072 lds
v_mfma_f32_16x16x32_bf16 v[104:107], a[60:63], a[176:179], v[104:107]
ds_read_b64_tr_b16 a[20:21], v15 offset:49152
ds_read_b64_tr_b16 a[22:23], v15 offset:53248
v_mfma_f32_16x16x32_bf16 v[108:111], a[60:63], a[180:183], v[108:111]
s_add_u32 s29, s29, 2048
s_add_u32 s16, s16, s18
s_lshl_b32 s38, s4, 4
s_lshl_b32 s39, s28, 2
s_add_u32 s38, s38, s39
s_lshl_b32 s38, s38, 5
s_add_u32 s38, s38, s5
s_lshl_b32 s38, s38, 10
s_add_u32 s38, s38, 20971520
s_waitcnt lgkmcnt(4)
v_mfma_f32_16x16x32_bf16 v[176:179], v[128:131], v[192:195], 0
v_mfma_f32_16x16x32_bf16 v[144:147], v[112:115], v[192:195], 0
v_mfma_f32_16x16x32_bf16 v[160:163], v[120:123], v[192:195], 0
v_mfma_f32_16x16x32_bf16 v[176:179], v[132:135], v[196:199], v[176:179]
v_mfma_f32_16x16x32_bf16 v[144:147], v[116:119], v[196:199], v[144:147]
v_mfma_f32_16x16x32_bf16 v[160:163], v[124:127], v[196:199], v[160:163]
v_mfma_f32_16x16x32_bf16 v[180:183], v[128:131], v[200:203], 0
v_mfma_f32_16x16x32_bf16 v[148:151], v[112:115], v[200:203], 0
s_nop 3
v_add_f32 v176, 0x358637bd, v176
v_rcp_f32 v176, v176
s_nop 0
v_mul_f32 v144, v144, v176
v_mfma_f32_16x16x32_bf16 v[164:167], v[120:123], v[200:203], 0
v_mul_f32 v145, v145, v176
v_mul_f32 v146, v146, v176
v_mul_f32 v147, v147, v176
v_mfma_f32_16x16x32_bf16 v[180:183], v[132:135], v[204:207], v[180:183]
v_mul_f32 v160, v160, v176
v_mul_f32 v161, v161, v176
v_mul_f32 v162, v162, v176
v_mfma_f32_16x16x32_bf16 v[148:151], v[116:119], v[204:207], v[148:151]
v_mul_f32 v163, v163, v176
v_cvt_pk_bf16_f32 v224, v144, v145
v_cvt_pk_bf16_f32 v225, v146, v147
v_mfma_f32_16x16x32_bf16 v[164:167], v[124:127], v[204:207], v[164:167]
v_cvt_pk_bf16_f32 v226, v160, v161
v_cvt_pk_bf16_f32 v227, v162, v163
buffer_store_dwordx4 v[224:227], v44, s[24:27], s38 offen sc1
s_add_u32 s38, s38, 32768
v_mfma_f32_16x16x32_bf16 v[184:187], v[128:131], v[208:211], 0
v_mfma_f32_16x16x32_bf16 v[152:155], v[112:115], v[208:211], 0
v_add_f32 v180, 0x358637bd, v180
v_rcp_f32 v180, v180
s_nop 0
v_mul_f32 v148, v148, v180
v_mfma_f32_16x16x32_bf16 v[168:171], v[120:123], v[208:211], 0
v_mul_f32 v149, v149, v180
v_mul_f32 v150, v150, v180
v_mul_f32 v151, v151, v180
v_mfma_f32_16x16x32_bf16 v[184:187], v[132:135], v[212:215], v[184:187]
v_mul_f32 v164, v164, v180
v_mul_f32 v165, v165, v180
v_mul_f32 v166, v166, v180
v_mfma_f32_16x16x32_bf16 v[152:155], v[116:119], v[212:215], v[152:155]
v_mul_f32 v167, v167, v180
v_cvt_pk_bf16_f32 v228, v148, v149
v_cvt_pk_bf16_f32 v229, v150, v151
v_mfma_f32_16x16x32_bf16 v[168:171], v[124:127], v[212:215], v[168:171]
v_cvt_pk_bf16_f32 v230, v164, v165
v_cvt_pk_bf16_f32 v231, v166, v167
buffer_store_dwordx4 v[228:231], v44, s[24:27], s38 offen sc1
s_add_u32 s38, s38, 32768
v_mfma_f32_16x16x32_bf16 v[188:191], v[128:131], v[216:219], 0
v_mfma_f32_16x16x32_bf16 v[156:159], v[112:115], v[216:219], 0
v_add_f32 v184, 0x358637bd, v184
v_rcp_f32 v184, v184
s_nop 0
v_mul_f32 v152, v152, v184
v_mfma_f32_16x16x32_bf16 v[172:175], v[120:123], v[216:219], 0
v_mul_f32 v153, v153, v184
v_mul_f32 v154, v154, v184
v_mul_f32 v155, v155, v184
v_mfma_f32_16x16x32_bf16 v[188:191], v[132:135], v[220:223], v[188:191]
v_mul_f32 v168, v168, v184
v_mul_f32 v169, v169, v184
v_mul_f32 v170, v170, v184
v_mfma_f32_16x16x32_bf16 v[156:159], v[116:119], v[220:223], v[156:159]
v_mul_f32 v171, v171, v184
v_cvt_pk_bf16_f32 v232, v152, v153
v_cvt_pk_bf16_f32 v233, v154, v155
v_mfma_f32_16x16x32_bf16 v[172:175], v[124:127], v[220:223], v[172:175]
v_cvt_pk_bf16_f32 v234, v168, v169
v_cvt_pk_bf16_f32 v235, v170, v171
buffer_store_dwordx4 v[232:235], v44, s[24:27], s38 offen sc1
s_add_u32 s38, s38, 32768
v_add_f32 v188, 0x358637bd, v188
v_rcp_f32 v188, v188
s_nop 0
v_mul_f32 v156, v156, v188
v_mul_f32 v157, v157, v188
v_mul_f32 v158, v158, v188
v_mul_f32 v159, v159, v188
v_mul_f32 v172, v172, v188
v_mul_f32 v173, v173, v188
v_mul_f32 v174, v174, v188
v_mul_f32 v175, v175, v188
v_cvt_pk_bf16_f32 v236, v156, v157
v_cvt_pk_bf16_f32 v237, v158, v159
v_cvt_pk_bf16_f32 v238, v172, v173
v_cvt_pk_bf16_f32 v239, v174, v175
buffer_store_dwordx4 v[236:239], v44, s[24:27], s38 offen sc1
s_waitcnt lgkmcnt(8)
v_mfma_f32_16x16x32_bf16 v[48:51], a[0:3], a[72:75], v[48:51]
ds_read_b64_tr_b16 a[24:25], v16 offset:49152
ds_read_b64_tr_b16 a[26:27], v16 offset:53248
v_mfma_f32_16x16x32_bf16 v[52:55], a[0:3], a[76:79], v[52:55]
buffer_load_dwordx4 a[136:139], v6, s[24:27], s29 offen sc1
v_mfma_f32_16x16x32_bf16 v[56:59], a[4:7], a[72:75], v[56:59]
ds_read_b64_tr_b16 a[28:29], v17 offset:49152
ds_read_b64_tr_b16 a[30:31], v17 offset:53248
s_add_u32 m0, s17, 16384
v_mfma_f32_16x16x32_bf16 v[60:63], a[4:7], a[76:79], v[60:63]
s_waitcnt lgkmcnt(8)
v_mfma_f32_16x16x32_bf16 v[64:67], a[8:11], a[72:75], v[64:67]
ds_read_b64_tr_b16 a[32:33], v10 offset:57344
ds_read_b64_tr_b16 a[34:35], v10 offset:61440
v_mfma_f32_16x16x32_bf16 v[68:71], a[8:11], a[76:79], v[68:71]
buffer_load_dwordx4 v32, s[12:15], s16 offen offset:0 lds
v_mfma_f32_16x16x32_bf16 v[72:75], a[12:15], a[72:75], v[72:75]
ds_read_b64_tr_b16 a[36:37], v11 offset:57344
ds_read_b64_tr_b16 a[38:39], v11 offset:61440
v_mfma_f32_16x16x32_bf16 v[76:79], a[12:15], a[76:79], v[76:79]
s_waitcnt lgkmcnt(8)
v_mfma_f32_16x16x32_bf16 v[80:83], a[16:19], a[72:75], v[80:83]
ds_read_b64_tr_b16 a[40:41], v12 offset:57344
ds_read_b64_tr_b16 a[42:43], v12 offset:61440
v_mfma_f32_16x16x32_bf16 v[84:87], a[16:19], a[76:79], v[84:87]
buffer_load_dwordx4 a[140:143], v7, s[24:27], s29 offen sc1
v_mfma_f32_16x16x32_bf16 v[88:91], a[20:23], a[72:75], v[88:91]
ds_read_b64_tr_b16 a[44:45], v13 offset:57344
ds_read_b64_tr_b16 a[46:47], v13 offset:61440
v_mfma_f32_16x16x32_bf16 v[92:95], a[20:23], a[76:79], v[92:95]
s_waitcnt lgkmcnt(8)
v_mfma_f32_16x16x32_bf16 v[96:99], a[24:27], a[72:75], v[96:99]
ds_read_b64_tr_b16 a[48:49], v14 offset:57344
ds_read_b64_tr_b16 a[50:51], v14 offset:61440
v_mfma_f32_16x16x32_bf16 v[100:103], a[24:27], a[76:79], v[100:103]
buffer_load_dwordx4 v33, s[12:15], s16 offen offset:1024 lds
v_mfma_f32_16x16x32_bf16 v[104:107], a[28:31], a[72:75], v[104:107]
ds_read_b64_tr_b16 a[52:53], v15 offset:57344
ds_read_b64_tr_b16 a[54:55], v15 offset:61440
v_mfma_f32_16x16x32_bf16 v[108:111], a[28:31], a[76:79], v[108:111]
s_waitcnt lgkmcnt(8)
v_mfma_f32_16x16x32_bf16 v[48:51], a[32:35], a[80:83], v[48:51]
ds_read_b64_tr_b16 a[56:57], v16 offset:57344
ds_read_b64_tr_b16 a[58:59], v16 offset:61440
v_mfma_f32_16x16x32_bf16 v[52:55], a[32:35], a[84:87], v[52:55]
buffer_load_dwordx4 a[144:147], v6, s[24:27], s29 offen offset:1024 sc1
v_mfma_f32_16x16x32_bf16 v[56:59], a[36:39], a[80:83], v[56:59]
ds_read_b64_tr_b16 a[60:61], v17 offset:57344
ds_read_b64_tr_b16 a[62:63], v17 offset:61440
v_mfma_f32_16x16x32_bf16 v[60:63], a[36:39], a[84:87], v[60:63]
s_barrier
s_waitcnt lgkmcnt(8)
v_mfma_f32_16x16x32_bf16 v[64:67], a[40:43], a[80:83], v[64:67]
ds_read_b64_tr_b16 a[0:1], v18 offset:0
ds_read_b64_tr_b16 a[2:3], v18 offset:4096
v_mfma_f32_16x16x32_bf16 v[68:71], a[40:43], a[84:87], v[68:71]
buffer_load_dwordx4 v34, s[12:15], s16 offen offset:2048 lds
v_mfma_f32_16x16x32_bf16 v[72:75], a[44:47], a[80:83], v[72:75]
ds_read_b64_tr_b16 a[4:5], v19 offset:0
ds_read_b64_tr_b16 a[6:7], v19 offset:4096
v_mfma_f32_16x16x32_bf16 v[76:79], a[44:47], a[84:87], v[76:79]
s_waitcnt lgkmcnt(8)
v_mfma_f32_16x16x32_bf16 v[80:83], a[48:51], a[80:83], v[80:83]
ds_read_b64_tr_b16 a[8:9], v20 offset:0
ds_read_b64_tr_b16 a[10:11], v20 offset:4096
v_mfma_f32_16x16x32_bf16 v[84:87], a[48:51], a[84:87], v[84:87]
buffer_load_dwordx4 a[148:151], v7, s[24:27], s29 offen offset:1024 sc1
v_mfma_f32_16x16x32_bf16 v[88:91], a[52:55], a[80:83], v[88:91]
ds_read_b64_tr_b16 a[12:13], v21 offset:0
ds_read_b64_tr_b16 a[14:15], v21 offset:4096
v_mfma_f32_16x16x32_bf16 v[92:95], a[52:55], a[84:87], v[92:95]
s_waitcnt lgkmcnt(8)
v_mfma_f32_16x16x32_bf16 v[96:99], a[56:59], a[80:83], v[96:99]
ds_read_b64_tr_b16 a[16:17], v22 offset:0
ds_read_b64_tr_b16 a[18:19], v22 offset:4096
v_mfma_f32_16x16x32_bf16 v[100:103], a[56:59], a[84:87], v[100:103]
buffer_load_dwordx4 v35, s[12:15], s16 offen offset:3072 lds
v_mfma_f32_16x16x32_bf16 v[104:107], a[60:63], a[80:83], v[104:107]
ds_read_b64_tr_b16 a[20:21], v23 offset:0
ds_read_b64_tr_b16 a[22:23], v23 offset:4096
v_mfma_f32_16x16x32_bf16 v[108:111], a[60:63], a[84:87], v[108:111]
s_add_u32 s29, s29, 2048
s_add_u32 s16, s16, s18
s_waitcnt lgkmcnt(8)
v_mfma_f32_16x16x32_bf16 v[48:51], a[0:3], a[88:91], v[48:51]
ds_read_b64_tr_b16 a[24:25], v24 offset:0
ds_read_b64_tr_b16 a[26:27], v24 offset:4096
v_mfma_f32_16x16x32_bf16 v[52:55], a[0:3], a[92:95], v[52:55]
buffer_load_dwordx2 a[152:153], v42, s[24:27], s29 offen offset:0 sc1
v_mfma_f32_16x16x32_bf16 v[56:59], a[4:7], a[88:91], v[56:59]
ds_read_b64_tr_b16 a[28:29], v25 offset:0
ds_read_b64_tr_b16 a[30:31], v25 offset:4096
v_mfma_f32_16x16x32_bf16 v[60:63], a[4:7], a[92:95], v[60:63]
buffer_load_dwordx2 a[154:155], v42, s[24:27], s29 offen offset:512 sc1
s_mov_b32 s40, s64
s_mov_b32 s41, s65
s_mov_b32 s42, 4194304
s_mov_b32 s43, 0x20000
v_lshrrev_b32 v46, 4, v1
v_and_b32 v45, 7, v1
v_xor_b32 v45, v45, v46
v_lshlrev_b32 v45, 4, v45
v_lshrrev_b32 v46, 3, v1
v_lshl_add_u32 v45, v46, 11, v45
v_xor_b32 v46, 64, v45
s_waitcnt lgkmcnt(8)
v_mfma_f32_16x16x32_bf16 v[64:67], a[8:11], a[88:91], v[64:67]
ds_read_b64_tr_b16 a[32:33], v18 offset:8192
ds_read_b64_tr_b16 a[34:35], v18 offset:12288
s_add_u32 m0, s17, 32768
v_mfma_f32_16x16x32_bf16 v[68:71], a[8:11], a[92:95], v[68:71]
v_mfma_f32_16x16x32_bf16 v[72:75], a[12:15], a[88:91], v[72:75]
ds_read_b64_tr_b16 a[36:37], v19 offset:8192
ds_read_b64_tr_b16 a[38:39], v19 offset:12288
v_mfma_f32_16x16x32_bf16 v[76:79], a[12:15], a[92:95], v[76:79]
buffer_load_dwordx4 v32, s[12:15], s16 offen offset:0 lds
s_lshl_b32 s59, s6, 2
s_add_u32 s59, s59, s28
s_lshl_b32 s59, s59, 16
s_lshl_b32 s38, s7, 1
s_add_u32 s38, s38, s54
s_lshl_b32 s38, s38, 7
s_add_u32 s59, s59, s38
s_lshl_b32 s55, s28, 12
s_add_u32 s55, s55, 16384
s_waitcnt lgkmcnt(8)
v_mfma_f32_16x16x32_bf16 v[80:83], a[16:19], a[88:91], v[80:83]
ds_read_b64_tr_b16 a[40:41], v20 offset:8192
ds_read_b64_tr_b16 a[42:43], v20 offset:12288
v_mfma_f32_16x16x32_bf16 v[84:87], a[16:19], a[92:95], v[84:87]
buffer_load_dwordx2 a[156:157], v43, s[24:27], s29 offen offset:0 sc1
v_mfma_f32_16x16x32_bf16 v[88:91], a[20:23], a[88:91], v[88:91]
ds_read_b64_tr_b16 a[44:45], v21 offset:8192
ds_read_b64_tr_b16 a[46:47], v21 offset:12288
v_mfma_f32_16x16x32_bf16 v[92:95], a[20:23], a[92:95], v[92:95]
s_waitcnt lgkmcnt(8)
v_mfma_f32_16x16x32_bf16 v[96:99], a[24:27], a[88:91], v[96:99]
ds_read_b64_tr_b16 a[48:49], v22 offset:8192
ds_read_b64_tr_b16 a[50:51], v22 offset:12288
v_mfma_f32_16x16x32_bf16 v[100:103], a[24:27], a[92:95], v[100:103]
buffer_load_dwordx4 v33, s[12:15], s16 offen offset:1024 lds
v_mfma_f32_16x16x32_bf16 v[104:107], a[28:31], a[88:91], v[104:107]
ds_read_b64_tr_b16 a[52:53], v23 offset:8192
ds_read_b64_tr_b16 a[54:55], v23 offset:12288
v_mfma_f32_16x16x32_bf16 v[108:111], a[28:31], a[92:95], v[108:111]
s_waitcnt lgkmcnt(8)
v_mfma_f32_16x16x32_bf16 v[48:51], a[32:35], a[96:99], v[48:51]
ds_read_b64_tr_b16 a[56:57], v24 offset:8192
ds_read_b64_tr_b16 a[58:59], v24 offset:12288
v_mfma_f32_16x16x32_bf16 v[52:55], a[32:35], a[100:103], v[52:55]
buffer_load_dwordx2 a[158:159], v43, s[24:27], s29 offen offset:512 sc1
v_mfma_f32_16x16x32_bf16 v[56:59], a[36:39], a[96:99], v[56:59]
ds_read_b64_tr_b16 a[60:61], v25 offset:8192
ds_read_b64_tr_b16 a[62:63], v25 offset:12288
v_mfma_f32_16x16x32_bf16 v[60:63], a[36:39], a[100:103], v[60:63]
buffer_load_dwordx4 v34, s[12:15], s16 offen offset:2048 lds
s_waitcnt vmcnt(28)
s_barrier
s_waitcnt lgkmcnt(8)
v_mfma_f32_16x16x32_bf16 v[64:67], a[40:43], a[96:99], v[64:67]
ds_read_b64_tr_b16 a[0:1], v18 offset:16384
ds_read_b64_tr_b16 a[2:3], v18 offset:20480
v_mfma_f32_16x16x32_bf16 v[68:71], a[40:43], a[100:103], v[68:71]
v_mfma_f32_16x16x32_bf16 v[72:75], a[44:47], a[96:99], v[72:75]
ds_read_b64_tr_b16 a[4:5], v19 offset:16384
ds_read_b64_tr_b16 a[6:7], v19 offset:20480
v_mfma_f32_16x16x32_bf16 v[76:79], a[44:47], a[100:103], v[76:79]
buffer_load_dwordx4 a[160:163], v6, s[24:27], s29 offen offset:1024 sc1
s_waitcnt lgkmcnt(8)
v_mfma_f32_16x16x32_bf16 v[80:83], a[48:51], a[96:99], v[80:83]
ds_read_b64_tr_b16 a[8:9], v20 offset:16384
ds_read_b64_tr_b16 a[10:11], v20 offset:20480
v_mfma_f32_16x16x32_bf16 v[84:87], a[48:51], a[100:103], v[84:87]
buffer_load_dwordx4 v35, s[12:15], s16 offen offset:3072 lds
v_mfma_f32_16x16x32_bf16 v[88:91], a[52:55], a[96:99], v[88:91]
ds_read_b64_tr_b16 a[12:13], v21 offset:16384
ds_read_b64_tr_b16 a[14:15], v21 offset:20480
v_mfma_f32_16x16x32_bf16 v[92:95], a[52:55], a[100:103], v[92:95]
s_waitcnt lgkmcnt(8)
v_mfma_f32_16x16x32_bf16 v[96:99], a[56:59], a[96:99], v[96:99]
ds_read_b64_tr_b16 a[16:17], v22 offset:16384
ds_read_b64_tr_b16 a[18:19], v22 offset:20480
v_mfma_f32_16x16x32_bf16 v[100:103], a[56:59], a[100:103], v[100:103]
buffer_load_dwordx4 a[164:167], v7, s[24:27], s29 offen offset:1024 sc1
v_mfma_f32_16x16x32_bf16 v[104:107], a[60:63], a[96:99], v[104:107]
ds_read_b64_tr_b16 a[20:21], v23 offset:16384
ds_read_b64_tr_b16 a[22:23], v23 offset:20480
v_mfma_f32_16x16x32_bf16 v[108:111], a[60:63], a[100:103], v[108:111]
s_add_u32 s29, s29, 2048
s_add_u32 s16, s16, s18
s_waitcnt lgkmcnt(8)
v_mfma_f32_16x16x32_bf16 v[48:51], a[0:3], a[104:107], v[48:51]
ds_read_b64_tr_b16 a[24:25], v24 offset:16384
ds_read_b64_tr_b16 a[26:27], v24 offset:20480
v_mfma_f32_16x16x32_bf16 v[52:55], a[0:3], a[108:111], v[52:55]
buffer_load_dwordx4 a[168:171], v6, s[24:27], s29 offen sc1
v_mfma_f32_16x16x32_bf16 v[56:59], a[4:7], a[104:107], v[56:59]
ds_read_b64_tr_b16 a[28:29], v25 offset:16384
ds_read_b64_tr_b16 a[30:31], v25 offset:20480
s_add_u32 m0, s17, 49152
v_mfma_f32_16x16x32_bf16 v[60:63], a[4:7], a[108:111], v[60:63]
s_waitcnt lgkmcnt(8)
v_mfma_f32_16x16x32_bf16 v[64:67], a[8:11], a[104:107], v[64:67]
ds_read_b64_tr_b16 a[32:33], v18 offset:24576
ds_read_b64_tr_b16 a[34:35], v18 offset:28672
v_mfma_f32_16x16x32_bf16 v[68:71], a[8:11], a[108:111], v[68:71]
buffer_load_dwordx4 v32, s[12:15], s16 offen offset:0 lds
v_mfma_f32_16x16x32_bf16 v[72:75], a[12:15], a[104:107], v[72:75]
ds_read_b64_tr_b16 a[36:37], v19 offset:24576
ds_read_b64_tr_b16 a[38:39], v19 offset:28672
v_mfma_f32_16x16x32_bf16 v[76:79], a[12:15], a[108:111], v[76:79]
s_waitcnt lgkmcnt(8)
v_mfma_f32_16x16x32_bf16 v[80:83], a[16:19], a[104:107], v[80:83]
ds_read_b64_tr_b16 a[40:41], v20 offset:24576
ds_read_b64_tr_b16 a[42:43], v20 offset:28672
v_mfma_f32_16x16x32_bf16 v[84:87], a[16:19], a[108:111], v[84:87]
buffer_load_dwordx4 a[172:175], v7, s[24:27], s29 offen sc1
v_mfma_f32_16x16x32_bf16 v[88:91], a[20:23], a[104:107], v[88:91]
ds_read_b64_tr_b16 a[44:45], v21 offset:24576
ds_read_b64_tr_b16 a[46:47], v21 offset:28672
v_mfma_f32_16x16x32_bf16 v[92:95], a[20:23], a[108:111], v[92:95]
s_waitcnt lgkmcnt(8)
v_mfma_f32_16x16x32_bf16 v[96:99], a[24:27], a[104:107], v[96:99]
ds_read_b64_tr_b16 a[48:49], v22 offset:24576
ds_read_b64_tr_b16 a[50:51], v22 offset:28672
v_mfma_f32_16x16x32_bf16 v[100:103], a[24:27], a[108:111], v[100:103]
buffer_load_dwordx4 v33, s[12:15], s16 offen offset:1024 lds
v_mfma_f32_16x16x32_bf16 v[104:107], a[28:31], a[104:107], v[104:107]
ds_read_b64_tr_b16 a[52:53], v23 offset:24576
ds_read_b64_tr_b16 a[54:55], v23 offset:28672
v_mfma_f32_16x16x32_bf16 v[108:111], a[28:31], a[108:111], v[108:111]
s_waitcnt lgkmcnt(8)
v_mfma_f32_16x16x32_bf16 v[48:51], a[32:35], a[112:115], v[48:51]
ds_read_b64_tr_b16 a[56:57], v24 offset:24576
ds_read_b64_tr_b16 a[58:59], v24 offset:28672
v_mfma_f32_16x16x32_bf16 v[52:55], a[32:35], a[116:119], v[52:55]
buffer_load_dwordx4 a[176:179], v6, s[24:27], s29 offen offset:1024 sc1
v_mfma_f32_16x16x32_bf16 v[56:59], a[36:39], a[112:115], v[56:59]
ds_read_b64_tr_b16 a[60:61], v25 offset:24576
ds_read_b64_tr_b16 a[62:63], v25 offset:28672
v_mfma_f32_16x16x32_bf16 v[60:63], a[36:39], a[116:119], v[60:63]
s_waitcnt vmcnt(23)
s_barrier
s_mul_i32 s39, s4, 128
s_add_u32 s39, s39, 39853056
s_cmp_lg_u32 s28, 0
s_cbranch_scc1 L_sig_20
v_mov_b32 v2, s39
v_mov_b32 v3, 1
s_mov_b64 exec, 1
buffer_atomic_add v3, v2, s[24:27], 0 offen sc1
s_mov_b64 exec, -1
L_sig_20:
s_waitcnt lgkmcnt(8)
v_mfma_f32_16x16x32_bf16 v[64:67], a[40:43], a[112:115], v[64:67]
ds_read_b64_tr_b16 a[0:1], v18 offset:32768
ds_read_b64_tr_b16 a[2:3], v18 offset:36864
v_mfma_f32_16x16x32_bf16 v[68:71], a[40:43], a[116:119], v[68:71]
buffer_load_dwordx4 v34, s[12:15], s16 offen offset:2048 lds
v_mfma_f32_16x16x32_bf16 v[72:75], a[44:47], a[112:115], v[72:75]
ds_read_b64_tr_b16 a[4:5], v19 offset:32768
ds_read_b64_tr_b16 a[6:7], v19 offset:36864
v_mfma_f32_16x16x32_bf16 v[76:79], a[44:47], a[116:119], v[76:79]
s_waitcnt lgkmcnt(8)
v_mfma_f32_16x16x32_bf16 v[80:83], a[48:51], a[112:115], v[80:83]
ds_read_b64_tr_b16 a[8:9], v20 offset:32768
ds_read_b64_tr_b16 a[10:11], v20 offset:36864
v_mfma_f32_16x16x32_bf16 v[84:87], a[48:51], a[116:119], v[84:87]
buffer_load_dwordx4 a[180:183], v7, s[24:27], s29 offen offset:1024 sc1
v_mfma_f32_16x16x32_bf16 v[88:91], a[52:55], a[112:115], v[88:91]
ds_read_b64_tr_b16 a[12:13], v21 offset:32768
ds_read_b64_tr_b16 a[14:15], v21 offset:36864
v_mfma_f32_16x16x32_bf16 v[92:95], a[52:55], a[116:119], v[92:95]
s_waitcnt lgkmcnt(8)
v_mfma_f32_16x16x32_bf16 v[96:99], a[56:59], a[112:115], v[96:99]
ds_read_b64_tr_b16 a[16:17], v22 offset:32768
ds_read_b64_tr_b16 a[18:19], v22 offset:36864
v_mfma_f32_16x16x32_bf16 v[100:103], a[56:59], a[116:119], v[100:103]
buffer_load_dwordx4 v35, s[12:15], s16 offen offset:3072 lds
v_mfma_f32_16x16x32_bf16 v[104:107], a[60:63], a[112:115], v[104:107]
ds_read_b64_tr_b16 a[20:21], v23 offset:32768
ds_read_b64_tr_b16 a[22:23], v23 offset:36864
v_mfma_f32_16x16x32_bf16 v[108:111], a[60:63], a[116:119], v[108:111]
s_add_u32 s29, s29, 2048
s_add_u32 s16, s16, s18
s_add_u32 m0, s55, 0
s_nop 0
buffer_load_dwordx4 v45, s[40:43], s59 offen lds
s_add_u32 s59, s59, 16384
s_waitcnt lgkmcnt(8)
v_mfma_f32_16x16x32_bf16 v[48:51], a[0:3], a[120:123], v[48:51]
ds_read_b64_tr_b16 a[24:25], v24 offset:32768
ds_read_b64_tr_b16 a[26:27], v24 offset:36864
v_mfma_f32_16x16x32_bf16 v[52:55], a[0:3], a[124:127], v[52:55]
buffer_load_dwordx4 a[72:75], v6, s[24:27], s29 offen sc1
v_mfma_f32_16x16x32_bf16 v[56:59], a[4:7], a[120:123], v[56:59]
ds_read_b64_tr_b16 a[28:29], v25 offset:32768
ds_read_b64_tr_b16 a[30:31], v25 offset:36864
s_add_u32 m0, s17, 65536
v_mfma_f32_16x16x32_bf16 v[60:63], a[4:7], a[124:127], v[60:63]
s_waitcnt lgkmcnt(8)
v_mfma_f32_16x16x32_bf16 v[64:67], a[8:11], a[120:123], v[64:67]
ds_read_b64_tr_b16 a[32:33], v18 offset:40960
ds_read_b64_tr_b16 a[34:35], v18 offset:45056
v_mfma_f32_16x16x32_bf16 v[68:71], a[8:11], a[124:127], v[68:71]
buffer_load_dwordx4 v32, s[12:15], s16 offen offset:0 lds
v_mfma_f32_16x16x32_bf16 v[72:75], a[12:15], a[120:123], v[72:75]
ds_read_b64_tr_b16 a[36:37], v19 offset:40960
ds_read_b64_tr_b16 a[38:39], v19 offset:45056
v_mfma_f32_16x16x32_bf16 v[76:79], a[12:15], a[124:127], v[76:79]
s_waitcnt lgkmcnt(8)
v_mfma_f32_16x16x32_bf16 v[80:83], a[16:19], a[120:123], v[80:83]
ds_read_b64_tr_b16 a[40:41], v20 offset:40960
ds_read_b64_tr_b16 a[42:43], v20 offset:45056
v_mfma_f32_16x16x32_bf16 v[84:87], a[16:19], a[124:127], v[84:87]
buffer_load_dwordx4 a[76:79], v7, s[24:27], s29 offen sc1
v_mfma_f32_16x16x32_bf16 v[88:91], a[20:23], a[120:123], v[88:91]
ds_read_b64_tr_b16 a[44:45], v21 offset:40960
ds_read_b64_tr_b16 a[46:47], v21 offset:45056
v_mfma_f32_16x16x32_bf16 v[92:95], a[20:23], a[124:127], v[92:95]
s_waitcnt lgkmcnt(8)
v_mfma_f32_16x16x32_bf16 v[96:99], a[24:27], a[120:123], v[96:99]
ds_read_b64_tr_b16 a[48:49], v22 offset:40960
ds_read_b64_tr_b16 a[50:51], v22 offset:45056
v_mfma_f32_16x16x32_bf16 v[100:103], a[24:27], a[124:127], v[100:103]
buffer_load_dwordx4 v33, s[12:15], s16 offen offset:1024 lds
v_mfma_f32_16x16x32_bf16 v[104:107], a[28:31], a[120:123], v[104:107]
ds_read_b64_tr_b16 a[52:53], v23 offset:40960
ds_read_b64_tr_b16 a[54:55], v23 offset:45056
v_mfma_f32_16x16x32_bf16 v[108:111], a[28:31], a[124:127], v[108:111]
s_waitcnt lgkmcnt(8)
v_mfma_f32_16x16x32_bf16 v[48:51], a[32:35], a[128:131], v[48:51]
ds_read_b64_tr_b16 a[56:57], v24 offset:40960
ds_read_b64_tr_b16 a[58:59], v24 offset:45056
v_mfma_f32_16x16x32_bf16 v[52:55], a[32:35], a[132:135], v[52:55]
buffer_load_dwordx4 a[80:83], v6, s[24:27], s29 offen offset:1024 sc1
v_mfma_f32_16x16x32_bf16 v[56:59], a[36:39], a[128:131], v[56:59]
ds_read_b64_tr_b16 a[60:61], v25 offset:40960
ds_read_b64_tr_b16 a[62:63], v25 offset:45056
v_mfma_f32_16x16x32_bf16 v[60:63], a[36:39], a[132:135], v[60:63]
s_waitcnt vmcnt(25)
s_barrier
s_waitcnt lgkmcnt(8)
v_mfma_f32_16x16x32_bf16 v[64:67], a[40:43], a[128:131], v[64:67]
ds_read_b64_tr_b16 a[0:1], v10 offset:0
ds_read_b64_tr_b16 a[2:3], v10 offset:4096
v_mfma_f32_16x16x32_bf16 v[68:71], a[40:43], a[132:135], v[68:71]
buffer_load_dwordx4 v34, s[12:15], s16 offen offset:2048 lds
v_mfma_f32_16x16x32_bf16 v[72:75], a[44:47], a[128:131], v[72:75]
ds_read_b64_tr_b16 a[4:5], v11 offset:0
ds_read_b64_tr_b16 a[6:7], v11 offset:4096
v_mfma_f32_16x16x32_bf16 v[76:79], a[44:47], a[132:135], v[76:79]
s_waitcnt lgkmcnt(8)
v_mfma_f32_16x16x32_bf16 v[80:83], a[48:51], a[128:131], v[80:83]
ds_read_b64_tr_b16 a[8:9], v12 offset:0
ds_read_b64_tr_b16 a[10:11], v12 offset:4096
v_mfma_f32_16x16x32_bf16 v[84:87], a[48:51], a[132:135], v[84:87]
buffer_load_dwordx4 a[84:87], v7, s[24:27], s29 offen offset:1024 sc1
v_mfma_f32_16x16x32_bf16 v[88:91], a[52:55], a[128:131], v[88:91]
ds_read_b64_tr_b16 a[12:13], v13 offset:0
ds_read_b64_tr_b16 a[14:15], v13 offset:4096
v_mfma_f32_16x16x32_bf16 v[92:95], a[52:55], a[132:135], v[92:95]
s_waitcnt lgkmcnt(8)
v_mfma_f32_16x16x32_bf16 v[96:99], a[56:59], a[128:131], v[96:99]
ds_read_b64_tr_b16 a[16:17], v14 offset:0
ds_read_b64_tr_b16 a[18:19], v14 offset:4096
v_mfma_f32_16x16x32_bf16 v[100:103], a[56:59], a[132:135], v[100:103]
buffer_load_dwordx4 v35, s[12:15], s16 offen offset:3072 lds
v_mfma_f32_16x16x32_bf16 v[104:107], a[60:63], a[128:131], v[104:107]
ds_read_b64_tr_b16 a[20:21], v15 offset:0
ds_read_b64_tr_b16 a[22:23], v15 offset:4096
v_mfma_f32_16x16x32_bf16 v[108:111], a[60:63], a[132:135], v[108:111]
s_add_u32 s29, s29, 2048
s_add_u32 s16, s16, s18
s_add_u32 m0, s55, 1024
s_nop 0
buffer_load_dwordx4 v46, s[40:43], s59 offen lds
s_add_u32 s59, s59, 16384
s_waitcnt lgkmcnt(8)
v_mfma_f32_16x16x32_bf16 v[48:51], a[0:3], a[136:139], v[48:51]
ds_read_b64_tr_b16 a[24:25], v16 offset:0
ds_read_b64_tr_b16 a[26:27], v16 offset:4096
v_mfma_f32_16x16x32_bf16 v[52:55], a[0:3], a[140:143], v[52:55]
buffer_load_dwordx4 a[88:91], v6, s[24:27], s29 offen sc1
v_mfma_f32_16x16x32_bf16 v[56:59], a[4:7], a[136:139], v[56:59]
ds_read_b64_tr_b16 a[28:29], v17 offset:0
ds_read_b64_tr_b16 a[30:31], v17 offset:4096
v_mfma_f32_16x16x32_bf16 v[60:63], a[4:7], a[140:143], v[60:63]
buffer_load_dwordx4 a[92:95], v7, s[24:27], s29 offen sc1
s_waitcnt lgkmcnt(8)
v_mfma_f32_16x16x32_bf16 v[64:67], a[8:11], a[136:139], v[64:67]
ds_read_b64_tr_b16 a[32:33], v10 offset:8192
ds_read_b64_tr_b16 a[34:35], v10 offset:12288
s_add_u32 m0, s17, 81920
v_mfma_f32_16x16x32_bf16 v[68:71], a[8:11], a[140:143], v[68:71]
v_mfma_f32_16x16x32_bf16 v[72:75], a[12:15], a[136:139], v[72:75]
ds_read_b64_tr_b16 a[36:37], v11 offset:8192
ds_read_b64_tr_b16 a[38:39], v11 offset:12288
v_mfma_f32_16x16x32_bf16 v[76:79], a[12:15], a[140:143], v[76:79]
buffer_load_dwordx4 v32, s[12:15], s16 offen offset:0 lds
s_waitcnt lgkmcnt(8)
v_mfma_f32_16x16x32_bf16 v[80:83], a[16:19], a[136:139], v[80:83]
ds_read_b64_tr_b16 a[40:41], v12 offset:8192
ds_read_b64_tr_b16 a[42:43], v12 offset:12288
v_mfma_f32_16x16x32_bf16 v[84:87], a[16:19], a[140:143], v[84:87]
buffer_load_dwordx2 a[96:97], v42, s[24:27], s29 offen offset:1024 sc1
v_mfma_f32_16x16x32_bf16 v[88:91], a[20:23], a[136:139], v[88:91]
ds_read_b64_tr_b16 a[44:45], v13 offset:8192
ds_read_b64_tr_b16 a[46:47], v13 offset:12288
v_mfma_f32_16x16x32_bf16 v[92:95], a[20:23], a[140:143], v[92:95]
s_waitcnt lgkmcnt(8)
v_mfma_f32_16x16x32_bf16 v[96:99], a[24:27], a[136:139], v[96:99]
ds_read_b64_tr_b16 a[48:49], v14 offset:8192
ds_read_b64_tr_b16 a[50:51], v14 offset:12288
v_mfma_f32_16x16x32_bf16 v[100:103], a[24:27], a[140:143], v[100:103]
buffer_load_dwordx4 v33, s[12:15], s16 offen offset:1024 lds
v_mfma_f32_16x16x32_bf16 v[104:107], a[28:31], a[136:139], v[104:107]
ds_read_b64_tr_b16 a[52:53], v15 offset:8192
ds_read_b64_tr_b16 a[54:55], v15 offset:12288
v_mfma_f32_16x16x32_bf16 v[108:111], a[28:31], a[140:143], v[108:111]
s_waitcnt lgkmcnt(8)
v_mfma_f32_16x16x32_bf16 v[48:51], a[32:35], a[144:147], v[48:51]
ds_read_b64_tr_b16 a[56:57], v16 offset:8192
ds_read_b64_tr_b16 a[58:59], v16 offset:12288
v_mfma_f32_16x16x32_bf16 v[52:55], a[32:35], a[148:151], v[52:55]
buffer_load_dwordx2 a[98:99], v42, s[24:27], s29 offen offset:1536 sc1
v_mfma_f32_16x16x32_bf16 v[56:59], a[36:39], a[144:147], v[56:59]
ds_read_b64_tr_b16 a[60:61], v17 offset:8192
ds_read_b64_tr_b16 a[62:63], v17 offset:12288
v_mfma_f32_16x16x32_bf16 v[60:63], a[36:39], a[148:151], v[60:63]
buffer_load_dwordx4 v34, s[12:15], s16 offen offset:2048 lds
s_waitcnt vmcnt(25)
s_barrier
s_waitcnt lgkmcnt(8)
v_mfma_f32_16x16x32_bf16 v[64:67], a[40:43], a[144:147], v[64:67]
ds_read_b64_tr_b16 a[0:1], v10 offset:16384
ds_read_b64_tr_b16 a[2:3], v10 offset:20480
v_mfma_f32_16x16x32_bf16 v[68:71], a[40:43], a[148:151], v[68:71]
v_mfma_f32_16x16x32_bf16 v[72:75], a[44:47], a[144:147], v[72:75]
ds_read_b64_tr_b16 a[4:5], v11 offset:16384
ds_read_b64_tr_b16 a[6:7], v11 offset:20480
v_mfma_f32_16x16x32_bf16 v[76:79], a[44:47], a[148:151], v[76:79]
buffer_load_dwordx2 a[100:101], v43, s[24:27], s29 offen offset:1024 sc1
s_waitcnt lgkmcnt(8)
v_mfma_f32_16x16x32_bf16 v[80:83], a[48:51], a[144:147], v[80:83]
ds_read_b64_tr_b16 a[8:9], v12 offset:16384
ds_read_b64_tr_b16 a[10:11], v12 offset:20480
v_mfma_f32_16x16x32_bf16 v[84:87], a[48:51], a[148:151], v[84:87]
buffer_load_dwordx4 v35, s[12:15], s16 offen offset:3072 lds
v_mfma_f32_16x16x32_bf16 v[88:91], a[52:55], a[144:147], v[88:91]
ds_read_b64_tr_b16 a[12:13], v13 offset:16384
ds_read_b64_tr_b16 a[14:15], v13 offset:20480
v_mfma_f32_16x16x32_bf16 v[92:95], a[52:55], a[148:151], v[92:95]
s_waitcnt lgkmcnt(8)
v_mfma_f32_16x16x32_bf16 v[96:99], a[56:59], a[144:147], v[96:99]
ds_read_b64_tr_b16 a[16:17], v14 offset:16384
ds_read_b64_tr_b16 a[18:19], v14 offset:20480
v_mfma_f32_16x16x32_bf16 v[100:103], a[56:59], a[148:151], v[100:103]
buffer_load_dwordx2 a[102:103], v43, s[24:27], s29 offen offset:1536 sc1
v_mfma_f32_16x16x32_bf16 v[104:107], a[60:63], a[144:147], v[104:107]
ds_read_b64_tr_b16 a[20:21], v15 offset:16384
ds_read_b64_tr_b16 a[22:23], v15 offset:20480
v_mfma_f32_16x16x32_bf16 v[108:111], a[60:63], a[148:151], v[108:111]
s_add_u32 s29, s29, 2048
s_add_u32 s16, s16, s18
s_add_u32 m0, s55, 2048
s_nop 0
buffer_load_dwordx4 v45, s[40:43], s59 offen lds
s_add_u32 s59, s59, 16384
s_waitcnt lgkmcnt(8)
v_mfma_f32_16x16x32_bf16 v[48:51], a[0:3], a[152:155], v[48:51]
ds_read_b64_tr_b16 a[24:25], v16 offset:16384
ds_read_b64_tr_b16 a[26:27], v16 offset:20480
v_mfma_f32_16x16x32_bf16 v[52:55], a[0:3], a[156:159], v[52:55]
buffer_load_dwordx4 a[104:107], v6, s[24:27], s29 offen sc1
v_mfma_f32_16x16x32_bf16 v[56:59], a[4:7], a[152:155], v[56:59]
ds_read_b64_tr_b16 a[28:29], v17 offset:16384
ds_read_b64_tr_b16 a[30:31], v17 offset:20480
s_add_u32 m0, s17, 98304
v_mfma_f32_16x16x32_bf16 v[60:63], a[4:7], a[156:159], v[60:63]
s_waitcnt lgkmcnt(8)
v_mfma_f32_16x16x32_bf16 v[64:67], a[8:11], a[152:155], v[64:67]
ds_read_b64_tr_b16 a[32:33], v10 offset:24576
ds_read_b64_tr_b16 a[34:35], v10 offset:28672
v_mfma_f32_16x16x32_bf16 v[68:71], a[8:11], a[156:159], v[68:71]
buffer_load_dwordx4 v32, s[12:15], s16 offen offset:0 lds
v_mfma_f32_16x16x32_bf16 v[72:75], a[12:15], a[152:155], v[72:75]
ds_read_b64_tr_b16 a[36:37], v11 offset:24576
ds_read_b64_tr_b16 a[38:39], v11 offset:28672
v_mfma_f32_16x16x32_bf16 v[76:79], a[12:15], a[156:159], v[76:79]
s_waitcnt lgkmcnt(8)
v_mfma_f32_16x16x32_bf16 v[80:83], a[16:19], a[152:155], v[80:83]
ds_read_b64_tr_b16 a[40:41], v12 offset:24576
ds_read_b64_tr_b16 a[42:43], v12 offset:28672
v_mfma_f32_16x16x32_bf16 v[84:87], a[16:19], a[156:159], v[84:87]
buffer_load_dwordx4 a[108:111], v7, s[24:27], s29 offen sc1
v_mfma_f32_16x16x32_bf16 v[88:91], a[20:23], a[152:155], v[88:91]
ds_read_b64_tr_b16 a[44:45], v13 offset:24576
ds_read_b64_tr_b16 a[46:47], v13 offset:28672
v_mfma_f32_16x16x32_bf16 v[92:95], a[20:23], a[156:159], v[92:95]
s_waitcnt lgkmcnt(8)
v_mfma_f32_16x16x32_bf16 v[96:99], a[24:27], a[152:155], v[96:99]
ds_read_b64_tr_b16 a[48:49], v14 offset:24576
ds_read_b64_tr_b16 a[50:51], v14 offset:28672
v_mfma_f32_16x16x32_bf16 v[100:103], a[24:27], a[156:159], v[100:103]
buffer_load_dwordx4 v33, s[12:15], s16 offen offset:1024 lds
v_mfma_f32_16x16x32_bf16 v[104:107], a[28:31], a[152:155], v[104:107]
ds_read_b64_tr_b16 a[52:53], v15 offset:24576
ds_read_b64_tr_b16 a[54:55], v15 offset:28672
v_mfma_f32_16x16x32_bf16 v[108:111], a[28:31], a[156:159], v[108:111]
s_waitcnt lgkmcnt(8)
v_mfma_f32_16x16x32_bf16 v[48:51], a[32:35], a[160:163], v[48:51]
ds_read_b64_tr_b16 a[56:57], v16 offset:24576
ds_read_b64_tr_b16 a[58:59], v16 offset:28672
v_mfma_f32_16x16x32_bf16 v[52:55], a[32:35], a[164:167], v[52:55]
buffer_load_dwordx4 a[112:115], v6, s[24:27], s29 offen offset:1024 sc1
v_mfma_f32_16x16x32_bf16 v[56:59], a[36:39], a[160:163], v[56:59]
ds_read_b64_tr_b16 a[60:61], v17 offset:24576
ds_read_b64_tr_b16 a[62:63], v17 offset:28672
v_mfma_f32_16x16x32_bf16 v[60:63], a[36:39], a[164:167], v[60:63]
s_waitcnt vmcnt(27)
s_barrier
s_waitcnt lgkmcnt(8)
v_mfma_f32_16x16x32_bf16 v[64:67], a[40:43], a[160:163], v[64:67]
ds_read_b64_tr_b16 a[0:1], v10 offset:32768
ds_read_b64_tr_b16 a[2:3], v10 offset:36864
v_mfma_f32_16x16x32_bf16 v[68:71], a[40:43], a[164:167], v[68:71]
buffer_load_dwordx4 v34, s[12:15], s16 offen offset:2048 lds
v_mfma_f32_16x16x32_bf16 v[72:75], a[44:47], a[160:163], v[72:75]
ds_read_b64_tr_b16 a[4:5], v11 offset:32768
ds_read_b64_tr_b16 a[6:7], v11 offset:36864
v_mfma_f32_16x16x32_bf16 v[76:79], a[44:47], a[164:167], v[76:79]
s_waitcnt lgkmcnt(8)
v_mfma_f32_16x16x32_bf16 v[80:83], a[48:51], a[160:163], v[80:83]
ds_read_b64_tr_b16 a[8:9], v12 offset:32768
ds_read_b64_tr_b16 a[10:11], v12 offset:36864
v_mfma_f32_16x16x32_bf16 v[84:87], a[48:51], a[164:167], v[84:87]
buffer_load_dwordx4 a[116:119], v7, s[24:27], s29 offen offset:1024 sc1
v_mfma_f32_16x16x32_bf16 v[88:91], a[52:55], a[160:163], v[88:91]
ds_read_b64_tr_b16 a[12:13], v13 offset:32768
ds_read_b64_tr_b16 a[14:15], v13 offset:36864
v_mfma_f32_16x16x32_bf16 v[92:95], a[52:55], a[164:167], v[92:95]
s_waitcnt lgkmcnt(8)
v_mfma_f32_16x16x32_bf16 v[96:99], a[56:59], a[160:163], v[96:99]
ds_read_b64_tr_b16 a[16:17], v14 offset:32768
ds_read_b64_tr_b16 a[18:19], v14 offset:36864
v_mfma_f32_16x16x32_bf16 v[100:103], a[56:59], a[164:167], v[100:103]
buffer_load_dwordx4 v35, s[12:15], s16 offen offset:3072 lds
v_mfma_f32_16x16x32_bf16 v[104:107], a[60:63], a[160:163], v[104:107]
ds_read_b64_tr_b16 a[20:21], v15 offset:32768
ds_read_b64_tr_b16 a[22:23], v15 offset:36864
v_mfma_f32_16x16x32_bf16 v[108:111], a[60:63], a[164:167], v[108:111]
s_add_u32 s29, s29, 2048
s_add_u32 s16, s16, s18
s_add_u32 m0, s55, 3072
s_nop 0
buffer_load_dwordx4 v46, s[40:43], s59 offen lds
s_add_u32 s59, s59, 16384
s_waitcnt lgkmcnt(8)
v_mfma_f32_16x16x32_bf16 v[48:51], a[0:3], a[168:171], v[48:51]
ds_read_b64_tr_b16 a[24:25], v16 offset:32768
ds_read_b64_tr_b16 a[26:27], v16 offset:36864
v_mfma_f32_16x16x32_bf16 v[52:55], a[0:3], a[172:175], v[52:55]
buffer_load_dwordx4 a[120:123], v6, s[24:27], s29 offen sc1
v_mfma_f32_16x16x32_bf16 v[56:59], a[4:7], a[168:171], v[56:59]
ds_read_b64_tr_b16 a[28:29], v17 offset:32768
ds_read_b64_tr_b16 a[30:31], v17 offset:36864
s_add_u32 m0, s17, 0
v_mfma_f32_16x16x32_bf16 v[60:63], a[4:7], a[172:175], v[60:63]
s_waitcnt lgkmcnt(8)
v_mfma_f32_16x16x32_bf16 v[64:67], a[8:11], a[168:171], v[64:67]
ds_read_b64_tr_b16 a[32:33], v10 offset:40960
ds_read_b64_tr_b16 a[34:35], v10 offset:45056
v_mfma_f32_16x16x32_bf16 v[68:71], a[8:11], a[172:175], v[68:71]
buffer_load_dwordx4 v32, s[12:15], s16 offen offset:0 lds
v_mfma_f32_16x16x32_bf16 v[72:75], a[12:15], a[168:171], v[72:75]
ds_read_b64_tr_b16 a[36:37], v11 offset:40960
ds_read_b64_tr_b16 a[38:39], v11 offset:45056
v_mfma_f32_16x16x32_bf16 v[76:79], a[12:15], a[172:175], v[76:79]
s_waitcnt lgkmcnt(8)
v_mfma_f32_16x16x32_bf16 v[80:83], a[16:19], a[168:171], v[80:83]
ds_read_b64_tr_b16 a[40:41], v12 offset:40960
ds_read_b64_tr_b16 a[42:43], v12 offset:45056
v_mfma_f32_16x16x32_bf16 v[84:87], a[16:19], a[172:175], v[84:87]
buffer_load_dwordx4 a[124:127], v7, s[24:27], s29 offen sc1
v_mfma_f32_16x16x32_bf16 v[88:91], a[20:23], a[168:171], v[88:91]
ds_read_b64_tr_b16 a[44:45], v13 offset:40960
ds_read_b64_tr_b16 a[46:47], v13 offset:45056
v_mfma_f32_16x16x32_bf16 v[92:95], a[20:23], a[172:175], v[92:95]
s_waitcnt lgkmcnt(8)
v_mfma_f32_16x16x32_bf16 v[96:99], a[24:27], a[168:171], v[96:99]
ds_read_b64_tr_b16 a[48:49], v14 offset:40960
ds_read_b64_tr_b16 a[50:51], v14 offset:45056
v_mfma_f32_16x16x32_bf16 v[100:103], a[24:27], a[172:175], v[100:103]
buffer_load_dwordx4 v33, s[12:15], s16 offen offset:1024 lds
v_mfma_f32_16x16x32_bf16 v[104:107], a[28:31], a[168:171], v[104:107]
ds_read_b64_tr_b16 a[52:53], v15 offset:40960
ds_read_b64_tr_b16 a[54:55], v15 offset:45056
v_mfma_f32_16x16x32_bf16 v[108:111], a[28:31], a[172:175], v[108:111]
s_waitcnt lgkmcnt(8)
v_mfma_f32_16x16x32_bf16 v[48:51], a[32:35], a[176:179], v[48:51]
ds_read_b64_tr_b16 a[56:57], v16 offset:40960
ds_read_b64_tr_b16 a[58:59], v16 offset:45056
v_mfma_f32_16x16x32_bf16 v[52:55], a[32:35], a[180:183], v[52:55]
buffer_load_dwordx4 a[128:131], v6, s[24:27], s29 offen offset:1024 sc1
v_mfma_f32_16x16x32_bf16 v[56:59], a[36:39], a[176:179], v[56:59]
ds_read_b64_tr_b16 a[60:61], v17 offset:40960
ds_read_b64_tr_b16 a[62:63], v17 offset:45056
v_mfma_f32_16x16x32_bf16 v[60:63], a[36:39], a[180:183], v[60:63]
s_waitcnt vmcnt(27)
s_barrier
s_waitcnt lgkmcnt(8)
v_mfma_f32_16x16x32_bf16 v[64:67], a[40:43], a[176:179], v[64:67]
ds_read_b64_tr_b16 a[0:1], v10 offset:49152
ds_read_b64_tr_b16 a[2:3], v10 offset:53248
v_mfma_f32_16x16x32_bf16 v[68:71], a[40:43], a[180:183], v[68:71]
buffer_load_dwordx4 v34, s[12:15], s16 offen offset:2048 lds
v_mfma_f32_16x16x32_bf16 v[72:75], a[44:47], a[176:179], v[72:75]
ds_read_b64_tr_b16 a[4:5], v11 offset:49152
ds_read_b64_tr_b16 a[6:7], v11 offset:53248
v_mfma_f32_16x16x32_bf16 v[76:79], a[44:47], a[180:183], v[76:79]
s_waitcnt lgkmcnt(8)
v_mfma_f32_16x16x32_bf16 v[80:83], a[48:51], a[176:179], v[80:83]
ds_read_b64_tr_b16 a[8:9], v12 offset:49152
ds_read_b64_tr_b16 a[10:11], v12 offset:53248
v_mfma_f32_16x16x32_bf16 v[84:87], a[48:51], a[180:183], v[84:87]
buffer_load_dwordx4 a[132:135], v7, s[24:27], s29 offen offset:1024 sc1
v_mfma_f32_16x16x32_bf16 v[88:91], a[52:55], a[176:179], v[88:91]
ds_read_b64_tr_b16 a[12:13], v13 offset:49152
ds_read_b64_tr_b16 a[14:15], v13 offset:53248
v_mfma_f32_16x16x32_bf16 v[92:95], a[52:55], a[180:183], v[92:95]
s_waitcnt lgkmcnt(8)
v_mfma_f32_16x16x32_bf16 v[96:99], a[56:59], a[176:179], v[96:99]
ds_read_b64_tr_b16 a[16:17], v14 offset:49152
ds_read_b64_tr_b16 a[18:19], v14 offset:53248
v_mfma_f32_16x16x32_bf16 v[100:103], a[56:59], a[180:183], v[100:103]
buffer_load_dwordx4 v35, s[12:15], s16 offen offset:3072 lds
v_mfma_f32_16x16x32_bf16 v[104:107], a[60:63], a[176:179], v[104:107]
ds_read_b64_tr_b16 a[20:21], v15 offset:49152
ds_read_b64_tr_b16 a[22:23], v15 offset:53248
v_mfma_f32_16x16x32_bf16 v[108:111], a[60:63], a[180:183], v[108:111]
s_add_u32 s29, s29, 2048
s_add_u32 s16, s16, s18
s_waitcnt lgkmcnt(8)
v_mfma_f32_16x16x32_bf16 v[48:51], a[0:3], a[72:75], v[48:51]
ds_read_b64_tr_b16 a[24:25], v16 offset:49152
ds_read_b64_tr_b16 a[26:27], v16 offset:53248
v_mfma_f32_16x16x32_bf16 v[52:55], a[0:3], a[76:79], v[52:55]
buffer_load_dwordx4 a[136:139], v6, s[24:27], s29 offen sc1
s_mul_i32 s39, s34, 128
s_add_u32 s39, s39, 39853056
v_mov_b32 v40, s39
buffer_load_dword v41, v40, s[24:27], 0 offen sc1
v_mfma_f32_16x16x32_bf16 v[56:59], a[4:7], a[72:75], v[56:59]
ds_read_b64_tr_b16 a[28:29], v17 offset:49152
ds_read_b64_tr_b16 a[30:31], v17 offset:53248
s_add_u32 m0, s17, 16384
v_mfma_f32_16x16x32_bf16 v[60:63], a[4:7], a[76:79], v[60:63]
s_waitcnt lgkmcnt(8)
v_mfma_f32_16x16x32_bf16 v[64:67], a[8:11], a[72:75], v[64:67]
ds_read_b64_tr_b16 a[32:33], v10 offset:57344
ds_read_b64_tr_b16 a[34:35], v10 offset:61440
v_mfma_f32_16x16x32_bf16 v[68:71], a[8:11], a[76:79], v[68:71]
buffer_load_dwordx4 v32, s[12:15], s16 offen offset:0 lds
v_mfma_f32_16x16x32_bf16 v[72:75], a[12:15], a[72:75], v[72:75]
ds_read_b64_tr_b16 a[36:37], v11 offset:57344
ds_read_b64_tr_b16 a[38:39], v11 offset:61440
v_mfma_f32_16x16x32_bf16 v[76:79], a[12:15], a[76:79], v[76:79]
s_waitcnt lgkmcnt(8)
v_mfma_f32_16x16x32_bf16 v[80:83], a[16:19], a[72:75], v[80:83]
ds_read_b64_tr_b16 a[40:41], v12 offset:57344
ds_read_b64_tr_b16 a[42:43], v12 offset:61440
v_mfma_f32_16x16x32_bf16 v[84:87], a[16:19], a[76:79], v[84:87]
buffer_load_dwordx4 a[140:143], v7, s[24:27], s29 offen sc1
v_mfma_f32_16x16x32_bf16 v[88:91], a[20:23], a[72:75], v[88:91]
ds_read_b64_tr_b16 a[44:45], v13 offset:57344
ds_read_b64_tr_b16 a[46:47], v13 offset:61440
v_mfma_f32_16x16x32_bf16 v[92:95], a[20:23], a[76:79], v[92:95]
s_waitcnt lgkmcnt(8)
v_mfma_f32_16x16x32_bf16 v[96:99], a[24:27], a[72:75], v[96:99]
ds_read_b64_tr_b16 a[48:49], v14 offset:57344
ds_read_b64_tr_b16 a[50:51], v14 offset:61440
v_mfma_f32_16x16x32_bf16 v[100:103], a[24:27], a[76:79], v[100:103]
buffer_load_dwordx4 v33, s[12:15], s16 offen offset:1024 lds
v_mfma_f32_16x16x32_bf16 v[104:107], a[28:31], a[72:75], v[104:107]
ds_read_b64_tr_b16 a[52:53], v15 offset:57344
ds_read_b64_tr_b16 a[54:55], v15 offset:61440
v_mfma_f32_16x16x32_bf16 v[108:111], a[28:31], a[76:79], v[108:111]
s_waitcnt lgkmcnt(8)
v_mfma_f32_16x16x32_bf16 v[48:51], a[32:35], a[80:83], v[48:51]
ds_read_b64_tr_b16 a[56:57], v16 offset:57344
ds_read_b64_tr_b16 a[58:59], v16 offset:61440
v_mfma_f32_16x16x32_bf16 v[52:55], a[32:35], a[84:87], v[52:55]
buffer_load_dwordx4 a[144:147], v6, s[24:27], s29 offen offset:1024 sc1
v_mfma_f32_16x16x32_bf16 v[56:59], a[36:39], a[80:83], v[56:59]
ds_read_b64_tr_b16 a[60:61], v17 offset:57344
ds_read_b64_tr_b16 a[62:63], v17 offset:61440
v_mfma_f32_16x16x32_bf16 v[60:63], a[36:39], a[84:87], v[60:63]
s_waitcnt vmcnt(24)
s_barrier
s_waitcnt lgkmcnt(8)
v_mfma_f32_16x16x32_bf16 v[64:67], a[40:43], a[80:83], v[64:67]
ds_read_b64_tr_b16 a[0:1], v18 offset:0
ds_read_b64_tr_b16 a[2:3], v18 offset:4096
v_mfma_f32_16x16x32_bf16 v[68:71], a[40:43], a[84:87], v[68:71]
buffer_load_dwordx4 v34, s[12:15], s16 offen offset:2048 lds
v_mfma_f32_16x16x32_bf16 v[72:75], a[44:47], a[80:83], v[72:75]
ds_read_b64_tr_b16 a[4:5], v19 offset:0
ds_read_b64_tr_b16 a[6:7], v19 offset:4096
v_mfma_f32_16x16x32_bf16 v[76:79], a[44:47], a[84:87], v[76:79]
s_waitcnt lgkmcnt(8)
v_mfma_f32_16x16x32_bf16 v[80:83], a[48:51], a[80:83], v[80:83]
ds_read_b64_tr_b16 a[8:9], v20 offset:0
ds_read_b64_tr_b16 a[10:11], v20 offset:4096
v_mfma_f32_16x16x32_bf16 v[84:87], a[48:51], a[84:87], v[84:87]
buffer_load_dwordx4 a[148:151], v7, s[24:27], s29 offen offset:1024 sc1
v_mfma_f32_16x16x32_bf16 v[88:91], a[52:55], a[80:83], v[88:91]
ds_read_b64_tr_b16 a[12:13], v21 offset:0
ds_read_b64_tr_b16 a[14:15], v21 offset:4096
v_mfma_f32_16x16x32_bf16 v[92:95], a[52:55], a[84:87], v[92:95]
s_waitcnt lgkmcnt(8)
v_mfma_f32_16x16x32_bf16 v[96:99], a[56:59], a[80:83], v[96:99]
ds_read_b64_tr_b16 a[16:17], v22 offset:0
ds_read_b64_tr_b16 a[18:19], v22 offset:4096
v_mfma_f32_16x16x32_bf16 v[100:103], a[56:59], a[84:87], v[100:103]
buffer_load_dwordx4 v35, s[12:15], s16 offen offset:3072 lds
v_mfma_f32_16x16x32_bf16 v[104:107], a[60:63], a[80:83], v[104:107]
ds_read_b64_tr_b16 a[20:21], v23 offset:0
ds_read_b64_tr_b16 a[22:23], v23 offset:4096
v_mfma_f32_16x16x32_bf16 v[108:111], a[60:63], a[84:87], v[108:111]
s_add_u32 s29, s29, 2048
s_add_u32 s16, s16, s18
s_waitcnt lgkmcnt(8)
v_mfma_f32_16x16x32_bf16 v[48:51], a[0:3], a[88:91], v[48:51]
ds_read_b64_tr_b16 a[24:25], v24 offset:0
ds_read_b64_tr_b16 a[26:27], v24 offset:4096
v_mfma_f32_16x16x32_bf16 v[52:55], a[0:3], a[92:95], v[52:55]
buffer_load_dwordx2 a[152:153], v42, s[24:27], s29 offen offset:0 sc1
v_mfma_f32_16x16x32_bf16 v[56:59], a[4:7], a[88:91], v[56:59]
ds_read_b64_tr_b16 a[28:29], v25 offset:0
ds_read_b64_tr_b16 a[30:31], v25 offset:4096
v_mfma_f32_16x16x32_bf16 v[60:63], a[4:7], a[92:95], v[60:63]
buffer_load_dwordx2 a[154:155], v42, s[24:27], s29 offen offset:512 sc1
s_waitcnt lgkmcnt(8)
v_mfma_f32_16x16x32_bf16 v[64:67], a[8:11], a[88:91], v[64:67]
ds_read_b64_tr_b16 a[32:33], v18 offset:8192
ds_read_b64_tr_b16 a[34:35], v18 offset:12288
s_add_u32 m0, s17, 32768
v_mfma_f32_16x16x32_bf16 v[68:71], a[8:11], a[92:95], v[68:71]
v_mfma_f32_16x16x32_bf16 v[72:75], a[12:15], a[88:91], v[72:75]
ds_read_b64_tr_b16 a[36:37], v19 offset:8192
ds_read_b64_tr_b16 a[38:39], v19 offset:12288
v_mfma_f32_16x16x32_bf16 v[76:79], a[12:15], a[92:95], v[76:79]
buffer_load_dwordx4 v32, s[12:15], s16 offen offset:0 lds
s_waitcnt lgkmcnt(8)
v_mfma_f32_16x16x32_bf16 v[80:83], a[16:19], a[88:91], v[80:83]
ds_read_b64_tr_b16 a[40:41], v20 offset:8192
ds_read_b64_tr_b16 a[42:43], v20 offset:12288
v_mfma_f32_16x16x32_bf16 v[84:87], a[16:19], a[92:95], v[84:87]
buffer_load_dwordx2 a[156:157], v43, s[24:27], s29 offen offset:0 sc1
v_mfma_f32_16x16x32_bf16 v[88:91], a[20:23], a[88:91], v[88:91]
ds_read_b64_tr_b16 a[44:45], v21 offset:8192
ds_read_b64_tr_b16 a[46:47], v21 offset:12288
v_mfma_f32_16x16x32_bf16 v[92:95], a[20:23], a[92:95], v[92:95]
s_waitcnt lgkmcnt(8)
v_mfma_f32_16x16x32_bf16 v[96:99], a[24:27], a[88:91], v[96:99]
ds_read_b64_tr_b16 a[48:49], v22 offset:8192
ds_read_b64_tr_b16 a[50:51], v22 offset:12288
v_mfma_f32_16x16x32_bf16 v[100:103], a[24:27], a[92:95], v[100:103]
buffer_load_dwordx4 v33, s[12:15], s16 offen offset:1024 lds
v_mfma_f32_16x16x32_bf16 v[104:107], a[28:31], a[88:91], v[104:107]
ds_read_b64_tr_b16 a[52:53], v23 offset:8192
ds_read_b64_tr_b16 a[54:55], v23 offset:12288
v_mfma_f32_16x16x32_bf16 v[108:111], a[28:31], a[92:95], v[108:111]
s_waitcnt lgkmcnt(8)
v_mfma_f32_16x16x32_bf16 v[48:51], a[32:35], a[96:99], v[48:51]
ds_read_b64_tr_b16 a[56:57], v24 offset:8192
ds_read_b64_tr_b16 a[58:59], v24 offset:12288
v_mfma_f32_16x16x32_bf16 v[52:55], a[32:35], a[100:103], v[52:55]
buffer_load_dwordx2 a[158:159], v43, s[24:27], s29 offen offset:512 sc1
v_mfma_f32_16x16x32_bf16 v[56:59], a[36:39], a[96:99], v[56:59]
ds_read_b64_tr_b16 a[60:61], v25 offset:8192
ds_read_b64_tr_b16 a[62:63], v25 offset:12288
v_mfma_f32_16x16x32_bf16 v[60:63], a[36:39], a[100:103], v[60:63]
buffer_load_dwordx4 v34, s[12:15], s16 offen offset:2048 lds
s_waitcnt vmcnt(26)
s_barrier
s_waitcnt lgkmcnt(8)
v_mfma_f32_16x16x32_bf16 v[64:67], a[40:43], a[96:99], v[64:67]
ds_read_b64_tr_b16 a[0:1], v18 offset:16384
ds_read_b64_tr_b16 a[2:3], v18 offset:20480
v_mfma_f32_16x16x32_bf16 v[68:71], a[40:43], a[100:103], v[68:71]
v_mfma_f32_16x16x32_bf16 v[72:75], a[44:47], a[96:99], v[72:75]
ds_read_b64_tr_b16 a[4:5], v19 offset:16384
ds_read_b64_tr_b16 a[6:7], v19 offset:20480
v_mfma_f32_16x16x32_bf16 v[76:79], a[44:47], a[100:103], v[76:79]
buffer_load_dwordx4 a[160:163], v6, s[24:27], s29 offen offset:1024 sc1
s_waitcnt lgkmcnt(8)
v_mfma_f32_16x16x32_bf16 v[80:83], a[48:51], a[96:99], v[80:83]
ds_read_b64_tr_b16 a[8:9], v20 offset:16384
ds_read_b64_tr_b16 a[10:11], v20 offset:20480
v_mfma_f32_16x16x32_bf16 v[84:87], a[48:51], a[100:103], v[84:87]
buffer_load_dwordx4 v35, s[12:15], s16 offen offset:3072 lds
v_mfma_f32_16x16x32_bf16 v[88:91], a[52:55], a[96:99], v[88:91]
ds_read_b64_tr_b16 a[12:13], v21 offset:16384
ds_read_b64_tr_b16 a[14:15], v21 offset:20480
v_mfma_f32_16x16x32_bf16 v[92:95], a[52:55], a[100:103], v[92:95]
s_waitcnt lgkmcnt(8)
v_mfma_f32_16x16x32_bf16 v[96:99], a[56:59], a[96:99], v[96:99]
ds_read_b64_tr_b16 a[16:17], v22 offset:16384
ds_read_b64_tr_b16 a[18:19], v22 offset:20480
v_mfma_f32_16x16x32_bf16 v[100:103], a[56:59], a[100:103], v[100:103]
buffer_load_dwordx4 a[164:167], v7, s[24:27], s29 offen offset:1024 sc1
v_mfma_f32_16x16x32_bf16 v[104:107], a[60:63], a[96:99], v[104:107]
ds_read_b64_tr_b16 a[20:21], v23 offset:16384
ds_read_b64_tr_b16 a[22:23], v23 offset:20480
v_mfma_f32_16x16x32_bf16 v[108:111], a[60:63], a[100:103], v[108:111]
s_add_u32 s29, s29, 2048
s_add_u32 s16, s16, s18
s_lshl_b32 s38, s7, 1
s_add_u32 s38, s38, s54
s_lshl_b32 s38, s38, 7
s_add_u32 s12, s70, s38
s_addc_u32 s13, s71, 0
s_sub_u32 s14, 2097152, s38
s_mov_b32 s15, 0x20000
s_lshl_b32 s16, s28, 15
s_mov_b32 s18, 131072
s_waitcnt lgkmcnt(8)
v_mfma_f32_16x16x32_bf16 v[48:51], a[0:3], a[104:107], v[48:51]
ds_read_b64_tr_b16 a[24:25], v24 offset:16384
ds_read_b64_tr_b16 a[26:27], v24 offset:20480
v_mfma_f32_16x16x32_bf16 v[52:55], a[0:3], a[108:111], v[52:55]
buffer_load_dwordx4 a[168:171], v6, s[24:27], s29 offen sc1
v_mfma_f32_16x16x32_bf16 v[56:59], a[4:7], a[104:107], v[56:59]
ds_read_b64_tr_b16 a[28:29], v25 offset:16384
ds_read_b64_tr_b16 a[30:31], v25 offset:20480
v_mfma_f32_16x16x32_bf16 v[60:63], a[4:7], a[108:111], v[60:63]
s_waitcnt lgkmcnt(8)
v_mfma_f32_16x16x32_bf16 v[64:67], a[8:11], a[104:107], v[64:67]
ds_read_b64_tr_b16 a[32:33], v18 offset:24576
ds_read_b64_tr_b16 a[34:35], v18 offset:28672
v_mfma_f32_16x16x32_bf16 v[68:71], a[8:11], a[108:111], v[68:71]
buffer_load_dwordx4 a[172:175], v7, s[24:27], s29 offen sc1
v_mfma_f32_16x16x32_bf16 v[72:75], a[12:15], a[104:107], v[72:75]
ds_read_b64_tr_b16 a[36:37], v19 offset:24576
ds_read_b64_tr_b16 a[38:39], v19 offset:28672
v_mfma_f32_16x16x32_bf16 v[76:79], a[12:15], a[108:111], v[76:79]
s_waitcnt lgkmcnt(8)
v_mfma_f32_16x16x32_bf16 v[80:83], a[16:19], a[104:107], v[80:83]
ds_read_b64_tr_b16 a[40:41], v20 offset:24576
ds_read_b64_tr_b16 a[42:43], v20 offset:28672
s_add_u32 m0, s32, 49152
v_mfma_f32_16x16x32_bf16 v[84:87], a[16:19], a[108:111], v[84:87]
v_mfma_f32_16x16x32_bf16 v[88:91], a[20:23], a[104:107], v[88:91]
ds_read_b64_tr_b16 a[44:45], v21 offset:24576
ds_read_b64_tr_b16 a[46:47], v21 offset:28672
v_mfma_f32_16x16x32_bf16 v[92:95], a[20:23], a[108:111], v[92:95]
buffer_load_dwordx4 v8, s[12:15], s16 offen offset:0 lds
s_waitcnt lgkmcnt(8)
v_mfma_f32_16x16x32_bf16 v[96:99], a[24:27], a[104:107], v[96:99]
ds_read_b64_tr_b16 a[48:49], v22 offset:24576
ds_read_b64_tr_b16 a[50:51], v22 offset:28672
v_mfma_f32_16x16x32_bf16 v[100:103], a[24:27], a[108:111], v[100:103]
v_mfma_f32_16x16x32_bf16 v[104:107], a[28:31], a[104:107], v[104:107]
ds_read_b64_tr_b16 a[52:53], v23 offset:24576
ds_read_b64_tr_b16 a[54:55], v23 offset:28672
v_mfma_f32_16x16x32_bf16 v[108:111], a[28:31], a[108:111], v[108:111]
s_waitcnt lgkmcnt(8)
v_mfma_f32_16x16x32_bf16 v[48:51], a[32:35], a[112:115], v[48:51]
ds_read_b64_tr_b16 a[56:57], v24 offset:24576
ds_read_b64_tr_b16 a[58:59], v24 offset:28672
v_mfma_f32_16x16x32_bf16 v[52:55], a[32:35], a[116:119], v[52:55]
buffer_load_dwordx4 a[176:179], v6, s[24:27], s29 offen offset:1024 sc1
v_mfma_f32_16x16x32_bf16 v[56:59], a[36:39], a[112:115], v[56:59]
ds_read_b64_tr_b16 a[60:61], v25 offset:24576
ds_read_b64_tr_b16 a[62:63], v25 offset:28672
v_mfma_f32_16x16x32_bf16 v[60:63], a[36:39], a[116:119], v[60:63]
s_waitcnt vmcnt(21)
s_cmp_lg_u32 s28, 0
s_cbranch_scc1 L_adone_21
v_readfirstlane_b32 s53, v41
s_nop 3
s_cmp_ge_u32 s53, 32
s_cbranch_scc1 L_adone_21
s_mov_b32 s52, 0
L_poll_22:
buffer_load_dword v41, v40, s[24:27], 0 offen sc1
s_waitcnt vmcnt(0)
v_readfirstlane_b32 s53, v41
s_add_u32 s52, s52, 1
s_nop 2
s_cmp_ge_u32 s53, 32
s_cbranch_scc1 L_adone_21
s_cmp_lt_u32 s52, 20000
s_cbranch_scc1 L_poll_22
L_adone_21:
s_barrier
s_waitcnt lgkmcnt(8)
v_mfma_f32_16x16x32_bf16 v[64:67], a[40:43], a[112:115], v[64:67]
ds_read_b64_tr_b16 a[0:1], v18 offset:32768
ds_read_b64_tr_b16 a[2:3], v18 offset:36864
v_mfma_f32_16x16x32_bf16 v[68:71], a[40:43], a[116:119], v[68:71]
buffer_load_dwordx4 v9, s[12:15], s16 offen offset:1024 lds
v_mfma_f32_16x16x32_bf16 v[72:75], a[44:47], a[112:115], v[72:75]
ds_read_b64_tr_b16 a[4:5], v19 offset:32768
ds_read_b64_tr_b16 a[6:7], v19 offset:36864
v_mfma_f32_16x16x32_bf16 v[76:79], a[44:47], a[116:119], v[76:79]
s_waitcnt lgkmcnt(8)
v_mfma_f32_16x16x32_bf16 v[80:83], a[48:51], a[112:115], v[80:83]
ds_read_b64_tr_b16 a[8:9], v20 offset:32768
ds_read_b64_tr_b16 a[10:11], v20 offset:36864
v_mfma_f32_16x16x32_bf16 v[84:87], a[48:51], a[116:119], v[84:87]
v_mfma_f32_16x16x32_bf16 v[88:91], a[52:55], a[112:115], v[88:91]
ds_read_b64_tr_b16 a[12:13], v21 offset:32768
ds_read_b64_tr_b16 a[14:15], v21 offset:36864
v_mfma_f32_16x16x32_bf16 v[92:95], a[52:55], a[116:119], v[92:95]
buffer_load_dwordx4 a[180:183], v7, s[24:27], s29 offen offset:1024 sc1
s_waitcnt lgkmcnt(8)
v_mfma_f32_16x16x32_bf16 v[96:99], a[56:59], a[112:115], v[96:99]
ds_read_b64_tr_b16 a[16:17], v22 offset:32768
ds_read_b64_tr_b16 a[18:19], v22 offset:36864
v_mfma_f32_16x16x32_bf16 v[100:103], a[56:59], a[116:119], v[100:103]
v_mfma_f32_16x16x32_bf16 v[104:107], a[60:63], a[112:115], v[104:107]
ds_read_b64_tr_b16 a[20:21], v23 offset:32768
ds_read_b64_tr_b16 a[22:23], v23 offset:36864
v_mfma_f32_16x16x32_bf16 v[108:111], a[60:63], a[116:119], v[108:111]
s_add_u32 s29, s29, 2048
s_add_u32 s16, s16, s18
s_mov_b32 s29, s33
v_add_u32 v7, 32768, v6
s_waitcnt lgkmcnt(8)
v_mfma_f32_16x16x32_bf16 v[48:51], a[0:3], a[120:123], v[48:51]
ds_read_b64_tr_b16 a[24:25], v24 offset:32768
ds_read_b64_tr_b16 a[26:27], v24 offset:36864
v_mfma_f32_16x16x32_bf16 v[52:55], a[0:3], a[124:127], v[52:55]
buffer_load_dwordx4 a[72:75], v6, s[24:27], s29 offen sc1
v_mfma_f32_16x16x32_bf16 v[56:59], a[4:7], a[120:123], v[56:59]
ds_read_b64_tr_b16 a[28:29], v25 offset:32768
ds_read_b64_tr_b16 a[30:31], v25 offset:36864
v_mfma_f32_16x16x32_bf16 v[60:63], a[4:7], a[124:127], v[60:63]
s_waitcnt lgkmcnt(8)
v_mfma_f32_16x16x32_bf16 v[64:67], a[8:11], a[120:123], v[64:67]
ds_read_b64_tr_b16 a[32:33], v18 offset:40960
ds_read_b64_tr_b16 a[34:35], v18 offset:45056
v_mfma_f32_16x16x32_bf16 v[68:71], a[8:11], a[124:127], v[68:71]
buffer_load_dwordx4 a[76:79], v7, s[24:27], s29 offen sc1
v_mfma_f32_16x16x32_bf16 v[72:75], a[12:15], a[120:123], v[72:75]
ds_read_b64_tr_b16 a[36:37], v19 offset:40960
ds_read_b64_tr_b16 a[38:39], v19 offset:45056
v_mfma_f32_16x16x32_bf16 v[76:79], a[12:15], a[124:127], v[76:79]
s_waitcnt lgkmcnt(8)
v_mfma_f32_16x16x32_bf16 v[80:83], a[16:19], a[120:123], v[80:83]
ds_read_b64_tr_b16 a[40:41], v20 offset:40960
ds_read_b64_tr_b16 a[42:43], v20 offset:45056
s_add_u32 m0, s32, 65536
v_mfma_f32_16x16x32_bf16 v[84:87], a[16:19], a[124:127], v[84:87]
v_mfma_f32_16x16x32_bf16 v[88:91], a[20:23], a[120:123], v[88:91]
ds_read_b64_tr_b16 a[44:45], v21 offset:40960
ds_read_b64_tr_b16 a[46:47], v21 offset:45056
v_mfma_f32_16x16x32_bf16 v[92:95], a[20:23], a[124:127], v[92:95]
buffer_load_dwordx4 v8, s[12:15], s16 offen offset:0 lds
s_waitcnt lgkmcnt(8)
v_mfma_f32_16x16x32_bf16 v[96:99], a[24:27], a[120:123], v[96:99]
ds_read_b64_tr_b16 a[48:49], v22 offset:40960
ds_read_b64_tr_b16 a[50:51], v22 offset:45056
v_mfma_f32_16x16x32_bf16 v[100:103], a[24:27], a[124:127], v[100:103]
v_mfma_f32_16x16x32_bf16 v[104:107], a[28:31], a[120:123], v[104:107]
ds_read_b64_tr_b16 a[52:53], v23 offset:40960
ds_read_b64_tr_b16 a[54:55], v23 offset:45056
v_mfma_f32_16x16x32_bf16 v[108:111], a[28:31], a[124:127], v[108:111]
s_waitcnt lgkmcnt(8)
v_mfma_f32_16x16x32_bf16 v[48:51], a[32:35], a[128:131], v[48:51]
ds_read_b64_tr_b16 a[56:57], v24 offset:40960
ds_read_b64_tr_b16 a[58:59], v24 offset:45056
v_mfma_f32_16x16x32_bf16 v[52:55], a[32:35], a[132:135], v[52:55]
buffer_load_dwordx4 a[80:83], v6, s[24:27], s29 offen offset:1024 sc1
v_mfma_f32_16x16x32_bf16 v[56:59], a[36:39], a[128:131], v[56:59]
ds_read_b64_tr_b16 a[60:61], v25 offset:40960
ds_read_b64_tr_b16 a[62:63], v25 offset:45056
v_mfma_f32_16x16x32_bf16 v[60:63], a[36:39], a[132:135], v[60:63]
s_waitcnt vmcnt(21)
s_barrier
s_waitcnt lgkmcnt(8)
v_mfma_f32_16x16x32_bf16 v[64:67], a[40:43], a[128:131], v[64:67]
ds_read_b64_tr_b16 a[0:1], v10 offset:0
ds_read_b64_tr_b16 a[2:3], v10 offset:4096
v_mfma_f32_16x16x32_bf16 v[68:71], a[40:43], a[132:135], v[68:71]
buffer_load_dwordx4 v9, s[12:15], s16 offen offset:1024 lds
v_mfma_f32_16x16x32_bf16 v[72:75], a[44:47], a[128:131], v[72:75]
ds_read_b64_tr_b16 a[4:5], v11 offset:0
ds_read_b64_tr_b16 a[6:7], v11 offset:4096
v_mfma_f32_16x16x32_bf16 v[76:79], a[44:47], a[132:135], v[76:79]
s_waitcnt lgkmcnt(8)
v_mfma_f32_16x16x32_bf16 v[80:83], a[48:51], a[128:131], v[80:83]
ds_read_b64_tr_b16 a[8:9], v12 offset:0
ds_read_b64_tr_b16 a[10:11], v12 offset:4096
v_mfma_f32_16x16x32_bf16 v[84:87], a[48:51], a[132:135], v[84:87]
v_mfma_f32_16x16x32_bf16 v[88:91], a[52:55], a[128:131], v[88:91]
ds_read_b64_tr_b16 a[12:13], v13 offset:0
ds_read_b64_tr_b16 a[14:15], v13 offset:4096
v_mfma_f32_16x16x32_bf16 v[92:95], a[52:55], a[132:135], v[92:95]
buffer_load_dwordx4 a[84:87], v7, s[24:27], s29 offen offset:1024 sc1
s_waitcnt lgkmcnt(8)
v_mfma_f32_16x16x32_bf16 v[96:99], a[56:59], a[128:131], v[96:99]
ds_read_b64_tr_b16 a[16:17], v14 offset:0
ds_read_b64_tr_b16 a[18:19], v14 offset:4096
v_mfma_f32_16x16x32_bf16 v[100:103], a[56:59], a[132:135], v[100:103]
v_mfma_f32_16x16x32_bf16 v[104:107], a[60:63], a[128:131], v[104:107]
ds_read_b64_tr_b16 a[20:21], v15 offset:0
ds_read_b64_tr_b16 a[22:23], v15 offset:4096
v_mfma_f32_16x16x32_bf16 v[108:111], a[60:63], a[132:135], v[108:111]
s_add_u32 s29, s29, 2048
s_add_u32 s16, s16, s18
s_waitcnt lgkmcnt(8)
v_mfma_f32_16x16x32_bf16 v[48:51], a[0:3], a[136:139], v[48:51]
ds_read_b64_tr_b16 a[24:25], v16 offset:0
ds_read_b64_tr_b16 a[26:27], v16 offset:4096
v_mfma_f32_16x16x32_bf16 v[52:55], a[0:3], a[140:143], v[52:55]
buffer_load_dwordx4 a[88:91], v6, s[24:27], s29 offen sc1
v_mfma_f32_16x16x32_bf16 v[56:59], a[4:7], a[136:139], v[56:59]
ds_read_b64_tr_b16 a[28:29], v17 offset:0
ds_read_b64_tr_b16 a[30:31], v17 offset:4096
v_mfma_f32_16x16x32_bf16 v[60:63], a[4:7], a[140:143], v[60:63]
s_waitcnt lgkmcnt(8)
v_mfma_f32_16x16x32_bf16 v[64:67], a[8:11], a[136:139], v[64:67]
ds_read_b64_tr_b16 a[32:33], v10 offset:8192
ds_read_b64_tr_b16 a[34:35], v10 offset:12288
v_mfma_f32_16x16x32_bf16 v[68:71], a[8:11], a[140:143], v[68:71]
buffer_load_dwordx4 a[92:95], v7, s[24:27], s29 offen sc1
v_mfma_f32_16x16x32_bf16 v[72:75], a[12:15], a[136:139], v[72:75]
ds_read_b64_tr_b16 a[36:37], v11 offset:8192
ds_read_b64_tr_b16 a[38:39], v11 offset:12288
v_mfma_f32_16x16x32_bf16 v[76:79], a[12:15], a[140:143], v[76:79]
s_waitcnt lgkmcnt(8)
v_mfma_f32_16x16x32_bf16 v[80:83], a[16:19], a[136:139], v[80:83]
ds_read_b64_tr_b16 a[40:41], v12 offset:8192
ds_read_b64_tr_b16 a[42:43], v12 offset:12288
s_add_u32 m0, s32, 81920
v_mfma_f32_16x16x32_bf16 v[84:87], a[16:19], a[140:143], v[84:87]
v_mfma_f32_16x16x32_bf16 v[88:91], a[20:23], a[136:139], v[88:91]
ds_read_b64_tr_b16 a[44:45], v13 offset:8192
ds_read_b64_tr_b16 a[46:47], v13 offset:12288
v_mfma_f32_16x16x32_bf16 v[92:95], a[20:23], a[140:143], v[92:95]
buffer_load_dwordx4 v8, s[12:15], s16 offen offset:0 lds
s_waitcnt lgkmcnt(8)
v_mfma_f32_16x16x32_bf16 v[96:99], a[24:27], a[136:139], v[96:99]
ds_read_b64_tr_b16 a[48:49], v14 offset:8192
ds_read_b64_tr_b16 a[50:51], v14 offset:12288
v_mfma_f32_16x16x32_bf16 v[100:103], a[24:27], a[140:143], v[100:103]
v_mfma_f32_16x16x32_bf16 v[104:107], a[28:31], a[136:139], v[104:107]
ds_read_b64_tr_b16 a[52:53], v15 offset:8192
ds_read_b64_tr_b16 a[54:55], v15 offset:12288
v_mfma_f32_16x16x32_bf16 v[108:111], a[28:31], a[140:143], v[108:111]
s_waitcnt lgkmcnt(8)
v_mfma_f32_16x16x32_bf16 v[48:51], a[32:35], a[144:147], v[48:51]
ds_read_b64_tr_b16 a[56:57], v16 offset:8192
ds_read_b64_tr_b16 a[58:59], v16 offset:12288
v_mfma_f32_16x16x32_bf16 v[52:55], a[32:35], a[148:151], v[52:55]
buffer_load_dwordx4 a[96:99], v6, s[24:27], s29 offen offset:1024 sc1
v_mfma_f32_16x16x32_bf16 v[56:59], a[36:39], a[144:147], v[56:59]
ds_read_b64_tr_b16 a[60:61], v17 offset:8192
ds_read_b64_tr_b16 a[62:63], v17 offset:12288
v_mfma_f32_16x16x32_bf16 v[60:63], a[36:39], a[148:151], v[60:63]
s_waitcnt vmcnt(16)
s_barrier
s_waitcnt lgkmcnt(8)
v_mfma_f32_16x16x32_bf16 v[64:67], a[40:43], a[144:147], v[64:67]
ds_read_b64_tr_b16 a[0:1], v10 offset:16384
ds_read_b64_tr_b16 a[2:3], v10 offset:20480
v_mfma_f32_16x16x32_bf16 v[68:71], a[40:43], a[148:151], v[68:71]
buffer_load_dwordx4 v9, s[12:15], s16 offen offset:1024 lds
v_mfma_f32_16x16x32_bf16 v[72:75], a[44:47], a[144:147], v[72:75]
ds_read_b64_tr_b16 a[4:5], v11 offset:16384
ds_read_b64_tr_b16 a[6:7], v11 offset:20480
v_mfma_f32_16x16x32_bf16 v[76:79], a[44:47], a[148:151], v[76:79]
s_waitcnt lgkmcnt(8)
v_mfma_f32_16x16x32_bf16 v[80:83], a[48:51], a[144:147], v[80:83]
ds_read_b64_tr_b16 a[8:9], v12 offset:16384
ds_read_b64_tr_b16 a[10:11], v12 offset:20480
v_mfma_f32_16x16x32_bf16 v[84:87], a[48:51], a[148:151], v[84:87]
v_mfma_f32_16x16x32_bf16 v[88:91], a[52:55], a[144:147], v[88:91]
ds_read_b64_tr_b16 a[12:13], v13 offset:16384
ds_read_b64_tr_b16 a[14:15], v13 offset:20480
v_mfma_f32_16x16x32_bf16 v[92:95], a[52:55], a[148:151], v[92:95]
buffer_load_dwordx4 a[100:103], v7, s[24:27], s29 offen offset:1024 sc1
s_waitcnt lgkmcnt(8)
v_mfma_f32_16x16x32_bf16 v[96:99], a[56:59], a[144:147], v[96:99]
ds_read_b64_tr_b16 a[16:17], v14 offset:16384
ds_read_b64_tr_b16 a[18:19], v14 offset:20480
v_mfma_f32_16x16x32_bf16 v[100:103], a[56:59], a[148:151], v[100:103]
v_mfma_f32_16x16x32_bf16 v[104:107], a[60:63], a[144:147], v[104:107]
ds_read_b64_tr_b16 a[20:21], v15 offset:16384
ds_read_b64_tr_b16 a[22:23], v15 offset:20480
v_mfma_f32_16x16x32_bf16 v[108:111], a[60:63], a[148:151], v[108:111]
s_add_u32 s29, s29, 2048
s_add_u32 s16, s16, s18
s_waitcnt lgkmcnt(8)
v_mfma_f32_16x16x32_bf16 v[48:51], a[0:3], a[152:155], v[48:51]
ds_read_b64_tr_b16 a[24:25], v16 offset:16384
ds_read_b64_tr_b16 a[26:27], v16 offset:20480
v_mfma_f32_16x16x32_bf16 v[52:55], a[0:3], a[156:159], v[52:55]
buffer_load_dwordx4 a[104:107], v6, s[24:27], s29 offen sc1
v_mfma_f32_16x16x32_bf16 v[56:59], a[4:7], a[152:155], v[56:59]
ds_read_b64_tr_b16 a[28:29], v17 offset:16384
ds_read_b64_tr_b16 a[30:31], v17 offset:20480
v_mfma_f32_16x16x32_bf16 v[60:63], a[4:7], a[156:159], v[60:63]
s_waitcnt lgkmcnt(8)
v_mfma_f32_16x16x32_bf16 v[64:67], a[8:11], a[152:155], v[64:67]
ds_read_b64_tr_b16 a[32:33], v10 offset:24576
ds_read_b64_tr_b16 a[34:35], v10 offset:28672
v_mfma_f32_16x16x32_bf16 v[68:71], a[8:11], a[156:159], v[68:71]
buffer_load_dwordx4 a[108:111], v7, s[24:27], s29 offen sc1
v_mfma_f32_16x16x32_bf16 v[72:75], a[12:15], a[152:155], v[72:75]
ds_read_b64_tr_b16 a[36:37], v11 offset:24576
ds_read_b64_tr_b16 a[38:39], v11 offset:28672
v_mfma_f32_16x16x32_bf16 v[76:79], a[12:15], a[156:159], v[76:79]
s_waitcnt lgkmcnt(8)
v_mfma_f32_16x16x32_bf16 v[80:83], a[16:19], a[152:155], v[80:83]
ds_read_b64_tr_b16 a[40:41], v12 offset:24576
ds_read_b64_tr_b16 a[42:43], v12 offset:28672
s_add_u32 m0, s32, 98304
v_mfma_f32_16x16x32_bf16 v[84:87], a[16:19], a[156:159], v[84:87]
v_mfma_f32_16x16x32_bf16 v[88:91], a[20:23], a[152:155], v[88:91]
ds_read_b64_tr_b16 a[44:45], v13 offset:24576
ds_read_b64_tr_b16 a[46:47], v13 offset:28672
v_mfma_f32_16x16x32_bf16 v[92:95], a[20:23], a[156:159], v[92:95]
buffer_load_dwordx4 v8, s[12:15], s16 offen offset:0 lds
s_waitcnt lgkmcnt(8)
v_mfma_f32_16x16x32_bf16 v[96:99], a[24:27], a[152:155], v[96:99]
ds_read_b64_tr_b16 a[48:49], v14 offset:24576
ds_read_b64_tr_b16 a[50:51], v14 offset:28672
v_mfma_f32_16x16x32_bf16 v[100:103], a[24:27], a[156:159], v[100:103]
v_mfma_f32_16x16x32_bf16 v[104:107], a[28:31], a[152:155], v[104:107]
ds_read_b64_tr_b16 a[52:53], v15 offset:24576
ds_read_b64_tr_b16 a[54:55], v15 offset:28672
v_mfma_f32_16x16x32_bf16 v[108:111], a[28:31], a[156:159], v[108:111]
s_waitcnt lgkmcnt(8)
v_mfma_f32_16x16x32_bf16 v[48:51], a[32:35], a[160:163], v[48:51]
ds_read_b64_tr_b16 a[56:57], v16 offset:24576
ds_read_b64_tr_b16 a[58:59], v16 offset:28672
v_mfma_f32_16x16x32_bf16 v[52:55], a[32:35], a[164:167], v[52:55]
buffer_load_dwordx4 a[112:115], v6, s[24:27], s29 offen offset:1024 sc1
v_mfma_f32_16x16x32_bf16 v[56:59], a[36:39], a[160:163], v[56:59]
ds_read_b64_tr_b16 a[60:61], v17 offset:24576
ds_read_b64_tr_b16 a[62:63], v17 offset:28672
v_mfma_f32_16x16x32_bf16 v[60:63], a[36:39], a[164:167], v[60:63]
s_waitcnt vmcnt(16)
s_barrier
s_waitcnt lgkmcnt(8)
v_mfma_f32_16x16x32_bf16 v[64:67], a[40:43], a[160:163], v[64:67]
ds_read_b64_tr_b16 a[0:1], v10 offset:32768
ds_read_b64_tr_b16 a[2:3], v10 offset:36864
v_mfma_f32_16x16x32_bf16 v[68:71], a[40:43], a[164:167], v[68:71]
buffer_load_dwordx4 v9, s[12:15], s16 offen offset:1024 lds
v_mfma_f32_16x16x32_bf16 v[72:75], a[44:47], a[160:163], v[72:75]
ds_read_b64_tr_b16 a[4:5], v11 offset:32768
ds_read_b64_tr_b16 a[6:7], v11 offset:36864
v_mfma_f32_16x16x32_bf16 v[76:79], a[44:47], a[164:167], v[76:79]
s_waitcnt lgkmcnt(8)
v_mfma_f32_16x16x32_bf16 v[80:83], a[48:51], a[160:163], v[80:83]
ds_read_b64_tr_b16 a[8:9], v12 offset:32768
ds_read_b64_tr_b16 a[10:11], v12 offset:36864
v_mfma_f32_16x16x32_bf16 v[84:87], a[48:51], a[164:167], v[84:87]
v_mfma_f32_16x16x32_bf16 v[88:91], a[52:55], a[160:163], v[88:91]
ds_read_b64_tr_b16 a[12:13], v13 offset:32768
ds_read_b64_tr_b16 a[14:15], v13 offset:36864
v_mfma_f32_16x16x32_bf16 v[92:95], a[52:55], a[164:167], v[92:95]
buffer_load_dwordx4 a[116:119], v7, s[24:27], s29 offen offset:1024 sc1
s_waitcnt lgkmcnt(8)
v_mfma_f32_16x16x32_bf16 v[96:99], a[56:59], a[160:163], v[96:99]
ds_read_b64_tr_b16 a[16:17], v14 offset:32768
ds_read_b64_tr_b16 a[18:19], v14 offset:36864
v_mfma_f32_16x16x32_bf16 v[100:103], a[56:59], a[164:167], v[100:103]
v_mfma_f32_16x16x32_bf16 v[104:107], a[60:63], a[160:163], v[104:107]
ds_read_b64_tr_b16 a[20:21], v15 offset:32768
ds_read_b64_tr_b16 a[22:23], v15 offset:36864
v_mfma_f32_16x16x32_bf16 v[108:111], a[60:63], a[164:167], v[108:111]
s_add_u32 s29, s29, 2048
s_add_u32 s16, s16, s18
s_waitcnt lgkmcnt(8)
v_mfma_f32_16x16x32_bf16 v[48:51], a[0:3], a[168:171], v[48:51]
ds_read_b64_tr_b16 a[24:25], v16 offset:32768
ds_read_b64_tr_b16 a[26:27], v16 offset:36864
v_mfma_f32_16x16x32_bf16 v[52:55], a[0:3], a[172:175], v[52:55]
buffer_load_dwordx4 a[120:123], v6, s[24:27], s29 offen sc1
v_mfma_f32_16x16x32_bf16 v[56:59], a[4:7], a[168:171], v[56:59]
ds_read_b64_tr_b16 a[28:29], v17 offset:32768
ds_read_b64_tr_b16 a[30:31], v17 offset:36864
v_mfma_f32_16x16x32_bf16 v[60:63], a[4:7], a[172:175], v[60:63]
s_waitcnt lgkmcnt(8)
v_mfma_f32_16x16x32_bf16 v[64:67], a[8:11], a[168:171], v[64:67]
ds_read_b64_tr_b16 a[32:33], v10 offset:40960
ds_read_b64_tr_b16 a[34:35], v10 offset:45056
v_mfma_f32_16x16x32_bf16 v[68:71], a[8:11], a[172:175], v[68:71]
buffer_load_dwordx4 a[124:127], v7, s[24:27], s29 offen sc1
v_mfma_f32_16x16x32_bf16 v[72:75], a[12:15], a[168:171], v[72:75]
ds_read_b64_tr_b16 a[36:37], v11 offset:40960
ds_read_b64_tr_b16 a[38:39], v11 offset:45056
v_mfma_f32_16x16x32_bf16 v[76:79], a[12:15], a[172:175], v[76:79]
s_waitcnt lgkmcnt(8)
v_mfma_f32_16x16x32_bf16 v[80:83], a[16:19], a[168:171], v[80:83]
ds_read_b64_tr_b16 a[40:41], v12 offset:40960
ds_read_b64_tr_b16 a[42:43], v12 offset:45056
s_add_u32 m0, s32, 0
v_mfma_f32_16x16x32_bf16 v[84:87], a[16:19], a[172:175], v[84:87]
v_mfma_f32_16x16x32_bf16 v[88:91], a[20:23], a[168:171], v[88:91]
ds_read_b64_tr_b16 a[44:45], v13 offset:40960
ds_read_b64_tr_b16 a[46:47], v13 offset:45056
v_mfma_f32_16x16x32_bf16 v[92:95], a[20:23], a[172:175], v[92:95]
buffer_load_dwordx4 v8, s[12:15], s16 offen offset:0 lds
s_waitcnt lgkmcnt(8)
v_mfma_f32_16x16x32_bf16 v[96:99], a[24:27], a[168:171], v[96:99]
ds_read_b64_tr_b16 a[48:49], v14 offset:40960
ds_read_b64_tr_b16 a[50:51], v14 offset:45056
v_mfma_f32_16x16x32_bf16 v[100:103], a[24:27], a[172:175], v[100:103]
v_mfma_f32_16x16x32_bf16 v[104:107], a[28:31], a[168:171], v[104:107]
ds_read_b64_tr_b16 a[52:53], v15 offset:40960
ds_read_b64_tr_b16 a[54:55], v15 offset:45056
v_mfma_f32_16x16x32_bf16 v[108:111], a[28:31], a[172:175], v[108:111]
s_waitcnt lgkmcnt(8)
v_mfma_f32_16x16x32_bf16 v[48:51], a[32:35], a[176:179], v[48:51]
ds_read_b64_tr_b16 a[56:57], v16 offset:40960
ds_read_b64_tr_b16 a[58:59], v16 offset:45056
v_mfma_f32_16x16x32_bf16 v[52:55], a[32:35], a[180:183], v[52:55]
buffer_load_dwordx4 a[128:131], v6, s[24:27], s29 offen offset:1024 sc1
v_mfma_f32_16x16x32_bf16 v[56:59], a[36:39], a[176:179], v[56:59]
ds_read_b64_tr_b16 a[60:61], v17 offset:40960
ds_read_b64_tr_b16 a[62:63], v17 offset:45056
v_mfma_f32_16x16x32_bf16 v[60:63], a[36:39], a[180:183], v[60:63]
s_waitcnt vmcnt(16)
s_barrier
s_waitcnt lgkmcnt(8)
v_mfma_f32_16x16x32_bf16 v[64:67], a[40:43], a[176:179], v[64:67]
ds_read_b64_tr_b16 a[0:1], v26 offset:49152
ds_read_b64_tr_b16 a[2:3], v26 offset:51200
v_mfma_f32_16x16x32_bf16 v[68:71], a[40:43], a[180:183], v[68:71]
buffer_load_dwordx4 v9, s[12:15], s16 offen offset:1024 lds
v_mfma_f32_16x16x32_bf16 v[72:75], a[44:47], a[176:179], v[72:75]
ds_read_b64_tr_b16 a[4:5], v27 offset:49152
ds_read_b64_tr_b16 a[6:7], v27 offset:51200
v_mfma_f32_16x16x32_bf16 v[76:79], a[44:47], a[180:183], v[76:79]
s_waitcnt lgkmcnt(8)
v_mfma_f32_16x16x32_bf16 v[80:83], a[48:51], a[176:179], v[80:83]
ds_read_b64_tr_b16 a[8:9], v28 offset:49152
ds_read_b64_tr_b16 a[10:11], v28 offset:51200
v_mfma_f32_16x16x32_bf16 v[84:87], a[48:51], a[180:183], v[84:87]
v_mfma_f32_16x16x32_bf16 v[88:91], a[52:55], a[176:179], v[88:91]
ds_read_b64_tr_b16 a[12:13], v29 offset:49152
ds_read_b64_tr_b16 a[14:15], v29 offset:51200
v_mfma_f32_16x16x32_bf16 v[92:95], a[52:55], a[180:183], v[92:95]
buffer_load_dwordx4 a[132:135], v7, s[24:27], s29 offen offset:1024 sc1
s_waitcnt lgkmcnt(8)
v_mfma_f32_16x16x32_bf16 v[96:99], a[56:59], a[176:179], v[96:99]
ds_read_b64_tr_b16 a[16:17], v26 offset:53248
ds_read_b64_tr_b16 a[18:19], v26 offset:55296
v_mfma_f32_16x16x32_bf16 v[100:103], a[56:59], a[180:183], v[100:103]
v_mfma_f32_16x16x32_bf16 v[104:107], a[60:63], a[176:179], v[104:107]
ds_read_b64_tr_b16 a[20:21], v27 offset:53248
ds_read_b64_tr_b16 a[22:23], v27 offset:55296
v_mfma_f32_16x16x32_bf16 v[108:111], a[60:63], a[180:183], v[108:111]
s_add_u32 s29, s29, 2048
s_add_u32 s16, s16, s18
s_waitcnt lgkmcnt(8)
v_mfma_f32_16x16x32_bf16 v[112:115], a[0:3], a[72:75], 0
ds_read_b64_tr_b16 a[24:25], v28 offset:53248
v_mfma_f32_16x16x32_bf16 v[116:119], a[0:3], a[76:79], 0
ds_read_b64_tr_b16 a[26:27], v28 offset:55296
buffer_load_dwordx4 a[136:139], v6, s[24:27], s29 offen sc1
v_mfma_f32_16x16x32_bf16 v[120:123], a[4:7], a[72:75], 0
ds_read_b64_tr_b16 a[28:29], v29 offset:53248
v_mfma_f32_16x16x32_bf16 v[124:127], a[4:7], a[76:79], 0
ds_read_b64_tr_b16 a[30:31], v29 offset:55296
buffer_load_dwordx4 a[140:143], v7, s[24:27], s29 offen sc1
s_waitcnt vmcnt(14)
s_barrier
s_waitcnt lgkmcnt(8)
v_mfma_f32_16x16x32_bf16 v[128:131], a[8:11], a[72:75], 0
ds_read_b64_tr_b16 a[32:33], v30 offset:0
s_add_u32 m0, s32, 16384
v_mfma_f32_16x16x32_bf16 v[132:135], a[8:11], a[76:79], 0
ds_read_b64_tr_b16 a[34:35], v30 offset:2048
buffer_load_dwordx4 v8, s[12:15], s16 offen offset:0 lds
v_mfma_f32_16x16x32_bf16 v[136:139], a[12:15], a[72:75], 0
ds_read_b64_tr_b16 a[36:37], v31 offset:0
v_mfma_f32_16x16x32_bf16 v[140:143], a[12:15], a[76:79], 0
ds_read_b64_tr_b16 a[38:39], v31 offset:2048
buffer_store_dwordx4 v[80:83], v44, s[24:27], s35 offen offset:0 sc1
s_waitcnt lgkmcnt(8)
v_mfma_f32_16x16x32_bf16 v[112:115], a[16:19], a[80:83], v[112:115]
ds_read_b64_tr_b16 a[40:41], v36 offset:0
v_mfma_f32_16x16x32_bf16 v[116:119], a[16:19], a[84:87], v[116:119]
ds_read_b64_tr_b16 a[42:43], v36 offset:2048
buffer_load_dwordx4 a[144:147], v6, s[24:27], s29 offen offset:1024 sc1
buffer_store_dwordx4 v[84:87], v44, s[24:27], s35 offen offset:1024 sc1
v_mfma_f32_16x16x32_bf16 v[120:123], a[20:23], a[80:83], v[120:123]
ds_read_b64_tr_b16 a[44:45], v37 offset:0
v_mfma_f32_16x16x32_bf16 v[124:127], a[20:23], a[84:87], v[124:127]
ds_read_b64_tr_b16 a[46:47], v37 offset:2048
buffer_load_dwordx4 v9, s[12:15], s16 offen offset:1024 lds
buffer_store_dwordx4 v[88:91], v44, s[24:27], s35 offen offset:2048 sc1
s_waitcnt lgkmcnt(8)
v_mfma_f32_16x16x32_bf16 v[128:131], a[24:27], a[80:83], v[128:131]
ds_read_b64_tr_b16 a[48:49], v30 offset:4096
v_mfma_f32_16x16x32_bf16 v[132:135], a[24:27], a[84:87], v[132:135]
ds_read_b64_tr_b16 a[50:51], v30 offset:6144
buffer_load_dwordx4 a[148:151], v7, s[24:27], s29 offen offset:1024 sc1
buffer_store_dwordx4 v[92:95], v44, s[24:27], s35 offen offset:3072 sc1
v_mfma_f32_16x16x32_bf16 v[136:139], a[28:31], a[80:83], v[136:139]
ds_read_b64_tr_b16 a[52:53], v31 offset:4096
v_mfma_f32_16x16x32_bf16 v[140:143], a[28:31], a[84:87], v[140:143]
ds_read_b64_tr_b16 a[54:55], v31 offset:6144
s_add_u32 s29, s29, 2048
s_add_u32 s16, s16, s18
s_add_u32 s60, s35, 4096
s_waitcnt lgkmcnt(8)
v_mfma_f32_16x16x32_bf16 v[112:115], a[32:35], a[88:91], v[112:115]
ds_read_b64_tr_b16 a[56:57], v36 offset:4096
v_mfma_f32_16x16x32_bf16 v[116:119], a[32:35], a[92:95], v[116:119]
ds_read_b64_tr_b16 a[58:59], v36 offset:6144
buffer_load_dwordx4 a[152:155], v6, s[24:27], s29 offen sc1
v_mfma_f32_16x16x32_bf16 v[120:123], a[36:39], a[88:91], v[120:123]
ds_read_b64_tr_b16 a[60:61], v37 offset:4096
v_mfma_f32_16x16x32_bf16 v[124:127], a[36:39], a[92:95], v[124:127]
ds_read_b64_tr_b16 a[62:63], v37 offset:6144
buffer_load_dwordx4 a[156:159], v7, s[24:27], s29 offen sc1
s_waitcnt vmcnt(18)
s_barrier
s_waitcnt lgkmcnt(8)
v_mfma_f32_16x16x32_bf16 v[128:131], a[40:43], a[88:91], v[128:131]
ds_read_b64_tr_b16 a[0:1], v30 offset:16384
s_add_u32 m0, s32, 32768
v_mfma_f32_16x16x32_bf16 v[132:135], a[40:43], a[92:95], v[132:135]
ds_read_b64_tr_b16 a[2:3], v30 offset:18432
buffer_load_dwordx4 v8, s[12:15], s16 offen offset:0 lds
v_mfma_f32_16x16x32_bf16 v[136:139], a[44:47], a[88:91], v[136:139]
ds_read_b64_tr_b16 a[4:5], v31 offset:16384
v_mfma_f32_16x16x32_bf16 v[140:143], a[44:47], a[92:95], v[140:143]
ds_read_b64_tr_b16 a[6:7], v31 offset:18432
buffer_store_dwordx4 v[96:99], v44, s[24:27], s60 offen offset:0 sc1
s_waitcnt lgkmcnt(8)
v_mfma_f32_16x16x32_bf16 v[112:115], a[48:51], a[96:99], v[112:115]
ds_read_b64_tr_b16 a[8:9], v36 offset:16384
v_mfma_f32_16x16x32_bf16 v[116:119], a[48:51], a[100:103], v[116:119]
ds_read_b64_tr_b16 a[10:11], v36 offset:18432
buffer_load_dwordx4 a[160:163], v6, s[24:27], s29 offen offset:1024 sc1
buffer_store_dwordx4 v[100:103], v44, s[24:27], s60 offen offset:1024 sc1
v_mfma_f32_16x16x32_bf16 v[120:123], a[52:55], a[96:99], v[120:123]
ds_read_b64_tr_b16 a[12:13], v37 offset:16384
v_mfma_f32_16x16x32_bf16 v[124:127], a[52:55], a[100:103], v[124:127]
ds_read_b64_tr_b16 a[14:15], v37 offset:18432
buffer_load_dwordx4 v9, s[12:15], s16 offen offset:1024 lds
buffer_store_dwordx4 v[104:107], v44, s[24:27], s60 offen offset:2048 sc1
s_waitcnt lgkmcnt(8)
v_mfma_f32_16x16x32_bf16 v[128:131], a[56:59], a[96:99], v[128:131]
ds_read_b64_tr_b16 a[16:17], v30 offset:20480
v_mfma_f32_16x16x32_bf16 v[132:135], a[56:59], a[100:103], v[132:135]
ds_read_b64_tr_b16 a[18:19], v30 offset:22528
buffer_load_dwordx4 a[164:167], v7, s[24:27], s29 offen offset:1024 sc1
buffer_store_dwordx4 v[108:111], v44, s[24:27], s60 offen offset:3072 sc1
v_mfma_f32_16x16x32_bf16 v[136:139], a[60:63], a[96:99], v[136:139]
ds_read_b64_tr_b16 a[20:21], v31 offset:20480
v_mfma_f32_16x16x32_bf16 v[140:143], a[60:63], a[100:103], v[140:143]
ds_read_b64_tr_b16 a[22:23], v31 offset:22528
s_add_u32 s29, s29, 2048
s_add_u32 s16, s16, s18
s_waitcnt lgkmcnt(8)
v_mfma_f32_16x16x32_bf16 v[112:115], a[0:3], a[104:107], v[112:115]
ds_read_b64_tr_b16 a[24:25], v36 offset:20480
v_mfma_f32_16x16x32_bf16 v[116:119], a[0:3], a[108:111], v[116:119]
ds_read_b64_tr_b16 a[26:27], v36 offset:22528
buffer_load_dwordx4 a[168:171], v6, s[24:27], s29 offen sc1
v_mfma_f32_16x16x32_bf16 v[120:123], a[4:7], a[104:107], v[120:123]
ds_read_b64_tr_b16 a[28:29], v37 offset:20480
v_mfma_f32_16x16x32_bf16 v[124:127], a[4:7], a[108:111], v[124:127]
ds_read_b64_tr_b16 a[30:31], v37 offset:22528
buffer_load_dwordx4 a[172:175], v7, s[24:27], s29 offen sc1
s_waitcnt vmcnt(22)
s_barrier
s_waitcnt lgkmcnt(8)
v_mfma_f32_16x16x32_bf16 v[128:131], a[8:11], a[104:107], v[128:131]
ds_read_b64_tr_b16 a[32:33], v30 offset:32768
s_add_u32 m0, s32, 49152
v_mfma_f32_16x16x32_bf16 v[132:135], a[8:11], a[108:111], v[132:135]
ds_read_b64_tr_b16 a[34:35], v30 offset:34816
buffer_load_dwordx4 v8, s[12:15], s16 offen offset:0 lds
v_mfma_f32_16x16x32_bf16 v[136:139], a[12:15], a[104:107], v[136:139]
ds_read_b64_tr_b16 a[36:37], v31 offset:32768
v_mfma_f32_16x16x32_bf16 v[140:143], a[12:15], a[108:111], v[140:143]
ds_read_b64_tr_b16 a[38:39], v31 offset:34816
s_waitcnt lgkmcnt(8)
v_mfma_f32_16x16x32_bf16 v[112:115], a[16:19], a[112:115], v[112:115]
ds_read_b64_tr_b16 a[40:41], v36 offset:32768
v_mfma_f32_16x16x32_bf16 v[116:119], a[16:19], a[116:119], v[116:119]
ds_read_b64_tr_b16 a[42:43], v36 offset:34816
buffer_load_dwordx4 a[176:179], v6, s[24:27], s29 offen offset:1024 sc1
v_mfma_f32_16x16x32_bf16 v[120:123], a[20:23], a[112:115], v[120:123]
ds_read_b64_tr_b16 a[44:45], v37 offset:32768
v_mfma_f32_16x16x32_bf16 v[124:127], a[20:23], a[116:119], v[124:127]
ds_read_b64_tr_b16 a[46:47], v37 offset:34816
buffer_load_dwordx4 v9, s[12:15], s16 offen offset:1024 lds
s_waitcnt lgkmcnt(8)
v_mfma_f32_16x16x32_bf16 v[128:131], a[24:27], a[112:115], v[128:131]
ds_read_b64_tr_b16 a[48:49], v30 offset:36864
v_mfma_f32_16x16x32_bf16 v[132:135], a[24:27], a[116:119], v[132:135]
ds_read_b64_tr_b16 a[50:51], v30 offset:38912
buffer_load_dwordx4 a[180:183], v7, s[24:27], s29 offen offset:1024 sc1
v_mfma_f32_16x16x32_bf16 v[136:139], a[28:31], a[112:115], v[136:139]
ds_read_b64_tr_b16 a[52:53], v31 offset:36864
v_mfma_f32_16x16x32_bf16 v[140:143], a[28:31], a[116:119], v[140:143]
ds_read_b64_tr_b16 a[54:55], v31 offset:38912
s_add_u32 s29, s29, 2048
s_add_u32 s16, s16, s18
s_waitcnt lgkmcnt(8)
v_mfma_f32_16x16x32_bf16 v[112:115], a[32:35], a[120:123], v[112:115]
ds_read_b64_tr_b16 a[56:57], v36 offset:36864
v_mfma_f32_16x16x32_bf16 v[116:119], a[32:35], a[124:127], v[116:119]
ds_read_b64_tr_b16 a[58:59], v36 offset:38912
buffer_load_dwordx4 a[72:75], v6, s[24:27], s29 offen sc1
v_mfma_f32_16x16x32_bf16 v[120:123], a[36:39], a[120:123], v[120:123]
ds_read_b64_tr_b16 a[60:61], v37 offset:36864
v_mfma_f32_16x16x32_bf16 v[124:127], a[36:39], a[124:127], v[124:127]
ds_read_b64_tr_b16 a[62:63], v37 offset:38912
buffer_load_dwordx4 a[76:79], v7, s[24:27], s29 offen sc1
s_waitcnt vmcnt(19)
s_barrier
s_waitcnt lgkmcnt(8)
v_mfma_f32_16x16x32_bf16 v[128:131], a[40:43], a[120:123], v[128:131]
ds_read_b64_tr_b16 a[0:1], v26 offset:0
s_add_u32 m0, s32, 65536
v_mfma_f32_16x16x32_bf16 v[132:135], a[40:43], a[124:127], v[132:135]
ds_read_b64_tr_b16 a[2:3], v26 offset:2048
buffer_load_dwordx4 v8, s[12:15], s16 offen offset:0 lds
v_mfma_f32_16x16x32_bf16 v[136:139], a[44:47], a[120:123], v[136:139]
ds_read_b64_tr_b16 a[4:5], v27 offset:0
v_mfma_f32_16x16x32_bf16 v[140:143], a[44:47], a[124:127], v[140:143]
ds_read_b64_tr_b16 a[6:7], v27 offset:2048
s_waitcnt lgkmcnt(8)
v_mfma_f32_16x16x32_bf16 v[112:115], a[48:51], a[128:131], v[112:115]
ds_read_b64_tr_b16 a[8:9], v28 offset:0
v_mfma_f32_16x16x32_bf16 v[116:119], a[48:51], a[132:135], v[116:119]
ds_read_b64_tr_b16 a[10:11], v28 offset:2048
buffer_load_dwordx4 a[80:83], v6, s[24:27], s29 offen offset:1024 sc1
v_mfma_f32_16x16x32_bf16 v[120:123], a[52:55], a[128:131], v[120:123]
ds_read_b64_tr_b16 a[12:13], v29 offset:0
v_mfma_f32_16x16x32_bf16 v[124:127], a[52:55], a[132:135], v[124:127]
ds_read_b64_tr_b16 a[14:15], v29 offset:2048
buffer_load_dwordx4 v9, s[12:15], s16 offen offset:1024 lds
s_waitcnt lgkmcnt(8)
v_mfma_f32_16x16x32_bf16 v[128:131], a[56:59], a[128:131], v[128:131]
ds_read_b64_tr_b16 a[16:17], v26 offset:4096
v_mfma_f32_16x16x32_bf16 v[132:135], a[56:59], a[132:135], v[132:135]
ds_read_b64_tr_b16 a[18:19], v26 offset:6144
buffer_load_dwordx4 a[84:87], v7, s[24:27], s29 offen offset:1024 sc1
v_mfma_f32_16x16x32_bf16 v[136:139], a[60:63], a[128:131], v[136:139]
ds_read_b64_tr_b16 a[20:21], v27 offset:4096
v_mfma_f32_16x16x32_bf16 v[140:143], a[60:63], a[132:135], v[140:143]
ds_read_b64_tr_b16 a[22:23], v27 offset:6144
s_add_u32 s29, s29, 2048
s_add_u32 s16, s16, s18
s_waitcnt lgkmcnt(8)
v_mfma_f32_16x16x32_bf16 v[112:115], a[0:3], a[136:139], v[112:115]
ds_read_b64_tr_b16 a[24:25], v28 offset:4096
v_mfma_f32_16x16x32_bf16 v[116:119], a[0:3], a[140:143], v[116:119]
ds_read_b64_tr_b16 a[26:27], v28 offset:6144
buffer_load_dwordx4 a[88:91], v6, s[24:27], s29 offen sc1
v_mfma_f32_16x16x32_bf16 v[120:123], a[4:7], a[136:139], v[120:123]
ds_read_b64_tr_b16 a[28:29], v29 offset:4096
v_mfma_f32_16x16x32_bf16 v[124:127], a[4:7], a[140:143], v[124:127]
ds_read_b64_tr_b16 a[30:31], v29 offset:6144
buffer_load_dwordx4 a[92:95], v7, s[24:27], s29 offen sc1
s_waitcnt vmcnt(14)
s_barrier
s_lshl_b32 s39, s6, 3
s_add_u32 s39, s39, s7
s_lshl_b32 s39, s39, 1
s_add_u32 s39, s39, s54
s_and_b32 s49, s39, 15
s_lshl_b32 s49, s49, 2
s_lshr_b32 s39, s39, 4
s_mul_i32 s39, s39, 128
s_add_u32 s39, s39, 39854080
s_add_u32 s39, s39, s49
s_cmp_lg_u32 s28, 0
s_cbranch_scc1 L_sig_23
v_mov_b32 v2, s39
v_mov_b32 v3, 1
s_mov_b64 exec, 1
buffer_store_dword v3, v2, s[24:27], 0 offen sc1
s_mov_b64 exec, -1
L_sig_23:
s_waitcnt lgkmcnt(8)
v_mfma_f32_16x16x32_bf16 v[128:131], a[8:11], a[136:139], v[128:131]
ds_read_b64_tr_b16 a[32:33], v26 offset:16384
s_add_u32 m0, s32, 81920
v_mfma_f32_16x16x32_bf16 v[132:135], a[8:11], a[140:143], v[132:135]
ds_read_b64_tr_b16 a[34:35], v26 offset:18432
buffer_load_dwordx4 v8, s[12:15], s16 offen offset:0 lds
v_mfma_f32_16x16x32_bf16 v[136:139], a[12:15], a[136:139], v[136:139]
ds_read_b64_tr_b16 a[36:37], v27 offset:16384
v_mfma_f32_16x16x32_bf16 v[140:143], a[12:15], a[140:143], v[140:143]
ds_read_b64_tr_b16 a[38:39], v27 offset:18432
s_waitcnt lgkmcnt(8)
v_mfma_f32_16x16x32_bf16 v[112:115], a[16:19], a[144:147], v[112:115]
ds_read_b64_tr_b16 a[40:41], v28 offset:16384
v_mfma_f32_16x16x32_bf16 v[116:119], a[16:19], a[148:151], v[116:119]
ds_read_b64_tr_b16 a[42:43], v28 offset:18432
buffer_load_dwordx4 a[96:99], v6, s[24:27], s29 offen offset:1024 sc1
v_mfma_f32_16x16x32_bf16 v[120:123], a[20:23], a[144:147], v[120:123]
ds_read_b64_tr_b16 a[44:45], v29 offset:16384
v_mfma_f32_16x16x32_bf16 v[124:127], a[20:23], a[148:151], v[124:127]
ds_read_b64_tr_b16 a[46:47], v29 offset:18432
buffer_load_dwordx4 v9, s[12:15], s16 offen offset:1024 lds
s_waitcnt lgkmcnt(8)
v_mfma_f32_16x16x32_bf16 v[128:131], a[24:27], a[144:147], v[128:131]
ds_read_b64_tr_b16 a[48:49], v26 offset:20480
v_mfma_f32_16x16x32_bf16 v[132:135], a[24:27], a[148:151], v[132:135]
ds_read_b64_tr_b16 a[50:51], v26 offset:22528
buffer_load_dwordx4 a[100:103], v7, s[24:27], s29 offen offset:1024 sc1
v_mfma_f32_16x16x32_bf16 v[136:139], a[28:31], a[144:147], v[136:139]
ds_read_b64_tr_b16 a[52:53], v27 offset:20480
v_mfma_f32_16x16x32_bf16 v[140:143], a[28:31], a[148:151], v[140:143]
ds_read_b64_tr_b16 a[54:55], v27 offset:22528
s_add_u32 s29, s29, 2048
s_add_u32 s16, s16, s18
s_waitcnt lgkmcnt(8)
v_mfma_f32_16x16x32_bf16 v[112:115], a[32:35], a[152:155], v[112:115]
ds_read_b64_tr_b16 a[56:57], v28 offset:20480
v_mfma_f32_16x16x32_bf16 v[116:119], a[32:35], a[156:159], v[116:119]
ds_read_b64_tr_b16 a[58:59], v28 offset:22528
buffer_load_dwordx4 a[104:107], v6, s[24:27], s29 offen sc1
v_mfma_f32_16x16x32_bf16 v[120:123], a[36:39], a[152:155], v[120:123]
ds_read_b64_tr_b16 a[60:61], v29 offset:20480
v_mfma_f32_16x16x32_bf16 v[124:127], a[36:39], a[156:159], v[124:127]
ds_read_b64_tr_b16 a[62:63], v29 offset:22528
buffer_load_dwordx4 a[108:111], v7, s[24:27], s29 offen sc1
s_waitcnt vmcnt(14)
s_barrier
s_waitcnt lgkmcnt(8)
v_mfma_f32_16x16x32_bf16 v[128:131], a[40:43], a[152:155], v[128:131]
ds_read_b64_tr_b16 a[0:1], v26 offset:32768
s_add_u32 m0, s32, 98304
v_mfma_f32_16x16x32_bf16 v[132:135], a[40:43], a[156:159], v[132:135]
ds_read_b64_tr_b16 a[2:3], v26 offset:34816
buffer_load_dwordx4 v8, s[12:15], s16 offen offset:0 lds
v_mfma_f32_16x16x32_bf16 v[136:139], a[44:47], a[152:155], v[136:139]
ds_read_b64_tr_b16 a[4:5], v27 offset:32768
v_mfma_f32_16x16x32_bf16 v[140:143], a[44:47], a[156:159], v[140:143]
ds_read_b64_tr_b16 a[6:7], v27 offset:34816
s_waitcnt lgkmcnt(8)
v_mfma_f32_16x16x32_bf16 v[112:115], a[48:51], a[160:163], v[112:115]
ds_read_b64_tr_b16 a[8:9], v28 offset:32768
v_mfma_f32_16x16x32_bf16 v[116:119], a[48:51], a[164:167], v[116:119]
ds_read_b64_tr_b16 a[10:11], v28 offset:34816
buffer_load_dwordx4 a[112:115], v6, s[24:27], s29 offen offset:1024 sc1
v_mfma_f32_16x16x32_bf16 v[120:123], a[52:55], a[160:163], v[120:123]
ds_read_b64_tr_b16 a[12:13], v29 offset:32768
v_mfma_f32_16x16x32_bf16 v[124:127], a[52:55], a[164:167], v[124:127]
ds_read_b64_tr_b16 a[14:15], v29 offset:34816
buffer_load_dwordx4 v9, s[12:15], s16 offen offset:1024 lds
s_waitcnt lgkmcnt(8)
v_mfma_f32_16x16x32_bf16 v[128:131], a[56:59], a[160:163], v[128:131]
ds_read_b64_tr_b16 a[16:17], v26 offset:36864
v_mfma_f32_16x16x32_bf16 v[132:135], a[56:59], a[164:167], v[132:135]
ds_read_b64_tr_b16 a[18:19], v26 offset:38912
buffer_load_dwordx4 a[116:119], v7, s[24:27], s29 offen offset:1024 sc1
v_mfma_f32_16x16x32_bf16 v[136:139], a[60:63], a[160:163], v[136:139]
ds_read_b64_tr_b16 a[20:21], v27 offset:36864
v_mfma_f32_16x16x32_bf16 v[140:143], a[60:63], a[164:167], v[140:143]
ds_read_b64_tr_b16 a[22:23], v27 offset:38912
s_add_u32 s29, s29, 2048
s_add_u32 s16, s16, s18
s_waitcnt lgkmcnt(8)
v_mfma_f32_16x16x32_bf16 v[112:115], a[0:3], a[168:171], v[112:115]
ds_read_b64_tr_b16 a[24:25], v28 offset:36864
v_mfma_f32_16x16x32_bf16 v[116:119], a[0:3], a[172:175], v[116:119]
ds_read_b64_tr_b16 a[26:27], v28 offset:38912
buffer_load_dwordx4 a[120:123], v6, s[24:27], s29 offen sc1
v_mfma_f32_16x16x32_bf16 v[120:123], a[4:7], a[168:171], v[120:123]
ds_read_b64_tr_b16 a[28:29], v29 offset:36864
v_mfma_f32_16x16x32_bf16 v[124:127], a[4:7], a[172:175], v[124:127]
ds_read_b64_tr_b16 a[30:31], v29 offset:38912
buffer_load_dwordx4 a[124:127], v7, s[24:27], s29 offen sc1
s_waitcnt vmcnt(14)
s_barrier
s_waitcnt lgkmcnt(8)
v_mfma_f32_16x16x32_bf16 v[128:131], a[8:11], a[168:171], v[128:131]
ds_read_b64_tr_b16 a[32:33], v26 offset:49152
s_add_u32 m0, s32, 0
v_mfma_f32_16x16x32_bf16 v[132:135], a[8:11], a[172:175], v[132:135]
ds_read_b64_tr_b16 a[34:35], v26 offset:51200
buffer_load_dwordx4 v8, s[12:15], s16 offen offset:0 lds
v_mfma_f32_16x16x32_bf16 v[136:139], a[12:15], a[168:171], v[136:139]
ds_read_b64_tr_b16 a[36:37], v27 offset:49152
v_mfma_f32_16x16x32_bf16 v[140:143], a[12:15], a[172:175], v[140:143]
ds_read_b64_tr_b16 a[38:39], v27 offset:51200
s_waitcnt lgkmcnt(8)
v_mfma_f32_16x16x32_bf16 v[112:115], a[16:19], a[176:179], v[112:115]
ds_read_b64_tr_b16 a[40:41], v28 offset:49152
v_mfma_f32_16x16x32_bf16 v[116:119], a[16:19], a[180:183], v[116:119]
ds_read_b64_tr_b16 a[42:43], v28 offset:51200
buffer_load_dwordx4 a[128:131], v6, s[24:27], s29 offen offset:1024 sc1
v_mfma_f32_16x16x32_bf16 v[120:123], a[20:23], a[176:179], v[120:123]
ds_read_b64_tr_b16 a[44:45], v29 offset:49152
v_mfma_f32_16x16x32_bf16 v[124:127], a[20:23], a[180:183], v[124:127]
ds_read_b64_tr_b16 a[46:47], v29 offset:51200
buffer_load_dwordx4 v9, s[12:15], s16 offen offset:1024 lds
s_waitcnt lgkmcnt(8)
v_mfma_f32_16x16x32_bf16 v[128:131], a[24:27], a[176:179], v[128:131]
ds_read_b64_tr_b16 a[48:49], v26 offset:53248
v_mfma_f32_16x16x32_bf16 v[132:135], a[24:27], a[180:183], v[132:135]
ds_read_b64_tr_b16 a[50:51], v26 offset:55296
buffer_load_dwordx4 a[132:135], v7, s[24:27], s29 offen offset:1024 sc1
v_mfma_f32_16x16x32_bf16 v[136:139], a[28:31], a[176:179], v[136:139]
ds_read_b64_tr_b16 a[52:53], v27 offset:53248
v_mfma_f32_16x16x32_bf16 v[140:143], a[28:31], a[180:183], v[140:143]
ds_read_b64_tr_b16 a[54:55], v27 offset:55296
s_add_u32 s29, s29, 2048
s_add_u32 s16, s16, s18
s_waitcnt lgkmcnt(8)
v_mfma_f32_16x16x32_bf16 v[112:115], a[32:35], a[72:75], v[112:115]
ds_read_b64_tr_b16 a[56:57], v28 offset:53248
v_mfma_f32_16x16x32_bf16 v[116:119], a[32:35], a[76:79], v[116:119]
ds_read_b64_tr_b16 a[58:59], v28 offset:55296
buffer_load_dwordx4 a[136:139], v6, s[24:27], s29 offen sc1
v_mfma_f32_16x16x32_bf16 v[120:123], a[36:39], a[72:75], v[120:123]
ds_read_b64_tr_b16 a[60:61], v29 offset:53248
v_mfma_f32_16x16x32_bf16 v[124:127], a[36:39], a[76:79], v[124:127]
ds_read_b64_tr_b16 a[62:63], v29 offset:55296
buffer_load_dwordx4 a[140:143], v7, s[24:27], s29 offen sc1
s_waitcnt vmcnt(14)
s_barrier
s_waitcnt lgkmcnt(8)
v_mfma_f32_16x16x32_bf16 v[128:131], a[40:43], a[72:75], v[128:131]
ds_read_b64_tr_b16 a[0:1], v30 offset:0
s_add_u32 m0, s32, 16384
v_mfma_f32_16x16x32_bf16 v[132:135], a[40:43], a[76:79], v[132:135]
ds_read_b64_tr_b16 a[2:3], v30 offset:2048
buffer_load_dwordx4 v8, s[12:15], s16 offen offset:0 lds
v_mfma_f32_16x16x32_bf16 v[136:139], a[44:47], a[72:75], v[136:139]
ds_read_b64_tr_b16 a[4:5], v31 offset:0
v_mfma_f32_16x16x32_bf16 v[140:143], a[44:47], a[76:79], v[140:143]
ds_read_b64_tr_b16 a[6:7], v31 offset:2048
s_waitcnt lgkmcnt(8)
v_mfma_f32_16x16x32_bf16 v[112:115], a[48:51], a[80:83], v[112:115]
ds_read_b64_tr_b16 a[8:9], v36 offset:0
v_mfma_f32_16x16x32_bf16 v[116:119], a[48:51], a[84:87], v[116:119]
ds_read_b64_tr_b16 a[10:11], v36 offset:2048
buffer_load_dwordx4 a[144:147], v6, s[24:27], s29 offen offset:1024 sc1
v_mfma_f32_16x16x32_bf16 v[120:123], a[52:55], a[80:83], v[120:123]
ds_read_b64_tr_b16 a[12:13], v37 offset:0
v_mfma_f32_16x16x32_bf16 v[124:127], a[52:55], a[84:87], v[124:127]
ds_read_b64_tr_b16 a[14:15], v37 offset:2048
buffer_load_dwordx4 v9, s[12:15], s16 offen offset:1024 lds
s_waitcnt lgkmcnt(8)
v_mfma_f32_16x16x32_bf16 v[128:131], a[56:59], a[80:83], v[128:131]
ds_read_b64_tr_b16 a[16:17], v30 offset:4096
v_mfma_f32_16x16x32_bf16 v[132:135], a[56:59], a[84:87], v[132:135]
ds_read_b64_tr_b16 a[18:19], v30 offset:6144
buffer_load_dwordx4 a[148:151], v7, s[24:27], s29 offen offset:1024 sc1
v_mfma_f32_16x16x32_bf16 v[136:139], a[60:63], a[80:83], v[136:139]
ds_read_b64_tr_b16 a[20:21], v31 offset:4096
v_mfma_f32_16x16x32_bf16 v[140:143], a[60:63], a[84:87], v[140:143]
ds_read_b64_tr_b16 a[22:23], v31 offset:6144
s_add_u32 s29, s29, 2048
s_add_u32 s16, s16, s18
s_waitcnt lgkmcnt(8)
v_mfma_f32_16x16x32_bf16 v[112:115], a[0:3], a[88:91], v[112:115]
ds_read_b64_tr_b16 a[24:25], v36 offset:4096
v_mfma_f32_16x16x32_bf16 v[116:119], a[0:3], a[92:95], v[116:119]
ds_read_b64_tr_b16 a[26:27], v36 offset:6144
buffer_load_dwordx4 a[152:155], v6, s[24:27], s29 offen sc1
v_mfma_f32_16x16x32_bf16 v[120:123], a[4:7], a[88:91], v[120:123]
ds_read_b64_tr_b16 a[28:29], v37 offset:4096
v_mfma_f32_16x16x32_bf16 v[124:127], a[4:7], a[92:95], v[124:127]
ds_read_b64_tr_b16 a[30:31], v37 offset:6144
buffer_load_dwordx4 a[156:159], v7, s[24:27], s29 offen sc1
s_waitcnt vmcnt(14)
s_barrier
s_waitcnt lgkmcnt(8)
v_mfma_f32_16x16x32_bf16 v[128:131], a[8:11], a[88:91], v[128:131]
ds_read_b64_tr_b16 a[32:33], v30 offset:16384
s_add_u32 m0, s32, 32768
v_mfma_f32_16x16x32_bf16 v[132:135], a[8:11], a[92:95], v[132:135]
ds_read_b64_tr_b16 a[34:35], v30 offset:18432
buffer_load_dwordx4 v8, s[12:15], s16 offen offset:0 lds
v_mfma_f32_16x16x32_bf16 v[136:139], a[12:15], a[88:91], v[136:139]
ds_read_b64_tr_b16 a[36:37], v31 offset:16384
v_mfma_f32_16x16x32_bf16 v[140:143], a[12:15], a[92:95], v[140:143]
ds_read_b64_tr_b16 a[38:39], v31 offset:18432
s_waitcnt lgkmcnt(8)
v_mfma_f32_16x16x32_bf16 v[112:115], a[16:19], a[96:99], v[112:115]
ds_read_b64_tr_b16 a[40:41], v36 offset:16384
v_mfma_f32_16x16x32_bf16 v[116:119], a[16:19], a[100:103], v[116:119]
ds_read_b64_tr_b16 a[42:43], v36 offset:18432
buffer_load_dwordx4 a[160:163], v6, s[24:27], s29 offen offset:1024 sc1
v_mfma_f32_16x16x32_bf16 v[120:123], a[20:23], a[96:99], v[120:123]
ds_read_b64_tr_b16 a[44:45], v37 offset:16384
v_mfma_f32_16x16x32_bf16 v[124:127], a[20:23], a[100:103], v[124:127]
ds_read_b64_tr_b16 a[46:47], v37 offset:18432
buffer_load_dwordx4 v9, s[12:15], s16 offen offset:1024 lds
s_waitcnt lgkmcnt(8)
v_mfma_f32_16x16x32_bf16 v[128:131], a[24:27], a[96:99], v[128:131]
ds_read_b64_tr_b16 a[48:49], v30 offset:20480
v_mfma_f32_16x16x32_bf16 v[132:135], a[24:27], a[100:103], v[132:135]
ds_read_b64_tr_b16 a[50:51], v30 offset:22528
buffer_load_dwordx4 a[164:167], v7, s[24:27], s29 offen offset:1024 sc1
v_mfma_f32_16x16x32_bf16 v[136:139], a[28:31], a[96:99], v[136:139]
ds_read_b64_tr_b16 a[52:53], v31 offset:20480
v_mfma_f32_16x16x32_bf16 v[140:143], a[28:31], a[100:103], v[140:143]
ds_read_b64_tr_b16 a[54:55], v31 offset:22528
s_add_u32 s29, s29, 2048
s_add_u32 s16, s16, s18
s_waitcnt lgkmcnt(8)
v_mfma_f32_16x16x32_bf16 v[112:115], a[32:35], a[104:107], v[112:115]
ds_read_b64_tr_b16 a[56:57], v36 offset:20480
v_mfma_f32_16x16x32_bf16 v[116:119], a[32:35], a[108:111], v[116:119]
ds_read_b64_tr_b16 a[58:59], v36 offset:22528
buffer_load_dwordx4 a[168:171], v6, s[24:27], s29 offen sc1
v_mfma_f32_16x16x32_bf16 v[120:123], a[36:39], a[104:107], v[120:123]
ds_read_b64_tr_b16 a[60:61], v37 offset:20480
v_mfma_f32_16x16x32_bf16 v[124:127], a[36:39], a[108:111], v[124:127]
ds_read_b64_tr_b16 a[62:63], v37 offset:22528
buffer_load_dwordx4 a[172:175], v7, s[24:27], s29 offen sc1
s_waitcnt vmcnt(14)
s_barrier
s_waitcnt lgkmcnt(8)
v_mfma_f32_16x16x32_bf16 v[128:131], a[40:43], a[104:107], v[128:131]
ds_read_b64_tr_b16 a[0:1], v30 offset:32768
s_add_u32 m0, s32, 49152
v_mfma_f32_16x16x32_bf16 v[132:135], a[40:43], a[108:111], v[132:135]
ds_read_b64_tr_b16 a[2:3], v30 offset:34816
buffer_load_dwordx4 v8, s[12:15], s16 offen offset:0 lds
v_mfma_f32_16x16x32_bf16 v[136:139], a[44:47], a[104:107], v[136:139]
ds_read_b64_tr_b16 a[4:5], v31 offset:32768
v_mfma_f32_16x16x32_bf16 v[140:143], a[44:47], a[108:111], v[140:143]
ds_read_b64_tr_b16 a[6:7], v31 offset:34816
s_lshl_b32 s39, s6, 3
s_add_u32 s39, s39, s7
s_lshl_b32 s39, s39, 1
s_add_u32 s39, s39, s54
s_xor_b32 s39, s39, 1
s_and_b32 s49, s39, 15
s_lshl_b32 s49, s49, 2
s_lshr_b32 s39, s39, 4
s_mul_i32 s39, s39, 128
s_add_u32 s39, s39, 39854080
s_add_u32 s39, s39, s49
v_mov_b32 v40, s39
buffer_load_dword v41, v40, s[24:27], 0 offen sc1
s_waitcnt lgkmcnt(8)
v_mfma_f32_16x16x32_bf16 v[112:115], a[48:51], a[112:115], v[112:115]
ds_read_b64_tr_b16 a[8:9], v36 offset:32768
v_mfma_f32_16x16x32_bf16 v[116:119], a[48:51], a[116:119], v[116:119]
ds_read_b64_tr_b16 a[10:11], v36 offset:34816
buffer_load_dwordx4 a[176:179], v6, s[24:27], s29 offen offset:1024 sc1
v_mfma_f32_16x16x32_bf16 v[120:123], a[52:55], a[112:115], v[120:123]
ds_read_b64_tr_b16 a[12:13], v37 offset:32768
v_mfma_f32_16x16x32_bf16 v[124:127], a[52:55], a[116:119], v[124:127]
ds_read_b64_tr_b16 a[14:15], v37 offset:34816
buffer_load_dwordx4 v9, s[12:15], s16 offen offset:1024 lds
s_waitcnt lgkmcnt(8)
v_mfma_f32_16x16x32_bf16 v[128:131], a[56:59], a[112:115], v[128:131]
ds_read_b64_tr_b16 a[16:17], v30 offset:36864
v_mfma_f32_16x16x32_bf16 v[132:135], a[56:59], a[116:119], v[132:135]
ds_read_b64_tr_b16 a[18:19], v30 offset:38912
buffer_load_dwordx4 a[180:183], v7, s[24:27], s29 offen offset:1024 sc1
v_mfma_f32_16x16x32_bf16 v[136:139], a[60:63], a[112:115], v[136:139]
ds_read_b64_tr_b16 a[20:21], v31 offset:36864
v_mfma_f32_16x16x32_bf16 v[140:143], a[60:63], a[116:119], v[140:143]
ds_read_b64_tr_b16 a[22:23], v31 offset:38912
s_add_u32 s29, s29, 2048
s_add_u32 s16, s16, s18
s_waitcnt lgkmcnt(8)
v_mfma_f32_16x16x32_bf16 v[112:115], a[0:3], a[120:123], v[112:115]
ds_read_b64_tr_b16 a[24:25], v36 offset:36864
v_mfma_f32_16x16x32_bf16 v[116:119], a[0:3], a[124:127], v[116:119]
ds_read_b64_tr_b16 a[26:27], v36 offset:38912
buffer_load_dwordx4 a[72:75], v6, s[24:27], s29 offen sc1
v_mfma_f32_16x16x32_bf16 v[120:123], a[4:7], a[120:123], v[120:123]
ds_read_b64_tr_b16 a[28:29], v37 offset:36864
v_mfma_f32_16x16x32_bf16 v[124:127], a[4:7], a[124:127], v[124:127]
ds_read_b64_tr_b16 a[30:31], v37 offset:38912
buffer_load_dwordx4 a[76:79], v7, s[24:27], s29 offen sc1
s_waitcnt vmcnt(15)
s_barrier
s_waitcnt lgkmcnt(8)
v_mfma_f32_16x16x32_bf16 v[128:131], a[8:11], a[120:123], v[128:131]
ds_read_b64_tr_b16 a[32:33], v26 offset:0
s_add_u32 m0, s32, 65536
v_mfma_f32_16x16x32_bf16 v[132:135], a[8:11], a[124:127], v[132:135]
ds_read_b64_tr_b16 a[34:35], v26 offset:2048
buffer_load_dwordx4 v8, s[12:15], s16 offen offset:0 lds
v_mfma_f32_16x16x32_bf16 v[136:139], a[12:15], a[120:123], v[136:139]
ds_read_b64_tr_b16 a[36:37], v27 offset:0
v_mfma_f32_16x16x32_bf16 v[140:143], a[12:15], a[124:127], v[140:143]
ds_read_b64_tr_b16 a[38:39], v27 offset:2048
s_waitcnt lgkmcnt(8)
v_mfma_f32_16x16x32_bf16 v[112:115], a[16:19], a[128:131], v[112:115]
ds_read_b64_tr_b16 a[40:41], v28 offset:0
v_mfma_f32_16x16x32_bf16 v[116:119], a[16:19], a[132:135], v[116:119]
ds_read_b64_tr_b16 a[42:43], v28 offset:2048
buffer_load_dwordx4 a[80:83], v6, s[24:27], s29 offen offset:1024 sc1
v_mfma_f32_16x16x32_bf16 v[120:123], a[20:23], a[128:131], v[120:123]
ds_read_b64_tr_b16 a[44:45], v29 offset:0
v_mfma_f32_16x16x32_bf16 v[124:127], a[20:23], a[132:135], v[124:127]
ds_read_b64_tr_b16 a[46:47], v29 offset:2048
buffer_load_dwordx4 v9, s[12:15], s16 offen offset:1024 lds
s_waitcnt lgkmcnt(8)
v_mfma_f32_16x16x32_bf16 v[128:131], a[24:27], a[128:131], v[128:131]
ds_read_b64_tr_b16 a[48:49], v26 offset:4096
v_mfma_f32_16x16x32_bf16 v[132:135], a[24:27], a[132:135], v[132:135]
ds_read_b64_tr_b16 a[50:51], v26 offset:6144
buffer_load_dwordx4 a[84:87], v7, s[24:27], s29 offen offset:1024 sc1
v_mfma_f32_16x16x32_bf16 v[136:139], a[28:31], a[128:131], v[136:139]
ds_read_b64_tr_b16 a[52:53], v27 offset:4096
v_mfma_f32_16x16x32_bf16 v[140:143], a[28:31], a[132:135], v[140:143]
ds_read_b64_tr_b16 a[54:55], v27 offset:6144
s_add_u32 s29, s29, 2048
s_add_u32 s16, s16, s18
s_waitcnt lgkmcnt(8)
v_mfma_f32_16x16x32_bf16 v[112:115], a[32:35], a[136:139], v[112:115]
ds_read_b64_tr_b16 a[56:57], v28 offset:4096
v_mfma_f32_16x16x32_bf16 v[116:119], a[32:35], a[140:143], v[116:119]
ds_read_b64_tr_b16 a[58:59], v28 offset:6144
buffer_load_dwordx4 a[88:91], v6, s[24:27], s29 offen sc1
v_mfma_f32_16x16x32_bf16 v[120:123], a[36:39], a[136:139], v[120:123]
ds_read_b64_tr_b16 a[60:61], v29 offset:4096
v_mfma_f32_16x16x32_bf16 v[124:127], a[36:39], a[140:143], v[124:127]
ds_read_b64_tr_b16 a[62:63], v29 offset:6144
s_waitcnt vmcnt(14)
s_barrier
s_waitcnt lgkmcnt(8)
v_mfma_f32_16x16x32_bf16 v[128:131], a[40:43], a[136:139], v[128:131]
ds_read_b64_tr_b16 a[0:1], v26 offset:16384
v_mfma_f32_16x16x32_bf16 v[132:135], a[40:43], a[140:143], v[132:135]
ds_read_b64_tr_b16 a[2:3], v26 offset:18432
buffer_load_dwordx4 a[92:95], v7, s[24:27], s29 offen sc1
v_mfma_f32_16x16x32_bf16 v[136:139], a[44:47], a[136:139], v[136:139]
ds_read_b64_tr_b16 a[4:5], v27 offset:16384
v_mfma_f32_16x16x32_bf16 v[140:143], a[44:47], a[140:143], v[140:143]
ds_read_b64_tr_b16 a[6:7], v27 offset:18432
s_waitcnt lgkmcnt(8)
v_mfma_f32_16x16x32_bf16 v[112:115], a[48:51], a[144:147], v[112:115]
ds_read_b64_tr_b16 a[8:9], v28 offset:16384
v_mfma_f32_16x16x32_bf16 v[116:119], a[48:51], a[148:151], v[116:119]
ds_read_b64_tr_b16 a[10:11], v28 offset:18432
buffer_load_dwordx4 a[96:99], v6, s[24:27], s29 offen offset:1024 sc1
v_mfma_f32_16x16x32_bf16 v[120:123], a[52:55], a[144:147], v[120:123]
ds_read_b64_tr_b16 a[12:13], v29 offset:16384
v_mfma_f32_16x16x32_bf16 v[124:127], a[52:55], a[148:151], v[124:127]
ds_read_b64_tr_b16 a[14:15], v29 offset:18432
s_waitcnt lgkmcnt(8)
v_mfma_f32_16x16x32_bf16 v[128:131], a[56:59], a[144:147], v[128:131]
ds_read_b64_tr_b16 a[16:17], v26 offset:20480
v_mfma_f32_16x16x32_bf16 v[132:135], a[56:59], a[148:151], v[132:135]
ds_read_b64_tr_b16 a[18:19], v26 offset:22528
buffer_load_dwordx4 a[100:103], v7, s[24:27], s29 offen offset:1024 sc1
v_mfma_f32_16x16x32_bf16 v[136:139], a[60:63], a[144:147], v[136:139]
ds_read_b64_tr_b16 a[20:21], v27 offset:20480
v_mfma_f32_16x16x32_bf16 v[140:143], a[60:63], a[148:151], v[140:143]
ds_read_b64_tr_b16 a[22:23], v27 offset:22528
s_add_u32 s29, s29, 2048
s_waitcnt lgkmcnt(8)
v_mfma_f32_16x16x32_bf16 v[112:115], a[0:3], a[152:155], v[112:115]
ds_read_b64_tr_b16 a[24:25], v28 offset:20480
v_mfma_f32_16x16x32_bf16 v[116:119], a[0:3], a[156:159], v[116:119]
ds_read_b64_tr_b16 a[26:27], v28 offset:22528
v_mfma_f32_16x16x32_bf16 v[120:123], a[4:7], a[152:155], v[120:123]
ds_read_b64_tr_b16 a[28:29], v29 offset:20480
v_mfma_f32_16x16x32_bf16 v[124:127], a[4:7], a[156:159], v[124:127]
ds_read_b64_tr_b16 a[30:31], v29 offset:22528
s_waitcnt vmcnt(10)
s_cmp_lg_u32 s28, 0
s_cbranch_scc1 L_adone_24
v_readfirstlane_b32 s53, v41
s_nop 3
s_cmp_ge_u32 s53, 1
s_cbranch_scc1 L_adone_24
s_mov_b32 s52, 0
L_poll_25:
buffer_load_dword v41, v40, s[24:27], 0 offen sc1
s_waitcnt vmcnt(0)
v_readfirstlane_b32 s53, v41
s_add_u32 s52, s52, 1
s_nop 2
s_cmp_ge_u32 s53, 1
s_cbranch_scc1 L_adone_24
s_cmp_lt_u32 s52, 20000
s_cbranch_scc1 L_poll_25
L_adone_24:
s_barrier
s_xor_b32 s35, s35, 32768
s_add_u32 s60, s35, 4096
s_waitcnt lgkmcnt(8)
v_mfma_f32_16x16x32_bf16 v[128:131], a[8:11], a[152:155], v[128:131]
ds_read_b64_tr_b16 a[32:33], v26 offset:32768
v_mfma_f32_16x16x32_bf16 v[132:135], a[8:11], a[156:159], v[132:135]
ds_read_b64_tr_b16 a[34:35], v26 offset:34816
v_mfma_f32_16x16x32_bf16 v[136:139], a[12:15], a[152:155], v[136:139]
ds_read_b64_tr_b16 a[36:37], v27 offset:32768
v_mfma_f32_16x16x32_bf16 v[140:143], a[12:15], a[156:159], v[140:143]
ds_read_b64_tr_b16 a[38:39], v27 offset:34816
buffer_load_dwordx4 v[144:147], v44, s[24:27], s35 offen offset:0 sc1
buffer_load_dwordx4 v[148:151], v44, s[24:27], s35 offen offset:1024 sc1
s_waitcnt lgkmcnt(8)
v_mfma_f32_16x16x32_bf16 v[112:115], a[16:19], a[160:163], v[112:115]
ds_read_b64_tr_b16 a[40:41], v28 offset:32768
v_mfma_f32_16x16x32_bf16 v[116:119], a[16:19], a[164:167], v[116:119]
ds_read_b64_tr_b16 a[42:43], v28 offset:34816
buffer_load_dwordx4 v[152:155], v44, s[24:27], s35 offen offset:2048 sc1
buffer_load_dwordx4 v[156:159], v44, s[24:27], s35 offen offset:3072 sc1
v_mfma_f32_16x16x32_bf16 v[120:123], a[20:23], a[160:163], v[120:123]
ds_read_b64_tr_b16 a[44:45], v29 offset:32768
v_mfma_f32_16x16x32_bf16 v[124:127], a[20:23], a[164:167], v[124:127]
ds_read_b64_tr_b16 a[46:47], v29 offset:34816
buffer_load_dwordx4 v[160:163], v44, s[24:27], s60 offen offset:0 sc1
buffer_load_dwordx4 v[164:167], v44, s[24:27], s60 offen offset:1024 sc1
s_waitcnt lgkmcnt(8)
v_mfma_f32_16x16x32_bf16 v[128:131], a[24:27], a[160:163], v[128:131]
ds_read_b64_tr_b16 a[48:49], v26 offset:36864
v_mfma_f32_16x16x32_bf16 v[132:135], a[24:27], a[164:167], v[132:135]
ds_read_b64_tr_b16 a[50:51], v26 offset:38912
buffer_load_dwordx4 v[168:171], v44, s[24:27], s60 offen offset:2048 sc1
buffer_load_dwordx4 v[172:175], v44, s[24:27], s60 offen offset:3072 sc1
v_mfma_f32_16x16x32_bf16 v[136:139], a[28:31], a[160:163], v[136:139]
ds_read_b64_tr_b16 a[52:53], v27 offset:36864
v_mfma_f32_16x16x32_bf16 v[140:143], a[28:31], a[164:167], v[140:143]
ds_read_b64_tr_b16 a[54:55], v27 offset:38912
s_waitcnt lgkmcnt(8)
v_mfma_f32_16x16x32_bf16 v[112:115], a[32:35], a[168:171], v[112:115]
ds_read_b64_tr_b16 a[56:57], v28 offset:36864
v_mfma_f32_16x16x32_bf16 v[116:119], a[32:35], a[172:175], v[116:119]
ds_read_b64_tr_b16 a[58:59], v28 offset:38912
v_mfma_f32_16x16x32_bf16 v[120:123], a[36:39], a[168:171], v[120:123]
ds_read_b64_tr_b16 a[60:61], v29 offset:36864
v_mfma_f32_16x16x32_bf16 v[124:127], a[36:39], a[172:175], v[124:127]
ds_read_b64_tr_b16 a[62:63], v29 offset:38912
s_waitcnt vmcnt(12)
s_barrier
s_waitcnt lgkmcnt(8)
v_mfma_f32_16x16x32_bf16 v[128:131], a[40:43], a[168:171], v[128:131]
ds_read_b64_tr_b16 a[0:1], v26 offset:49152
v_mfma_f32_16x16x32_bf16 v[132:135], a[40:43], a[172:175], v[132:135]
ds_read_b64_tr_b16 a[2:3], v26 offset:51200
v_mfma_f32_16x16x32_bf16 v[136:139], a[44:47], a[168:171], v[136:139]
ds_read_b64_tr_b16 a[4:5], v27 offset:49152
v_mfma_f32_16x16x32_bf16 v[140:143], a[44:47], a[172:175], v[140:143]
ds_read_b64_tr_b16 a[6:7], v27 offset:51200
s_waitcnt lgkmcnt(8)
v_mfma_f32_16x16x32_bf16 v[112:115], a[48:51], a[176:179], v[112:115]
ds_read_b64_tr_b16 a[8:9], v28 offset:49152
v_mfma_f32_16x16x32_bf16 v[116:119], a[48:51], a[180:183], v[116:119]
ds_read_b64_tr_b16 a[10:11], v28 offset:51200
v_mfma_f32_16x16x32_bf16 v[120:123], a[52:55], a[176:179], v[120:123]
ds_read_b64_tr_b16 a[12:13], v29 offset:49152
v_mfma_f32_16x16x32_bf16 v[124:127], a[52:55], a[180:183], v[124:127]
ds_read_b64_tr_b16 a[14:15], v29 offset:51200
v_lshrrev_b32 v45, 4, v1
v_and_b32 v46, 15, v1
v_lshrrev_b32 v47, 1, v46
v_and_b32 v47, 7, v47
v_lshrrev_b32 v2, 1, v45
v_xor_b32 v47, v47, v2
v_lshlrev_b32 v47, 4, v47
s_waitcnt lgkmcnt(8)
v_mfma_f32_16x16x32_bf16 v[128:131], a[56:59], a[176:179], v[128:131]
ds_read_b64_tr_b16 a[16:17], v26 offset:53248
v_mfma_f32_16x16x32_bf16 v[132:135], a[56:59], a[180:183], v[132:135]
ds_read_b64_tr_b16 a[18:19], v26 offset:55296
v_mfma_f32_16x16x32_bf16 v[136:139], a[60:63], a[176:179], v[136:139]
ds_read_b64_tr_b16 a[20:21], v27 offset:53248
v_mfma_f32_16x16x32_bf16 v[140:143], a[60:63], a[180:183], v[140:143]
ds_read_b64_tr_b16 a[22:23], v27 offset:55296
s_waitcnt lgkmcnt(8)
v_mfma_f32_16x16x32_bf16 v[112:115], a[0:3], a[72:75], v[112:115]
ds_read_b64_tr_b16 a[24:25], v28 offset:53248
v_mfma_f32_16x16x32_bf16 v[116:119], a[0:3], a[76:79], v[116:119]
ds_read_b64_tr_b16 a[26:27], v28 offset:55296
v_mfma_f32_16x16x32_bf16 v[120:123], a[4:7], a[72:75], v[120:123]
ds_read_b64_tr_b16 a[28:29], v29 offset:53248
v_mfma_f32_16x16x32_bf16 v[124:127], a[4:7], a[76:79], v[124:127]
ds_read_b64_tr_b16 a[30:31], v29 offset:55296
s_waitcnt vmcnt(8)
s_barrier
s_waitcnt lgkmcnt(8)
v_mfma_f32_16x16x32_bf16 v[128:131], a[8:11], a[72:75], v[128:131]
ds_read_b64_tr_b16 a[32:33], v30 offset:0
v_mfma_f32_16x16x32_bf16 v[132:135], a[8:11], a[76:79], v[132:135]
ds_read_b64_tr_b16 a[34:35], v30 offset:2048
v_mfma_f32_16x16x32_bf16 v[136:139], a[12:15], a[72:75], v[136:139]
ds_read_b64_tr_b16 a[36:37], v31 offset:0
v_mfma_f32_16x16x32_bf16 v[140:143], a[12:15], a[76:79], v[140:143]
ds_read_b64_tr_b16 a[38:39], v31 offset:2048
s_waitcnt lgkmcnt(8)
v_mfma_f32_16x16x32_bf16 v[112:115], a[16:19], a[80:83], v[112:115]
ds_read_b64_tr_b16 a[40:41], v36 offset:0
v_mfma_f32_16x16x32_bf16 v[116:119], a[16:19], a[84:87], v[116:119]
ds_read_b64_tr_b16 a[42:43], v36 offset:2048
v_mfma_f32_16x16x32_bf16 v[120:123], a[20:23], a[80:83], v[120:123]
ds_read_b64_tr_b16 a[44:45], v37 offset:0
v_mfma_f32_16x16x32_bf16 v[124:127], a[20:23], a[84:87], v[124:127]
ds_read_b64_tr_b16 a[46:47], v37 offset:2048
v_and_b32 v45, 1, v45
v_lshl_add_u32 v47, v45, 3, v47
v_lshl_add_u32 v47, v46, 7, v47
v_add_u32 v47, s55, v47
v_xor_b32 v45, 32, v47
v_xor_b32 v46, 64, v47
v_xor_b32 v5, 96, v47
s_waitcnt lgkmcnt(8)
v_mfma_f32_16x16x32_bf16 v[128:131], a[24:27], a[80:83], v[128:131]
ds_read_b64_tr_b16 a[48:49], v30 offset:4096
v_mfma_f32_16x16x32_bf16 v[132:135], a[24:27], a[84:87], v[132:135]
ds_read_b64_tr_b16 a[50:51], v30 offset:6144
v_mfma_f32_16x16x32_bf16 v[136:139], a[28:31], a[80:83], v[136:139]
ds_read_b64_tr_b16 a[52:53], v31 offset:4096
v_mfma_f32_16x16x32_bf16 v[140:143], a[28:31], a[84:87], v[140:143]
ds_read_b64_tr_b16 a[54:55], v31 offset:6144
s_waitcnt lgkmcnt(8)
v_mfma_f32_16x16x32_bf16 v[112:115], a[32:35], a[88:91], v[112:115]
ds_read_b64_tr_b16 a[56:57], v36 offset:4096
v_mfma_f32_16x16x32_bf16 v[116:119], a[32:35], a[92:95], v[116:119]
ds_read_b64_tr_b16 a[58:59], v36 offset:6144
v_mfma_f32_16x16x32_bf16 v[120:123], a[36:39], a[88:91], v[120:123]
ds_read_b64_tr_b16 a[60:61], v37 offset:4096
v_mfma_f32_16x16x32_bf16 v[124:127], a[36:39], a[92:95], v[124:127]
ds_read_b64_tr_b16 a[62:63], v37 offset:6144
s_waitcnt lgkmcnt(8)
v_mfma_f32_16x16x32_bf16 v[128:131], a[40:43], a[88:91], v[128:131]
v_mfma_f32_16x16x32_bf16 v[132:135], a[40:43], a[92:95], v[132:135]
ds_read_b64 v[224:225], v47 offset:0
ds_read_b64 v[228:229], v47 offset:2048
v_mfma_f32_16x16x32_bf16 v[136:139], a[44:47], a[88:91], v[136:139]
v_mfma_f32_16x16x32_bf16 v[140:143], a[44:47], a[92:95], v[140:143]
ds_read_b64 v[226:227], v45 offset:0
ds_read_b64 v[230:231], v45 offset:2048
s_waitcnt lgkmcnt(4)
v_mfma_f32_16x16x32_bf16 v[112:115], a[48:51], a[96:99], v[112:115]
v_mfma_f32_16x16x32_bf16 v[116:119], a[48:51], a[100:103], v[116:119]
ds_read_b64 v[232:233], v46 offset:0
ds_read_b64 v[236:237], v46 offset:2048
v_mfma_f32_16x16x32_bf16 v[120:123], a[52:55], a[96:99], v[120:123]
v_mfma_f32_16x16x32_bf16 v[124:127], a[52:55], a[100:103], v[124:127]
ds_read_b64 v[234:235], v5 offset:0
ds_read_b64 v[238:239], v5 offset:2048
s_waitcnt lgkmcnt(0)
v_mfma_f32_16x16x32_bf16 v[128:131], a[56:59], a[96:99], v[128:131]
v_mfma_f32_16x16x32_bf16 v[132:135], a[56:59], a[100:103], v[132:135]
v_mfma_f32_16x16x32_bf16 v[136:139], a[60:63], a[96:99], v[136:139]
v_mfma_f32_16x16x32_bf16 v[140:143], a[60:63], a[100:103], v[140:143]
s_waitcnt vmcnt(0)
s_waitcnt lgkmcnt(0)
s_mov_b32 s40, s82
s_mov_b32 s41, s83
s_mov_b32 s42, 4194304
s_mov_b32 s43, 0x20000
s_mov_b32 s58, 0xbfb8aa3b
s_mov_b32 s61, 0xffff0000
v_pk_add_f32 v[48:49], v[48:49], v[144:145]
v_pk_add_f32 v[50:51], v[50:51], v[146:147]
v_pk_mul_f32 v[176:177], v[48:49], s[58:59] op_sel:[0,0] op_sel_hi:[1,0]
v_pk_mul_f32 v[178:179], v[50:51], s[58:59] op_sel:[0,0] op_sel_hi:[1,0]
v_exp_f32 v176, v176
v_exp_f32 v177, v177
v_exp_f32 v178, v178
v_exp_f32 v179, v179
v_lshlrev_b32 v184, 16, v224
v_and_b32 v185, s61, v224
v_pk_add_f32 v[176:177], v[176:177], 1.0 op_sel_hi:[1,0]
v_pk_add_f32 v[178:179], v[178:179], 1.0 op_sel_hi:[1,0]
v_rcp_f32 v176, v176
v_rcp_f32 v177, v177
v_rcp_f32 v178, v178
v_rcp_f32 v179, v179
v_lshlrev_b32 v186, 16, v225
v_and_b32 v187, s61, v225
v_pk_mul_f32 v[48:49], v[48:49], v[176:177]
v_pk_mul_f32 v[50:51], v[50:51], v[178:179]
v_pk_fma_f32 v[176:177], v[48:49], v[112:113], v[184:185]
v_pk_fma_f32 v[178:179], v[50:51], v[114:115], v[186:187]
v_cvt_pk_bf16_f32 v224, v176, v177
v_cvt_pk_bf16_f32 v225, v178, v179
v_pk_add_f32 v[56:57], v[56:57], v[152:153]
v_pk_add_f32 v[58:59], v[58:59], v[154:155]
v_pk_mul_f32 v[180:181], v[56:57], s[58:59] op_sel:[0,0] op_sel_hi:[1,0]
v_pk_mul_f32 v[182:183], v[58:59], s[58:59] op_sel:[0,0] op_sel_hi:[1,0]
v_exp_f32 v180, v180
v_exp_f32 v181, v181
v_exp_f32 v182, v182
v_exp_f32 v183, v183
v_lshlrev_b32 v188, 16, v226
v_and_b32 v189, s61, v226
v_pk_add_f32 v[180:181], v[180:181], 1.0 op_sel_hi:[1,0]
v_pk_add_f32 v[182:183], v[182:183], 1.0 op_sel_hi:[1,0]
v_rcp_f32 v180, v180
v_rcp_f32 v181, v181
v_rcp_f32 v182, v182
v_rcp_f32 v183, v183
v_lshlrev_b32 v190, 16, v227
v_and_b32 v191, s61, v227
v_pk_mul_f32 v[56:57], v[56:57], v[180:181]
v_pk_mul_f32 v[58:59], v[58:59], v[182:183]
v_pk_fma_f32 v[180:181], v[56:57], v[120:121], v[188:189]
v_pk_fma_f32 v[182:183], v[58:59], v[122:123], v[190:191]
v_cvt_pk_bf16_f32 v226, v180, v181
v_cvt_pk_bf16_f32 v227, v182, v183
s_nop 0
v_permlane16_swap_b32 v224, v226
v_permlane16_swap_b32 v225, v227
buffer_store_dwordx4 v[224:227], v38, s[40:43], 0 offen offset:0
v_pk_add_f32 v[52:53], v[52:53], v[148:149]
v_pk_add_f32 v[54:55], v[54:55], v[150:151]
v_pk_mul_f32 v[176:177], v[52:53], s[58:59] op_sel:[0,0] op_sel_hi:[1,0]
v_pk_mul_f32 v[178:179], v[54:55], s[58:59] op_sel:[0,0] op_sel_hi:[1,0]
v_exp_f32 v176, v176
v_exp_f32 v177, v177
v_exp_f32 v178, v178
v_exp_f32 v179, v179
v_lshlrev_b32 v184, 16, v228
v_and_b32 v185, s61, v228
v_pk_add_f32 v[176:177], v[176:177], 1.0 op_sel_hi:[1,0]
v_pk_add_f32 v[178:179], v[178:179], 1.0 op_sel_hi:[1,0]
v_rcp_f32 v176, v176
v_rcp_f32 v177, v177
v_rcp_f32 v178, v178
v_rcp_f32 v179, v179
v_lshlrev_b32 v186, 16, v229
v_and_b32 v187, s61, v229
v_pk_mul_f32 v[52:53], v[52:53], v[176:177]
v_pk_mul_f32 v[54:55], v[54:55], v[178:179]
v_pk_fma_f32 v[176:177], v[52:53], v[116:117], v[184:185]
v_pk_fma_f32 v[178:179], v[54:55], v[118:119], v[186:187]
v_cvt_pk_bf16_f32 v228, v176, v177
v_cvt_pk_bf16_f32 v229, v178, v179
v_pk_add_f32 v[60:61], v[60:61], v[156:157]
v_pk_add_f32 v[62:63], v[62:63], v[158:159]
v_pk_mul_f32 v[180:181], v[60:61], s[58:59] op_sel:[0,0] op_sel_hi:[1,0]
v_pk_mul_f32 v[182:183], v[62:63], s[58:59] op_sel:[0,0] op_sel_hi:[1,0]
v_exp_f32 v180, v180
v_exp_f32 v181, v181
v_exp_f32 v182, v182
v_exp_f32 v183, v183
v_lshlrev_b32 v188, 16, v230
v_and_b32 v189, s61, v230
v_pk_add_f32 v[180:181], v[180:181], 1.0 op_sel_hi:[1,0]
v_pk_add_f32 v[182:183], v[182:183], 1.0 op_sel_hi:[1,0]
v_rcp_f32 v180, v180
v_rcp_f32 v181, v181
v_rcp_f32 v182, v182
v_rcp_f32 v183, v183
v_lshlrev_b32 v190, 16, v231
v_and_b32 v191, s61, v231
v_pk_mul_f32 v[60:61], v[60:61], v[180:181]
v_pk_mul_f32 v[62:63], v[62:63], v[182:183]
v_pk_fma_f32 v[180:181], v[60:61], v[124:125], v[188:189]
v_pk_fma_f32 v[182:183], v[62:63], v[126:127], v[190:191]
v_cvt_pk_bf16_f32 v230, v180, v181
v_cvt_pk_bf16_f32 v231, v182, v183
s_nop 0
v_permlane16_swap_b32 v228, v230
v_permlane16_swap_b32 v229, v231
buffer_store_dwordx4 v[228:231], v39, s[40:43], 0 offen offset:0
v_pk_add_f32 v[64:65], v[64:65], v[160:161]
v_pk_add_f32 v[66:67], v[66:67], v[162:163]
v_pk_mul_f32 v[176:177], v[64:65], s[58:59] op_sel:[0,0] op_sel_hi:[1,0]
v_pk_mul_f32 v[178:179], v[66:67], s[58:59] op_sel:[0,0] op_sel_hi:[1,0]
v_exp_f32 v176, v176
v_exp_f32 v177, v177
v_exp_f32 v178, v178
v_exp_f32 v179, v179
v_lshlrev_b32 v184, 16, v232
v_and_b32 v185, s61, v232
v_pk_add_f32 v[176:177], v[176:177], 1.0 op_sel_hi:[1,0]
v_pk_add_f32 v[178:179], v[178:179], 1.0 op_sel_hi:[1,0]
v_rcp_f32 v176, v176
v_rcp_f32 v177, v177
v_rcp_f32 v178, v178
v_rcp_f32 v179, v179
v_lshlrev_b32 v186, 16, v233
v_and_b32 v187, s61, v233
v_pk_mul_f32 v[64:65], v[64:65], v[176:177]
v_pk_mul_f32 v[66:67], v[66:67], v[178:179]
v_pk_fma_f32 v[176:177], v[64:65], v[128:129], v[184:185]
v_pk_fma_f32 v[178:179], v[66:67], v[130:131], v[186:187]
v_cvt_pk_bf16_f32 v232, v176, v177
v_cvt_pk_bf16_f32 v233, v178, v179
v_pk_add_f32 v[72:73], v[72:73], v[168:169]
v_pk_add_f32 v[74:75], v[74:75], v[170:171]
v_pk_mul_f32 v[180:181], v[72:73], s[58:59] op_sel:[0,0] op_sel_hi:[1,0]
v_pk_mul_f32 v[182:183], v[74:75], s[58:59] op_sel:[0,0] op_sel_hi:[1,0]
v_exp_f32 v180, v180
v_exp_f32 v181, v181
v_exp_f32 v182, v182
v_exp_f32 v183, v183
v_lshlrev_b32 v188, 16, v234
v_and_b32 v189, s61, v234
v_pk_add_f32 v[180:181], v[180:181], 1.0 op_sel_hi:[1,0]
v_pk_add_f32 v[182:183], v[182:183], 1.0 op_sel_hi:[1,0]
v_rcp_f32 v180, v180
v_rcp_f32 v181, v181
v_rcp_f32 v182, v182
v_rcp_f32 v183, v183
v_lshlrev_b32 v190, 16, v235
v_and_b32 v191, s61, v235
v_pk_mul_f32 v[72:73], v[72:73], v[180:181]
v_pk_mul_f32 v[74:75], v[74:75], v[182:183]
v_pk_fma_f32 v[180:181], v[72:73], v[136:137], v[188:189]
v_pk_fma_f32 v[182:183], v[74:75], v[138:139], v[190:191]
v_cvt_pk_bf16_f32 v234, v180, v181
v_cvt_pk_bf16_f32 v235, v182, v183
s_nop 0
v_permlane16_swap_b32 v232, v234
v_permlane16_swap_b32 v233, v235
buffer_store_dwordx4 v[232:235], v38, s[40:43], 0 offen offset:64
v_pk_add_f32 v[68:69], v[68:69], v[164:165]
v_pk_add_f32 v[70:71], v[70:71], v[166:167]
v_pk_mul_f32 v[176:177], v[68:69], s[58:59] op_sel:[0,0] op_sel_hi:[1,0]
v_pk_mul_f32 v[178:179], v[70:71], s[58:59] op_sel:[0,0] op_sel_hi:[1,0]
v_exp_f32 v176, v176
v_exp_f32 v177, v177
v_exp_f32 v178, v178
v_exp_f32 v179, v179
v_lshlrev_b32 v184, 16, v236
v_and_b32 v185, s61, v236
v_pk_add_f32 v[176:177], v[176:177], 1.0 op_sel_hi:[1,0]
v_pk_add_f32 v[178:179], v[178:179], 1.0 op_sel_hi:[1,0]
v_rcp_f32 v176, v176
v_rcp_f32 v177, v177
v_rcp_f32 v178, v178
v_rcp_f32 v179, v179
v_lshlrev_b32 v186, 16, v237
v_and_b32 v187, s61, v237
v_pk_mul_f32 v[68:69], v[68:69], v[176:177]
v_pk_mul_f32 v[70:71], v[70:71], v[178:179]
v_pk_fma_f32 v[176:177], v[68:69], v[132:133], v[184:185]
v_pk_fma_f32 v[178:179], v[70:71], v[134:135], v[186:187]
v_cvt_pk_bf16_f32 v236, v176, v177
v_cvt_pk_bf16_f32 v237, v178, v179
v_pk_add_f32 v[76:77], v[76:77], v[172:173]
v_pk_add_f32 v[78:79], v[78:79], v[174:175]
v_pk_mul_f32 v[180:181], v[76:77], s[58:59] op_sel:[0,0] op_sel_hi:[1,0]
v_pk_mul_f32 v[182:183], v[78:79], s[58:59] op_sel:[0,0] op_sel_hi:[1,0]
v_exp_f32 v180, v180
v_exp_f32 v181, v181
v_exp_f32 v182, v182
v_exp_f32 v183, v183
v_lshlrev_b32 v188, 16, v238
v_and_b32 v189, s61, v238
v_pk_add_f32 v[180:181], v[180:181], 1.0 op_sel_hi:[1,0]
v_pk_add_f32 v[182:183], v[182:183], 1.0 op_sel_hi:[1,0]
v_rcp_f32 v180, v180
v_rcp_f32 v181, v181
v_rcp_f32 v182, v182
v_rcp_f32 v183, v183
v_lshlrev_b32 v190, 16, v239
v_and_b32 v191, s61, v239
v_pk_mul_f32 v[76:77], v[76:77], v[180:181]
v_pk_mul_f32 v[78:79], v[78:79], v[182:183]
v_pk_fma_f32 v[180:181], v[76:77], v[140:141], v[188:189]
v_pk_fma_f32 v[182:183], v[78:79], v[142:143], v[190:191]
v_cvt_pk_bf16_f32 v238, v180, v181
v_cvt_pk_bf16_f32 v239, v182, v183
s_nop 0
v_permlane16_swap_b32 v236, v238
v_permlane16_swap_b32 v237, v239
buffer_store_dwordx4 v[236:239], v39, s[40:43], 0 offen offset:64
L_end:
s_endpgm
.section .rodata,"a"
.p2align 6
.amdhsa_kernel recurrent_scan__linear_kernel_hedgehog__dense_activation_squared_relu__prompt_kernel
  .amdhsa_next_free_vgpr 512
  .amdhsa_next_free_sgpr 102
  .amdhsa_accum_offset 256
  .amdhsa_group_segment_fixed_size 0
  .amdhsa_kernarg_size 96
  .amdhsa_user_sgpr_count 2
  .amdhsa_user_sgpr_kernarg_segment_ptr 1
  .amdhsa_system_sgpr_workgroup_id_x 1
.end_amdhsa_kernel
```
